```python
import torch

def _softmax(x, axis=-1):
    return torch.softmax(x, dim=axis)

def _gelu(x):
    return torch.nn.functional.gelu(x, approximate='tanh')

def _silu(x):
    return torch.nn.functional.silu(x)

def _sigmoid(x):
    return torch.sigmoid(x)

def _layernorm(x, axis=-1, eps=1e-05):
    m = x.mean(dim=axis, keepdim=True)
    v = x.var(dim=axis, keepdim=True, unbiased=False)
    return (x - m) / torch.sqrt(v + eps)

def _scatter_add(tgt, idx, src, axis=0):
    return tgt.clone().index_add_(axis, idx, src)

def _segment_sum(src, seg, n):
    out = torch.zeros((n,) + src.shape[1:], dtype=src.dtype)
    return out.index_add_(0, seg, src)

def _pad(x, pw):
    flat = tuple((v for pair in reversed(pw) for v in pair))
    return torch.nn.functional.pad(x, flat)
kernel_name = 'recurrent_scan__memory_aug_recurrent_mem_tr__swiglu_ffn__prompt'

def setup_inputs():

    _w = lambda a: (lambda t: t.to(torch.bfloat16) if t.is_floating_point() else t)(torch.as_tensor(a))

    def _A_setup():
        B, S, Dm = (1, 2048, 512)
        H, Dh = (32, 128)
        M, seg = (8, 32)
        seg = min(seg, S)
        S = S // seg * seg
        return {'x': _w((lambda *s: torch.randn(*s, dtype=torch.bfloat16) * 0.05)(B, S, Dm)), 'mem0': _w((lambda *s: torch.randn(*s, dtype=torch.bfloat16) * 0.2)(B, M, Dm)), 'Wq': _w((lambda *s: torch.randn(*s, dtype=torch.bfloat16) * 0.8)(Dm, H, Dh) * Dm ** (-0.5)), 'Wk': _w((lambda *s: torch.randn(*s, dtype=torch.bfloat16) * 0.8)(Dm, H, Dh) * Dm ** (-0.5)), 'Wv': _w((lambda *s: torch.randn(*s, dtype=torch.bfloat16) * 0.2)(Dm, H, Dh) * Dm ** (-0.5)), 'Wo': _w((lambda *s: torch.randn(*s, dtype=torch.bfloat16) * 0.2)(H, Dh, Dm) * (H * Dh) ** (-0.5)), 'seg_len': seg}
    _A_in = _A_setup()

    def _B_setup():
        B, S, D, F = (1, 2048, 512, 1792)
        return {'x': _w((lambda *s: torch.randn(*s, dtype=torch.bfloat16) * 0.05)(B, S, D)), 'w_gate': _w((lambda *s: torch.randn(*s, dtype=torch.bfloat16) * 0.1)(D, F)), 'w_up': _w((lambda *s: torch.randn(*s, dtype=torch.bfloat16) * 0.1)(D, F)), 'w_down': _w((lambda *s: torch.randn(*s, dtype=torch.bfloat16) * 0.1)(F, D))}
    _B_in = _B_setup()
    return {'A_x': _A_in['x'], 'A_mem0': _A_in['mem0'], 'A_Wq': _A_in['Wq'], 'A_Wk': _A_in['Wk'], 'A_Wv': _A_in['Wv'], 'A_Wo': _A_in['Wo'], 'A_seg_len': _A_in['seg_len'], 'B_x': _B_in['x'], 'B_w_gate': _B_in['w_gate'], 'B_w_up': _B_in['w_up'], 'B_w_down': _B_in['w_down']}

def reference(A_x, A_mem0, A_Wq, A_Wk, A_Wv, A_Wo, A_seg_len, B_x, B_w_gate, B_w_up, B_w_down):

    def _A_ref(x, mem0, Wq, Wk, Wv, Wo, seg_len):
        B, S, Dm = x.shape
        H, Dh = (Wq.shape[1], Wq.shape[2])
        M = mem0.shape[1]
        scale = Dh ** (-0.5)
        n_seg = S // seg_len
        L = M + seg_len
        idx = torch.arange(L)
        mask = (idx[:, None] < M) | (idx[:, None] >= idx[None, :])
        mem = mem0
        outs = []
        for s in range(n_seg):
            xs = x[:, s * seg_len:(s + 1) * seg_len, :].clone()
            h = torch.concatenate([mem, xs], axis=1)
            q = torch.einsum('btd,dhe->bhte', h, Wq)
            k = torch.einsum('btd,dhe->bhte', h, Wk)
            v = torch.einsum('btd,dhe->bhte', h, Wv)
            scores = torch.einsum('bhqe,bhke->bhqk', q, k) * scale
            scores = torch.where(mask[None, None], scores, -1000000000.0)
            p = _softmax(scores, axis=-1)
            o = torch.einsum('bhqk,bhke->bhqe', p, v)
            o = torch.einsum('bhte,hed->btd', o, Wo)
            mem = o[:, :M, :].clone()
            outs.append(o[:, M:, :])
        return torch.concatenate(outs, axis=1)

    def _B_ref(x, w_gate, w_up, w_down):
        g = _silu(x @ w_gate)
        u = x @ w_up
        return g * u @ w_down
    x = A_x
    xn = _layernorm(x, axis=-1)
    s = _A_ref(xn, A_mem0, A_Wq, A_Wk, A_Wv, A_Wo, A_seg_len)
    g = _silu(_B_ref(xn, B_w_gate, B_w_up, B_w_down))
    return x + s * g
```

```asm
; @launch kernel=recurrent_scan__memory_aug_recurrent_mem_tr__swiglu_ffn__prompt_kernel grid=(256,1,1) block=(256,1,1) lds=163840
.amdgcn_target "amdgcn-amd-amdhsa--gfx950"
.text
.globl recurrent_scan__memory_aug_recurrent_mem_tr__swiglu_ffn__prompt_kernel
.p2align 8
.type recurrent_scan__memory_aug_recurrent_mem_tr__swiglu_ffn__prompt_kernel,@function
recurrent_scan__memory_aug_recurrent_mem_tr__swiglu_ffn__prompt_kernel:
    s_cmp_ge_u32 s2, 256
    s_cbranch_scc1 mega_done
    s_and_b32 s7, s2, 7
    s_cmp_lg_u32 s7, 0
    s_cbranch_scc1 mega_worker
    s_lshr_b32 s3, s2, 3
    v_and_b32 v14, 63, v0
    v_lshrrev_b32 v15, 6, v0
    s_load_dwordx2 s[8:9], s[0:1], 16
    s_load_dwordx2 s[18:19], s[0:1], 104
    s_load_dwordx2 s[10:11], s[0:1], 24
    s_load_dwordx2 s[12:13], s[0:1], 32
    s_load_dwordx2 s[14:15], s[0:1], 40
    s_load_dwordx2 s[20:21], s[0:1], 96
    s_load_dwordx2 s[16:17], s[0:1], 8
    v_readfirstlane_b32 s4, v15
    v_lshlrev_b32 v4, 4, v14
    v_add_u32 v13, 131072, v4
    s_waitcnt lgkmcnt(0)
    s_lshl_b32 s54, s3, 2
    s_add_u32 s54, s54, s4
    s_lshl_b32 s55, s54, 11
    s_add_u32 s55, s55, 60817408
    s_add_u32 s26, s18, s55
    s_addc_u32 s27, s19, 0
    s_add_u32 s52, s18, 61603840
    s_addc_u32 s53, s19, 0
    v_lshrrev_b32 v44, 4, v14
    v_and_b32 v45, 15, v14
    v_and_b32 v46, 1, v44
    v_lshlrev_b32 v46, 1, v46
    v_or_b32 v46, 0, v46
    v_xor_b32 v46, v46, v45
    v_lshlrev_b32 v46, 4, v46
    s_lshl_b32 s54, s4, 4
    s_add_u32 s54, s54, 0
    v_add_u32 v24, s54, v44
    v_lshl_add_u32 v24, v24, 13, v46
    v_and_b32 v46, 1, v44
    v_lshlrev_b32 v46, 1, v46
    v_or_b32 v46, 4, v46
    v_xor_b32 v46, v46, v45
    v_lshlrev_b32 v46, 4, v46
    s_lshl_b32 s54, s4, 4
    s_add_u32 s54, s54, 4
    v_add_u32 v25, s54, v44
    v_lshl_add_u32 v25, v25, 13, v46
    v_and_b32 v46, 1, v44
    v_lshlrev_b32 v46, 1, v46
    v_or_b32 v46, 8, v46
    v_xor_b32 v46, v46, v45
    v_lshlrev_b32 v46, 4, v46
    s_lshl_b32 s54, s4, 4
    s_add_u32 s54, s54, 8
    v_add_u32 v26, s54, v44
    v_lshl_add_u32 v26, v26, 13, v46
    v_and_b32 v46, 1, v44
    v_lshlrev_b32 v46, 1, v46
    v_or_b32 v46, 12, v46
    v_xor_b32 v46, v46, v45
    v_lshlrev_b32 v46, 4, v46
    s_lshl_b32 s54, s4, 4
    s_add_u32 s54, s54, 12
    v_add_u32 v27, s54, v44
    v_lshl_add_u32 v27, v27, 13, v46
    s_and_b32 s54, s4, 1
    s_lshl_b32 s54, s54, 2
    s_lshr_b32 s55, s4, 1
    s_lshl_b32 s55, s55, 3
    s_or_b32 s54, s54, s55
    v_and_b32 v46, 1, v44
    v_lshlrev_b32 v46, 1, v46
    v_or_b32 v46, s54, v46
    v_xor_b32 v46, v46, v45
    v_lshlrev_b32 v46, 4, v46
    s_lshl_b32 s54, s4, 4
    s_add_u32 s54, s54, 0
    v_add_u32 v28, s54, v44
    v_lshl_add_u32 v28, v28, 10, v46
    s_lshl_b32 s54, s4, 4
    s_add_u32 s54, s54, 4
    v_add_u32 v29, s54, v44
    v_lshl_add_u32 v29, v29, 10, v46
    s_lshl_b32 s54, s4, 4
    s_add_u32 s54, s54, 8
    v_add_u32 v30, s54, v44
    v_lshl_add_u32 v30, v30, 10, v46
    s_lshl_b32 s54, s4, 4
    s_add_u32 s54, s54, 12
    v_add_u32 v31, s54, v44
    v_lshl_add_u32 v31, v31, 10, v46
    s_lshl_b32 s54, s3, 8
    s_add_u32 s8, s8, s54
    s_addc_u32 s9, s9, 0
    s_add_u32 s10, s10, s54
    s_addc_u32 s11, s11, 0
    s_add_u32 s12, s12, s54
    s_addc_u32 s13, s13, 0
    s_lshl_b32 s54, s3, 17
    s_add_u32 s14, s14, s54
    s_addc_u32 s15, s15, 0
    s_add_u32 s58, s8, 0
    s_addc_u32 s59, s9, 0
    s_lshl_b32 s54, s4, 12
    s_add_u32 m0, s54, 0
    s_nop 0
    global_load_lds_dwordx4 v24, s[58:59] nt
    s_add_u32 m0, s54, 1024
    s_nop 0
    global_load_lds_dwordx4 v25, s[58:59] nt
    s_add_u32 m0, s54, 2048
    s_nop 0
    global_load_lds_dwordx4 v26, s[58:59] nt
    s_add_u32 m0, s54, 3072
    s_nop 0
    global_load_lds_dwordx4 v27, s[58:59] nt
    s_add_u32 s58, s8, 524288
    s_addc_u32 s59, s9, 0
    s_lshl_b32 s54, s4, 12
    s_add_u32 m0, s54, 16384
    s_nop 0
    global_load_lds_dwordx4 v24, s[58:59] nt
    s_add_u32 m0, s54, 17408
    s_nop 0
    global_load_lds_dwordx4 v25, s[58:59] nt
    s_add_u32 m0, s54, 18432
    s_nop 0
    global_load_lds_dwordx4 v26, s[58:59] nt
    s_add_u32 m0, s54, 19456
    s_nop 0
    global_load_lds_dwordx4 v27, s[58:59] nt
    s_add_u32 s58, s8, 1048576
    s_addc_u32 s59, s9, 0
    s_lshl_b32 s54, s4, 12
    s_add_u32 m0, s54, 32768
    s_nop 0
    global_load_lds_dwordx4 v24, s[58:59] nt
    s_add_u32 m0, s54, 33792
    s_nop 0
    global_load_lds_dwordx4 v25, s[58:59] nt
    s_add_u32 m0, s54, 34816
    s_nop 0
    global_load_lds_dwordx4 v26, s[58:59] nt
    s_add_u32 m0, s54, 35840
    s_nop 0
    global_load_lds_dwordx4 v27, s[58:59] nt
    s_add_u32 s58, s8, 1572864
    s_addc_u32 s59, s9, 0
    s_lshl_b32 s54, s4, 12
    s_add_u32 m0, s54, 49152
    s_nop 0
    global_load_lds_dwordx4 v24, s[58:59] nt
    s_add_u32 m0, s54, 50176
    s_nop 0
    global_load_lds_dwordx4 v25, s[58:59] nt
    s_add_u32 m0, s54, 51200
    s_nop 0
    global_load_lds_dwordx4 v26, s[58:59] nt
    s_add_u32 m0, s54, 52224
    s_nop 0
    global_load_lds_dwordx4 v27, s[58:59] nt
    s_add_u32 s58, s8, 2097152
    s_addc_u32 s59, s9, 0
    s_lshl_b32 s54, s4, 12
    s_add_u32 m0, s54, 65536
    s_nop 0
    global_load_lds_dwordx4 v24, s[58:59] nt
    s_add_u32 m0, s54, 66560
    s_nop 0
    global_load_lds_dwordx4 v25, s[58:59] nt
    s_add_u32 m0, s54, 67584
    s_nop 0
    global_load_lds_dwordx4 v26, s[58:59] nt
    s_add_u32 m0, s54, 68608
    s_nop 0
    global_load_lds_dwordx4 v27, s[58:59] nt
    s_add_u32 s58, s8, 2621440
    s_addc_u32 s59, s9, 0
    s_lshl_b32 s54, s4, 12
    s_add_u32 m0, s54, 81920
    s_nop 0
    global_load_lds_dwordx4 v24, s[58:59] nt
    s_add_u32 m0, s54, 82944
    s_nop 0
    global_load_lds_dwordx4 v25, s[58:59] nt
    s_add_u32 m0, s54, 83968
    s_nop 0
    global_load_lds_dwordx4 v26, s[58:59] nt
    s_add_u32 m0, s54, 84992
    s_nop 0
    global_load_lds_dwordx4 v27, s[58:59] nt
    s_add_u32 s58, s8, 3145728
    s_addc_u32 s59, s9, 0
    s_lshl_b32 s54, s4, 12
    s_add_u32 m0, s54, 98304
    s_nop 0
    global_load_lds_dwordx4 v24, s[58:59] nt
    s_add_u32 m0, s54, 99328
    s_nop 0
    global_load_lds_dwordx4 v25, s[58:59] nt
    s_add_u32 m0, s54, 100352
    s_nop 0
    global_load_lds_dwordx4 v26, s[58:59] nt
    s_add_u32 m0, s54, 101376
    s_nop 0
    global_load_lds_dwordx4 v27, s[58:59] nt
    v_mov_b32 v56, -1
    v_mov_b32 v57, -1
    v_mov_b32 v58, -1
    v_mov_b32 v59, -1
    global_store_dwordx4 v4, v[56:59], s[26:27] offset:0 sc1
    global_store_dwordx4 v4, v[56:59], s[26:27] offset:1024 sc1
    s_lshl_b32 s54, s3, 2
    s_add_u32 s54, s54, s4
    s_mul_i32 s54, s54, 192
    s_add_u32 s54, s54, 61341696
    s_add_u32 s58, s18, s54
    s_addc_u32 s59, s19, 0
    s_mov_b64 exec, 0xfff
    global_store_dwordx4 v4, v[56:59], s[58:59] sc1
    s_mov_b64 exec, -1
    v_lshrrev_b32 v47, 4, v14
    v_bfe_u32 v48, v14, 2, 2
    v_and_b32 v49, 3, v14
    v_lshrrev_b32 v50, 1, v47
    v_lshlrev_b32 v50, 4, v50
    v_and_b32 v46, 1, v47
    v_lshl_add_u32 v50, v46, 2, v50
    v_lshlrev_b32 v51, 2, v46
    v_and_b32 v46, 1, v48
    v_add_u32 v50, v50, v46
    v_lshl_or_b32 v51, v46, 1, v51
    v_lshrrev_b32 v46, 1, v48
    v_lshl_add_u32 v50, v46, 3, v50
    v_lshl_or_b32 v51, v46, 3, v51
    s_lshl_b32 s54, s4, 2
    s_add_u32 s54, s54, 0
    v_lshrrev_b32 v46, 1, v49
    v_add_u32 v46, s54, v46
    v_xor_b32 v46, v46, v51
    v_lshlrev_b32 v46, 4, v46
    v_lshl_add_u32 v46, v50, 8, v46
    v_and_b32 v32, 1, v49
    v_lshl_add_u32 v32, v32, 3, v46
    s_lshl_b32 s54, s4, 2
    s_add_u32 s54, s54, 2
    v_lshrrev_b32 v46, 1, v49
    v_add_u32 v46, s54, v46
    v_xor_b32 v46, v46, v51
    v_lshlrev_b32 v46, 4, v46
    v_lshl_add_u32 v46, v50, 8, v46
    v_and_b32 v33, 1, v49
    v_lshl_add_u32 v33, v33, 3, v46
    v_lshrrev_b32 v46, 1, v48
    v_lshlrev_b32 v52, 5, v46
    v_and_b32 v46, 1, v47
    v_lshl_add_u32 v52, v46, 4, v52
    v_lshrrev_b32 v46, 1, v47
    v_lshl_add_u32 v52, v46, 2, v52
    v_and_b32 v46, 1, v48
    v_add_u32 v52, v52, v46
    v_lshrrev_b32 v46, 1, v49
    v_or_b32 v46, 0, v46
    v_xor_b32 v46, v46, v51
    v_lshlrev_b32 v46, 4, v46
    v_lshl_add_u32 v46, v52, 8, v46
    v_and_b32 v34, 1, v49
    v_lshl_add_u32 v34, v34, 3, v46
    v_lshrrev_b32 v46, 1, v49
    v_or_b32 v46, 2, v46
    v_xor_b32 v46, v46, v51
    v_lshlrev_b32 v46, 4, v46
    v_lshl_add_u32 v46, v52, 8, v46
    v_and_b32 v35, 1, v49
    v_lshl_add_u32 v35, v35, 3, v46
    v_lshrrev_b32 v46, 1, v49
    v_or_b32 v46, 4, v46
    v_xor_b32 v46, v46, v51
    v_lshlrev_b32 v46, 4, v46
    v_lshl_add_u32 v46, v52, 8, v46
    v_and_b32 v36, 1, v49
    v_lshl_add_u32 v36, v36, 3, v46
    v_lshrrev_b32 v46, 1, v49
    v_or_b32 v46, 6, v46
    v_xor_b32 v46, v46, v51
    v_lshlrev_b32 v46, 4, v46
    v_lshl_add_u32 v46, v52, 8, v46
    v_and_b32 v37, 1, v49
    v_lshl_add_u32 v37, v37, 3, v46
    v_lshrrev_b32 v46, 1, v49
    v_or_b32 v46, 8, v46
    v_xor_b32 v46, v46, v51
    v_lshlrev_b32 v46, 4, v46
    v_lshl_add_u32 v46, v52, 8, v46
    v_and_b32 v38, 1, v49
    v_lshl_add_u32 v38, v38, 3, v46
    v_lshrrev_b32 v46, 1, v49
    v_or_b32 v46, 10, v46
    v_xor_b32 v46, v46, v51
    v_lshlrev_b32 v46, 4, v46
    v_lshl_add_u32 v46, v52, 8, v46
    v_and_b32 v39, 1, v49
    v_lshl_add_u32 v39, v39, 3, v46
    v_lshrrev_b32 v46, 1, v49
    v_or_b32 v46, 12, v46
    v_xor_b32 v46, v46, v51
    v_lshlrev_b32 v46, 4, v46
    v_lshl_add_u32 v46, v52, 8, v46
    v_and_b32 v40, 1, v49
    v_lshl_add_u32 v40, v40, 3, v46
    v_lshrrev_b32 v46, 1, v49
    v_or_b32 v46, 14, v46
    v_xor_b32 v46, v46, v51
    v_lshlrev_b32 v46, 4, v46
    v_lshl_add_u32 v46, v52, 8, v46
    v_and_b32 v41, 1, v49
    v_lshl_add_u32 v41, v41, 3, v46
    s_waitcnt vmcnt(27)
    s_barrier
    s_add_u32 s58, s8, 3670016
    s_addc_u32 s59, s9, 0
    s_lshl_b32 s54, s4, 12
    s_add_u32 m0, s54, 114688
    s_nop 0
    global_load_lds_dwordx4 v24, s[58:59] nt
    s_add_u32 m0, s54, 115712
    s_nop 0
    global_load_lds_dwordx4 v25, s[58:59] nt
    s_add_u32 m0, s54, 116736
    s_nop 0
    global_load_lds_dwordx4 v26, s[58:59] nt
    s_add_u32 m0, s54, 117760
    s_nop 0
    global_load_lds_dwordx4 v27, s[58:59] nt
    s_cmp_eq_u32 s4, 1
    s_cbranch_scc1 rot_2
    s_cmp_eq_u32 s4, 2
    s_cbranch_scc1 rot_3
    s_cmp_eq_u32 s4, 3
    s_cbranch_scc1 rot_4
    ds_read_b64_tr_b16 v[128:129], v32 offset:0
    ds_read_b64_tr_b16 v[130:131], v32 offset:512
    ds_read_b64_tr_b16 v[132:133], v32 offset:8192
    ds_read_b64_tr_b16 v[134:135], v32 offset:8704
    ds_read_b64_tr_b16 v[192:193], v33 offset:0
    ds_read_b64_tr_b16 v[194:195], v33 offset:512
    ds_read_b64_tr_b16 v[196:197], v33 offset:8192
    ds_read_b64_tr_b16 v[198:199], v33 offset:8704
    s_branch rote_5
rot_2:
    ds_read_b64_tr_b16 v[176:177], v32 offset:0
    ds_read_b64_tr_b16 v[178:179], v32 offset:512
    ds_read_b64_tr_b16 v[180:181], v32 offset:8192
    ds_read_b64_tr_b16 v[182:183], v32 offset:8704
    ds_read_b64_tr_b16 v[240:241], v33 offset:0
    ds_read_b64_tr_b16 v[242:243], v33 offset:512
    ds_read_b64_tr_b16 v[244:245], v33 offset:8192
    ds_read_b64_tr_b16 v[246:247], v33 offset:8704
    s_branch rote_5
rot_3:
    ds_read_b64_tr_b16 v[160:161], v32 offset:0
    ds_read_b64_tr_b16 v[162:163], v32 offset:512
    ds_read_b64_tr_b16 v[164:165], v32 offset:8192
    ds_read_b64_tr_b16 v[166:167], v32 offset:8704
    ds_read_b64_tr_b16 v[224:225], v33 offset:0
    ds_read_b64_tr_b16 v[226:227], v33 offset:512
    ds_read_b64_tr_b16 v[228:229], v33 offset:8192
    ds_read_b64_tr_b16 v[230:231], v33 offset:8704
    s_branch rote_5
rot_4:
    ds_read_b64_tr_b16 v[144:145], v32 offset:0
    ds_read_b64_tr_b16 v[146:147], v32 offset:512
    ds_read_b64_tr_b16 v[148:149], v32 offset:8192
    ds_read_b64_tr_b16 v[150:151], v32 offset:8704
    ds_read_b64_tr_b16 v[208:209], v33 offset:0
    ds_read_b64_tr_b16 v[210:211], v33 offset:512
    ds_read_b64_tr_b16 v[212:213], v33 offset:8192
    ds_read_b64_tr_b16 v[214:215], v33 offset:8704
rote_5:
    s_waitcnt lgkmcnt(0)
    s_waitcnt vmcnt(27)
    s_barrier
    s_add_u32 s58, s12, 0
    s_addc_u32 s59, s13, 0
    s_lshl_b32 s54, s4, 12
    s_add_u32 m0, s54, 0
    s_nop 0
    global_load_lds_dwordx4 v24, s[58:59] nt
    s_add_u32 m0, s54, 1024
    s_nop 0
    global_load_lds_dwordx4 v25, s[58:59] nt
    s_add_u32 m0, s54, 2048
    s_nop 0
    global_load_lds_dwordx4 v26, s[58:59] nt
    s_add_u32 m0, s54, 3072
    s_nop 0
    global_load_lds_dwordx4 v27, s[58:59] nt
    s_cmp_eq_u32 s4, 1
    s_cbranch_scc1 rot_7
    s_cmp_eq_u32 s4, 2
    s_cbranch_scc1 rot_8
    s_cmp_eq_u32 s4, 3
    s_cbranch_scc1 rot_9
    ds_read_b64_tr_b16 v[136:137], v32 offset:16384
    ds_read_b64_tr_b16 v[138:139], v32 offset:16896
    ds_read_b64_tr_b16 v[140:141], v32 offset:24576
    ds_read_b64_tr_b16 v[142:143], v32 offset:25088
    ds_read_b64_tr_b16 v[200:201], v33 offset:16384
    ds_read_b64_tr_b16 v[202:203], v33 offset:16896
    ds_read_b64_tr_b16 v[204:205], v33 offset:24576
    ds_read_b64_tr_b16 v[206:207], v33 offset:25088
    s_branch rote_10
rot_7:
    ds_read_b64_tr_b16 v[184:185], v32 offset:16384
    ds_read_b64_tr_b16 v[186:187], v32 offset:16896
    ds_read_b64_tr_b16 v[188:189], v32 offset:24576
    ds_read_b64_tr_b16 v[190:191], v32 offset:25088
    ds_read_b64_tr_b16 v[248:249], v33 offset:16384
    ds_read_b64_tr_b16 v[250:251], v33 offset:16896
    ds_read_b64_tr_b16 v[252:253], v33 offset:24576
    ds_read_b64_tr_b16 v[254:255], v33 offset:25088
    s_branch rote_10
rot_8:
    ds_read_b64_tr_b16 v[168:169], v32 offset:16384
    ds_read_b64_tr_b16 v[170:171], v32 offset:16896
    ds_read_b64_tr_b16 v[172:173], v32 offset:24576
    ds_read_b64_tr_b16 v[174:175], v32 offset:25088
    ds_read_b64_tr_b16 v[232:233], v33 offset:16384
    ds_read_b64_tr_b16 v[234:235], v33 offset:16896
    ds_read_b64_tr_b16 v[236:237], v33 offset:24576
    ds_read_b64_tr_b16 v[238:239], v33 offset:25088
    s_branch rote_10
rot_9:
    ds_read_b64_tr_b16 v[152:153], v32 offset:16384
    ds_read_b64_tr_b16 v[154:155], v32 offset:16896
    ds_read_b64_tr_b16 v[156:157], v32 offset:24576
    ds_read_b64_tr_b16 v[158:159], v32 offset:25088
    ds_read_b64_tr_b16 v[216:217], v33 offset:16384
    ds_read_b64_tr_b16 v[218:219], v33 offset:16896
    ds_read_b64_tr_b16 v[220:221], v33 offset:24576
    ds_read_b64_tr_b16 v[222:223], v33 offset:25088
rote_10:
    s_waitcnt lgkmcnt(0)
    s_waitcnt vmcnt(27)
    s_barrier
    s_add_u32 s58, s12, 524288
    s_addc_u32 s59, s13, 0
    s_lshl_b32 s54, s4, 12
    s_add_u32 m0, s54, 16384
    s_nop 0
    global_load_lds_dwordx4 v24, s[58:59] nt
    s_add_u32 m0, s54, 17408
    s_nop 0
    global_load_lds_dwordx4 v25, s[58:59] nt
    s_add_u32 m0, s54, 18432
    s_nop 0
    global_load_lds_dwordx4 v26, s[58:59] nt
    s_add_u32 m0, s54, 19456
    s_nop 0
    global_load_lds_dwordx4 v27, s[58:59] nt
    s_cmp_eq_u32 s4, 1
    s_cbranch_scc1 rot_12
    s_cmp_eq_u32 s4, 2
    s_cbranch_scc1 rot_13
    s_cmp_eq_u32 s4, 3
    s_cbranch_scc1 rot_14
    ds_read_b64_tr_b16 v[144:145], v32 offset:32768
    ds_read_b64_tr_b16 v[146:147], v32 offset:33280
    ds_read_b64_tr_b16 v[148:149], v32 offset:40960
    ds_read_b64_tr_b16 v[150:151], v32 offset:41472
    ds_read_b64_tr_b16 v[208:209], v33 offset:32768
    ds_read_b64_tr_b16 v[210:211], v33 offset:33280
    ds_read_b64_tr_b16 v[212:213], v33 offset:40960
    ds_read_b64_tr_b16 v[214:215], v33 offset:41472
    s_branch rote_15
rot_12:
    ds_read_b64_tr_b16 v[128:129], v32 offset:32768
    ds_read_b64_tr_b16 v[130:131], v32 offset:33280
    ds_read_b64_tr_b16 v[132:133], v32 offset:40960
    ds_read_b64_tr_b16 v[134:135], v32 offset:41472
    ds_read_b64_tr_b16 v[192:193], v33 offset:32768
    ds_read_b64_tr_b16 v[194:195], v33 offset:33280
    ds_read_b64_tr_b16 v[196:197], v33 offset:40960
    ds_read_b64_tr_b16 v[198:199], v33 offset:41472
    s_branch rote_15
rot_13:
    ds_read_b64_tr_b16 v[176:177], v32 offset:32768
    ds_read_b64_tr_b16 v[178:179], v32 offset:33280
    ds_read_b64_tr_b16 v[180:181], v32 offset:40960
    ds_read_b64_tr_b16 v[182:183], v32 offset:41472
    ds_read_b64_tr_b16 v[240:241], v33 offset:32768
    ds_read_b64_tr_b16 v[242:243], v33 offset:33280
    ds_read_b64_tr_b16 v[244:245], v33 offset:40960
    ds_read_b64_tr_b16 v[246:247], v33 offset:41472
    s_branch rote_15
rot_14:
    ds_read_b64_tr_b16 v[160:161], v32 offset:32768
    ds_read_b64_tr_b16 v[162:163], v32 offset:33280
    ds_read_b64_tr_b16 v[164:165], v32 offset:40960
    ds_read_b64_tr_b16 v[166:167], v32 offset:41472
    ds_read_b64_tr_b16 v[224:225], v33 offset:32768
    ds_read_b64_tr_b16 v[226:227], v33 offset:33280
    ds_read_b64_tr_b16 v[228:229], v33 offset:40960
    ds_read_b64_tr_b16 v[230:231], v33 offset:41472
rote_15:
    s_waitcnt lgkmcnt(0)
    s_waitcnt vmcnt(27)
    s_barrier
    s_add_u32 s58, s12, 1048576
    s_addc_u32 s59, s13, 0
    s_lshl_b32 s54, s4, 12
    s_add_u32 m0, s54, 32768
    s_nop 0
    global_load_lds_dwordx4 v24, s[58:59] nt
    s_add_u32 m0, s54, 33792
    s_nop 0
    global_load_lds_dwordx4 v25, s[58:59] nt
    s_add_u32 m0, s54, 34816
    s_nop 0
    global_load_lds_dwordx4 v26, s[58:59] nt
    s_add_u32 m0, s54, 35840
    s_nop 0
    global_load_lds_dwordx4 v27, s[58:59] nt
    s_cmp_eq_u32 s4, 1
    s_cbranch_scc1 rot_17
    s_cmp_eq_u32 s4, 2
    s_cbranch_scc1 rot_18
    s_cmp_eq_u32 s4, 3
    s_cbranch_scc1 rot_19
    ds_read_b64_tr_b16 v[152:153], v32 offset:49152
    ds_read_b64_tr_b16 v[154:155], v32 offset:49664
    ds_read_b64_tr_b16 v[156:157], v32 offset:57344
    ds_read_b64_tr_b16 v[158:159], v32 offset:57856
    ds_read_b64_tr_b16 v[216:217], v33 offset:49152
    ds_read_b64_tr_b16 v[218:219], v33 offset:49664
    ds_read_b64_tr_b16 v[220:221], v33 offset:57344
    ds_read_b64_tr_b16 v[222:223], v33 offset:57856
    s_branch rote_20
rot_17:
    ds_read_b64_tr_b16 v[136:137], v32 offset:49152
    ds_read_b64_tr_b16 v[138:139], v32 offset:49664
    ds_read_b64_tr_b16 v[140:141], v32 offset:57344
    ds_read_b64_tr_b16 v[142:143], v32 offset:57856
    ds_read_b64_tr_b16 v[200:201], v33 offset:49152
    ds_read_b64_tr_b16 v[202:203], v33 offset:49664
    ds_read_b64_tr_b16 v[204:205], v33 offset:57344
    ds_read_b64_tr_b16 v[206:207], v33 offset:57856
    s_branch rote_20
rot_18:
    ds_read_b64_tr_b16 v[184:185], v32 offset:49152
    ds_read_b64_tr_b16 v[186:187], v32 offset:49664
    ds_read_b64_tr_b16 v[188:189], v32 offset:57344
    ds_read_b64_tr_b16 v[190:191], v32 offset:57856
    ds_read_b64_tr_b16 v[248:249], v33 offset:49152
    ds_read_b64_tr_b16 v[250:251], v33 offset:49664
    ds_read_b64_tr_b16 v[252:253], v33 offset:57344
    ds_read_b64_tr_b16 v[254:255], v33 offset:57856
    s_branch rote_20
rot_19:
    ds_read_b64_tr_b16 v[168:169], v32 offset:49152
    ds_read_b64_tr_b16 v[170:171], v32 offset:49664
    ds_read_b64_tr_b16 v[172:173], v32 offset:57344
    ds_read_b64_tr_b16 v[174:175], v32 offset:57856
    ds_read_b64_tr_b16 v[232:233], v33 offset:49152
    ds_read_b64_tr_b16 v[234:235], v33 offset:49664
    ds_read_b64_tr_b16 v[236:237], v33 offset:57344
    ds_read_b64_tr_b16 v[238:239], v33 offset:57856
rote_20:
    s_waitcnt lgkmcnt(0)
    s_waitcnt vmcnt(27)
    s_barrier
    s_add_u32 s58, s12, 1572864
    s_addc_u32 s59, s13, 0
    s_lshl_b32 s54, s4, 12
    s_add_u32 m0, s54, 49152
    s_nop 0
    global_load_lds_dwordx4 v24, s[58:59] nt
    s_add_u32 m0, s54, 50176
    s_nop 0
    global_load_lds_dwordx4 v25, s[58:59] nt
    s_add_u32 m0, s54, 51200
    s_nop 0
    global_load_lds_dwordx4 v26, s[58:59] nt
    s_add_u32 m0, s54, 52224
    s_nop 0
    global_load_lds_dwordx4 v27, s[58:59] nt
    v_bfe_u32 v88, v14, 1, 1
    v_mul_u32_u24 v88, 0xAAAA, v88
    v_add_u32 v5, 0x4444, v88
    v_mov_b32 v1, 0
    v_mov_b32 v2, 0
    v_and_b32 v88, 15, v14
    v_lshrrev_b32 v89, 4, v14
    s_lshl_b32 s43, s4, 11
    s_add_u32 s42, s43, 131072
    s_lshl_b32 s54, s4, 12
    s_lshl_b32 s55, s4, 15
    s_add_u32 s54, s54, s55
    v_add_u32 v6, s54, v4
    s_lshl_b32 s54, s4, 1
    s_add_u32 s54, s54, 2
    s_and_b32 s54, s54, 7
    s_lshl_b32 s56, s54, 14
    s_sub_u32 s90, s56, s55
    s_lshl_b32 s56, s54, 10
    s_add_u32 s93, s56, 147456
    s_lshl_b32 s54, s4, 1
    s_add_u32 s54, s54, 4
    s_and_b32 s54, s54, 7
    s_lshl_b32 s56, s54, 14
    s_sub_u32 s91, s56, s55
    s_lshl_b32 s56, s54, 10
    s_add_u32 s94, s56, 147456
    s_lshl_b32 s54, s4, 1
    s_add_u32 s54, s54, 6
    s_and_b32 s54, s54, 7
    s_lshl_b32 s56, s54, 14
    s_sub_u32 s92, s56, s55
    s_lshl_b32 s56, s54, 10
    s_add_u32 s95, s56, 147456
    s_lshl_b32 s54, s4, 5
    v_add_u32 v90, s54, v88
    v_lshlrev_b32 v90, 4, v90
    v_lshl_add_u32 v90, v89, 2, v90
    v_add_u32 v7, 155648, v90
    s_lshl_b32 s54, s4, 5
    v_add_u32 v90, s54, v88
    v_lshlrev_b32 v90, 5, v90
    v_bfe_u32 v91, v88, 2, 2
    v_xor_b32 v91, v91, v89
    v_lshl_add_u32 v90, v91, 3, v90
    v_add_u32 v23, 157696, v90
    v_bfe_u32 v90, v14, 2, 2
    v_lshrrev_b32 v91, 1, v89
    v_lshl_add_u32 v90, v91, 4, v90
    v_and_b32 v91, 1, v89
    v_lshl_add_u32 v90, v91, 2, v90
    v_and_b32 v91, 1, v14
    v_lshlrev_b32 v91, 3, v91
    v_lshl_add_u32 v8, v90, 4, v91
    v_add_u32 v8, 155648, v8
    v_and_b32 v91, 3, v14
    v_and_b32 v92, 1, v89
    v_xor_b32 v91, v91, v92
    v_lshlrev_b32 v91, 3, v91
    v_lshl_add_u32 v9, v90, 5, v91
    v_add_u32 v9, 157696, v9
    v_bfe_u32 v90, v88, 1, 2
    v_lshlrev_b32 v90, 2, v90
    v_and_b32 v91, 1, v88
    v_add_u32 v90, v90, v91
    v_lshl_add_u32 v90, v89, 4, v90
    s_and_b32 s54, s4, 1
    s_lshl_b32 s54, s54, 1
    v_add_u32 v90, s54, v90
    v_lshlrev_b32 v90, 4, v90
    s_lshr_b32 s54, s4, 1
    s_lshl_b32 s54, s54, 10
    s_add_u32 s54, s54, 147456
    v_add_u32 v10, s54, v90
    v_lshrrev_b32 v90, 2, v88
    v_lshl_add_u32 v90, v90, 2, v89
    s_lshl_b32 s54, s4, 5
    v_add_u32 v90, s54, v90
    v_lshlrev_b32 v90, 11, v90
    v_and_b32 v91, 3, v88
    v_lshl_add_u32 v11, v91, 4, v90
    v_bfe_u32 v90, v14, 3, 1
    v_and_b32 v91, 1, v89
    v_lshl_add_u32 v90, v91, 1, v90
    v_lshlrev_b32 v90, 8, v90
    v_bfe_u32 v91, v14, 2, 1
    v_lshl_add_u32 v90, v91, 4, v90
    v_and_b32 v91, 3, v14
    v_lshl_add_u32 v90, v91, 1, v90
    s_lshl_b32 s54, s3, 2
    s_add_u32 s54, s54, s4
    s_lshr_b32 s55, s54, 4
    s_lshl_b32 s55, s55, 10
    s_and_b32 s56, s54, 3
    s_lshl_b32 s56, s56, 6
    s_add_u32 s55, s55, s56
    s_bfe_u32 s56, s54, 0x10003
    s_lshl_b32 s56, s56, 5
    s_add_u32 s55, s55, s56
    s_bfe_u32 s56, s54, 0x10002
    s_lshl_b32 s56, s56, 3
    s_add_u32 s55, s55, s56
    v_add_u32 v12, s55, v90
    s_lshl_b32 s55, s3, 6
    s_add_u32 s55, s55, 60817408
    s_add_u32 s22, s18, s55
    s_addc_u32 s23, s19, 0
    s_add_u32 s24, s22, 32768
    s_addc_u32 s25, s23, 0
    s_add_u32 s32, s18, 61341696
    s_addc_u32 s33, s19, 0
    s_add_u32 s28, s18, 61349888
    s_addc_u32 s29, s19, 0
    s_add_u32 s30, s18, 61358080
    s_addc_u32 s31, s19, 0
    s_lshl_b32 s55, s3, 13
    s_add_u32 s55, s55, s43
    s_add_u32 s34, s18, s55
    s_addc_u32 s35, s19, 0
    s_add_u32 s55, s55, 16777216
    s_add_u32 s36, s18, s55
    s_addc_u32 s37, s19, 0
    s_lshl_b32 s55, s3, 12
    s_lshl_b32 s56, s4, 10
    s_add_u32 s55, s55, s56
    s_add_u32 s56, s55, 50462720
    s_add_u32 s38, s18, s56
    s_addc_u32 s39, s19, 0
    s_mov_b32 s44, 0x3e0293ee
    s_mov_b32 s45, 0x3e0293ee
    s_mov_b32 s46, 0x55555555
    s_mov_b32 s47, 0
    s_mov_b32 s6, 0x40000
    s_lshl_b32 s55, s3, 7
    s_add_u32 s55, s55, 10240
    s_add_u32 s100, s52, s55
    s_addc_u32 s101, s53, 0
    s_cmp_eq_u32 s4, 1
    s_cbranch_scc1 rot_22
    s_cmp_eq_u32 s4, 2
    s_cbranch_scc1 rot_23
    s_cmp_eq_u32 s4, 3
    s_cbranch_scc1 rot_24
    v_add_u32 v54, 65536, v32
    ds_read_b64_tr_b16 v[160:161], v54 offset:0
    v_add_u32 v54, 65536, v32
    ds_read_b64_tr_b16 v[162:163], v54 offset:512
    v_add_u32 v54, 65536, v32
    ds_read_b64_tr_b16 v[164:165], v54 offset:8192
    v_add_u32 v54, 65536, v32
    ds_read_b64_tr_b16 v[166:167], v54 offset:8704
    v_add_u32 v54, 65536, v33
    ds_read_b64_tr_b16 v[224:225], v54 offset:0
    v_add_u32 v54, 65536, v33
    ds_read_b64_tr_b16 v[226:227], v54 offset:512
    v_add_u32 v54, 65536, v33
    ds_read_b64_tr_b16 v[228:229], v54 offset:8192
    v_add_u32 v54, 65536, v33
    ds_read_b64_tr_b16 v[230:231], v54 offset:8704
    s_branch rote_25
rot_22:
    v_add_u32 v54, 65536, v32
    ds_read_b64_tr_b16 v[144:145], v54 offset:0
    v_add_u32 v54, 65536, v32
    ds_read_b64_tr_b16 v[146:147], v54 offset:512
    v_add_u32 v54, 65536, v32
    ds_read_b64_tr_b16 v[148:149], v54 offset:8192
    v_add_u32 v54, 65536, v32
    ds_read_b64_tr_b16 v[150:151], v54 offset:8704
    v_add_u32 v54, 65536, v33
    ds_read_b64_tr_b16 v[208:209], v54 offset:0
    v_add_u32 v54, 65536, v33
    ds_read_b64_tr_b16 v[210:211], v54 offset:512
    v_add_u32 v54, 65536, v33
    ds_read_b64_tr_b16 v[212:213], v54 offset:8192
    v_add_u32 v54, 65536, v33
    ds_read_b64_tr_b16 v[214:215], v54 offset:8704
    s_branch rote_25
rot_23:
    v_add_u32 v54, 65536, v32
    ds_read_b64_tr_b16 v[128:129], v54 offset:0
    v_add_u32 v54, 65536, v32
    ds_read_b64_tr_b16 v[130:131], v54 offset:512
    v_add_u32 v54, 65536, v32
    ds_read_b64_tr_b16 v[132:133], v54 offset:8192
    v_add_u32 v54, 65536, v32
    ds_read_b64_tr_b16 v[134:135], v54 offset:8704
    v_add_u32 v54, 65536, v33
    ds_read_b64_tr_b16 v[192:193], v54 offset:0
    v_add_u32 v54, 65536, v33
    ds_read_b64_tr_b16 v[194:195], v54 offset:512
    v_add_u32 v54, 65536, v33
    ds_read_b64_tr_b16 v[196:197], v54 offset:8192
    v_add_u32 v54, 65536, v33
    ds_read_b64_tr_b16 v[198:199], v54 offset:8704
    s_branch rote_25
rot_24:
    v_add_u32 v54, 65536, v32
    ds_read_b64_tr_b16 v[176:177], v54 offset:0
    v_add_u32 v54, 65536, v32
    ds_read_b64_tr_b16 v[178:179], v54 offset:512
    v_add_u32 v54, 65536, v32
    ds_read_b64_tr_b16 v[180:181], v54 offset:8192
    v_add_u32 v54, 65536, v32
    ds_read_b64_tr_b16 v[182:183], v54 offset:8704
    v_add_u32 v54, 65536, v33
    ds_read_b64_tr_b16 v[240:241], v54 offset:0
    v_add_u32 v54, 65536, v33
    ds_read_b64_tr_b16 v[242:243], v54 offset:512
    v_add_u32 v54, 65536, v33
    ds_read_b64_tr_b16 v[244:245], v54 offset:8192
    v_add_u32 v54, 65536, v33
    ds_read_b64_tr_b16 v[246:247], v54 offset:8704
rote_25:
    s_waitcnt lgkmcnt(0)
    s_waitcnt vmcnt(27)
    s_barrier
    s_add_u32 s58, s12, 2097152
    s_addc_u32 s59, s13, 0
    s_lshl_b32 s54, s4, 12
    s_add_u32 m0, s54, 65536
    s_nop 0
    global_load_lds_dwordx4 v24, s[58:59] nt
    s_add_u32 m0, s54, 66560
    s_nop 0
    global_load_lds_dwordx4 v25, s[58:59] nt
    s_add_u32 m0, s54, 67584
    s_nop 0
    global_load_lds_dwordx4 v26, s[58:59] nt
    s_add_u32 m0, s54, 68608
    s_nop 0
    global_load_lds_dwordx4 v27, s[58:59] nt
    s_cmp_eq_u32 s4, 1
    s_cbranch_scc1 rot_27
    s_cmp_eq_u32 s4, 2
    s_cbranch_scc1 rot_28
    s_cmp_eq_u32 s4, 3
    s_cbranch_scc1 rot_29
    v_add_u32 v54, 65536, v32
    ds_read_b64_tr_b16 v[168:169], v54 offset:16384
    v_add_u32 v54, 65536, v32
    ds_read_b64_tr_b16 v[170:171], v54 offset:16896
    v_add_u32 v54, 65536, v32
    ds_read_b64_tr_b16 v[172:173], v54 offset:24576
    v_add_u32 v54, 65536, v32
    ds_read_b64_tr_b16 v[174:175], v54 offset:25088
    v_add_u32 v54, 65536, v33
    ds_read_b64_tr_b16 v[232:233], v54 offset:16384
    v_add_u32 v54, 65536, v33
    ds_read_b64_tr_b16 v[234:235], v54 offset:16896
    v_add_u32 v54, 65536, v33
    ds_read_b64_tr_b16 v[236:237], v54 offset:24576
    v_add_u32 v54, 65536, v33
    ds_read_b64_tr_b16 v[238:239], v54 offset:25088
    s_branch rote_30
rot_27:
    v_add_u32 v54, 65536, v32
    ds_read_b64_tr_b16 v[152:153], v54 offset:16384
    v_add_u32 v54, 65536, v32
    ds_read_b64_tr_b16 v[154:155], v54 offset:16896
    v_add_u32 v54, 65536, v32
    ds_read_b64_tr_b16 v[156:157], v54 offset:24576
    v_add_u32 v54, 65536, v32
    ds_read_b64_tr_b16 v[158:159], v54 offset:25088
    v_add_u32 v54, 65536, v33
    ds_read_b64_tr_b16 v[216:217], v54 offset:16384
    v_add_u32 v54, 65536, v33
    ds_read_b64_tr_b16 v[218:219], v54 offset:16896
    v_add_u32 v54, 65536, v33
    ds_read_b64_tr_b16 v[220:221], v54 offset:24576
    v_add_u32 v54, 65536, v33
    ds_read_b64_tr_b16 v[222:223], v54 offset:25088
    s_branch rote_30
rot_28:
    v_add_u32 v54, 65536, v32
    ds_read_b64_tr_b16 v[136:137], v54 offset:16384
    v_add_u32 v54, 65536, v32
    ds_read_b64_tr_b16 v[138:139], v54 offset:16896
    v_add_u32 v54, 65536, v32
    ds_read_b64_tr_b16 v[140:141], v54 offset:24576
    v_add_u32 v54, 65536, v32
    ds_read_b64_tr_b16 v[142:143], v54 offset:25088
    v_add_u32 v54, 65536, v33
    ds_read_b64_tr_b16 v[200:201], v54 offset:16384
    v_add_u32 v54, 65536, v33
    ds_read_b64_tr_b16 v[202:203], v54 offset:16896
    v_add_u32 v54, 65536, v33
    ds_read_b64_tr_b16 v[204:205], v54 offset:24576
    v_add_u32 v54, 65536, v33
    ds_read_b64_tr_b16 v[206:207], v54 offset:25088
    s_branch rote_30
rot_29:
    v_add_u32 v54, 65536, v32
    ds_read_b64_tr_b16 v[184:185], v54 offset:16384
    v_add_u32 v54, 65536, v32
    ds_read_b64_tr_b16 v[186:187], v54 offset:16896
    v_add_u32 v54, 65536, v32
    ds_read_b64_tr_b16 v[188:189], v54 offset:24576
    v_add_u32 v54, 65536, v32
    ds_read_b64_tr_b16 v[190:191], v54 offset:25088
    v_add_u32 v54, 65536, v33
    ds_read_b64_tr_b16 v[248:249], v54 offset:16384
    v_add_u32 v54, 65536, v33
    ds_read_b64_tr_b16 v[250:251], v54 offset:16896
    v_add_u32 v54, 65536, v33
    ds_read_b64_tr_b16 v[252:253], v54 offset:24576
    v_add_u32 v54, 65536, v33
    ds_read_b64_tr_b16 v[254:255], v54 offset:25088
rote_30:
    s_waitcnt lgkmcnt(0)
    s_waitcnt vmcnt(27)
    s_barrier
    s_add_u32 s58, s12, 2621440
    s_addc_u32 s59, s13, 0
    s_lshl_b32 s54, s4, 12
    s_add_u32 m0, s54, 81920
    s_nop 0
    global_load_lds_dwordx4 v24, s[58:59] nt
    s_add_u32 m0, s54, 82944
    s_nop 0
    global_load_lds_dwordx4 v25, s[58:59] nt
    s_add_u32 m0, s54, 83968
    s_nop 0
    global_load_lds_dwordx4 v26, s[58:59] nt
    s_add_u32 m0, s54, 84992
    s_nop 0
    global_load_lds_dwordx4 v27, s[58:59] nt
    s_cmp_eq_u32 s4, 1
    s_cbranch_scc1 rot_32
    s_cmp_eq_u32 s4, 2
    s_cbranch_scc1 rot_33
    s_cmp_eq_u32 s4, 3
    s_cbranch_scc1 rot_34
    v_add_u32 v54, 65536, v32
    ds_read_b64_tr_b16 v[176:177], v54 offset:32768
    v_add_u32 v54, 65536, v32
    ds_read_b64_tr_b16 v[178:179], v54 offset:33280
    v_add_u32 v54, 65536, v32
    ds_read_b64_tr_b16 v[180:181], v54 offset:40960
    v_add_u32 v54, 65536, v32
    ds_read_b64_tr_b16 v[182:183], v54 offset:41472
    v_add_u32 v54, 65536, v33
    ds_read_b64_tr_b16 v[240:241], v54 offset:32768
    v_add_u32 v54, 65536, v33
    ds_read_b64_tr_b16 v[242:243], v54 offset:33280
    v_add_u32 v54, 65536, v33
    ds_read_b64_tr_b16 v[244:245], v54 offset:40960
    v_add_u32 v54, 65536, v33
    ds_read_b64_tr_b16 v[246:247], v54 offset:41472
    s_branch rote_35
rot_32:
    v_add_u32 v54, 65536, v32
    ds_read_b64_tr_b16 v[160:161], v54 offset:32768
    v_add_u32 v54, 65536, v32
    ds_read_b64_tr_b16 v[162:163], v54 offset:33280
    v_add_u32 v54, 65536, v32
    ds_read_b64_tr_b16 v[164:165], v54 offset:40960
    v_add_u32 v54, 65536, v32
    ds_read_b64_tr_b16 v[166:167], v54 offset:41472
    v_add_u32 v54, 65536, v33
    ds_read_b64_tr_b16 v[224:225], v54 offset:32768
    v_add_u32 v54, 65536, v33
    ds_read_b64_tr_b16 v[226:227], v54 offset:33280
    v_add_u32 v54, 65536, v33
    ds_read_b64_tr_b16 v[228:229], v54 offset:40960
    v_add_u32 v54, 65536, v33
    ds_read_b64_tr_b16 v[230:231], v54 offset:41472
    s_branch rote_35
rot_33:
    v_add_u32 v54, 65536, v32
    ds_read_b64_tr_b16 v[144:145], v54 offset:32768
    v_add_u32 v54, 65536, v32
    ds_read_b64_tr_b16 v[146:147], v54 offset:33280
    v_add_u32 v54, 65536, v32
    ds_read_b64_tr_b16 v[148:149], v54 offset:40960
    v_add_u32 v54, 65536, v32
    ds_read_b64_tr_b16 v[150:151], v54 offset:41472
    v_add_u32 v54, 65536, v33
    ds_read_b64_tr_b16 v[208:209], v54 offset:32768
    v_add_u32 v54, 65536, v33
    ds_read_b64_tr_b16 v[210:211], v54 offset:33280
    v_add_u32 v54, 65536, v33
    ds_read_b64_tr_b16 v[212:213], v54 offset:40960
    v_add_u32 v54, 65536, v33
    ds_read_b64_tr_b16 v[214:215], v54 offset:41472
    s_branch rote_35
rot_34:
    v_add_u32 v54, 65536, v32
    ds_read_b64_tr_b16 v[128:129], v54 offset:32768
    v_add_u32 v54, 65536, v32
    ds_read_b64_tr_b16 v[130:131], v54 offset:33280
    v_add_u32 v54, 65536, v32
    ds_read_b64_tr_b16 v[132:133], v54 offset:40960
    v_add_u32 v54, 65536, v32
    ds_read_b64_tr_b16 v[134:135], v54 offset:41472
    v_add_u32 v54, 65536, v33
    ds_read_b64_tr_b16 v[192:193], v54 offset:32768
    v_add_u32 v54, 65536, v33
    ds_read_b64_tr_b16 v[194:195], v54 offset:33280
    v_add_u32 v54, 65536, v33
    ds_read_b64_tr_b16 v[196:197], v54 offset:40960
    v_add_u32 v54, 65536, v33
    ds_read_b64_tr_b16 v[198:199], v54 offset:41472
rote_35:
    s_waitcnt lgkmcnt(0)
    s_waitcnt vmcnt(24)
    s_barrier
    s_add_u32 s58, s12, 3145728
    s_addc_u32 s59, s13, 0
    s_lshl_b32 s54, s4, 12
    s_add_u32 m0, s54, 98304
    s_nop 0
    global_load_lds_dwordx4 v24, s[58:59] nt
    s_add_u32 m0, s54, 99328
    s_nop 0
    global_load_lds_dwordx4 v25, s[58:59] nt
    s_add_u32 m0, s54, 100352
    s_nop 0
    global_load_lds_dwordx4 v26, s[58:59] nt
    s_add_u32 m0, s54, 101376
    s_nop 0
    global_load_lds_dwordx4 v27, s[58:59] nt
    s_cmp_eq_u32 s4, 1
    s_cbranch_scc1 rot_37
    s_cmp_eq_u32 s4, 2
    s_cbranch_scc1 rot_38
    s_cmp_eq_u32 s4, 3
    s_cbranch_scc1 rot_39
    v_add_u32 v54, 65536, v32
    ds_read_b64_tr_b16 v[184:185], v54 offset:49152
    v_add_u32 v54, 65536, v32
    ds_read_b64_tr_b16 v[186:187], v54 offset:49664
    v_add_u32 v54, 65536, v32
    ds_read_b64_tr_b16 v[188:189], v54 offset:57344
    v_add_u32 v54, 65536, v32
    ds_read_b64_tr_b16 v[190:191], v54 offset:57856
    v_add_u32 v54, 65536, v33
    ds_read_b64_tr_b16 v[248:249], v54 offset:49152
    v_add_u32 v54, 65536, v33
    ds_read_b64_tr_b16 v[250:251], v54 offset:49664
    v_add_u32 v54, 65536, v33
    ds_read_b64_tr_b16 v[252:253], v54 offset:57344
    v_add_u32 v54, 65536, v33
    ds_read_b64_tr_b16 v[254:255], v54 offset:57856
    s_branch rote_40
rot_37:
    v_add_u32 v54, 65536, v32
    ds_read_b64_tr_b16 v[168:169], v54 offset:49152
    v_add_u32 v54, 65536, v32
    ds_read_b64_tr_b16 v[170:171], v54 offset:49664
    v_add_u32 v54, 65536, v32
    ds_read_b64_tr_b16 v[172:173], v54 offset:57344
    v_add_u32 v54, 65536, v32
    ds_read_b64_tr_b16 v[174:175], v54 offset:57856
    v_add_u32 v54, 65536, v33
    ds_read_b64_tr_b16 v[232:233], v54 offset:49152
    v_add_u32 v54, 65536, v33
    ds_read_b64_tr_b16 v[234:235], v54 offset:49664
    v_add_u32 v54, 65536, v33
    ds_read_b64_tr_b16 v[236:237], v54 offset:57344
    v_add_u32 v54, 65536, v33
    ds_read_b64_tr_b16 v[238:239], v54 offset:57856
    s_branch rote_40
rot_38:
    v_add_u32 v54, 65536, v32
    ds_read_b64_tr_b16 v[152:153], v54 offset:49152
    v_add_u32 v54, 65536, v32
    ds_read_b64_tr_b16 v[154:155], v54 offset:49664
    v_add_u32 v54, 65536, v32
    ds_read_b64_tr_b16 v[156:157], v54 offset:57344
    v_add_u32 v54, 65536, v32
    ds_read_b64_tr_b16 v[158:159], v54 offset:57856
    v_add_u32 v54, 65536, v33
    ds_read_b64_tr_b16 v[216:217], v54 offset:49152
    v_add_u32 v54, 65536, v33
    ds_read_b64_tr_b16 v[218:219], v54 offset:49664
    v_add_u32 v54, 65536, v33
    ds_read_b64_tr_b16 v[220:221], v54 offset:57344
    v_add_u32 v54, 65536, v33
    ds_read_b64_tr_b16 v[222:223], v54 offset:57856
    s_branch rote_40
rot_39:
    v_add_u32 v54, 65536, v32
    ds_read_b64_tr_b16 v[136:137], v54 offset:49152
    v_add_u32 v54, 65536, v32
    ds_read_b64_tr_b16 v[138:139], v54 offset:49664
    v_add_u32 v54, 65536, v32
    ds_read_b64_tr_b16 v[140:141], v54 offset:57344
    v_add_u32 v54, 65536, v32
    ds_read_b64_tr_b16 v[142:143], v54 offset:57856
    v_add_u32 v54, 65536, v33
    ds_read_b64_tr_b16 v[200:201], v54 offset:49152
    v_add_u32 v54, 65536, v33
    ds_read_b64_tr_b16 v[202:203], v54 offset:49664
    v_add_u32 v54, 65536, v33
    ds_read_b64_tr_b16 v[204:205], v54 offset:57344
    v_add_u32 v54, 65536, v33
    ds_read_b64_tr_b16 v[206:207], v54 offset:57856
rote_40:
    s_waitcnt lgkmcnt(0)
    s_waitcnt vmcnt(24)
    s_barrier
    s_add_u32 s58, s12, 3670016
    s_addc_u32 s59, s13, 0
    s_lshl_b32 s54, s4, 12
    s_add_u32 m0, s54, 114688
    s_nop 0
    global_load_lds_dwordx4 v24, s[58:59] nt
    s_add_u32 m0, s54, 115712
    s_nop 0
    global_load_lds_dwordx4 v25, s[58:59] nt
    s_add_u32 m0, s54, 116736
    s_nop 0
    global_load_lds_dwordx4 v26, s[58:59] nt
    s_add_u32 m0, s54, 117760
    s_nop 0
    global_load_lds_dwordx4 v27, s[58:59] nt
    s_cmp_lg_u32 s4, 0
    s_cbranch_scc1 initsig_41
    s_getreg_b32 s54, hwreg(HW_REG_XCC_ID, 0, 3)
    s_lshl_b32 s54, s54, 3
    s_lshl_b64 s[58:59], 1, s54
    v_mov_b32 v56, 0
    v_mov_b32 v58, s58
    v_mov_b32 v59, s59
    v_mov_b32 v57, 1
    s_mov_b64 exec, 1
    global_atomic_add_x2 v56, v[58:59], s[20:21] offset:128 sc1
    s_mov_b64 exec, -1
initsig_41:
    s_cmp_eq_u32 s4, 1
    s_cbranch_scc1 rot_43
    s_cmp_eq_u32 s4, 2
    s_cbranch_scc1 rot_44
    s_cmp_eq_u32 s4, 3
    s_cbranch_scc1 rot_45
    ds_read_b64_tr_b16 a[0:1], v32 offset:0
    ds_read_b64_tr_b16 a[2:3], v32 offset:512
    ds_read_b64_tr_b16 a[4:5], v32 offset:8192
    ds_read_b64_tr_b16 a[6:7], v32 offset:8704
    ds_read_b64_tr_b16 a[64:65], v33 offset:0
    ds_read_b64_tr_b16 a[66:67], v33 offset:512
    ds_read_b64_tr_b16 a[68:69], v33 offset:8192
    ds_read_b64_tr_b16 a[70:71], v33 offset:8704
    s_branch rote_46
rot_43:
    ds_read_b64_tr_b16 a[48:49], v32 offset:0
    ds_read_b64_tr_b16 a[50:51], v32 offset:512
    ds_read_b64_tr_b16 a[52:53], v32 offset:8192
    ds_read_b64_tr_b16 a[54:55], v32 offset:8704
    ds_read_b64_tr_b16 a[112:113], v33 offset:0
    ds_read_b64_tr_b16 a[114:115], v33 offset:512
    ds_read_b64_tr_b16 a[116:117], v33 offset:8192
    ds_read_b64_tr_b16 a[118:119], v33 offset:8704
    s_branch rote_46
rot_44:
    ds_read_b64_tr_b16 a[32:33], v32 offset:0
    ds_read_b64_tr_b16 a[34:35], v32 offset:512
    ds_read_b64_tr_b16 a[36:37], v32 offset:8192
    ds_read_b64_tr_b16 a[38:39], v32 offset:8704
    ds_read_b64_tr_b16 a[96:97], v33 offset:0
    ds_read_b64_tr_b16 a[98:99], v33 offset:512
    ds_read_b64_tr_b16 a[100:101], v33 offset:8192
    ds_read_b64_tr_b16 a[102:103], v33 offset:8704
    s_branch rote_46
rot_45:
    ds_read_b64_tr_b16 a[16:17], v32 offset:0
    ds_read_b64_tr_b16 a[18:19], v32 offset:512
    ds_read_b64_tr_b16 a[20:21], v32 offset:8192
    ds_read_b64_tr_b16 a[22:23], v32 offset:8704
    ds_read_b64_tr_b16 a[80:81], v33 offset:0
    ds_read_b64_tr_b16 a[82:83], v33 offset:512
    ds_read_b64_tr_b16 a[84:85], v33 offset:8192
    ds_read_b64_tr_b16 a[86:87], v33 offset:8704
rote_46:
    s_waitcnt lgkmcnt(0)
    s_waitcnt vmcnt(25)
    s_barrier
    s_add_u32 s58, s14, 0
    s_addc_u32 s59, s15, 0
    s_lshl_b32 s54, s4, 12
    s_add_u32 m0, s54, 0
    s_nop 0
    global_load_lds_dwordx4 v28, s[58:59] nt
    s_add_u32 m0, s54, 1024
    s_nop 0
    global_load_lds_dwordx4 v29, s[58:59] nt
    s_add_u32 m0, s54, 2048
    s_nop 0
    global_load_lds_dwordx4 v30, s[58:59] nt
    s_add_u32 m0, s54, 3072
    s_nop 0
    global_load_lds_dwordx4 v31, s[58:59] nt
    s_cmp_eq_u32 s4, 1
    s_cbranch_scc1 rot_48
    s_cmp_eq_u32 s4, 2
    s_cbranch_scc1 rot_49
    s_cmp_eq_u32 s4, 3
    s_cbranch_scc1 rot_50
    ds_read_b64_tr_b16 a[8:9], v32 offset:16384
    ds_read_b64_tr_b16 a[10:11], v32 offset:16896
    ds_read_b64_tr_b16 a[12:13], v32 offset:24576
    ds_read_b64_tr_b16 a[14:15], v32 offset:25088
    ds_read_b64_tr_b16 a[72:73], v33 offset:16384
    ds_read_b64_tr_b16 a[74:75], v33 offset:16896
    ds_read_b64_tr_b16 a[76:77], v33 offset:24576
    ds_read_b64_tr_b16 a[78:79], v33 offset:25088
    s_branch rote_51
rot_48:
    ds_read_b64_tr_b16 a[56:57], v32 offset:16384
    ds_read_b64_tr_b16 a[58:59], v32 offset:16896
    ds_read_b64_tr_b16 a[60:61], v32 offset:24576
    ds_read_b64_tr_b16 a[62:63], v32 offset:25088
    ds_read_b64_tr_b16 a[120:121], v33 offset:16384
    ds_read_b64_tr_b16 a[122:123], v33 offset:16896
    ds_read_b64_tr_b16 a[124:125], v33 offset:24576
    ds_read_b64_tr_b16 a[126:127], v33 offset:25088
    s_branch rote_51
rot_49:
    ds_read_b64_tr_b16 a[40:41], v32 offset:16384
    ds_read_b64_tr_b16 a[42:43], v32 offset:16896
    ds_read_b64_tr_b16 a[44:45], v32 offset:24576
    ds_read_b64_tr_b16 a[46:47], v32 offset:25088
    ds_read_b64_tr_b16 a[104:105], v33 offset:16384
    ds_read_b64_tr_b16 a[106:107], v33 offset:16896
    ds_read_b64_tr_b16 a[108:109], v33 offset:24576
    ds_read_b64_tr_b16 a[110:111], v33 offset:25088
    s_branch rote_51
rot_50:
    ds_read_b64_tr_b16 a[24:25], v32 offset:16384
    ds_read_b64_tr_b16 a[26:27], v32 offset:16896
    ds_read_b64_tr_b16 a[28:29], v32 offset:24576
    ds_read_b64_tr_b16 a[30:31], v32 offset:25088
    ds_read_b64_tr_b16 a[88:89], v33 offset:16384
    ds_read_b64_tr_b16 a[90:91], v33 offset:16896
    ds_read_b64_tr_b16 a[92:93], v33 offset:24576
    ds_read_b64_tr_b16 a[94:95], v33 offset:25088
rote_51:
    s_waitcnt lgkmcnt(0)
    s_waitcnt vmcnt(25)
    s_barrier
    s_add_u32 s58, s14, 256
    s_addc_u32 s59, s15, 0
    s_lshl_b32 s54, s4, 12
    s_add_u32 m0, s54, 16384
    s_nop 0
    global_load_lds_dwordx4 v28, s[58:59] nt
    s_add_u32 m0, s54, 17408
    s_nop 0
    global_load_lds_dwordx4 v29, s[58:59] nt
    s_add_u32 m0, s54, 18432
    s_nop 0
    global_load_lds_dwordx4 v30, s[58:59] nt
    s_add_u32 m0, s54, 19456
    s_nop 0
    global_load_lds_dwordx4 v31, s[58:59] nt
    s_cmp_eq_u32 s4, 1
    s_cbranch_scc1 rot_53
    s_cmp_eq_u32 s4, 2
    s_cbranch_scc1 rot_54
    s_cmp_eq_u32 s4, 3
    s_cbranch_scc1 rot_55
    ds_read_b64_tr_b16 a[16:17], v32 offset:32768
    ds_read_b64_tr_b16 a[18:19], v32 offset:33280
    ds_read_b64_tr_b16 a[20:21], v32 offset:40960
    ds_read_b64_tr_b16 a[22:23], v32 offset:41472
    ds_read_b64_tr_b16 a[80:81], v33 offset:32768
    ds_read_b64_tr_b16 a[82:83], v33 offset:33280
    ds_read_b64_tr_b16 a[84:85], v33 offset:40960
    ds_read_b64_tr_b16 a[86:87], v33 offset:41472
    s_branch rote_56
rot_53:
    ds_read_b64_tr_b16 a[0:1], v32 offset:32768
    ds_read_b64_tr_b16 a[2:3], v32 offset:33280
    ds_read_b64_tr_b16 a[4:5], v32 offset:40960
    ds_read_b64_tr_b16 a[6:7], v32 offset:41472
    ds_read_b64_tr_b16 a[64:65], v33 offset:32768
    ds_read_b64_tr_b16 a[66:67], v33 offset:33280
    ds_read_b64_tr_b16 a[68:69], v33 offset:40960
    ds_read_b64_tr_b16 a[70:71], v33 offset:41472
    s_branch rote_56
rot_54:
    ds_read_b64_tr_b16 a[48:49], v32 offset:32768
    ds_read_b64_tr_b16 a[50:51], v32 offset:33280
    ds_read_b64_tr_b16 a[52:53], v32 offset:40960
    ds_read_b64_tr_b16 a[54:55], v32 offset:41472
    ds_read_b64_tr_b16 a[112:113], v33 offset:32768
    ds_read_b64_tr_b16 a[114:115], v33 offset:33280
    ds_read_b64_tr_b16 a[116:117], v33 offset:40960
    ds_read_b64_tr_b16 a[118:119], v33 offset:41472
    s_branch rote_56
rot_55:
    ds_read_b64_tr_b16 a[32:33], v32 offset:32768
    ds_read_b64_tr_b16 a[34:35], v32 offset:33280
    ds_read_b64_tr_b16 a[36:37], v32 offset:40960
    ds_read_b64_tr_b16 a[38:39], v32 offset:41472
    ds_read_b64_tr_b16 a[96:97], v33 offset:32768
    ds_read_b64_tr_b16 a[98:99], v33 offset:33280
    ds_read_b64_tr_b16 a[100:101], v33 offset:40960
    ds_read_b64_tr_b16 a[102:103], v33 offset:41472
rote_56:
    s_waitcnt lgkmcnt(0)
    s_waitcnt vmcnt(25)
    s_barrier
    s_add_u32 s58, s14, 512
    s_addc_u32 s59, s15, 0
    s_lshl_b32 s54, s4, 12
    s_add_u32 m0, s54, 32768
    s_nop 0
    global_load_lds_dwordx4 v28, s[58:59] nt
    s_add_u32 m0, s54, 33792
    s_nop 0
    global_load_lds_dwordx4 v29, s[58:59] nt
    s_add_u32 m0, s54, 34816
    s_nop 0
    global_load_lds_dwordx4 v30, s[58:59] nt
    s_add_u32 m0, s54, 35840
    s_nop 0
    global_load_lds_dwordx4 v31, s[58:59] nt
    s_cmp_eq_u32 s4, 1
    s_cbranch_scc1 rot_58
    s_cmp_eq_u32 s4, 2
    s_cbranch_scc1 rot_59
    s_cmp_eq_u32 s4, 3
    s_cbranch_scc1 rot_60
    ds_read_b64_tr_b16 a[24:25], v32 offset:49152
    ds_read_b64_tr_b16 a[26:27], v32 offset:49664
    ds_read_b64_tr_b16 a[28:29], v32 offset:57344
    ds_read_b64_tr_b16 a[30:31], v32 offset:57856
    ds_read_b64_tr_b16 a[88:89], v33 offset:49152
    ds_read_b64_tr_b16 a[90:91], v33 offset:49664
    ds_read_b64_tr_b16 a[92:93], v33 offset:57344
    ds_read_b64_tr_b16 a[94:95], v33 offset:57856
    s_branch rote_61
rot_58:
    ds_read_b64_tr_b16 a[8:9], v32 offset:49152
    ds_read_b64_tr_b16 a[10:11], v32 offset:49664
    ds_read_b64_tr_b16 a[12:13], v32 offset:57344
    ds_read_b64_tr_b16 a[14:15], v32 offset:57856
    ds_read_b64_tr_b16 a[72:73], v33 offset:49152
    ds_read_b64_tr_b16 a[74:75], v33 offset:49664
    ds_read_b64_tr_b16 a[76:77], v33 offset:57344
    ds_read_b64_tr_b16 a[78:79], v33 offset:57856
    s_branch rote_61
rot_59:
    ds_read_b64_tr_b16 a[56:57], v32 offset:49152
    ds_read_b64_tr_b16 a[58:59], v32 offset:49664
    ds_read_b64_tr_b16 a[60:61], v32 offset:57344
    ds_read_b64_tr_b16 a[62:63], v32 offset:57856
    ds_read_b64_tr_b16 a[120:121], v33 offset:49152
    ds_read_b64_tr_b16 a[122:123], v33 offset:49664
    ds_read_b64_tr_b16 a[124:125], v33 offset:57344
    ds_read_b64_tr_b16 a[126:127], v33 offset:57856
    s_branch rote_61
rot_60:
    ds_read_b64_tr_b16 a[40:41], v32 offset:49152
    ds_read_b64_tr_b16 a[42:43], v32 offset:49664
    ds_read_b64_tr_b16 a[44:45], v32 offset:57344
    ds_read_b64_tr_b16 a[46:47], v32 offset:57856
    ds_read_b64_tr_b16 a[104:105], v33 offset:49152
    ds_read_b64_tr_b16 a[106:107], v33 offset:49664
    ds_read_b64_tr_b16 a[108:109], v33 offset:57344
    ds_read_b64_tr_b16 a[110:111], v33 offset:57856
rote_61:
    s_waitcnt lgkmcnt(0)
    s_waitcnt vmcnt(25)
    s_barrier
    s_add_u32 s58, s14, 768
    s_addc_u32 s59, s15, 0
    s_lshl_b32 s54, s4, 12
    s_add_u32 m0, s54, 49152
    s_nop 0
    global_load_lds_dwordx4 v28, s[58:59] nt
    s_add_u32 m0, s54, 50176
    s_nop 0
    global_load_lds_dwordx4 v29, s[58:59] nt
    s_add_u32 m0, s54, 51200
    s_nop 0
    global_load_lds_dwordx4 v30, s[58:59] nt
    s_add_u32 m0, s54, 52224
    s_nop 0
    global_load_lds_dwordx4 v31, s[58:59] nt
    s_cmp_eq_u32 s4, 1
    s_cbranch_scc1 rot_63
    s_cmp_eq_u32 s4, 2
    s_cbranch_scc1 rot_64
    s_cmp_eq_u32 s4, 3
    s_cbranch_scc1 rot_65
    v_add_u32 v54, 65536, v32
    ds_read_b64_tr_b16 a[32:33], v54 offset:0
    v_add_u32 v54, 65536, v32
    ds_read_b64_tr_b16 a[34:35], v54 offset:512
    v_add_u32 v54, 65536, v32
    ds_read_b64_tr_b16 a[36:37], v54 offset:8192
    v_add_u32 v54, 65536, v32
    ds_read_b64_tr_b16 a[38:39], v54 offset:8704
    v_add_u32 v54, 65536, v33
    ds_read_b64_tr_b16 a[96:97], v54 offset:0
    v_add_u32 v54, 65536, v33
    ds_read_b64_tr_b16 a[98:99], v54 offset:512
    v_add_u32 v54, 65536, v33
    ds_read_b64_tr_b16 a[100:101], v54 offset:8192
    v_add_u32 v54, 65536, v33
    ds_read_b64_tr_b16 a[102:103], v54 offset:8704
    s_branch rote_66
rot_63:
    v_add_u32 v54, 65536, v32
    ds_read_b64_tr_b16 a[16:17], v54 offset:0
    v_add_u32 v54, 65536, v32
    ds_read_b64_tr_b16 a[18:19], v54 offset:512
    v_add_u32 v54, 65536, v32
    ds_read_b64_tr_b16 a[20:21], v54 offset:8192
    v_add_u32 v54, 65536, v32
    ds_read_b64_tr_b16 a[22:23], v54 offset:8704
    v_add_u32 v54, 65536, v33
    ds_read_b64_tr_b16 a[80:81], v54 offset:0
    v_add_u32 v54, 65536, v33
    ds_read_b64_tr_b16 a[82:83], v54 offset:512
    v_add_u32 v54, 65536, v33
    ds_read_b64_tr_b16 a[84:85], v54 offset:8192
    v_add_u32 v54, 65536, v33
    ds_read_b64_tr_b16 a[86:87], v54 offset:8704
    s_branch rote_66
rot_64:
    v_add_u32 v54, 65536, v32
    ds_read_b64_tr_b16 a[0:1], v54 offset:0
    v_add_u32 v54, 65536, v32
    ds_read_b64_tr_b16 a[2:3], v54 offset:512
    v_add_u32 v54, 65536, v32
    ds_read_b64_tr_b16 a[4:5], v54 offset:8192
    v_add_u32 v54, 65536, v32
    ds_read_b64_tr_b16 a[6:7], v54 offset:8704
    v_add_u32 v54, 65536, v33
    ds_read_b64_tr_b16 a[64:65], v54 offset:0
    v_add_u32 v54, 65536, v33
    ds_read_b64_tr_b16 a[66:67], v54 offset:512
    v_add_u32 v54, 65536, v33
    ds_read_b64_tr_b16 a[68:69], v54 offset:8192
    v_add_u32 v54, 65536, v33
    ds_read_b64_tr_b16 a[70:71], v54 offset:8704
    s_branch rote_66
rot_65:
    v_add_u32 v54, 65536, v32
    ds_read_b64_tr_b16 a[48:49], v54 offset:0
    v_add_u32 v54, 65536, v32
    ds_read_b64_tr_b16 a[50:51], v54 offset:512
    v_add_u32 v54, 65536, v32
    ds_read_b64_tr_b16 a[52:53], v54 offset:8192
    v_add_u32 v54, 65536, v32
    ds_read_b64_tr_b16 a[54:55], v54 offset:8704
    v_add_u32 v54, 65536, v33
    ds_read_b64_tr_b16 a[112:113], v54 offset:0
    v_add_u32 v54, 65536, v33
    ds_read_b64_tr_b16 a[114:115], v54 offset:512
    v_add_u32 v54, 65536, v33
    ds_read_b64_tr_b16 a[116:117], v54 offset:8192
    v_add_u32 v54, 65536, v33
    ds_read_b64_tr_b16 a[118:119], v54 offset:8704
rote_66:
    s_waitcnt lgkmcnt(0)
    s_waitcnt vmcnt(25)
    s_barrier
    s_add_u32 s58, s14, 65536
    s_addc_u32 s59, s15, 0
    s_lshl_b32 s54, s4, 12
    s_add_u32 m0, s54, 65536
    s_nop 0
    global_load_lds_dwordx4 v28, s[58:59] nt
    s_add_u32 m0, s54, 66560
    s_nop 0
    global_load_lds_dwordx4 v29, s[58:59] nt
    s_add_u32 m0, s54, 67584
    s_nop 0
    global_load_lds_dwordx4 v30, s[58:59] nt
    s_add_u32 m0, s54, 68608
    s_nop 0
    global_load_lds_dwordx4 v31, s[58:59] nt
    s_cmp_eq_u32 s4, 1
    s_cbranch_scc1 rot_68
    s_cmp_eq_u32 s4, 2
    s_cbranch_scc1 rot_69
    s_cmp_eq_u32 s4, 3
    s_cbranch_scc1 rot_70
    v_add_u32 v54, 65536, v32
    ds_read_b64_tr_b16 a[40:41], v54 offset:16384
    v_add_u32 v54, 65536, v32
    ds_read_b64_tr_b16 a[42:43], v54 offset:16896
    v_add_u32 v54, 65536, v32
    ds_read_b64_tr_b16 a[44:45], v54 offset:24576
    v_add_u32 v54, 65536, v32
    ds_read_b64_tr_b16 a[46:47], v54 offset:25088
    v_add_u32 v54, 65536, v33
    ds_read_b64_tr_b16 a[104:105], v54 offset:16384
    v_add_u32 v54, 65536, v33
    ds_read_b64_tr_b16 a[106:107], v54 offset:16896
    v_add_u32 v54, 65536, v33
    ds_read_b64_tr_b16 a[108:109], v54 offset:24576
    v_add_u32 v54, 65536, v33
    ds_read_b64_tr_b16 a[110:111], v54 offset:25088
    s_branch rote_71
rot_68:
    v_add_u32 v54, 65536, v32
    ds_read_b64_tr_b16 a[24:25], v54 offset:16384
    v_add_u32 v54, 65536, v32
    ds_read_b64_tr_b16 a[26:27], v54 offset:16896
    v_add_u32 v54, 65536, v32
    ds_read_b64_tr_b16 a[28:29], v54 offset:24576
    v_add_u32 v54, 65536, v32
    ds_read_b64_tr_b16 a[30:31], v54 offset:25088
    v_add_u32 v54, 65536, v33
    ds_read_b64_tr_b16 a[88:89], v54 offset:16384
    v_add_u32 v54, 65536, v33
    ds_read_b64_tr_b16 a[90:91], v54 offset:16896
    v_add_u32 v54, 65536, v33
    ds_read_b64_tr_b16 a[92:93], v54 offset:24576
    v_add_u32 v54, 65536, v33
    ds_read_b64_tr_b16 a[94:95], v54 offset:25088
    s_branch rote_71
rot_69:
    v_add_u32 v54, 65536, v32
    ds_read_b64_tr_b16 a[8:9], v54 offset:16384
    v_add_u32 v54, 65536, v32
    ds_read_b64_tr_b16 a[10:11], v54 offset:16896
    v_add_u32 v54, 65536, v32
    ds_read_b64_tr_b16 a[12:13], v54 offset:24576
    v_add_u32 v54, 65536, v32
    ds_read_b64_tr_b16 a[14:15], v54 offset:25088
    v_add_u32 v54, 65536, v33
    ds_read_b64_tr_b16 a[72:73], v54 offset:16384
    v_add_u32 v54, 65536, v33
    ds_read_b64_tr_b16 a[74:75], v54 offset:16896
    v_add_u32 v54, 65536, v33
    ds_read_b64_tr_b16 a[76:77], v54 offset:24576
    v_add_u32 v54, 65536, v33
    ds_read_b64_tr_b16 a[78:79], v54 offset:25088
    s_branch rote_71
rot_70:
    v_add_u32 v54, 65536, v32
    ds_read_b64_tr_b16 a[56:57], v54 offset:16384
    v_add_u32 v54, 65536, v32
    ds_read_b64_tr_b16 a[58:59], v54 offset:16896
    v_add_u32 v54, 65536, v32
    ds_read_b64_tr_b16 a[60:61], v54 offset:24576
    v_add_u32 v54, 65536, v32
    ds_read_b64_tr_b16 a[62:63], v54 offset:25088
    v_add_u32 v54, 65536, v33
    ds_read_b64_tr_b16 a[120:121], v54 offset:16384
    v_add_u32 v54, 65536, v33
    ds_read_b64_tr_b16 a[122:123], v54 offset:16896
    v_add_u32 v54, 65536, v33
    ds_read_b64_tr_b16 a[124:125], v54 offset:24576
    v_add_u32 v54, 65536, v33
    ds_read_b64_tr_b16 a[126:127], v54 offset:25088
rote_71:
    s_waitcnt lgkmcnt(0)
    s_waitcnt vmcnt(25)
    s_barrier
    s_add_u32 s58, s14, 65792
    s_addc_u32 s59, s15, 0
    s_lshl_b32 s54, s4, 12
    s_add_u32 m0, s54, 81920
    s_nop 0
    global_load_lds_dwordx4 v28, s[58:59] nt
    s_add_u32 m0, s54, 82944
    s_nop 0
    global_load_lds_dwordx4 v29, s[58:59] nt
    s_add_u32 m0, s54, 83968
    s_nop 0
    global_load_lds_dwordx4 v30, s[58:59] nt
    s_add_u32 m0, s54, 84992
    s_nop 0
    global_load_lds_dwordx4 v31, s[58:59] nt
    s_cmp_eq_u32 s4, 1
    s_cbranch_scc1 rot_73
    s_cmp_eq_u32 s4, 2
    s_cbranch_scc1 rot_74
    s_cmp_eq_u32 s4, 3
    s_cbranch_scc1 rot_75
    v_add_u32 v54, 65536, v32
    ds_read_b64_tr_b16 a[48:49], v54 offset:32768
    v_add_u32 v54, 65536, v32
    ds_read_b64_tr_b16 a[50:51], v54 offset:33280
    v_add_u32 v54, 65536, v32
    ds_read_b64_tr_b16 a[52:53], v54 offset:40960
    v_add_u32 v54, 65536, v32
    ds_read_b64_tr_b16 a[54:55], v54 offset:41472
    v_add_u32 v54, 65536, v33
    ds_read_b64_tr_b16 a[112:113], v54 offset:32768
    v_add_u32 v54, 65536, v33
    ds_read_b64_tr_b16 a[114:115], v54 offset:33280
    v_add_u32 v54, 65536, v33
    ds_read_b64_tr_b16 a[116:117], v54 offset:40960
    v_add_u32 v54, 65536, v33
    ds_read_b64_tr_b16 a[118:119], v54 offset:41472
    s_branch rote_76
rot_73:
    v_add_u32 v54, 65536, v32
    ds_read_b64_tr_b16 a[32:33], v54 offset:32768
    v_add_u32 v54, 65536, v32
    ds_read_b64_tr_b16 a[34:35], v54 offset:33280
    v_add_u32 v54, 65536, v32
    ds_read_b64_tr_b16 a[36:37], v54 offset:40960
    v_add_u32 v54, 65536, v32
    ds_read_b64_tr_b16 a[38:39], v54 offset:41472
    v_add_u32 v54, 65536, v33
    ds_read_b64_tr_b16 a[96:97], v54 offset:32768
    v_add_u32 v54, 65536, v33
    ds_read_b64_tr_b16 a[98:99], v54 offset:33280
    v_add_u32 v54, 65536, v33
    ds_read_b64_tr_b16 a[100:101], v54 offset:40960
    v_add_u32 v54, 65536, v33
    ds_read_b64_tr_b16 a[102:103], v54 offset:41472
    s_branch rote_76
rot_74:
    v_add_u32 v54, 65536, v32
    ds_read_b64_tr_b16 a[16:17], v54 offset:32768
    v_add_u32 v54, 65536, v32
    ds_read_b64_tr_b16 a[18:19], v54 offset:33280
    v_add_u32 v54, 65536, v32
    ds_read_b64_tr_b16 a[20:21], v54 offset:40960
    v_add_u32 v54, 65536, v32
    ds_read_b64_tr_b16 a[22:23], v54 offset:41472
    v_add_u32 v54, 65536, v33
    ds_read_b64_tr_b16 a[80:81], v54 offset:32768
    v_add_u32 v54, 65536, v33
    ds_read_b64_tr_b16 a[82:83], v54 offset:33280
    v_add_u32 v54, 65536, v33
    ds_read_b64_tr_b16 a[84:85], v54 offset:40960
    v_add_u32 v54, 65536, v33
    ds_read_b64_tr_b16 a[86:87], v54 offset:41472
    s_branch rote_76
rot_75:
    v_add_u32 v54, 65536, v32
    ds_read_b64_tr_b16 a[0:1], v54 offset:32768
    v_add_u32 v54, 65536, v32
    ds_read_b64_tr_b16 a[2:3], v54 offset:33280
    v_add_u32 v54, 65536, v32
    ds_read_b64_tr_b16 a[4:5], v54 offset:40960
    v_add_u32 v54, 65536, v32
    ds_read_b64_tr_b16 a[6:7], v54 offset:41472
    v_add_u32 v54, 65536, v33
    ds_read_b64_tr_b16 a[64:65], v54 offset:32768
    v_add_u32 v54, 65536, v33
    ds_read_b64_tr_b16 a[66:67], v54 offset:33280
    v_add_u32 v54, 65536, v33
    ds_read_b64_tr_b16 a[68:69], v54 offset:40960
    v_add_u32 v54, 65536, v33
    ds_read_b64_tr_b16 a[70:71], v54 offset:41472
rote_76:
    s_waitcnt lgkmcnt(0)
    s_waitcnt vmcnt(25)
    s_barrier
    s_add_u32 s58, s14, 66048
    s_addc_u32 s59, s15, 0
    s_lshl_b32 s54, s4, 12
    s_add_u32 m0, s54, 98304
    s_nop 0
    global_load_lds_dwordx4 v28, s[58:59] nt
    s_add_u32 m0, s54, 99328
    s_nop 0
    global_load_lds_dwordx4 v29, s[58:59] nt
    s_add_u32 m0, s54, 100352
    s_nop 0
    global_load_lds_dwordx4 v30, s[58:59] nt
    s_add_u32 m0, s54, 101376
    s_nop 0
    global_load_lds_dwordx4 v31, s[58:59] nt
    s_cmp_eq_u32 s4, 1
    s_cbranch_scc1 rot_78
    s_cmp_eq_u32 s4, 2
    s_cbranch_scc1 rot_79
    s_cmp_eq_u32 s4, 3
    s_cbranch_scc1 rot_80
    v_add_u32 v54, 65536, v32
    ds_read_b64_tr_b16 a[56:57], v54 offset:49152
    v_add_u32 v54, 65536, v32
    ds_read_b64_tr_b16 a[58:59], v54 offset:49664
    v_add_u32 v54, 65536, v32
    ds_read_b64_tr_b16 a[60:61], v54 offset:57344
    v_add_u32 v54, 65536, v32
    ds_read_b64_tr_b16 a[62:63], v54 offset:57856
    v_add_u32 v54, 65536, v33
    ds_read_b64_tr_b16 a[120:121], v54 offset:49152
    v_add_u32 v54, 65536, v33
    ds_read_b64_tr_b16 a[122:123], v54 offset:49664
    v_add_u32 v54, 65536, v33
    ds_read_b64_tr_b16 a[124:125], v54 offset:57344
    v_add_u32 v54, 65536, v33
    ds_read_b64_tr_b16 a[126:127], v54 offset:57856
    s_branch rote_81
rot_78:
    v_add_u32 v54, 65536, v32
    ds_read_b64_tr_b16 a[40:41], v54 offset:49152
    v_add_u32 v54, 65536, v32
    ds_read_b64_tr_b16 a[42:43], v54 offset:49664
    v_add_u32 v54, 65536, v32
    ds_read_b64_tr_b16 a[44:45], v54 offset:57344
    v_add_u32 v54, 65536, v32
    ds_read_b64_tr_b16 a[46:47], v54 offset:57856
    v_add_u32 v54, 65536, v33
    ds_read_b64_tr_b16 a[104:105], v54 offset:49152
    v_add_u32 v54, 65536, v33
    ds_read_b64_tr_b16 a[106:107], v54 offset:49664
    v_add_u32 v54, 65536, v33
    ds_read_b64_tr_b16 a[108:109], v54 offset:57344
    v_add_u32 v54, 65536, v33
    ds_read_b64_tr_b16 a[110:111], v54 offset:57856
    s_branch rote_81
rot_79:
    v_add_u32 v54, 65536, v32
    ds_read_b64_tr_b16 a[24:25], v54 offset:49152
    v_add_u32 v54, 65536, v32
    ds_read_b64_tr_b16 a[26:27], v54 offset:49664
    v_add_u32 v54, 65536, v32
    ds_read_b64_tr_b16 a[28:29], v54 offset:57344
    v_add_u32 v54, 65536, v32
    ds_read_b64_tr_b16 a[30:31], v54 offset:57856
    v_add_u32 v54, 65536, v33
    ds_read_b64_tr_b16 a[88:89], v54 offset:49152
    v_add_u32 v54, 65536, v33
    ds_read_b64_tr_b16 a[90:91], v54 offset:49664
    v_add_u32 v54, 65536, v33
    ds_read_b64_tr_b16 a[92:93], v54 offset:57344
    v_add_u32 v54, 65536, v33
    ds_read_b64_tr_b16 a[94:95], v54 offset:57856
    s_branch rote_81
rot_80:
    v_add_u32 v54, 65536, v32
    ds_read_b64_tr_b16 a[8:9], v54 offset:49152
    v_add_u32 v54, 65536, v32
    ds_read_b64_tr_b16 a[10:11], v54 offset:49664
    v_add_u32 v54, 65536, v32
    ds_read_b64_tr_b16 a[12:13], v54 offset:57344
    v_add_u32 v54, 65536, v32
    ds_read_b64_tr_b16 a[14:15], v54 offset:57856
    v_add_u32 v54, 65536, v33
    ds_read_b64_tr_b16 a[72:73], v54 offset:49152
    v_add_u32 v54, 65536, v33
    ds_read_b64_tr_b16 a[74:75], v54 offset:49664
    v_add_u32 v54, 65536, v33
    ds_read_b64_tr_b16 a[76:77], v54 offset:57344
    v_add_u32 v54, 65536, v33
    ds_read_b64_tr_b16 a[78:79], v54 offset:57856
rote_81:
    s_waitcnt lgkmcnt(0)
    s_waitcnt vmcnt(24)
    s_barrier
    s_add_u32 s58, s14, 66304
    s_addc_u32 s59, s15, 0
    s_lshl_b32 s54, s4, 12
    s_add_u32 m0, s54, 114688
    s_nop 0
    global_load_lds_dwordx4 v28, s[58:59] nt
    s_add_u32 m0, s54, 115712
    s_nop 0
    global_load_lds_dwordx4 v29, s[58:59] nt
    s_add_u32 m0, s54, 116736
    s_nop 0
    global_load_lds_dwordx4 v30, s[58:59] nt
    s_add_u32 m0, s54, 117760
    s_nop 0
    global_load_lds_dwordx4 v31, s[58:59] nt
    s_cmp_lg_u32 s4, 0
    s_cbranch_scc1 wo_82
    ds_read_b64_tr_b16 a[128:129], v34 offset:0
    ds_read_b64_tr_b16 a[130:131], v34 offset:512
    ds_read_b64_tr_b16 a[132:133], v34 offset:2048
    ds_read_b64_tr_b16 a[134:135], v34 offset:2560
    s_waitcnt lgkmcnt(0)
    ds_read_b64_tr_b16 a[144:145], v35 offset:0
    ds_read_b64_tr_b16 a[146:147], v35 offset:512
    ds_read_b64_tr_b16 a[148:149], v35 offset:2048
    ds_read_b64_tr_b16 a[150:151], v35 offset:2560
    s_waitcnt lgkmcnt(0)
    ds_read_b64_tr_b16 a[160:161], v36 offset:0
    ds_read_b64_tr_b16 a[162:163], v36 offset:512
    ds_read_b64_tr_b16 a[164:165], v36 offset:2048
    ds_read_b64_tr_b16 a[166:167], v36 offset:2560
    s_waitcnt lgkmcnt(0)
    ds_read_b64_tr_b16 a[176:177], v37 offset:0
    ds_read_b64_tr_b16 a[178:179], v37 offset:512
    ds_read_b64_tr_b16 a[180:181], v37 offset:2048
    ds_read_b64_tr_b16 a[182:183], v37 offset:2560
    s_waitcnt lgkmcnt(0)
    ds_read_b64_tr_b16 a[192:193], v38 offset:0
    ds_read_b64_tr_b16 a[194:195], v38 offset:512
    ds_read_b64_tr_b16 a[196:197], v38 offset:2048
    ds_read_b64_tr_b16 a[198:199], v38 offset:2560
    s_waitcnt lgkmcnt(0)
    ds_read_b64_tr_b16 a[208:209], v39 offset:0
    ds_read_b64_tr_b16 a[210:211], v39 offset:512
    ds_read_b64_tr_b16 a[212:213], v39 offset:2048
    ds_read_b64_tr_b16 a[214:215], v39 offset:2560
    s_waitcnt lgkmcnt(0)
    ds_read_b64_tr_b16 a[224:225], v40 offset:0
    ds_read_b64_tr_b16 a[226:227], v40 offset:512
    ds_read_b64_tr_b16 a[228:229], v40 offset:2048
    ds_read_b64_tr_b16 a[230:231], v40 offset:2560
    s_waitcnt lgkmcnt(0)
    ds_read_b64_tr_b16 a[240:241], v41 offset:0
    ds_read_b64_tr_b16 a[242:243], v41 offset:512
    ds_read_b64_tr_b16 a[244:245], v41 offset:2048
    ds_read_b64_tr_b16 a[246:247], v41 offset:2560
    s_waitcnt lgkmcnt(0)
wo_82:
    s_waitcnt vmcnt(24)
    s_barrier
    s_add_u32 s58, s10, 0
    s_addc_u32 s59, s11, 0
    s_lshl_b32 s54, s4, 12
    s_add_u32 m0, s54, 0
    s_nop 0
    global_load_lds_dwordx4 v24, s[58:59] nt
    s_add_u32 m0, s54, 1024
    s_nop 0
    global_load_lds_dwordx4 v25, s[58:59] nt
    s_add_u32 m0, s54, 2048
    s_nop 0
    global_load_lds_dwordx4 v26, s[58:59] nt
    s_add_u32 m0, s54, 3072
    s_nop 0
    global_load_lds_dwordx4 v27, s[58:59] nt
    s_cmp_lg_u32 s4, 1
    s_cbranch_scc1 wo_83
    ds_read_b64_tr_b16 a[128:129], v34 offset:16384
    ds_read_b64_tr_b16 a[130:131], v34 offset:16896
    ds_read_b64_tr_b16 a[132:133], v34 offset:18432
    ds_read_b64_tr_b16 a[134:135], v34 offset:18944
    s_waitcnt lgkmcnt(0)
    ds_read_b64_tr_b16 a[144:145], v35 offset:16384
    ds_read_b64_tr_b16 a[146:147], v35 offset:16896
    ds_read_b64_tr_b16 a[148:149], v35 offset:18432
    ds_read_b64_tr_b16 a[150:151], v35 offset:18944
    s_waitcnt lgkmcnt(0)
    ds_read_b64_tr_b16 a[160:161], v36 offset:16384
    ds_read_b64_tr_b16 a[162:163], v36 offset:16896
    ds_read_b64_tr_b16 a[164:165], v36 offset:18432
    ds_read_b64_tr_b16 a[166:167], v36 offset:18944
    s_waitcnt lgkmcnt(0)
    ds_read_b64_tr_b16 a[176:177], v37 offset:16384
    ds_read_b64_tr_b16 a[178:179], v37 offset:16896
    ds_read_b64_tr_b16 a[180:181], v37 offset:18432
    ds_read_b64_tr_b16 a[182:183], v37 offset:18944
    s_waitcnt lgkmcnt(0)
    ds_read_b64_tr_b16 a[192:193], v38 offset:16384
    ds_read_b64_tr_b16 a[194:195], v38 offset:16896
    ds_read_b64_tr_b16 a[196:197], v38 offset:18432
    ds_read_b64_tr_b16 a[198:199], v38 offset:18944
    s_waitcnt lgkmcnt(0)
    ds_read_b64_tr_b16 a[208:209], v39 offset:16384
    ds_read_b64_tr_b16 a[210:211], v39 offset:16896
    ds_read_b64_tr_b16 a[212:213], v39 offset:18432
    ds_read_b64_tr_b16 a[214:215], v39 offset:18944
    s_waitcnt lgkmcnt(0)
    ds_read_b64_tr_b16 a[224:225], v40 offset:16384
    ds_read_b64_tr_b16 a[226:227], v40 offset:16896
    ds_read_b64_tr_b16 a[228:229], v40 offset:18432
    ds_read_b64_tr_b16 a[230:231], v40 offset:18944
    s_waitcnt lgkmcnt(0)
    ds_read_b64_tr_b16 a[240:241], v41 offset:16384
    ds_read_b64_tr_b16 a[242:243], v41 offset:16896
    ds_read_b64_tr_b16 a[244:245], v41 offset:18432
    ds_read_b64_tr_b16 a[246:247], v41 offset:18944
    s_waitcnt lgkmcnt(0)
wo_83:
    s_waitcnt vmcnt(24)
    s_barrier
    s_add_u32 s58, s10, 524288
    s_addc_u32 s59, s11, 0
    s_lshl_b32 s54, s4, 12
    s_add_u32 m0, s54, 16384
    s_nop 0
    global_load_lds_dwordx4 v24, s[58:59] nt
    s_add_u32 m0, s54, 17408
    s_nop 0
    global_load_lds_dwordx4 v25, s[58:59] nt
    s_add_u32 m0, s54, 18432
    s_nop 0
    global_load_lds_dwordx4 v26, s[58:59] nt
    s_add_u32 m0, s54, 19456
    s_nop 0
    global_load_lds_dwordx4 v27, s[58:59] nt
    s_cmp_lg_u32 s4, 2
    s_cbranch_scc1 wo_84
    ds_read_b64_tr_b16 a[128:129], v34 offset:32768
    ds_read_b64_tr_b16 a[130:131], v34 offset:33280
    ds_read_b64_tr_b16 a[132:133], v34 offset:34816
    ds_read_b64_tr_b16 a[134:135], v34 offset:35328
    s_waitcnt lgkmcnt(0)
    ds_read_b64_tr_b16 a[144:145], v35 offset:32768
    ds_read_b64_tr_b16 a[146:147], v35 offset:33280
    ds_read_b64_tr_b16 a[148:149], v35 offset:34816
    ds_read_b64_tr_b16 a[150:151], v35 offset:35328
    s_waitcnt lgkmcnt(0)
    ds_read_b64_tr_b16 a[160:161], v36 offset:32768
    ds_read_b64_tr_b16 a[162:163], v36 offset:33280
    ds_read_b64_tr_b16 a[164:165], v36 offset:34816
    ds_read_b64_tr_b16 a[166:167], v36 offset:35328
    s_waitcnt lgkmcnt(0)
    ds_read_b64_tr_b16 a[176:177], v37 offset:32768
    ds_read_b64_tr_b16 a[178:179], v37 offset:33280
    ds_read_b64_tr_b16 a[180:181], v37 offset:34816
    ds_read_b64_tr_b16 a[182:183], v37 offset:35328
    s_waitcnt lgkmcnt(0)
    ds_read_b64_tr_b16 a[192:193], v38 offset:32768
    ds_read_b64_tr_b16 a[194:195], v38 offset:33280
    ds_read_b64_tr_b16 a[196:197], v38 offset:34816
    ds_read_b64_tr_b16 a[198:199], v38 offset:35328
    s_waitcnt lgkmcnt(0)
    ds_read_b64_tr_b16 a[208:209], v39 offset:32768
    ds_read_b64_tr_b16 a[210:211], v39 offset:33280
    ds_read_b64_tr_b16 a[212:213], v39 offset:34816
    ds_read_b64_tr_b16 a[214:215], v39 offset:35328
    s_waitcnt lgkmcnt(0)
    ds_read_b64_tr_b16 a[224:225], v40 offset:32768
    ds_read_b64_tr_b16 a[226:227], v40 offset:33280
    ds_read_b64_tr_b16 a[228:229], v40 offset:34816
    ds_read_b64_tr_b16 a[230:231], v40 offset:35328
    s_waitcnt lgkmcnt(0)
    ds_read_b64_tr_b16 a[240:241], v41 offset:32768
    ds_read_b64_tr_b16 a[242:243], v41 offset:33280
    ds_read_b64_tr_b16 a[244:245], v41 offset:34816
    ds_read_b64_tr_b16 a[246:247], v41 offset:35328
    s_waitcnt lgkmcnt(0)
wo_84:
    s_waitcnt vmcnt(24)
    s_barrier
    s_add_u32 s58, s10, 1048576
    s_addc_u32 s59, s11, 0
    s_lshl_b32 s54, s4, 12
    s_add_u32 m0, s54, 32768
    s_nop 0
    global_load_lds_dwordx4 v24, s[58:59] nt
    s_add_u32 m0, s54, 33792
    s_nop 0
    global_load_lds_dwordx4 v25, s[58:59] nt
    s_add_u32 m0, s54, 34816
    s_nop 0
    global_load_lds_dwordx4 v26, s[58:59] nt
    s_add_u32 m0, s54, 35840
    s_nop 0
    global_load_lds_dwordx4 v27, s[58:59] nt
    s_cmp_lg_u32 s4, 3
    s_cbranch_scc1 wo_85
    ds_read_b64_tr_b16 a[128:129], v34 offset:49152
    ds_read_b64_tr_b16 a[130:131], v34 offset:49664
    ds_read_b64_tr_b16 a[132:133], v34 offset:51200
    ds_read_b64_tr_b16 a[134:135], v34 offset:51712
    s_waitcnt lgkmcnt(0)
    ds_read_b64_tr_b16 a[144:145], v35 offset:49152
    ds_read_b64_tr_b16 a[146:147], v35 offset:49664
    ds_read_b64_tr_b16 a[148:149], v35 offset:51200
    ds_read_b64_tr_b16 a[150:151], v35 offset:51712
    s_waitcnt lgkmcnt(0)
    ds_read_b64_tr_b16 a[160:161], v36 offset:49152
    ds_read_b64_tr_b16 a[162:163], v36 offset:49664
    ds_read_b64_tr_b16 a[164:165], v36 offset:51200
    ds_read_b64_tr_b16 a[166:167], v36 offset:51712
    s_waitcnt lgkmcnt(0)
    ds_read_b64_tr_b16 a[176:177], v37 offset:49152
    ds_read_b64_tr_b16 a[178:179], v37 offset:49664
    ds_read_b64_tr_b16 a[180:181], v37 offset:51200
    ds_read_b64_tr_b16 a[182:183], v37 offset:51712
    s_waitcnt lgkmcnt(0)
    ds_read_b64_tr_b16 a[192:193], v38 offset:49152
    ds_read_b64_tr_b16 a[194:195], v38 offset:49664
    ds_read_b64_tr_b16 a[196:197], v38 offset:51200
    ds_read_b64_tr_b16 a[198:199], v38 offset:51712
    s_waitcnt lgkmcnt(0)
    ds_read_b64_tr_b16 a[208:209], v39 offset:49152
    ds_read_b64_tr_b16 a[210:211], v39 offset:49664
    ds_read_b64_tr_b16 a[212:213], v39 offset:51200
    ds_read_b64_tr_b16 a[214:215], v39 offset:51712
    s_waitcnt lgkmcnt(0)
    ds_read_b64_tr_b16 a[224:225], v40 offset:49152
    ds_read_b64_tr_b16 a[226:227], v40 offset:49664
    ds_read_b64_tr_b16 a[228:229], v40 offset:51200
    ds_read_b64_tr_b16 a[230:231], v40 offset:51712
    s_waitcnt lgkmcnt(0)
    ds_read_b64_tr_b16 a[240:241], v41 offset:49152
    ds_read_b64_tr_b16 a[242:243], v41 offset:49664
    ds_read_b64_tr_b16 a[244:245], v41 offset:51200
    ds_read_b64_tr_b16 a[246:247], v41 offset:51712
    s_waitcnt lgkmcnt(0)
wo_85:
    s_waitcnt vmcnt(24)
    s_barrier
    s_add_u32 s58, s10, 1572864
    s_addc_u32 s59, s11, 0
    s_lshl_b32 s54, s4, 12
    s_add_u32 m0, s54, 49152
    s_nop 0
    global_load_lds_dwordx4 v24, s[58:59] nt
    s_add_u32 m0, s54, 50176
    s_nop 0
    global_load_lds_dwordx4 v25, s[58:59] nt
    s_add_u32 m0, s54, 51200
    s_nop 0
    global_load_lds_dwordx4 v26, s[58:59] nt
    s_add_u32 m0, s54, 52224
    s_nop 0
    global_load_lds_dwordx4 v27, s[58:59] nt
    s_cmp_lg_u32 s4, 0
    s_cbranch_scc1 wo_86
    v_add_u32 v54, 65536, v34
    ds_read_b64_tr_b16 a[136:137], v54 offset:0
    v_add_u32 v54, 65536, v34
    ds_read_b64_tr_b16 a[138:139], v54 offset:512
    v_add_u32 v54, 65536, v34
    ds_read_b64_tr_b16 a[140:141], v54 offset:2048
    v_add_u32 v54, 65536, v34
    ds_read_b64_tr_b16 a[142:143], v54 offset:2560
    s_waitcnt lgkmcnt(0)
    v_add_u32 v54, 65536, v35
    ds_read_b64_tr_b16 a[152:153], v54 offset:0
    v_add_u32 v54, 65536, v35
    ds_read_b64_tr_b16 a[154:155], v54 offset:512
    v_add_u32 v54, 65536, v35
    ds_read_b64_tr_b16 a[156:157], v54 offset:2048
    v_add_u32 v54, 65536, v35
    ds_read_b64_tr_b16 a[158:159], v54 offset:2560
    s_waitcnt lgkmcnt(0)
    v_add_u32 v54, 65536, v36
    ds_read_b64_tr_b16 a[168:169], v54 offset:0
    v_add_u32 v54, 65536, v36
    ds_read_b64_tr_b16 a[170:171], v54 offset:512
    v_add_u32 v54, 65536, v36
    ds_read_b64_tr_b16 a[172:173], v54 offset:2048
    v_add_u32 v54, 65536, v36
    ds_read_b64_tr_b16 a[174:175], v54 offset:2560
    s_waitcnt lgkmcnt(0)
    v_add_u32 v54, 65536, v37
    ds_read_b64_tr_b16 a[184:185], v54 offset:0
    v_add_u32 v54, 65536, v37
    ds_read_b64_tr_b16 a[186:187], v54 offset:512
    v_add_u32 v54, 65536, v37
    ds_read_b64_tr_b16 a[188:189], v54 offset:2048
    v_add_u32 v54, 65536, v37
    ds_read_b64_tr_b16 a[190:191], v54 offset:2560
    s_waitcnt lgkmcnt(0)
    v_add_u32 v54, 65536, v38
    ds_read_b64_tr_b16 a[200:201], v54 offset:0
    v_add_u32 v54, 65536, v38
    ds_read_b64_tr_b16 a[202:203], v54 offset:512
    v_add_u32 v54, 65536, v38
    ds_read_b64_tr_b16 a[204:205], v54 offset:2048
    v_add_u32 v54, 65536, v38
    ds_read_b64_tr_b16 a[206:207], v54 offset:2560
    s_waitcnt lgkmcnt(0)
    v_add_u32 v54, 65536, v39
    ds_read_b64_tr_b16 a[216:217], v54 offset:0
    v_add_u32 v54, 65536, v39
    ds_read_b64_tr_b16 a[218:219], v54 offset:512
    v_add_u32 v54, 65536, v39
    ds_read_b64_tr_b16 a[220:221], v54 offset:2048
    v_add_u32 v54, 65536, v39
    ds_read_b64_tr_b16 a[222:223], v54 offset:2560
    s_waitcnt lgkmcnt(0)
    v_add_u32 v54, 65536, v40
    ds_read_b64_tr_b16 a[232:233], v54 offset:0
    v_add_u32 v54, 65536, v40
    ds_read_b64_tr_b16 a[234:235], v54 offset:512
    v_add_u32 v54, 65536, v40
    ds_read_b64_tr_b16 a[236:237], v54 offset:2048
    v_add_u32 v54, 65536, v40
    ds_read_b64_tr_b16 a[238:239], v54 offset:2560
    s_waitcnt lgkmcnt(0)
    v_add_u32 v54, 65536, v41
    ds_read_b64_tr_b16 a[248:249], v54 offset:0
    v_add_u32 v54, 65536, v41
    ds_read_b64_tr_b16 a[250:251], v54 offset:512
    v_add_u32 v54, 65536, v41
    ds_read_b64_tr_b16 a[252:253], v54 offset:2048
    v_add_u32 v54, 65536, v41
    ds_read_b64_tr_b16 a[254:255], v54 offset:2560
    s_waitcnt lgkmcnt(0)
wo_86:
    s_waitcnt vmcnt(24)
    s_barrier
    s_add_u32 s58, s10, 2097152
    s_addc_u32 s59, s11, 0
    s_lshl_b32 s54, s4, 12
    s_add_u32 m0, s54, 65536
    s_nop 0
    global_load_lds_dwordx4 v24, s[58:59] nt
    s_add_u32 m0, s54, 66560
    s_nop 0
    global_load_lds_dwordx4 v25, s[58:59] nt
    s_add_u32 m0, s54, 67584
    s_nop 0
    global_load_lds_dwordx4 v26, s[58:59] nt
    s_add_u32 m0, s54, 68608
    s_nop 0
    global_load_lds_dwordx4 v27, s[58:59] nt
    s_cmp_lg_u32 s4, 1
    s_cbranch_scc1 wo_87
    v_add_u32 v54, 65536, v34
    ds_read_b64_tr_b16 a[136:137], v54 offset:16384
    v_add_u32 v54, 65536, v34
    ds_read_b64_tr_b16 a[138:139], v54 offset:16896
    v_add_u32 v54, 65536, v34
    ds_read_b64_tr_b16 a[140:141], v54 offset:18432
    v_add_u32 v54, 65536, v34
    ds_read_b64_tr_b16 a[142:143], v54 offset:18944
    s_waitcnt lgkmcnt(0)
    v_add_u32 v54, 65536, v35
    ds_read_b64_tr_b16 a[152:153], v54 offset:16384
    v_add_u32 v54, 65536, v35
    ds_read_b64_tr_b16 a[154:155], v54 offset:16896
    v_add_u32 v54, 65536, v35
    ds_read_b64_tr_b16 a[156:157], v54 offset:18432
    v_add_u32 v54, 65536, v35
    ds_read_b64_tr_b16 a[158:159], v54 offset:18944
    s_waitcnt lgkmcnt(0)
    v_add_u32 v54, 65536, v36
    ds_read_b64_tr_b16 a[168:169], v54 offset:16384
    v_add_u32 v54, 65536, v36
    ds_read_b64_tr_b16 a[170:171], v54 offset:16896
    v_add_u32 v54, 65536, v36
    ds_read_b64_tr_b16 a[172:173], v54 offset:18432
    v_add_u32 v54, 65536, v36
    ds_read_b64_tr_b16 a[174:175], v54 offset:18944
    s_waitcnt lgkmcnt(0)
    v_add_u32 v54, 65536, v37
    ds_read_b64_tr_b16 a[184:185], v54 offset:16384
    v_add_u32 v54, 65536, v37
    ds_read_b64_tr_b16 a[186:187], v54 offset:16896
    v_add_u32 v54, 65536, v37
    ds_read_b64_tr_b16 a[188:189], v54 offset:18432
    v_add_u32 v54, 65536, v37
    ds_read_b64_tr_b16 a[190:191], v54 offset:18944
    s_waitcnt lgkmcnt(0)
    v_add_u32 v54, 65536, v38
    ds_read_b64_tr_b16 a[200:201], v54 offset:16384
    v_add_u32 v54, 65536, v38
    ds_read_b64_tr_b16 a[202:203], v54 offset:16896
    v_add_u32 v54, 65536, v38
    ds_read_b64_tr_b16 a[204:205], v54 offset:18432
    v_add_u32 v54, 65536, v38
    ds_read_b64_tr_b16 a[206:207], v54 offset:18944
    s_waitcnt lgkmcnt(0)
    v_add_u32 v54, 65536, v39
    ds_read_b64_tr_b16 a[216:217], v54 offset:16384
    v_add_u32 v54, 65536, v39
    ds_read_b64_tr_b16 a[218:219], v54 offset:16896
    v_add_u32 v54, 65536, v39
    ds_read_b64_tr_b16 a[220:221], v54 offset:18432
    v_add_u32 v54, 65536, v39
    ds_read_b64_tr_b16 a[222:223], v54 offset:18944
    s_waitcnt lgkmcnt(0)
    v_add_u32 v54, 65536, v40
    ds_read_b64_tr_b16 a[232:233], v54 offset:16384
    v_add_u32 v54, 65536, v40
    ds_read_b64_tr_b16 a[234:235], v54 offset:16896
    v_add_u32 v54, 65536, v40
    ds_read_b64_tr_b16 a[236:237], v54 offset:18432
    v_add_u32 v54, 65536, v40
    ds_read_b64_tr_b16 a[238:239], v54 offset:18944
    s_waitcnt lgkmcnt(0)
    v_add_u32 v54, 65536, v41
    ds_read_b64_tr_b16 a[248:249], v54 offset:16384
    v_add_u32 v54, 65536, v41
    ds_read_b64_tr_b16 a[250:251], v54 offset:16896
    v_add_u32 v54, 65536, v41
    ds_read_b64_tr_b16 a[252:253], v54 offset:18432
    v_add_u32 v54, 65536, v41
    ds_read_b64_tr_b16 a[254:255], v54 offset:18944
    s_waitcnt lgkmcnt(0)
wo_87:
    s_waitcnt vmcnt(24)
    s_barrier
    s_add_u32 s58, s10, 2621440
    s_addc_u32 s59, s11, 0
    s_lshl_b32 s54, s4, 12
    s_add_u32 m0, s54, 81920
    s_nop 0
    global_load_lds_dwordx4 v24, s[58:59] nt
    s_add_u32 m0, s54, 82944
    s_nop 0
    global_load_lds_dwordx4 v25, s[58:59] nt
    s_add_u32 m0, s54, 83968
    s_nop 0
    global_load_lds_dwordx4 v26, s[58:59] nt
    s_add_u32 m0, s54, 84992
    s_nop 0
    global_load_lds_dwordx4 v27, s[58:59] nt
    s_cmp_lg_u32 s4, 2
    s_cbranch_scc1 wo_88
    v_add_u32 v54, 65536, v34
    ds_read_b64_tr_b16 a[136:137], v54 offset:32768
    v_add_u32 v54, 65536, v34
    ds_read_b64_tr_b16 a[138:139], v54 offset:33280
    v_add_u32 v54, 65536, v34
    ds_read_b64_tr_b16 a[140:141], v54 offset:34816
    v_add_u32 v54, 65536, v34
    ds_read_b64_tr_b16 a[142:143], v54 offset:35328
    s_waitcnt lgkmcnt(0)
    v_add_u32 v54, 65536, v35
    ds_read_b64_tr_b16 a[152:153], v54 offset:32768
    v_add_u32 v54, 65536, v35
    ds_read_b64_tr_b16 a[154:155], v54 offset:33280
    v_add_u32 v54, 65536, v35
    ds_read_b64_tr_b16 a[156:157], v54 offset:34816
    v_add_u32 v54, 65536, v35
    ds_read_b64_tr_b16 a[158:159], v54 offset:35328
    s_waitcnt lgkmcnt(0)
    v_add_u32 v54, 65536, v36
    ds_read_b64_tr_b16 a[168:169], v54 offset:32768
    v_add_u32 v54, 65536, v36
    ds_read_b64_tr_b16 a[170:171], v54 offset:33280
    v_add_u32 v54, 65536, v36
    ds_read_b64_tr_b16 a[172:173], v54 offset:34816
    v_add_u32 v54, 65536, v36
    ds_read_b64_tr_b16 a[174:175], v54 offset:35328
    s_waitcnt lgkmcnt(0)
    v_add_u32 v54, 65536, v37
    ds_read_b64_tr_b16 a[184:185], v54 offset:32768
    v_add_u32 v54, 65536, v37
    ds_read_b64_tr_b16 a[186:187], v54 offset:33280
    v_add_u32 v54, 65536, v37
    ds_read_b64_tr_b16 a[188:189], v54 offset:34816
    v_add_u32 v54, 65536, v37
    ds_read_b64_tr_b16 a[190:191], v54 offset:35328
    s_waitcnt lgkmcnt(0)
    v_add_u32 v54, 65536, v38
    ds_read_b64_tr_b16 a[200:201], v54 offset:32768
    v_add_u32 v54, 65536, v38
    ds_read_b64_tr_b16 a[202:203], v54 offset:33280
    v_add_u32 v54, 65536, v38
    ds_read_b64_tr_b16 a[204:205], v54 offset:34816
    v_add_u32 v54, 65536, v38
    ds_read_b64_tr_b16 a[206:207], v54 offset:35328
    s_waitcnt lgkmcnt(0)
    v_add_u32 v54, 65536, v39
    ds_read_b64_tr_b16 a[216:217], v54 offset:32768
    v_add_u32 v54, 65536, v39
    ds_read_b64_tr_b16 a[218:219], v54 offset:33280
    v_add_u32 v54, 65536, v39
    ds_read_b64_tr_b16 a[220:221], v54 offset:34816
    v_add_u32 v54, 65536, v39
    ds_read_b64_tr_b16 a[222:223], v54 offset:35328
    s_waitcnt lgkmcnt(0)
    v_add_u32 v54, 65536, v40
    ds_read_b64_tr_b16 a[232:233], v54 offset:32768
    v_add_u32 v54, 65536, v40
    ds_read_b64_tr_b16 a[234:235], v54 offset:33280
    v_add_u32 v54, 65536, v40
    ds_read_b64_tr_b16 a[236:237], v54 offset:34816
    v_add_u32 v54, 65536, v40
    ds_read_b64_tr_b16 a[238:239], v54 offset:35328
    s_waitcnt lgkmcnt(0)
    v_add_u32 v54, 65536, v41
    ds_read_b64_tr_b16 a[248:249], v54 offset:32768
    v_add_u32 v54, 65536, v41
    ds_read_b64_tr_b16 a[250:251], v54 offset:33280
    v_add_u32 v54, 65536, v41
    ds_read_b64_tr_b16 a[252:253], v54 offset:34816
    v_add_u32 v54, 65536, v41
    ds_read_b64_tr_b16 a[254:255], v54 offset:35328
    s_waitcnt lgkmcnt(0)
wo_88:
    s_waitcnt vmcnt(24)
    s_barrier
    s_add_u32 s58, s10, 3145728
    s_addc_u32 s59, s11, 0
    s_lshl_b32 s54, s4, 12
    s_add_u32 m0, s54, 98304
    s_nop 0
    global_load_lds_dwordx4 v24, s[58:59] nt
    s_add_u32 m0, s54, 99328
    s_nop 0
    global_load_lds_dwordx4 v25, s[58:59] nt
    s_add_u32 m0, s54, 100352
    s_nop 0
    global_load_lds_dwordx4 v26, s[58:59] nt
    s_add_u32 m0, s54, 101376
    s_nop 0
    global_load_lds_dwordx4 v27, s[58:59] nt
    s_cmp_lg_u32 s4, 3
    s_cbranch_scc1 wo_89
    v_add_u32 v54, 65536, v34
    ds_read_b64_tr_b16 a[136:137], v54 offset:49152
    v_add_u32 v54, 65536, v34
    ds_read_b64_tr_b16 a[138:139], v54 offset:49664
    v_add_u32 v54, 65536, v34
    ds_read_b64_tr_b16 a[140:141], v54 offset:51200
    v_add_u32 v54, 65536, v34
    ds_read_b64_tr_b16 a[142:143], v54 offset:51712
    s_waitcnt lgkmcnt(0)
    v_add_u32 v54, 65536, v35
    ds_read_b64_tr_b16 a[152:153], v54 offset:49152
    v_add_u32 v54, 65536, v35
    ds_read_b64_tr_b16 a[154:155], v54 offset:49664
    v_add_u32 v54, 65536, v35
    ds_read_b64_tr_b16 a[156:157], v54 offset:51200
    v_add_u32 v54, 65536, v35
    ds_read_b64_tr_b16 a[158:159], v54 offset:51712
    s_waitcnt lgkmcnt(0)
    v_add_u32 v54, 65536, v36
    ds_read_b64_tr_b16 a[168:169], v54 offset:49152
    v_add_u32 v54, 65536, v36
    ds_read_b64_tr_b16 a[170:171], v54 offset:49664
    v_add_u32 v54, 65536, v36
    ds_read_b64_tr_b16 a[172:173], v54 offset:51200
    v_add_u32 v54, 65536, v36
    ds_read_b64_tr_b16 a[174:175], v54 offset:51712
    s_waitcnt lgkmcnt(0)
    v_add_u32 v54, 65536, v37
    ds_read_b64_tr_b16 a[184:185], v54 offset:49152
    v_add_u32 v54, 65536, v37
    ds_read_b64_tr_b16 a[186:187], v54 offset:49664
    v_add_u32 v54, 65536, v37
    ds_read_b64_tr_b16 a[188:189], v54 offset:51200
    v_add_u32 v54, 65536, v37
    ds_read_b64_tr_b16 a[190:191], v54 offset:51712
    s_waitcnt lgkmcnt(0)
    v_add_u32 v54, 65536, v38
    ds_read_b64_tr_b16 a[200:201], v54 offset:49152
    v_add_u32 v54, 65536, v38
    ds_read_b64_tr_b16 a[202:203], v54 offset:49664
    v_add_u32 v54, 65536, v38
    ds_read_b64_tr_b16 a[204:205], v54 offset:51200
    v_add_u32 v54, 65536, v38
    ds_read_b64_tr_b16 a[206:207], v54 offset:51712
    s_waitcnt lgkmcnt(0)
    v_add_u32 v54, 65536, v39
    ds_read_b64_tr_b16 a[216:217], v54 offset:49152
    v_add_u32 v54, 65536, v39
    ds_read_b64_tr_b16 a[218:219], v54 offset:49664
    v_add_u32 v54, 65536, v39
    ds_read_b64_tr_b16 a[220:221], v54 offset:51200
    v_add_u32 v54, 65536, v39
    ds_read_b64_tr_b16 a[222:223], v54 offset:51712
    s_waitcnt lgkmcnt(0)
    v_add_u32 v54, 65536, v40
    ds_read_b64_tr_b16 a[232:233], v54 offset:49152
    v_add_u32 v54, 65536, v40
    ds_read_b64_tr_b16 a[234:235], v54 offset:49664
    v_add_u32 v54, 65536, v40
    ds_read_b64_tr_b16 a[236:237], v54 offset:51200
    v_add_u32 v54, 65536, v40
    ds_read_b64_tr_b16 a[238:239], v54 offset:51712
    s_waitcnt lgkmcnt(0)
    v_add_u32 v54, 65536, v41
    ds_read_b64_tr_b16 a[248:249], v54 offset:49152
    v_add_u32 v54, 65536, v41
    ds_read_b64_tr_b16 a[250:251], v54 offset:49664
    v_add_u32 v54, 65536, v41
    ds_read_b64_tr_b16 a[252:253], v54 offset:51200
    v_add_u32 v54, 65536, v41
    ds_read_b64_tr_b16 a[254:255], v54 offset:51712
    s_waitcnt lgkmcnt(0)
wo_89:
    s_waitcnt vmcnt(24)
    s_barrier
    s_add_u32 s58, s10, 3670016
    s_addc_u32 s59, s11, 0
    s_lshl_b32 s54, s4, 12
    s_add_u32 m0, s54, 114688
    s_nop 0
    global_load_lds_dwordx4 v24, s[58:59] nt
    s_add_u32 m0, s54, 115712
    s_nop 0
    global_load_lds_dwordx4 v25, s[58:59] nt
    s_add_u32 m0, s54, 116736
    s_nop 0
    global_load_lds_dwordx4 v26, s[58:59] nt
    s_add_u32 m0, s54, 117760
    s_nop 0
    global_load_lds_dwordx4 v27, s[58:59] nt
    ds_read_b64_tr_b16 v[56:57], v32 offset:0
    ds_read_b64_tr_b16 v[58:59], v32 offset:512
    ds_read_b64_tr_b16 v[60:61], v32 offset:8192
    ds_read_b64_tr_b16 v[62:63], v32 offset:8704
    ds_read_b64_tr_b16 v[64:65], v33 offset:0
    ds_read_b64_tr_b16 v[66:67], v33 offset:512
    ds_read_b64_tr_b16 v[68:69], v33 offset:8192
    ds_read_b64_tr_b16 v[70:71], v33 offset:8704
    s_waitcnt lgkmcnt(0)
    s_barrier
    s_lshl_b32 s54, s4, 12
    s_add_u32 s54, s54, 0
    v_add_u32 v54, s54, v4
    ds_write_b128 v54, v[56:59] offset:0
    ds_write_b128 v54, v[60:63] offset:1024
    ds_write_b128 v54, v[64:67] offset:2048
    ds_write_b128 v54, v[68:71] offset:3072
    s_waitcnt lgkmcnt(0)
    s_waitcnt vmcnt(24)
    s_barrier
    ds_read_b64_tr_b16 v[56:57], v32 offset:16384
    ds_read_b64_tr_b16 v[58:59], v32 offset:16896
    ds_read_b64_tr_b16 v[60:61], v32 offset:24576
    ds_read_b64_tr_b16 v[62:63], v32 offset:25088
    ds_read_b64_tr_b16 v[64:65], v33 offset:16384
    ds_read_b64_tr_b16 v[66:67], v33 offset:16896
    ds_read_b64_tr_b16 v[68:69], v33 offset:24576
    ds_read_b64_tr_b16 v[70:71], v33 offset:25088
    s_waitcnt lgkmcnt(0)
    s_barrier
    s_lshl_b32 s54, s4, 12
    s_add_u32 s54, s54, 16384
    v_add_u32 v54, s54, v4
    ds_write_b128 v54, v[56:59] offset:0
    ds_write_b128 v54, v[60:63] offset:1024
    ds_write_b128 v54, v[64:67] offset:2048
    ds_write_b128 v54, v[68:71] offset:3072
    s_waitcnt lgkmcnt(0)
    s_waitcnt vmcnt(20)
    s_barrier
    ds_read_b64_tr_b16 v[56:57], v32 offset:32768
    ds_read_b64_tr_b16 v[58:59], v32 offset:33280
    ds_read_b64_tr_b16 v[60:61], v32 offset:40960
    ds_read_b64_tr_b16 v[62:63], v32 offset:41472
    ds_read_b64_tr_b16 v[64:65], v33 offset:32768
    ds_read_b64_tr_b16 v[66:67], v33 offset:33280
    ds_read_b64_tr_b16 v[68:69], v33 offset:40960
    ds_read_b64_tr_b16 v[70:71], v33 offset:41472
    s_waitcnt lgkmcnt(0)
    s_barrier
    s_lshl_b32 s54, s4, 12
    s_add_u32 s54, s54, 32768
    v_add_u32 v54, s54, v4
    ds_write_b128 v54, v[56:59] offset:0
    ds_write_b128 v54, v[60:63] offset:1024
    ds_write_b128 v54, v[64:67] offset:2048
    ds_write_b128 v54, v[68:71] offset:3072
    s_waitcnt lgkmcnt(0)
    s_waitcnt vmcnt(16)
    s_barrier
    ds_read_b64_tr_b16 v[56:57], v32 offset:49152
    ds_read_b64_tr_b16 v[58:59], v32 offset:49664
    ds_read_b64_tr_b16 v[60:61], v32 offset:57344
    ds_read_b64_tr_b16 v[62:63], v32 offset:57856
    ds_read_b64_tr_b16 v[64:65], v33 offset:49152
    ds_read_b64_tr_b16 v[66:67], v33 offset:49664
    ds_read_b64_tr_b16 v[68:69], v33 offset:57344
    ds_read_b64_tr_b16 v[70:71], v33 offset:57856
    s_waitcnt lgkmcnt(0)
    s_barrier
    s_lshl_b32 s54, s4, 12
    s_add_u32 s54, s54, 49152
    v_add_u32 v54, s54, v4
    ds_write_b128 v54, v[56:59] offset:0
    ds_write_b128 v54, v[60:63] offset:1024
    ds_write_b128 v54, v[64:67] offset:2048
    ds_write_b128 v54, v[68:71] offset:3072
    s_waitcnt lgkmcnt(0)
    s_waitcnt vmcnt(12)
    s_barrier
    v_add_u32 v54, 65536, v32
    ds_read_b64_tr_b16 v[56:57], v54 offset:0
    v_add_u32 v54, 65536, v32
    ds_read_b64_tr_b16 v[58:59], v54 offset:512
    v_add_u32 v54, 65536, v32
    ds_read_b64_tr_b16 v[60:61], v54 offset:8192
    v_add_u32 v54, 65536, v32
    ds_read_b64_tr_b16 v[62:63], v54 offset:8704
    v_add_u32 v54, 65536, v33
    ds_read_b64_tr_b16 v[64:65], v54 offset:0
    v_add_u32 v54, 65536, v33
    ds_read_b64_tr_b16 v[66:67], v54 offset:512
    v_add_u32 v54, 65536, v33
    ds_read_b64_tr_b16 v[68:69], v54 offset:8192
    v_add_u32 v54, 65536, v33
    ds_read_b64_tr_b16 v[70:71], v54 offset:8704
    s_waitcnt lgkmcnt(0)
    s_barrier
    s_lshl_b32 s54, s4, 12
    s_add_u32 s54, s54, 65536
    v_add_u32 v54, s54, v4
    ds_write_b128 v54, v[56:59] offset:0
    ds_write_b128 v54, v[60:63] offset:1024
    ds_write_b128 v54, v[64:67] offset:2048
    ds_write_b128 v54, v[68:71] offset:3072
    s_waitcnt lgkmcnt(0)
    s_waitcnt vmcnt(8)
    s_barrier
    v_add_u32 v54, 65536, v32
    ds_read_b64_tr_b16 v[56:57], v54 offset:16384
    v_add_u32 v54, 65536, v32
    ds_read_b64_tr_b16 v[58:59], v54 offset:16896
    v_add_u32 v54, 65536, v32
    ds_read_b64_tr_b16 v[60:61], v54 offset:24576
    v_add_u32 v54, 65536, v32
    ds_read_b64_tr_b16 v[62:63], v54 offset:25088
    v_add_u32 v54, 65536, v33
    ds_read_b64_tr_b16 v[64:65], v54 offset:16384
    v_add_u32 v54, 65536, v33
    ds_read_b64_tr_b16 v[66:67], v54 offset:16896
    v_add_u32 v54, 65536, v33
    ds_read_b64_tr_b16 v[68:69], v54 offset:24576
    v_add_u32 v54, 65536, v33
    ds_read_b64_tr_b16 v[70:71], v54 offset:25088
    s_waitcnt lgkmcnt(0)
    s_barrier
    s_lshl_b32 s54, s4, 12
    s_add_u32 s54, s54, 81920
    v_add_u32 v54, s54, v4
    ds_write_b128 v54, v[56:59] offset:0
    ds_write_b128 v54, v[60:63] offset:1024
    ds_write_b128 v54, v[64:67] offset:2048
    ds_write_b128 v54, v[68:71] offset:3072
    s_waitcnt lgkmcnt(0)
    s_waitcnt vmcnt(4)
    s_barrier
    v_add_u32 v54, 65536, v32
    ds_read_b64_tr_b16 v[56:57], v54 offset:32768
    v_add_u32 v54, 65536, v32
    ds_read_b64_tr_b16 v[58:59], v54 offset:33280
    v_add_u32 v54, 65536, v32
    ds_read_b64_tr_b16 v[60:61], v54 offset:40960
    v_add_u32 v54, 65536, v32
    ds_read_b64_tr_b16 v[62:63], v54 offset:41472
    v_add_u32 v54, 65536, v33
    ds_read_b64_tr_b16 v[64:65], v54 offset:32768
    v_add_u32 v54, 65536, v33
    ds_read_b64_tr_b16 v[66:67], v54 offset:33280
    v_add_u32 v54, 65536, v33
    ds_read_b64_tr_b16 v[68:69], v54 offset:40960
    v_add_u32 v54, 65536, v33
    ds_read_b64_tr_b16 v[70:71], v54 offset:41472
    s_waitcnt lgkmcnt(0)
    s_barrier
    s_lshl_b32 s54, s4, 12
    s_add_u32 s54, s54, 98304
    v_add_u32 v54, s54, v4
    ds_write_b128 v54, v[56:59] offset:0
    ds_write_b128 v54, v[60:63] offset:1024
    ds_write_b128 v54, v[64:67] offset:2048
    ds_write_b128 v54, v[68:71] offset:3072
    s_waitcnt lgkmcnt(0)
    s_waitcnt vmcnt(0)
    s_barrier
    v_add_u32 v54, 65536, v32
    ds_read_b64_tr_b16 v[56:57], v54 offset:49152
    v_add_u32 v54, 65536, v32
    ds_read_b64_tr_b16 v[58:59], v54 offset:49664
    v_add_u32 v54, 65536, v32
    ds_read_b64_tr_b16 v[60:61], v54 offset:57344
    v_add_u32 v54, 65536, v32
    ds_read_b64_tr_b16 v[62:63], v54 offset:57856
    v_add_u32 v54, 65536, v33
    ds_read_b64_tr_b16 v[64:65], v54 offset:49152
    v_add_u32 v54, 65536, v33
    ds_read_b64_tr_b16 v[66:67], v54 offset:49664
    v_add_u32 v54, 65536, v33
    ds_read_b64_tr_b16 v[68:69], v54 offset:57344
    v_add_u32 v54, 65536, v33
    ds_read_b64_tr_b16 v[70:71], v54 offset:57856
    s_waitcnt lgkmcnt(0)
    s_barrier
    s_lshl_b32 s54, s4, 12
    s_add_u32 s54, s54, 114688
    v_add_u32 v54, s54, v4
    ds_write_b128 v54, v[56:59] offset:0
    ds_write_b128 v54, v[60:63] offset:1024
    ds_write_b128 v54, v[64:67] offset:2048
    ds_write_b128 v54, v[68:71] offset:3072
    s_waitcnt lgkmcnt(0)
    s_barrier
    v_mov_b32 v88, 0
initw_90:
    global_load_dwordx2 v[90:91], v88, s[20:21] offset:128 sc1
    global_load_dword v92, v88, s[20:21] offset:192 sc1
    s_waitcnt vmcnt(0)
    v_readfirstlane_b32 s58, v90
    v_readfirstlane_b32 s59, v91
    v_readfirstlane_b32 s56, v92
    s_and_b32 s54, s58, 0x00ff00ff
    s_lshr_b32 s55, s58, 8
    s_and_b32 s55, s55, 0x00ff00ff
    s_add_u32 s54, s54, s55
    s_and_b32 s55, s59, 0x00ff00ff
    s_add_u32 s54, s54, s55
    s_lshr_b32 s55, s59, 8
    s_and_b32 s55, s55, 0x00ff00ff
    s_add_u32 s54, s54, s55
    s_lshr_b32 s55, s54, 16
    s_and_b32 s54, s54, 0xffff
    s_add_u32 s54, s54, s55
    s_cmp_eq_u32 s56, 0
    s_cbranch_scc1 inita_92
    s_cmp_ge_u32 s54, 32
    s_cbranch_scc1 initd_91
inita_92:
    s_sub_u32 s6, s6, 1
    s_cbranch_scc1 initd_91
    s_sleep 4
    s_branch initw_90
initd_91:
    s_getreg_b32 s54, hwreg(HW_REG_XCC_ID, 0, 3)
    s_lshl_b32 s54, s54, 3
    s_lshr_b64 s[58:59], s[58:59], s54
    s_and_b32 s54, s58, 0xff
    s_sub_u32 s50, s54, 32
    v_lshrrev_b32 v15, 4, v4
    v_and_b32 v88, 15, v15
    v_mov_b32 v92, 0
    v_cmp_eq_u32 vcc, 0, v88
    v_mov_b32 v96, 0x3f80
    s_nop 0
    v_cndmask_b32 v92, v92, v96, vcc
    v_cmp_eq_u32 vcc, 1, v88
    v_mov_b32 v96, 0x3f800000
    s_nop 0
    v_cndmask_b32 v92, v92, v96, vcc
    v_mov_b32 v93, 0
    v_cmp_eq_u32 vcc, 2, v88
    v_mov_b32 v96, 0x3f80
    s_nop 0
    v_cndmask_b32 v93, v93, v96, vcc
    v_cmp_eq_u32 vcc, 3, v88
    v_mov_b32 v96, 0x3f800000
    s_nop 0
    v_cndmask_b32 v93, v93, v96, vcc
    v_mov_b32 v94, 0
    v_cmp_eq_u32 vcc, 4, v88
    v_mov_b32 v96, 0x3f80
    s_nop 0
    v_cndmask_b32 v94, v94, v96, vcc
    v_cmp_eq_u32 vcc, 5, v88
    v_mov_b32 v96, 0x3f800000
    s_nop 0
    v_cndmask_b32 v94, v94, v96, vcc
    v_mov_b32 v95, 0
    v_cmp_eq_u32 vcc, 6, v88
    v_mov_b32 v96, 0x3f80
    s_nop 0
    v_cndmask_b32 v95, v95, v96, vcc
    v_cmp_eq_u32 vcc, 7, v88
    v_mov_b32 v96, 0x3f800000
    s_nop 0
    v_cndmask_b32 v95, v95, v96, vcc
    v_add_u32 v96, 161792, v4
    ds_write_b128 v96, v[92:95]
    v_bfe_u32 v89, v15, 2, 2
    v_lshlrev_b32 v89, 1, v89
    v_and_b32 v90, 1, v15
    v_add_u32 v89, v89, v90
    v_lshlrev_b32 v89, 10, v89
    v_lshrrev_b32 v90, 4, v15
    v_lshl_add_u32 v89, v90, 5, v89
    v_bfe_u32 v90, v15, 1, 1
    v_lshl_add_u32 v89, v90, 4, v89
    s_lshl_b32 s54, s4, 8
    v_add_u32 v89, s54, v89
    global_load_dwordx4 v[24:27], v89, s[16:17]
    global_load_dwordx4 v[28:31], v89, s[16:17] offset:128
    s_mov_b32 s55, 2048
    v_mov_b32 v96, s55
wf_93:
    global_load_dword v97, v96, s[52:53] sc1
    s_waitcnt vmcnt(0)
    v_readfirstlane_b32 s54, v97
    s_cmp_ge_u32 s54, 32
    s_cbranch_scc1 wfd_94
    s_sub_u32 s6, s6, 1
    s_cbranch_scc1 wfd_94_x
    s_sleep 2
    s_branch wf_93
wfd_94_x:
    s_mov_b32 s6, 0
wfd_94:
    s_mov_b32 m0, s42
    s_nop 0
    global_load_lds_dwordx4 v4, s[34:35] sc1
    global_load_lds_dwordx4 v4, s[34:35] offset:1024 sc1
    global_load_dwordx4 v[112:115], v4, s[36:37] sc1
    global_load_dwordx4 v[116:119], v4, s[36:37] offset:1024 sc1
    s_add_u32 s34, s34, 262144
    s_addc_u32 s35, s35, 0
    s_add_u32 s36, s36, 262144
    s_addc_u32 s37, s37, 0
    s_sub_u32 s38, s38, 131072
    s_subb_u32 s39, s39, 0
    s_waitcnt vmcnt(0)
    s_mov_b32 s5, 0
    v_xor_b32 v15, 16, v9
    v_mov_b32 v22, 32
    s_mov_b32 s49, 2048
    s_add_u32 s86, s52, 2048
    s_addc_u32 s87, s53, 0
    v_mov_b32 v88, 0
    v_mov_b32 v89, 0
    v_mov_b32 v90, 0
    v_mov_b32 v91, 0
    ds_write_b128 v13, v[88:91] offset:31744
    v_add_u32 v17, s43, v13
    v_add_u32 v48, s93, v4
    v_add_u32 v52, s94, v4
    v_add_u32 v53, s95, v4
    ds_read_b128 v[56:59], v6 offset:0
    ds_read_b128 v[60:63], v6 offset:1024
    ds_read_b128 v[64:67], v6 offset:2048
    ds_read_b128 v[68:71], v6 offset:3072
    ds_read_b128 v[72:75], v6 offset:16384
    ds_read_b128 v[76:79], v6 offset:17408
    ds_read_b128 v[80:83], v6 offset:18432
    ds_read_b128 v[84:87], v6 offset:19456
    v_mov_b64 v[88:89], 0
    v_mov_b64 v[90:91], 0
    v_mov_b64 v[92:93], 0
    v_mov_b64 v[94:95], 0
    v_mov_b64 v[96:97], 0
    v_mov_b64 v[98:99], 0
    v_mov_b64 v[100:101], 0
    v_mov_b64 v[102:103], 0
    v_mov_b64 v[104:105], 0
    v_mov_b64 v[106:107], 0
    v_mov_b64 v[108:109], 0
    v_mov_b64 v[110:111], 0
    s_waitcnt lgkmcnt(0)
    s_barrier
    s_cmp_lg_u32 s50, 0
    s_cbranch_scc1 chain_slow
chain_loop_95:
    ds_write_b128 v17, v[24:27] offset:16384
    ds_write_b128 v17, v[28:31] offset:17408
    v_smfmac_f32_16x16x64_bf16 v[88:91], v[24:27], v[128:135], v5
    v_add_u32 v14, s90, v6
    v_smfmac_f32_16x16x64_bf16 v[92:95], v[24:27], v[192:199], v5
    v_smfmac_f32_16x16x64_bf16 v[96:99], v[24:27], v[56:63], v5
    v_smfmac_f32_16x16x64_bf16 v[100:103], v[24:27], v[64:71], v5
    ds_read_b128 v[56:59], v14 offset:0
    ds_read_b128 v[60:63], v14 offset:1024
    v_smfmac_f32_16x16x64_bf16 v[104:107], v[24:27], a[0:7], v5
    ds_read_b128 v[64:67], v14 offset:2048
    ds_read_b128 v[68:71], v14 offset:3072
    v_smfmac_f32_16x16x64_bf16 v[108:111], v[24:27], a[64:71], v5
    s_waitcnt lgkmcnt(4)
    s_barrier
    ds_read_b128 v[32:35], v48 offset:0
    ds_read_b128 v[36:39], v48 offset:1024
    ds_read_b128 v[40:43], v52 offset:0
    ds_read_b128 v[44:47], v52 offset:1024
    ds_read_b128 v[48:51], v53 offset:0
    ds_read_b128 v[52:55], v53 offset:1024
    v_smfmac_f32_16x16x64_bf16 v[88:91], v[28:31], v[136:143], v5
    v_smfmac_f32_16x16x64_bf16 v[92:95], v[28:31], v[200:207], v5
    global_load_dwordx4 v[120:123], v4, s[36:37] sc1
    v_smfmac_f32_16x16x64_bf16 v[96:99], v[28:31], v[72:79], v5
    v_smfmac_f32_16x16x64_bf16 v[100:103], v[28:31], v[80:87], v5
    ds_read_b128 v[72:75], v14 offset:16384
    ds_read_b128 v[76:79], v14 offset:17408
    v_smfmac_f32_16x16x64_bf16 v[104:107], v[28:31], a[8:15], v5
    ds_read_b128 v[80:83], v14 offset:18432
    ds_read_b128 v[84:87], v14 offset:19456
    ds_read_b128 v[24:27], v13 offset:0
    v_smfmac_f32_16x16x64_bf16 v[108:111], v[28:31], a[72:79], v5
    s_waitcnt lgkmcnt(10)
    v_smfmac_f32_16x16x64_bf16 v[88:91], v[32:35], v[144:151], v5
    v_add_u32 v14, s91, v6
    v_smfmac_f32_16x16x64_bf16 v[92:95], v[32:35], v[208:215], v5
    global_load_dwordx4 v[124:127], v4, s[36:37] offset:1024 sc1
    v_smfmac_f32_16x16x64_bf16 v[96:99], v[32:35], v[56:63], v5
    v_smfmac_f32_16x16x64_bf16 v[100:103], v[32:35], v[64:71], v5
    ds_read_b128 v[56:59], v14 offset:0
    ds_read_b128 v[60:63], v14 offset:1024
    v_smfmac_f32_16x16x64_bf16 v[104:107], v[32:35], a[16:23], v5
    ds_read_b128 v[64:67], v14 offset:2048
    ds_read_b128 v[68:71], v14 offset:3072
    ds_read_b128 v[28:31], v13 offset:4096
    v_smfmac_f32_16x16x64_bf16 v[108:111], v[32:35], a[80:87], v5
    s_waitcnt lgkmcnt(14)
    v_smfmac_f32_16x16x64_bf16 v[88:91], v[36:39], v[152:159], v5
    v_smfmac_f32_16x16x64_bf16 v[92:95], v[36:39], v[216:223], v5
    s_add_u32 m0, s42, 8192
    s_nop 0
    global_load_lds_dwordx4 v4, s[34:35] sc1
    s_waitcnt lgkmcnt(8)
    v_smfmac_f32_16x16x64_bf16 v[96:99], v[36:39], v[72:79], v5
    s_waitcnt lgkmcnt(6)
    v_smfmac_f32_16x16x64_bf16 v[100:103], v[36:39], v[80:87], v5
    ds_read_b128 v[72:75], v14 offset:16384
    ds_read_b128 v[76:79], v14 offset:17408
    v_smfmac_f32_16x16x64_bf16 v[104:107], v[36:39], a[24:31], v5
    ds_read_b128 v[80:83], v14 offset:18432
    ds_read_b128 v[84:87], v14 offset:19456
    ds_read_b128 v[32:35], v13 offset:1024
    v_smfmac_f32_16x16x64_bf16 v[108:111], v[36:39], a[88:95], v5
    v_smfmac_f32_16x16x64_bf16 v[88:91], v[40:43], v[160:167], v5
    v_add_u32 v14, s92, v6
    v_smfmac_f32_16x16x64_bf16 v[92:95], v[40:43], v[224:231], v5
    global_load_lds_dwordx4 v4, s[34:35] offset:1024 sc1
    s_waitcnt lgkmcnt(8)
    v_smfmac_f32_16x16x64_bf16 v[96:99], v[40:43], v[56:63], v5
    s_waitcnt lgkmcnt(6)
    v_smfmac_f32_16x16x64_bf16 v[100:103], v[40:43], v[64:71], v5
    ds_read_b128 v[56:59], v14 offset:0
    ds_read_b128 v[60:63], v14 offset:1024
    v_smfmac_f32_16x16x64_bf16 v[104:107], v[40:43], a[32:39], v5
    ds_read_b128 v[64:67], v14 offset:2048
    ds_read_b128 v[68:71], v14 offset:3072
    ds_read_b128 v[36:39], v13 offset:5120
    v_smfmac_f32_16x16x64_bf16 v[108:111], v[40:43], a[96:103], v5
    v_smfmac_f32_16x16x64_bf16 v[88:91], v[44:47], v[168:175], v5
    v_smfmac_f32_16x16x64_bf16 v[92:95], v[44:47], v[232:239], v5
    global_store_dwordx4 v4, v[18:21], s[38:39] sc1
    s_waitcnt lgkmcnt(8)
    v_smfmac_f32_16x16x64_bf16 v[96:99], v[44:47], v[72:79], v5
    s_waitcnt lgkmcnt(6)
    v_smfmac_f32_16x16x64_bf16 v[100:103], v[44:47], v[80:87], v5
    ds_read_b128 v[72:75], v14 offset:16384
    ds_read_b128 v[76:79], v14 offset:17408
    v_smfmac_f32_16x16x64_bf16 v[104:107], v[44:47], a[40:47], v5
    ds_read_b128 v[80:83], v14 offset:18432
    ds_read_b128 v[84:87], v14 offset:19456
    ds_read_b128 v[40:43], v13 offset:2048
    v_smfmac_f32_16x16x64_bf16 v[108:111], v[44:47], a[104:111], v5
    v_smfmac_f32_16x16x64_bf16 v[88:91], v[48:51], v[176:183], v5
    v_smfmac_f32_16x16x64_bf16 v[92:95], v[48:51], v[240:247], v5
    global_load_dword v22, v1, s[86:87] sc1
    s_waitcnt lgkmcnt(8)
    v_smfmac_f32_16x16x64_bf16 v[96:99], v[48:51], v[56:63], v5
    s_waitcnt lgkmcnt(6)
    v_smfmac_f32_16x16x64_bf16 v[100:103], v[48:51], v[64:71], v5
    ds_read_b128 v[44:47], v13 offset:6144
    v_smfmac_f32_16x16x64_bf16 v[88:91], v[52:55], v[184:191], v5
    v_smfmac_f32_16x16x64_bf16 v[92:95], v[52:55], v[248:255], v5
    s_waitcnt lgkmcnt(4)
    v_smfmac_f32_16x16x64_bf16 v[96:99], v[52:55], v[72:79], v5
    s_waitcnt lgkmcnt(2)
    v_smfmac_f32_16x16x64_bf16 v[100:103], v[52:55], v[80:87], v5
    v_smfmac_f32_16x16x64_bf16 v[104:107], v[48:51], a[48:55], v5
    v_smfmac_f32_16x16x64_bf16 v[108:111], v[48:51], a[112:119], v5
    v_smfmac_f32_16x16x64_bf16 v[104:107], v[52:55], a[56:63], v5
    v_smfmac_f32_16x16x64_bf16 v[108:111], v[52:55], a[120:127], v5
    v_add_f32 v88, v88, v90
    v_add_f32 v89, v89, v91
    v_add_f32 v92, v92, v94
    v_add_f32 v93, v93, v95
    v_cvt_pk_bf16_f32 v16, v88, v89
    v_cvt_pk_bf16_f32 v17, v92, v93
    ds_write2_b32 v7, v16, v17 offset0:0 offset1:64
    v_add_f32 v96, v96, v98
    v_add_f32 v97, v97, v99
    v_add_f32 v100, v100, v102
    v_add_f32 v101, v101, v103
    v_cvt_pk_bf16_f32 v18, v96, v97
    v_cvt_pk_bf16_f32 v19, v100, v101
    ds_write2_b32 v23, v18, v19 offset0:0 offset1:128
    ds_read_b128 v[48:51], v13 offset:3072
    ds_read_b128 v[52:55], v13 offset:7168
    v_add_f32 v104, v104, v106
    v_add_f32 v105, v105, v107
    v_add_f32 v108, v108, v110
    v_add_f32 v109, v109, v111
    v_cvt_pk_bf16_f32 v20, v104, v105
    v_cvt_pk_bf16_f32 v21, v108, v109
    v_mov_b32 v100, 0x3f803f80
    v_mov_b32 v101, 0x3f803f80
    s_waitcnt lgkmcnt(2)
    s_barrier
    ds_read_b64_tr_b16 v[56:57], v8 offset:0
    ds_read_b64_tr_b16 v[58:59], v8 offset:128
    ds_read_b64_tr_b16 v[72:73], v9 offset:0
    ds_read_b64_tr_b16 v[74:75], v15 offset:256
    ds_read_b64_tr_b16 v[60:61], v8 offset:512
    ds_read_b64_tr_b16 v[62:63], v8 offset:640
    ds_read_b64_tr_b16 v[76:77], v9 offset:1024
    ds_read_b64_tr_b16 v[78:79], v15 offset:1280
    ds_read_b64_tr_b16 v[64:65], v8 offset:1024
    ds_read_b64_tr_b16 v[66:67], v8 offset:1152
    ds_read_b64_tr_b16 v[80:81], v9 offset:2048
    ds_read_b64_tr_b16 v[82:83], v15 offset:2304
    ds_read_b64_tr_b16 v[68:69], v8 offset:1536
    ds_read_b64_tr_b16 v[70:71], v8 offset:1664
    ds_read_b64_tr_b16 v[84:85], v9 offset:3072
    ds_read_b64_tr_b16 v[86:87], v15 offset:3328
    s_waitcnt lgkmcnt(14)
    v_mfma_f32_16x16x32_bf16 v[92:95], v[24:27], v[56:59], 0
    v_mfma_f32_16x16x32_bf16 v[96:99], v[28:31], v[56:59], 0
    s_waitcnt lgkmcnt(12)
    v_mfma_f32_16x16x32_bf16 v[88:91], v[72:75], v[56:59], 0
    s_waitcnt lgkmcnt(10)
    v_mfma_f32_16x16x32_bf16 v[92:95], v[32:35], v[60:63], v[92:95]
    v_mfma_f32_16x16x32_bf16 v[96:99], v[36:39], v[60:63], v[96:99]
    s_waitcnt lgkmcnt(8)
    v_mfma_f32_16x16x32_bf16 v[88:91], v[76:79], v[60:63], v[88:91]
    s_waitcnt lgkmcnt(6)
    v_mfma_f32_16x16x32_bf16 v[92:95], v[40:43], v[64:67], v[92:95]
    v_mfma_f32_16x16x32_bf16 v[96:99], v[44:47], v[64:67], v[96:99]
    s_waitcnt lgkmcnt(4)
    v_mfma_f32_16x16x32_bf16 v[88:91], v[80:83], v[64:67], v[88:91]
    v_mov_b32 v102, 0x3f803f80
    v_mov_b32 v103, 0x3f803f80
    s_waitcnt lgkmcnt(2)
    v_mfma_f32_16x16x32_bf16 v[92:95], v[48:51], v[68:71], v[92:95]
    v_mfma_f32_16x16x32_bf16 v[96:99], v[52:55], v[68:71], v[96:99]
    s_waitcnt lgkmcnt(0)
    v_mfma_f32_16x16x32_bf16 v[88:91], v[84:87], v[68:71], v[88:91]
    s_nop 4
    v_max3_f32 v24, v92, v93, v94
    v_max3_f32 v25, v95, v96, v97
    v_max3_f32 v24, v98, v99, v24
    v_max3_f32 v25, v88, v89, v25
    v_max_f32 v24, v24, v25
    v_mov_b32 v25, v24
    v_mov_b64 v[56:57], 0
    v_mov_b64 v[58:59], 0
    v_permlane32_swap_b32 v24, v25
    v_max_f32 v24, v24, v25
    v_mov_b32 v25, v24
    v_mov_b64 v[60:61], 0
    v_mov_b64 v[62:63], 0
    v_permlane16_swap_b32 v24, v25
    v_max_f32 v24, v24, v25
    v_mul_f32 v24, s44, v24
    v_pk_fma_f32 v[88:89], v[88:89], s[44:45], v[24:25] op_sel_hi:[1,1,0] neg_lo:[0,0,1] neg_hi:[0,0,1]
    v_pk_fma_f32 v[92:93], v[92:93], s[44:45], v[24:25] op_sel_hi:[1,1,0] neg_lo:[0,0,1] neg_hi:[0,0,1]
    v_pk_fma_f32 v[94:95], v[94:95], s[44:45], v[24:25] op_sel_hi:[1,1,0] neg_lo:[0,0,1] neg_hi:[0,0,1]
    v_pk_fma_f32 v[96:97], v[96:97], s[44:45], v[24:25] op_sel_hi:[1,1,0] neg_lo:[0,0,1] neg_hi:[0,0,1]
    v_pk_fma_f32 v[98:99], v[98:99], s[44:45], v[24:25] op_sel_hi:[1,1,0] neg_lo:[0,0,1] neg_hi:[0,0,1]
    v_exp_f32 v88, v88
    v_exp_f32 v89, v89
    v_exp_f32 v92, v92
    v_cvt_pk_bf16_f32 v0, v88, v89
    v_exp_f32 v93, v93
    v_mov_b32 v3, v0
    v_exp_f32 v94, v94
    v_mfma_f32_16x16x16_bf16 v[40:43], v[100:101], v[0:1], 0
    v_exp_f32 v95, v95
    v_cvt_pk_bf16_f32 v28, v92, v93
    v_mfma_f32_16x16x16_bf16 v[32:35], v[20:21], v[0:1], 0
    v_exp_f32 v96, v96
    v_cvt_pk_bf16_f32 v29, v94, v95
    v_mfma_f32_16x16x16_bf16 v[36:39], v[20:21], v[2:3], 0
    v_exp_f32 v97, v97
    v_exp_f32 v98, v98
    v_exp_f32 v99, v99
    v_cvt_pk_bf16_f32 v30, v96, v97
    v_cvt_pk_bf16_f32 v31, v98, v99
    v_mov_b64 v[64:65], 0
    v_mov_b64 v[66:67], 0
    v_mfma_f32_16x16x32_bf16 v[40:43], v[100:103], v[28:31], v[40:43]
    v_mov_b64 v[68:69], 0
    v_mfma_f32_16x16x32_bf16 v[32:35], v[112:115], v[28:31], v[32:35]
    v_mov_b64 v[70:71], 0
    v_mfma_f32_16x16x32_bf16 v[36:39], v[116:119], v[28:31], v[36:39]
    v_mov_b64 v[72:73], 0
    v_mov_b64 v[74:75], 0
    v_mov_b64 v[76:77], 0
    v_mov_b64 v[78:79], 0
    v_rcp_f32 v24, v40
    v_mov_b64 v[80:81], 0
    v_mul_f32 v32, v24, v32
    v_mul_f32 v33, v24, v33
    v_mul_f32 v34, v24, v34
    v_mul_f32 v35, v24, v35
    v_cvt_pk_bf16_f32 v44, v32, v33
    v_cvt_pk_bf16_f32 v45, v34, v35
    v_mul_f32 v36, v24, v36
    v_mul_f32 v37, v24, v37
    v_mul_f32 v38, v24, v38
    v_mul_f32 v39, v24, v39
    v_cvt_pk_bf16_f32 v46, v36, v37
    v_cvt_pk_bf16_f32 v47, v38, v39
    ds_write_b128 v10, v[44:47]
    v_mov_b64 v[82:83], 0
    v_mov_b64 v[84:85], 0
    v_mov_b64 v[86:87], 0
    s_waitcnt lgkmcnt(0)
    s_barrier
    ds_read_b128 v[48:51], v13 offset:16384
    ds_read_b128 v[52:55], v13 offset:17408
    s_waitcnt lgkmcnt(0)
    v_smfmac_f32_16x16x64_bf16 v[56:59], v[48:51], a[128:135], v5
    v_smfmac_f32_16x16x64_bf16 v[56:59], v[52:55], a[136:143], v5
    v_smfmac_f32_16x16x64_bf16 v[60:63], v[48:51], a[144:151], v5
    v_smfmac_f32_16x16x64_bf16 v[60:63], v[52:55], a[152:159], v5
    v_smfmac_f32_16x16x64_bf16 v[64:67], v[48:51], a[160:167], v5
    v_smfmac_f32_16x16x64_bf16 v[64:67], v[52:55], a[168:175], v5
    v_smfmac_f32_16x16x64_bf16 v[68:71], v[48:51], a[176:183], v5
    v_smfmac_f32_16x16x64_bf16 v[68:71], v[52:55], a[184:191], v5
    v_smfmac_f32_16x16x64_bf16 v[72:75], v[48:51], a[192:199], v5
    v_smfmac_f32_16x16x64_bf16 v[72:75], v[52:55], a[200:207], v5
    v_add_f32 v56, v56, v58
    v_add_f32 v57, v57, v59
    v_smfmac_f32_16x16x64_bf16 v[76:79], v[48:51], a[208:215], v5
    v_cvt_pk_bf16_f32 v24, v56, v57
    v_add_f32 v60, v60, v62
    v_smfmac_f32_16x16x64_bf16 v[76:79], v[52:55], a[216:223], v5
    v_add_f32 v61, v61, v63
    v_cvt_pk_bf16_f32 v25, v60, v61
    v_smfmac_f32_16x16x64_bf16 v[80:83], v[48:51], a[224:231], v5
    v_add_f32 v64, v64, v66
    v_add_f32 v65, v65, v67
    v_smfmac_f32_16x16x64_bf16 v[80:83], v[52:55], a[232:239], v5
    v_cvt_pk_bf16_f32 v26, v64, v65
    v_add_f32 v68, v68, v70
    v_smfmac_f32_16x16x64_bf16 v[84:87], v[48:51], a[240:247], v5
    v_add_f32 v69, v69, v71
    v_cvt_pk_bf16_f32 v27, v68, v69
    v_smfmac_f32_16x16x64_bf16 v[84:87], v[52:55], a[248:255], v5
    v_and_b32 v24, -2, v24
    global_store_dwordx4 v11, v[24:27], s[22:23]
    v_add_f32 v72, v72, v74
    v_add_f32 v73, v73, v75
    v_cvt_pk_bf16_f32 v28, v72, v73
    v_add_f32 v76, v76, v78
    v_add_f32 v77, v77, v79
    v_cvt_pk_bf16_f32 v29, v76, v77
    v_add_f32 v80, v80, v82
    v_add_f32 v81, v81, v83
    v_cvt_pk_bf16_f32 v30, v80, v81
    v_add_f32 v84, v84, v86
    v_add_f32 v85, v85, v87
    v_cvt_pk_bf16_f32 v31, v84, v85
    v_and_b32 v28, -2, v28
    global_store_dwordx4 v11, v[28:31], s[24:25]
    v_add_u32 v14, 161792, v4
    ds_read_b128 v[48:51], v14
    ds_read_b128 v[56:59], v6 offset:0
    ds_read_b128 v[60:63], v6 offset:1024
    ds_read_b128 v[64:67], v6 offset:2048
    ds_read_b128 v[68:71], v6 offset:3072
    ds_read_b128 v[72:75], v6 offset:16384
    ds_read_b128 v[76:79], v6 offset:17408
    ds_read_b128 v[80:83], v6 offset:18432
    ds_read_b128 v[84:87], v6 offset:19456
    v_mov_b64 v[88:89], 0
    v_mov_b64 v[90:91], 0
    v_mov_b64 v[92:93], 0
    v_mov_b64 v[94:95], 0
    v_mov_b64 v[96:97], 0
    v_mov_b64 v[98:99], 0
    v_mov_b64 v[100:101], 0
    v_mov_b64 v[102:103], 0
    v_mov_b64 v[104:105], 0
    v_mov_b64 v[106:107], 0
    v_mov_b64 v[108:109], 0
    v_mov_b64 v[110:111], 0
    s_add_u32 s34, s34, 262144
    s_addc_u32 s35, s35, 0
    s_add_u32 s36, s36, 262144
    s_addc_u32 s37, s37, 0
    s_add_u32 s38, s38, 131072
    s_addc_u32 s39, s39, 0
    s_add_u32 s5, s5, 1
    s_waitcnt lgkmcnt(8)
    s_sleep 2
h1_97:
    global_load_dwordx4 v[32:35], v4, s[26:27] offset:0 sc1
    global_load_dwordx4 v[36:39], v4, s[26:27] offset:1024 sc1
    s_waitcnt vmcnt(0)
    v_or_b32 v14, v32, v36
    v_and_b32 v14, 1, v14
    v_cmp_ne_u32 vcc, 0, v14
    s_cbranch_vccz h1a_98
    s_add_u32 s40, s40, 1
    s_sub_u32 s6, s6, 1
    s_cbranch_scc0 h1_97
    s_mov_b32 s6, 0
h1a_98:
    v_mfma_f32_16x16x32_bf16 v[40:43], v[48:51], v[32:35], 0
    v_mfma_f32_16x16x32_bf16 v[40:43], v[48:51], v[36:39], v[40:43]
    v_add_u32 v16, s43, v4
    v_xor_b32 v15, 16, v9
    v_add_u32 v17, s43, v13
    v_add_u32 v48, s93, v4
    v_add_u32 v52, s94, v4
    v_add_u32 v53, s95, v4
    s_nop 1
    v_add_f32_dpp v44, v40, v40 row_ror:8 row_mask:0xf bank_mask:0x3
    v_add_f32_dpp v45, v41, v41 row_ror:8 row_mask:0xf bank_mask:0x3
    s_nop 0
    v_add_f32_dpp v44, v42, v42 row_ror:8 row_mask:0xf bank_mask:0xc
    v_add_f32_dpp v45, v43, v43 row_ror:8 row_mask:0xf bank_mask:0xc
    v_mov_b32 v39, -1
    v_add_f32_dpp v46, v44, v44 row_shl:4 row_mask:0xf bank_mask:0x5
    s_nop 1
    v_add_f32_dpp v46, v45, v45 row_shr:4 row_mask:0xf bank_mask:0xa
    s_mov_b64 s[60:61], s[28:29]
    s_nop 0
    v_mov_b32_dpp v47, v46 quad_perm:[1,0,3,2] row_mask:0xf bank_mask:0xf
    v_cvt_pk_bf16_f32 v46, v46, v47
    v_min_u32 v46, -2, v46
    s_mov_b64 exec, s[46:47]
    global_store_dword v12, v46, s[28:29]
    global_store_dword v12, v39, s[30:31]
    s_mov_b64 exec, -1
    v_cmp_gt_u32 vcc, 32, v22
    s_cbranch_vccnz kvslow_99
kvback_100:
    s_mov_b64 s[28:29], s[30:31]
    s_mov_b64 s[30:31], s[32:33]
    s_mov_b64 s[32:33], s[60:61]
    s_sleep 5
h2_101:
    global_load_dwordx4 v[24:27], v16, s[32:33] sc1
    global_load_dwordx4 v[28:31], v16, s[32:33] offset:1024 sc1
    s_waitcnt vmcnt(0)
    v_max3_u32 v40, v24, v25, v26
    v_max3_u32 v41, v27, v28, v29
    v_max3_u32 v40, v30, v31, v40
    v_max_u32 v40, v40, v41
    v_cmp_eq_u32 vcc, -1, v40
    s_cbranch_vccz h2a_102
    s_add_u32 s41, s41, 1
    s_sub_u32 s6, s6, 1
    s_cbranch_scc0 h2_101
    s_mov_b32 s6, 0
h2a_102:
    s_waitcnt lgkmcnt(0)
    ds_write_b128 v17, v[24:27] offset:16384
    ds_write_b128 v17, v[28:31] offset:17408
    v_smfmac_f32_16x16x64_bf16 v[88:91], v[24:27], v[128:135], v5
    v_add_u32 v14, s90, v6
    v_smfmac_f32_16x16x64_bf16 v[92:95], v[24:27], v[192:199], v5
    v_smfmac_f32_16x16x64_bf16 v[96:99], v[24:27], v[56:63], v5
    v_smfmac_f32_16x16x64_bf16 v[100:103], v[24:27], v[64:71], v5
    ds_read_b128 v[56:59], v14 offset:0
    ds_read_b128 v[60:63], v14 offset:1024
    v_smfmac_f32_16x16x64_bf16 v[104:107], v[24:27], a[0:7], v5
    ds_read_b128 v[64:67], v14 offset:2048
    ds_read_b128 v[68:71], v14 offset:3072
    v_smfmac_f32_16x16x64_bf16 v[108:111], v[24:27], a[64:71], v5
    s_waitcnt lgkmcnt(4)
    s_barrier
    ds_read_b128 v[32:35], v48 offset:0
    ds_read_b128 v[36:39], v48 offset:1024
    ds_read_b128 v[40:43], v52 offset:0
    ds_read_b128 v[44:47], v52 offset:1024
    ds_read_b128 v[48:51], v53 offset:0
    ds_read_b128 v[52:55], v53 offset:1024
    v_smfmac_f32_16x16x64_bf16 v[88:91], v[28:31], v[136:143], v5
    v_smfmac_f32_16x16x64_bf16 v[92:95], v[28:31], v[200:207], v5
    v_mov_b32 v17, s5
    global_store_dword v1, v17, s[100:101] sc1
    v_smfmac_f32_16x16x64_bf16 v[96:99], v[28:31], v[72:79], v5
    v_smfmac_f32_16x16x64_bf16 v[100:103], v[28:31], v[80:87], v5
    ds_read_b128 v[72:75], v14 offset:16384
    ds_read_b128 v[76:79], v14 offset:17408
    v_smfmac_f32_16x16x64_bf16 v[104:107], v[28:31], a[8:15], v5
    ds_read_b128 v[80:83], v14 offset:18432
    ds_read_b128 v[84:87], v14 offset:19456
    ds_read_b128 v[24:27], v13 offset:8192
    v_smfmac_f32_16x16x64_bf16 v[108:111], v[28:31], a[72:79], v5
    s_waitcnt lgkmcnt(10)
    v_smfmac_f32_16x16x64_bf16 v[88:91], v[32:35], v[144:151], v5
    v_add_u32 v14, s91, v6
    v_smfmac_f32_16x16x64_bf16 v[92:95], v[32:35], v[208:215], v5
    global_load_dwordx4 v[112:115], v4, s[36:37] sc1
    v_smfmac_f32_16x16x64_bf16 v[96:99], v[32:35], v[56:63], v5
    v_smfmac_f32_16x16x64_bf16 v[100:103], v[32:35], v[64:71], v5
    ds_read_b128 v[56:59], v14 offset:0
    ds_read_b128 v[60:63], v14 offset:1024
    v_smfmac_f32_16x16x64_bf16 v[104:107], v[32:35], a[16:23], v5
    ds_read_b128 v[64:67], v14 offset:2048
    ds_read_b128 v[68:71], v14 offset:3072
    ds_read_b128 v[28:31], v13 offset:12288
    v_smfmac_f32_16x16x64_bf16 v[108:111], v[32:35], a[80:87], v5
    s_waitcnt lgkmcnt(14)
    v_smfmac_f32_16x16x64_bf16 v[88:91], v[36:39], v[152:159], v5
    v_smfmac_f32_16x16x64_bf16 v[92:95], v[36:39], v[216:223], v5
    global_load_dwordx4 v[116:119], v4, s[36:37] offset:1024 sc1
    s_waitcnt lgkmcnt(8)
    v_smfmac_f32_16x16x64_bf16 v[96:99], v[36:39], v[72:79], v5
    s_waitcnt lgkmcnt(6)
    v_smfmac_f32_16x16x64_bf16 v[100:103], v[36:39], v[80:87], v5
    ds_read_b128 v[72:75], v14 offset:16384
    ds_read_b128 v[76:79], v14 offset:17408
    v_smfmac_f32_16x16x64_bf16 v[104:107], v[36:39], a[24:31], v5
    ds_read_b128 v[80:83], v14 offset:18432
    ds_read_b128 v[84:87], v14 offset:19456
    ds_read_b128 v[32:35], v13 offset:9216
    v_smfmac_f32_16x16x64_bf16 v[108:111], v[36:39], a[88:95], v5
    v_smfmac_f32_16x16x64_bf16 v[88:91], v[40:43], v[160:167], v5
    v_add_u32 v14, s92, v6
    v_smfmac_f32_16x16x64_bf16 v[92:95], v[40:43], v[224:231], v5
    s_add_u32 m0, s42, 0
    s_nop 0
    global_load_lds_dwordx4 v4, s[34:35] sc1
    s_waitcnt lgkmcnt(8)
    v_smfmac_f32_16x16x64_bf16 v[96:99], v[40:43], v[56:63], v5
    s_waitcnt lgkmcnt(6)
    v_smfmac_f32_16x16x64_bf16 v[100:103], v[40:43], v[64:71], v5
    ds_read_b128 v[56:59], v14 offset:0
    ds_read_b128 v[60:63], v14 offset:1024
    v_smfmac_f32_16x16x64_bf16 v[104:107], v[40:43], a[32:39], v5
    ds_read_b128 v[64:67], v14 offset:2048
    ds_read_b128 v[68:71], v14 offset:3072
    ds_read_b128 v[36:39], v13 offset:13312
    v_smfmac_f32_16x16x64_bf16 v[108:111], v[40:43], a[96:103], v5
    v_smfmac_f32_16x16x64_bf16 v[88:91], v[44:47], v[168:175], v5
    v_smfmac_f32_16x16x64_bf16 v[92:95], v[44:47], v[232:239], v5
    global_load_lds_dwordx4 v4, s[34:35] offset:1024 sc1
    s_waitcnt lgkmcnt(8)
    v_smfmac_f32_16x16x64_bf16 v[96:99], v[44:47], v[72:79], v5
    s_waitcnt lgkmcnt(6)
    v_smfmac_f32_16x16x64_bf16 v[100:103], v[44:47], v[80:87], v5
    ds_read_b128 v[72:75], v14 offset:16384
    ds_read_b128 v[76:79], v14 offset:17408
    v_smfmac_f32_16x16x64_bf16 v[104:107], v[44:47], a[40:47], v5
    ds_read_b128 v[80:83], v14 offset:18432
    ds_read_b128 v[84:87], v14 offset:19456
    ds_read_b128 v[40:43], v13 offset:10240
    v_smfmac_f32_16x16x64_bf16 v[108:111], v[44:47], a[104:111], v5
    v_smfmac_f32_16x16x64_bf16 v[88:91], v[48:51], v[176:183], v5
    v_smfmac_f32_16x16x64_bf16 v[92:95], v[48:51], v[240:247], v5
    global_store_dwordx4 v4, v[18:21], s[38:39] sc1
    s_waitcnt lgkmcnt(8)
    v_smfmac_f32_16x16x64_bf16 v[96:99], v[48:51], v[56:63], v5
    s_waitcnt lgkmcnt(6)
    v_smfmac_f32_16x16x64_bf16 v[100:103], v[48:51], v[64:71], v5
    ds_read_b128 v[44:47], v13 offset:14336
    v_smfmac_f32_16x16x64_bf16 v[88:91], v[52:55], v[184:191], v5
    v_smfmac_f32_16x16x64_bf16 v[92:95], v[52:55], v[248:255], v5
    s_waitcnt lgkmcnt(4)
    v_smfmac_f32_16x16x64_bf16 v[96:99], v[52:55], v[72:79], v5
    s_waitcnt lgkmcnt(2)
    v_smfmac_f32_16x16x64_bf16 v[100:103], v[52:55], v[80:87], v5
    v_smfmac_f32_16x16x64_bf16 v[104:107], v[48:51], a[48:55], v5
    v_smfmac_f32_16x16x64_bf16 v[108:111], v[48:51], a[112:119], v5
    v_smfmac_f32_16x16x64_bf16 v[104:107], v[52:55], a[56:63], v5
    v_smfmac_f32_16x16x64_bf16 v[108:111], v[52:55], a[120:127], v5
    v_add_f32 v88, v88, v90
    v_add_f32 v89, v89, v91
    v_add_f32 v92, v92, v94
    v_add_f32 v93, v93, v95
    v_cvt_pk_bf16_f32 v16, v88, v89
    v_cvt_pk_bf16_f32 v17, v92, v93
    ds_write2_b32 v7, v16, v17 offset0:0 offset1:64
    v_add_f32 v96, v96, v98
    v_add_f32 v97, v97, v99
    v_add_f32 v100, v100, v102
    v_add_f32 v101, v101, v103
    v_cvt_pk_bf16_f32 v18, v96, v97
    v_cvt_pk_bf16_f32 v19, v100, v101
    ds_write2_b32 v23, v18, v19 offset0:0 offset1:128
    ds_read_b128 v[48:51], v13 offset:11264
    ds_read_b128 v[52:55], v13 offset:15360
    v_add_f32 v104, v104, v106
    v_add_f32 v105, v105, v107
    v_add_f32 v108, v108, v110
    v_add_f32 v109, v109, v111
    v_cvt_pk_bf16_f32 v20, v104, v105
    v_cvt_pk_bf16_f32 v21, v108, v109
    v_mov_b32 v100, 0x3f803f80
    v_mov_b32 v101, 0x3f803f80
    s_waitcnt lgkmcnt(2)
    s_barrier
    ds_read_b64_tr_b16 v[56:57], v8 offset:0
    ds_read_b64_tr_b16 v[58:59], v8 offset:128
    ds_read_b64_tr_b16 v[72:73], v9 offset:0
    ds_read_b64_tr_b16 v[74:75], v15 offset:256
    ds_read_b64_tr_b16 v[60:61], v8 offset:512
    ds_read_b64_tr_b16 v[62:63], v8 offset:640
    ds_read_b64_tr_b16 v[76:77], v9 offset:1024
    ds_read_b64_tr_b16 v[78:79], v15 offset:1280
    ds_read_b64_tr_b16 v[64:65], v8 offset:1024
    ds_read_b64_tr_b16 v[66:67], v8 offset:1152
    ds_read_b64_tr_b16 v[80:81], v9 offset:2048
    ds_read_b64_tr_b16 v[82:83], v15 offset:2304
    ds_read_b64_tr_b16 v[68:69], v8 offset:1536
    ds_read_b64_tr_b16 v[70:71], v8 offset:1664
    ds_read_b64_tr_b16 v[84:85], v9 offset:3072
    ds_read_b64_tr_b16 v[86:87], v15 offset:3328
    s_cmp_eq_u32 s5, 63
    s_cbranch_scc1 chain_exit_96
    s_waitcnt lgkmcnt(14)
    v_mfma_f32_16x16x32_bf16 v[92:95], v[24:27], v[56:59], 0
    v_mfma_f32_16x16x32_bf16 v[96:99], v[28:31], v[56:59], 0
    s_waitcnt lgkmcnt(12)
    v_mfma_f32_16x16x32_bf16 v[88:91], v[72:75], v[56:59], 0
    s_waitcnt lgkmcnt(10)
    v_mfma_f32_16x16x32_bf16 v[92:95], v[32:35], v[60:63], v[92:95]
    v_mfma_f32_16x16x32_bf16 v[96:99], v[36:39], v[60:63], v[96:99]
    s_waitcnt lgkmcnt(8)
    v_mfma_f32_16x16x32_bf16 v[88:91], v[76:79], v[60:63], v[88:91]
    s_waitcnt lgkmcnt(6)
    v_mfma_f32_16x16x32_bf16 v[92:95], v[40:43], v[64:67], v[92:95]
    v_mfma_f32_16x16x32_bf16 v[96:99], v[44:47], v[64:67], v[96:99]
    s_waitcnt lgkmcnt(4)
    v_mfma_f32_16x16x32_bf16 v[88:91], v[80:83], v[64:67], v[88:91]
    v_mov_b32 v102, 0x3f803f80
    v_mov_b32 v103, 0x3f803f80
    s_waitcnt lgkmcnt(2)
    v_mfma_f32_16x16x32_bf16 v[92:95], v[48:51], v[68:71], v[92:95]
    v_mfma_f32_16x16x32_bf16 v[96:99], v[52:55], v[68:71], v[96:99]
    s_waitcnt lgkmcnt(0)
    v_mfma_f32_16x16x32_bf16 v[88:91], v[84:87], v[68:71], v[88:91]
    s_nop 4
    v_max3_f32 v24, v92, v93, v94
    v_max3_f32 v25, v95, v96, v97
    v_max3_f32 v24, v98, v99, v24
    v_max3_f32 v25, v88, v89, v25
    v_max_f32 v24, v24, v25
    v_mov_b32 v25, v24
    v_mov_b64 v[56:57], 0
    v_mov_b64 v[58:59], 0
    v_permlane32_swap_b32 v24, v25
    v_max_f32 v24, v24, v25
    v_mov_b32 v25, v24
    v_mov_b64 v[60:61], 0
    v_mov_b64 v[62:63], 0
    v_permlane16_swap_b32 v24, v25
    v_max_f32 v24, v24, v25
    v_mul_f32 v24, s44, v24
    v_pk_fma_f32 v[88:89], v[88:89], s[44:45], v[24:25] op_sel_hi:[1,1,0] neg_lo:[0,0,1] neg_hi:[0,0,1]
    v_pk_fma_f32 v[92:93], v[92:93], s[44:45], v[24:25] op_sel_hi:[1,1,0] neg_lo:[0,0,1] neg_hi:[0,0,1]
    v_pk_fma_f32 v[94:95], v[94:95], s[44:45], v[24:25] op_sel_hi:[1,1,0] neg_lo:[0,0,1] neg_hi:[0,0,1]
    v_pk_fma_f32 v[96:97], v[96:97], s[44:45], v[24:25] op_sel_hi:[1,1,0] neg_lo:[0,0,1] neg_hi:[0,0,1]
    v_pk_fma_f32 v[98:99], v[98:99], s[44:45], v[24:25] op_sel_hi:[1,1,0] neg_lo:[0,0,1] neg_hi:[0,0,1]
    v_exp_f32 v88, v88
    v_exp_f32 v89, v89
    v_exp_f32 v92, v92
    v_cvt_pk_bf16_f32 v0, v88, v89
    v_exp_f32 v93, v93
    v_mov_b32 v3, v0
    v_exp_f32 v94, v94
    v_mfma_f32_16x16x16_bf16 v[40:43], v[100:101], v[0:1], 0
    v_exp_f32 v95, v95
    v_cvt_pk_bf16_f32 v28, v92, v93
    v_mfma_f32_16x16x16_bf16 v[32:35], v[20:21], v[0:1], 0
    v_exp_f32 v96, v96
    v_cvt_pk_bf16_f32 v29, v94, v95
    v_mfma_f32_16x16x16_bf16 v[36:39], v[20:21], v[2:3], 0
    v_exp_f32 v97, v97
    v_exp_f32 v98, v98
    v_exp_f32 v99, v99
    v_cvt_pk_bf16_f32 v30, v96, v97
    v_cvt_pk_bf16_f32 v31, v98, v99
    v_mov_b64 v[64:65], 0
    v_mov_b64 v[66:67], 0
    v_mfma_f32_16x16x32_bf16 v[40:43], v[100:103], v[28:31], v[40:43]
    v_mov_b64 v[68:69], 0
    v_mfma_f32_16x16x32_bf16 v[32:35], v[120:123], v[28:31], v[32:35]
    v_mov_b64 v[70:71], 0
    v_mfma_f32_16x16x32_bf16 v[36:39], v[124:127], v[28:31], v[36:39]
    v_mov_b64 v[72:73], 0
    v_mov_b64 v[74:75], 0
    v_mov_b64 v[76:77], 0
    v_mov_b64 v[78:79], 0
    v_rcp_f32 v24, v40
    v_mov_b64 v[80:81], 0
    v_mul_f32 v32, v24, v32
    v_mul_f32 v33, v24, v33
    v_mul_f32 v34, v24, v34
    v_mul_f32 v35, v24, v35
    v_cvt_pk_bf16_f32 v44, v32, v33
    v_cvt_pk_bf16_f32 v45, v34, v35
    v_mul_f32 v36, v24, v36
    v_mul_f32 v37, v24, v37
    v_mul_f32 v38, v24, v38
    v_mul_f32 v39, v24, v39
    v_cvt_pk_bf16_f32 v46, v36, v37
    v_cvt_pk_bf16_f32 v47, v38, v39
    ds_write_b128 v10, v[44:47]
    v_mov_b64 v[82:83], 0
    v_mov_b64 v[84:85], 0
    v_mov_b64 v[86:87], 0
    s_waitcnt lgkmcnt(0)
    s_barrier
    ds_read_b128 v[48:51], v13 offset:16384
    ds_read_b128 v[52:55], v13 offset:17408
    s_waitcnt lgkmcnt(0)
    v_smfmac_f32_16x16x64_bf16 v[56:59], v[48:51], a[128:135], v5
    v_smfmac_f32_16x16x64_bf16 v[56:59], v[52:55], a[136:143], v5
    v_smfmac_f32_16x16x64_bf16 v[60:63], v[48:51], a[144:151], v5
    v_smfmac_f32_16x16x64_bf16 v[60:63], v[52:55], a[152:159], v5
    v_smfmac_f32_16x16x64_bf16 v[64:67], v[48:51], a[160:167], v5
    v_smfmac_f32_16x16x64_bf16 v[64:67], v[52:55], a[168:175], v5
    v_smfmac_f32_16x16x64_bf16 v[68:71], v[48:51], a[176:183], v5
    v_smfmac_f32_16x16x64_bf16 v[68:71], v[52:55], a[184:191], v5
    v_smfmac_f32_16x16x64_bf16 v[72:75], v[48:51], a[192:199], v5
    v_smfmac_f32_16x16x64_bf16 v[72:75], v[52:55], a[200:207], v5
    v_add_f32 v56, v56, v58
    v_add_f32 v57, v57, v59
    v_smfmac_f32_16x16x64_bf16 v[76:79], v[48:51], a[208:215], v5
    v_cvt_pk_bf16_f32 v24, v56, v57
    v_add_f32 v60, v60, v62
    v_smfmac_f32_16x16x64_bf16 v[76:79], v[52:55], a[216:223], v5
    v_add_f32 v61, v61, v63
    v_cvt_pk_bf16_f32 v25, v60, v61
    v_smfmac_f32_16x16x64_bf16 v[80:83], v[48:51], a[224:231], v5
    v_add_f32 v64, v64, v66
    v_add_f32 v65, v65, v67
    v_smfmac_f32_16x16x64_bf16 v[80:83], v[52:55], a[232:239], v5
    v_cvt_pk_bf16_f32 v26, v64, v65
    v_add_f32 v68, v68, v70
    v_smfmac_f32_16x16x64_bf16 v[84:87], v[48:51], a[240:247], v5
    v_add_f32 v69, v69, v71
    v_cvt_pk_bf16_f32 v27, v68, v69
    v_smfmac_f32_16x16x64_bf16 v[84:87], v[52:55], a[248:255], v5
    v_or_b32 v24, 1, v24
    global_store_dwordx4 v11, v[24:27], s[22:23]
    v_add_f32 v72, v72, v74
    v_add_f32 v73, v73, v75
    v_cvt_pk_bf16_f32 v28, v72, v73
    v_add_f32 v76, v76, v78
    v_add_f32 v77, v77, v79
    v_cvt_pk_bf16_f32 v29, v76, v77
    v_add_f32 v80, v80, v82
    v_add_f32 v81, v81, v83
    v_cvt_pk_bf16_f32 v30, v80, v81
    v_add_f32 v84, v84, v86
    v_add_f32 v85, v85, v87
    v_cvt_pk_bf16_f32 v31, v84, v85
    v_or_b32 v28, 1, v28
    global_store_dwordx4 v11, v[28:31], s[24:25]
    v_add_u32 v14, 161792, v4
    ds_read_b128 v[48:51], v14
    ds_read_b128 v[56:59], v6 offset:0
    ds_read_b128 v[60:63], v6 offset:1024
    ds_read_b128 v[64:67], v6 offset:2048
    ds_read_b128 v[68:71], v6 offset:3072
    ds_read_b128 v[72:75], v6 offset:16384
    ds_read_b128 v[76:79], v6 offset:17408
    ds_read_b128 v[80:83], v6 offset:18432
    ds_read_b128 v[84:87], v6 offset:19456
    v_mov_b64 v[88:89], 0
    v_mov_b64 v[90:91], 0
    v_mov_b64 v[92:93], 0
    v_mov_b64 v[94:95], 0
    v_mov_b64 v[96:97], 0
    v_mov_b64 v[98:99], 0
    v_mov_b64 v[100:101], 0
    v_mov_b64 v[102:103], 0
    v_mov_b64 v[104:105], 0
    v_mov_b64 v[106:107], 0
    v_mov_b64 v[108:109], 0
    v_mov_b64 v[110:111], 0
    s_add_u32 s34, s34, 262144
    s_addc_u32 s35, s35, 0
    s_add_u32 s36, s36, 262144
    s_addc_u32 s37, s37, 0
    s_add_u32 s38, s38, 131072
    s_addc_u32 s39, s39, 0
    s_add_u32 s5, s5, 1
    s_add_u32 s54, s5, 2
    s_lshr_b32 s54, s54, 2
    s_min_u32 s54, s54, 15
    s_lshl_b32 s54, s54, 7
    s_add_u32 s49, s54, 2048
    s_add_u32 s86, s52, s49
    s_addc_u32 s87, s53, 0
    s_waitcnt lgkmcnt(8)
    s_sleep 2
h1_103:
    global_load_dwordx4 v[32:35], v4, s[26:27] offset:0 sc1
    global_load_dwordx4 v[36:39], v4, s[26:27] offset:1024 sc1
    s_waitcnt vmcnt(0)
    v_and_b32 v14, v32, v36
    v_and_b32 v14, 1, v14
    v_cmp_eq_u32 vcc, 0, v14
    s_cbranch_vccz h1a_104
    s_add_u32 s40, s40, 1
    s_sub_u32 s6, s6, 1
    s_cbranch_scc0 h1_103
    s_mov_b32 s6, 0
h1a_104:
    v_mfma_f32_16x16x32_bf16 v[40:43], v[48:51], v[32:35], 0
    v_mfma_f32_16x16x32_bf16 v[40:43], v[48:51], v[36:39], v[40:43]
    v_add_u32 v16, s43, v4
    v_xor_b32 v15, 16, v9
    v_add_u32 v17, s43, v13
    v_add_u32 v48, s93, v4
    v_add_u32 v52, s94, v4
    v_add_u32 v53, s95, v4
    s_nop 1
    v_add_f32_dpp v44, v40, v40 row_ror:8 row_mask:0xf bank_mask:0x3
    v_add_f32_dpp v45, v41, v41 row_ror:8 row_mask:0xf bank_mask:0x3
    s_nop 0
    v_add_f32_dpp v44, v42, v42 row_ror:8 row_mask:0xf bank_mask:0xc
    v_add_f32_dpp v45, v43, v43 row_ror:8 row_mask:0xf bank_mask:0xc
    v_mov_b32 v39, -1
    v_add_f32_dpp v46, v44, v44 row_shl:4 row_mask:0xf bank_mask:0x5
    s_nop 1
    v_add_f32_dpp v46, v45, v45 row_shr:4 row_mask:0xf bank_mask:0xa
    s_mov_b64 s[60:61], s[28:29]
    s_nop 0
    v_mov_b32_dpp v47, v46 quad_perm:[1,0,3,2] row_mask:0xf bank_mask:0xf
    v_cvt_pk_bf16_f32 v46, v46, v47
    v_min_u32 v46, -2, v46
    s_mov_b64 exec, s[46:47]
    global_store_dword v12, v46, s[28:29]
    global_store_dword v12, v39, s[30:31]
    s_mov_b64 exec, -1
    s_mov_b64 s[28:29], s[30:31]
    s_mov_b64 s[30:31], s[32:33]
    s_mov_b64 s[32:33], s[60:61]
    s_sleep 5
h2_105:
    global_load_dwordx4 v[24:27], v16, s[32:33] sc1
    global_load_dwordx4 v[28:31], v16, s[32:33] offset:1024 sc1
    s_waitcnt vmcnt(0)
    v_max3_u32 v40, v24, v25, v26
    v_max3_u32 v41, v27, v28, v29
    v_max3_u32 v40, v30, v31, v40
    v_max_u32 v40, v40, v41
    v_cmp_eq_u32 vcc, -1, v40
    s_cbranch_vccz h2a_106
    s_add_u32 s41, s41, 1
    s_sub_u32 s6, s6, 1
    s_cbranch_scc0 h2_105
    s_mov_b32 s6, 0
h2a_106:
    s_waitcnt lgkmcnt(0)
    s_branch chain_loop_95
kvslow_99:
    v_mov_b32 v42, s49
wf_107:
    global_load_dword v43, v42, s[52:53] sc1
    s_waitcnt vmcnt(0)
    v_readfirstlane_b32 s54, v43
    s_cmp_ge_u32 s54, 32
    s_cbranch_scc1 wfd_108
    s_sub_u32 s6, s6, 1
    s_cbranch_scc1 wfd_108_x
    s_sleep 2
    s_branch wf_107
wfd_108_x:
    s_mov_b32 s6, 0
wfd_108:
    s_branch kvback_100
chain_exit_96:
    s_add_u32 s38, s38, 131072
    s_addc_u32 s39, s39, 0
    global_store_dwordx4 v4, v[18:21], s[38:39] sc1
    s_waitcnt vmcnt(0)
    s_barrier
    v_mov_b32 v17, 66
    s_mov_b64 exec, 1
    global_store_dword v1, v17, s[100:101] sc1
    s_mov_b64 exec, -1
    s_branch chain_end
chain_slow:
chain_loop_109:
    ds_write_b128 v17, v[24:27] offset:16384
    ds_write_b128 v17, v[28:31] offset:17408
    v_smfmac_f32_16x16x64_bf16 v[88:91], v[24:27], v[128:135], v5
    v_add_u32 v14, s90, v6
    v_smfmac_f32_16x16x64_bf16 v[92:95], v[24:27], v[192:199], v5
    v_smfmac_f32_16x16x64_bf16 v[96:99], v[24:27], v[56:63], v5
    v_smfmac_f32_16x16x64_bf16 v[100:103], v[24:27], v[64:71], v5
    ds_read_b128 v[56:59], v14 offset:0
    ds_read_b128 v[60:63], v14 offset:1024
    v_smfmac_f32_16x16x64_bf16 v[104:107], v[24:27], a[0:7], v5
    ds_read_b128 v[64:67], v14 offset:2048
    ds_read_b128 v[68:71], v14 offset:3072
    v_smfmac_f32_16x16x64_bf16 v[108:111], v[24:27], a[64:71], v5
    s_waitcnt lgkmcnt(4)
    s_barrier
    ds_read_b128 v[32:35], v48 offset:0
    ds_read_b128 v[36:39], v48 offset:1024
    ds_read_b128 v[40:43], v52 offset:0
    ds_read_b128 v[44:47], v52 offset:1024
    ds_read_b128 v[48:51], v53 offset:0
    ds_read_b128 v[52:55], v53 offset:1024
    v_smfmac_f32_16x16x64_bf16 v[88:91], v[28:31], v[136:143], v5
    v_smfmac_f32_16x16x64_bf16 v[92:95], v[28:31], v[200:207], v5
    global_load_dwordx4 v[120:123], v4, s[36:37] sc1
    v_smfmac_f32_16x16x64_bf16 v[96:99], v[28:31], v[72:79], v5
    v_smfmac_f32_16x16x64_bf16 v[100:103], v[28:31], v[80:87], v5
    ds_read_b128 v[72:75], v14 offset:16384
    ds_read_b128 v[76:79], v14 offset:17408
    v_smfmac_f32_16x16x64_bf16 v[104:107], v[28:31], a[8:15], v5
    ds_read_b128 v[80:83], v14 offset:18432
    ds_read_b128 v[84:87], v14 offset:19456
    ds_read_b128 v[24:27], v13 offset:0
    v_smfmac_f32_16x16x64_bf16 v[108:111], v[28:31], a[72:79], v5
    s_waitcnt lgkmcnt(10)
    v_smfmac_f32_16x16x64_bf16 v[88:91], v[32:35], v[144:151], v5
    v_add_u32 v14, s91, v6
    v_smfmac_f32_16x16x64_bf16 v[92:95], v[32:35], v[208:215], v5
    global_load_dwordx4 v[124:127], v4, s[36:37] offset:1024 sc1
    v_smfmac_f32_16x16x64_bf16 v[96:99], v[32:35], v[56:63], v5
    v_smfmac_f32_16x16x64_bf16 v[100:103], v[32:35], v[64:71], v5
    ds_read_b128 v[56:59], v14 offset:0
    ds_read_b128 v[60:63], v14 offset:1024
    v_smfmac_f32_16x16x64_bf16 v[104:107], v[32:35], a[16:23], v5
    ds_read_b128 v[64:67], v14 offset:2048
    ds_read_b128 v[68:71], v14 offset:3072
    ds_read_b128 v[28:31], v13 offset:4096
    v_smfmac_f32_16x16x64_bf16 v[108:111], v[32:35], a[80:87], v5
    s_waitcnt lgkmcnt(14)
    v_smfmac_f32_16x16x64_bf16 v[88:91], v[36:39], v[152:159], v5
    v_smfmac_f32_16x16x64_bf16 v[92:95], v[36:39], v[216:223], v5
    s_add_u32 m0, s42, 8192
    s_nop 0
    global_load_lds_dwordx4 v4, s[34:35] sc1
    s_waitcnt lgkmcnt(8)
    v_smfmac_f32_16x16x64_bf16 v[96:99], v[36:39], v[72:79], v5
    s_waitcnt lgkmcnt(6)
    v_smfmac_f32_16x16x64_bf16 v[100:103], v[36:39], v[80:87], v5
    ds_read_b128 v[72:75], v14 offset:16384
    ds_read_b128 v[76:79], v14 offset:17408
    v_smfmac_f32_16x16x64_bf16 v[104:107], v[36:39], a[24:31], v5
    ds_read_b128 v[80:83], v14 offset:18432
    ds_read_b128 v[84:87], v14 offset:19456
    ds_read_b128 v[32:35], v13 offset:1024
    v_smfmac_f32_16x16x64_bf16 v[108:111], v[36:39], a[88:95], v5
    v_smfmac_f32_16x16x64_bf16 v[88:91], v[40:43], v[160:167], v5
    v_add_u32 v14, s92, v6
    v_smfmac_f32_16x16x64_bf16 v[92:95], v[40:43], v[224:231], v5
    global_load_lds_dwordx4 v4, s[34:35] offset:1024 sc1
    s_waitcnt lgkmcnt(8)
    v_smfmac_f32_16x16x64_bf16 v[96:99], v[40:43], v[56:63], v5
    s_waitcnt lgkmcnt(6)
    v_smfmac_f32_16x16x64_bf16 v[100:103], v[40:43], v[64:71], v5
    ds_read_b128 v[56:59], v14 offset:0
    ds_read_b128 v[60:63], v14 offset:1024
    v_smfmac_f32_16x16x64_bf16 v[104:107], v[40:43], a[32:39], v5
    ds_read_b128 v[64:67], v14 offset:2048
    ds_read_b128 v[68:71], v14 offset:3072
    ds_read_b128 v[36:39], v13 offset:5120
    v_smfmac_f32_16x16x64_bf16 v[108:111], v[40:43], a[96:103], v5
    v_smfmac_f32_16x16x64_bf16 v[88:91], v[44:47], v[168:175], v5
    v_smfmac_f32_16x16x64_bf16 v[92:95], v[44:47], v[232:239], v5
    global_store_dwordx4 v4, v[18:21], s[38:39] sc1
    s_waitcnt lgkmcnt(8)
    v_smfmac_f32_16x16x64_bf16 v[96:99], v[44:47], v[72:79], v5
    s_waitcnt lgkmcnt(6)
    v_smfmac_f32_16x16x64_bf16 v[100:103], v[44:47], v[80:87], v5
    ds_read_b128 v[72:75], v14 offset:16384
    ds_read_b128 v[76:79], v14 offset:17408
    v_smfmac_f32_16x16x64_bf16 v[104:107], v[44:47], a[40:47], v5
    ds_read_b128 v[80:83], v14 offset:18432
    ds_read_b128 v[84:87], v14 offset:19456
    ds_read_b128 v[40:43], v13 offset:2048
    v_smfmac_f32_16x16x64_bf16 v[108:111], v[44:47], a[104:111], v5
    v_smfmac_f32_16x16x64_bf16 v[88:91], v[48:51], v[176:183], v5
    v_smfmac_f32_16x16x64_bf16 v[92:95], v[48:51], v[240:247], v5
    global_load_dword v22, v1, s[86:87] sc1
    s_waitcnt lgkmcnt(8)
    v_smfmac_f32_16x16x64_bf16 v[96:99], v[48:51], v[56:63], v5
    s_waitcnt lgkmcnt(6)
    v_smfmac_f32_16x16x64_bf16 v[100:103], v[48:51], v[64:71], v5
    ds_read_b128 v[44:47], v13 offset:6144
    v_smfmac_f32_16x16x64_bf16 v[88:91], v[52:55], v[184:191], v5
    v_smfmac_f32_16x16x64_bf16 v[92:95], v[52:55], v[248:255], v5
    s_waitcnt lgkmcnt(4)
    v_smfmac_f32_16x16x64_bf16 v[96:99], v[52:55], v[72:79], v5
    s_waitcnt lgkmcnt(2)
    v_smfmac_f32_16x16x64_bf16 v[100:103], v[52:55], v[80:87], v5
    v_smfmac_f32_16x16x64_bf16 v[104:107], v[48:51], a[48:55], v5
    v_smfmac_f32_16x16x64_bf16 v[108:111], v[48:51], a[112:119], v5
    v_smfmac_f32_16x16x64_bf16 v[104:107], v[52:55], a[56:63], v5
    v_smfmac_f32_16x16x64_bf16 v[108:111], v[52:55], a[120:127], v5
    v_add_f32 v88, v88, v90
    v_add_f32 v89, v89, v91
    v_add_f32 v92, v92, v94
    v_add_f32 v93, v93, v95
    v_cvt_pk_bf16_f32 v16, v88, v89
    v_cvt_pk_bf16_f32 v17, v92, v93
    ds_write2_b32 v7, v16, v17 offset0:0 offset1:64
    v_add_f32 v96, v96, v98
    v_add_f32 v97, v97, v99
    v_add_f32 v100, v100, v102
    v_add_f32 v101, v101, v103
    v_cvt_pk_bf16_f32 v18, v96, v97
    v_cvt_pk_bf16_f32 v19, v100, v101
    ds_write2_b32 v23, v18, v19 offset0:0 offset1:128
    ds_read_b128 v[48:51], v13 offset:3072
    ds_read_b128 v[52:55], v13 offset:7168
    v_add_f32 v104, v104, v106
    v_add_f32 v105, v105, v107
    v_add_f32 v108, v108, v110
    v_add_f32 v109, v109, v111
    v_cvt_pk_bf16_f32 v20, v104, v105
    v_cvt_pk_bf16_f32 v21, v108, v109
    v_mov_b32 v100, 0x3f803f80
    v_mov_b32 v101, 0x3f803f80
    s_waitcnt lgkmcnt(2)
    s_barrier
    ds_read_b64_tr_b16 v[56:57], v8 offset:0
    ds_read_b64_tr_b16 v[58:59], v8 offset:128
    ds_read_b64_tr_b16 v[72:73], v9 offset:0
    ds_read_b64_tr_b16 v[74:75], v15 offset:256
    ds_read_b64_tr_b16 v[60:61], v8 offset:512
    ds_read_b64_tr_b16 v[62:63], v8 offset:640
    ds_read_b64_tr_b16 v[76:77], v9 offset:1024
    ds_read_b64_tr_b16 v[78:79], v15 offset:1280
    ds_read_b64_tr_b16 v[64:65], v8 offset:1024
    ds_read_b64_tr_b16 v[66:67], v8 offset:1152
    ds_read_b64_tr_b16 v[80:81], v9 offset:2048
    ds_read_b64_tr_b16 v[82:83], v15 offset:2304
    ds_read_b64_tr_b16 v[68:69], v8 offset:1536
    ds_read_b64_tr_b16 v[70:71], v8 offset:1664
    ds_read_b64_tr_b16 v[84:85], v9 offset:3072
    ds_read_b64_tr_b16 v[86:87], v15 offset:3328
    s_waitcnt lgkmcnt(14)
    v_mfma_f32_16x16x32_bf16 v[92:95], v[24:27], v[56:59], 0
    v_mfma_f32_16x16x32_bf16 v[96:99], v[28:31], v[56:59], 0
    s_waitcnt lgkmcnt(12)
    v_mfma_f32_16x16x32_bf16 v[88:91], v[72:75], v[56:59], 0
    s_waitcnt lgkmcnt(10)
    v_mfma_f32_16x16x32_bf16 v[92:95], v[32:35], v[60:63], v[92:95]
    v_mfma_f32_16x16x32_bf16 v[96:99], v[36:39], v[60:63], v[96:99]
    s_waitcnt lgkmcnt(8)
    v_mfma_f32_16x16x32_bf16 v[88:91], v[76:79], v[60:63], v[88:91]
    s_waitcnt lgkmcnt(6)
    v_mfma_f32_16x16x32_bf16 v[92:95], v[40:43], v[64:67], v[92:95]
    v_mfma_f32_16x16x32_bf16 v[96:99], v[44:47], v[64:67], v[96:99]
    s_waitcnt lgkmcnt(4)
    v_mfma_f32_16x16x32_bf16 v[88:91], v[80:83], v[64:67], v[88:91]
    v_mov_b32 v102, 0x3f803f80
    v_mov_b32 v103, 0x3f803f80
    s_waitcnt lgkmcnt(2)
    v_mfma_f32_16x16x32_bf16 v[92:95], v[48:51], v[68:71], v[92:95]
    v_mfma_f32_16x16x32_bf16 v[96:99], v[52:55], v[68:71], v[96:99]
    s_waitcnt lgkmcnt(0)
    v_mfma_f32_16x16x32_bf16 v[88:91], v[84:87], v[68:71], v[88:91]
    s_nop 4
    v_max3_f32 v24, v92, v93, v94
    v_max3_f32 v25, v95, v96, v97
    v_max3_f32 v24, v98, v99, v24
    v_max3_f32 v25, v88, v89, v25
    v_max_f32 v24, v24, v25
    v_mov_b32 v25, v24
    v_mov_b64 v[56:57], 0
    v_mov_b64 v[58:59], 0
    v_permlane32_swap_b32 v24, v25
    v_max_f32 v24, v24, v25
    v_mov_b32 v25, v24
    v_mov_b64 v[60:61], 0
    v_mov_b64 v[62:63], 0
    v_permlane16_swap_b32 v24, v25
    v_max_f32 v24, v24, v25
    v_mul_f32 v24, s44, v24
    v_pk_fma_f32 v[88:89], v[88:89], s[44:45], v[24:25] op_sel_hi:[1,1,0] neg_lo:[0,0,1] neg_hi:[0,0,1]
    v_pk_fma_f32 v[92:93], v[92:93], s[44:45], v[24:25] op_sel_hi:[1,1,0] neg_lo:[0,0,1] neg_hi:[0,0,1]
    v_pk_fma_f32 v[94:95], v[94:95], s[44:45], v[24:25] op_sel_hi:[1,1,0] neg_lo:[0,0,1] neg_hi:[0,0,1]
    v_pk_fma_f32 v[96:97], v[96:97], s[44:45], v[24:25] op_sel_hi:[1,1,0] neg_lo:[0,0,1] neg_hi:[0,0,1]
    v_pk_fma_f32 v[98:99], v[98:99], s[44:45], v[24:25] op_sel_hi:[1,1,0] neg_lo:[0,0,1] neg_hi:[0,0,1]
    v_exp_f32 v88, v88
    v_exp_f32 v89, v89
    v_exp_f32 v92, v92
    v_cvt_pk_bf16_f32 v0, v88, v89
    v_exp_f32 v93, v93
    v_mov_b32 v3, v0
    v_exp_f32 v94, v94
    v_mfma_f32_16x16x16_bf16 v[40:43], v[100:101], v[0:1], 0
    v_exp_f32 v95, v95
    v_cvt_pk_bf16_f32 v28, v92, v93
    v_mfma_f32_16x16x16_bf16 v[32:35], v[20:21], v[0:1], 0
    v_exp_f32 v96, v96
    v_cvt_pk_bf16_f32 v29, v94, v95
    v_mfma_f32_16x16x16_bf16 v[36:39], v[20:21], v[2:3], 0
    v_exp_f32 v97, v97
    v_exp_f32 v98, v98
    v_exp_f32 v99, v99
    v_cvt_pk_bf16_f32 v30, v96, v97
    v_cvt_pk_bf16_f32 v31, v98, v99
    v_mov_b64 v[64:65], 0
    v_mov_b64 v[66:67], 0
    v_mfma_f32_16x16x32_bf16 v[40:43], v[100:103], v[28:31], v[40:43]
    v_mov_b64 v[68:69], 0
    v_mfma_f32_16x16x32_bf16 v[32:35], v[112:115], v[28:31], v[32:35]
    v_mov_b64 v[70:71], 0
    v_mfma_f32_16x16x32_bf16 v[36:39], v[116:119], v[28:31], v[36:39]
    v_mov_b64 v[72:73], 0
    v_mov_b64 v[74:75], 0
    v_mov_b64 v[76:77], 0
    v_mov_b64 v[78:79], 0
    v_rcp_f32 v24, v40
    v_mov_b64 v[80:81], 0
    v_mul_f32 v32, v24, v32
    v_mul_f32 v33, v24, v33
    v_mul_f32 v34, v24, v34
    v_mul_f32 v35, v24, v35
    v_cvt_pk_bf16_f32 v44, v32, v33
    v_cvt_pk_bf16_f32 v45, v34, v35
    v_mul_f32 v36, v24, v36
    v_mul_f32 v37, v24, v37
    v_mul_f32 v38, v24, v38
    v_mul_f32 v39, v24, v39
    v_cvt_pk_bf16_f32 v46, v36, v37
    v_cvt_pk_bf16_f32 v47, v38, v39
    ds_write_b128 v10, v[44:47]
    v_mov_b64 v[82:83], 0
    v_mov_b64 v[84:85], 0
    v_mov_b64 v[86:87], 0
    s_waitcnt lgkmcnt(0)
    s_barrier
    ds_read_b128 v[48:51], v13 offset:16384
    ds_read_b128 v[52:55], v13 offset:17408
    s_waitcnt lgkmcnt(0)
    v_smfmac_f32_16x16x64_bf16 v[56:59], v[48:51], a[128:135], v5
    v_smfmac_f32_16x16x64_bf16 v[56:59], v[52:55], a[136:143], v5
    v_smfmac_f32_16x16x64_bf16 v[60:63], v[48:51], a[144:151], v5
    v_smfmac_f32_16x16x64_bf16 v[60:63], v[52:55], a[152:159], v5
    v_smfmac_f32_16x16x64_bf16 v[64:67], v[48:51], a[160:167], v5
    v_smfmac_f32_16x16x64_bf16 v[64:67], v[52:55], a[168:175], v5
    v_smfmac_f32_16x16x64_bf16 v[68:71], v[48:51], a[176:183], v5
    v_smfmac_f32_16x16x64_bf16 v[68:71], v[52:55], a[184:191], v5
    v_smfmac_f32_16x16x64_bf16 v[72:75], v[48:51], a[192:199], v5
    v_smfmac_f32_16x16x64_bf16 v[72:75], v[52:55], a[200:207], v5
    v_add_f32 v56, v56, v58
    v_add_f32 v57, v57, v59
    v_smfmac_f32_16x16x64_bf16 v[76:79], v[48:51], a[208:215], v5
    v_cvt_pk_bf16_f32 v24, v56, v57
    v_add_f32 v60, v60, v62
    v_smfmac_f32_16x16x64_bf16 v[76:79], v[52:55], a[216:223], v5
    v_add_f32 v61, v61, v63
    v_cvt_pk_bf16_f32 v25, v60, v61
    v_smfmac_f32_16x16x64_bf16 v[80:83], v[48:51], a[224:231], v5
    v_add_f32 v64, v64, v66
    v_add_f32 v65, v65, v67
    v_smfmac_f32_16x16x64_bf16 v[80:83], v[52:55], a[232:239], v5
    v_cvt_pk_bf16_f32 v26, v64, v65
    v_add_f32 v68, v68, v70
    v_smfmac_f32_16x16x64_bf16 v[84:87], v[48:51], a[240:247], v5
    v_add_f32 v69, v69, v71
    v_cvt_pk_bf16_f32 v27, v68, v69
    v_smfmac_f32_16x16x64_bf16 v[84:87], v[52:55], a[248:255], v5
    v_and_b32 v24, -2, v24
    global_store_dwordx4 v11, v[24:27], s[22:23] sc1
    v_add_f32 v72, v72, v74
    v_add_f32 v73, v73, v75
    v_cvt_pk_bf16_f32 v28, v72, v73
    v_add_f32 v76, v76, v78
    v_add_f32 v77, v77, v79
    v_cvt_pk_bf16_f32 v29, v76, v77
    v_add_f32 v80, v80, v82
    v_add_f32 v81, v81, v83
    v_cvt_pk_bf16_f32 v30, v80, v81
    v_add_f32 v84, v84, v86
    v_add_f32 v85, v85, v87
    v_cvt_pk_bf16_f32 v31, v84, v85
    v_and_b32 v28, -2, v28
    global_store_dwordx4 v11, v[28:31], s[24:25] sc1
    v_add_u32 v14, 161792, v4
    ds_read_b128 v[48:51], v14
    ds_read_b128 v[56:59], v6 offset:0
    ds_read_b128 v[60:63], v6 offset:1024
    ds_read_b128 v[64:67], v6 offset:2048
    ds_read_b128 v[68:71], v6 offset:3072
    ds_read_b128 v[72:75], v6 offset:16384
    ds_read_b128 v[76:79], v6 offset:17408
    ds_read_b128 v[80:83], v6 offset:18432
    ds_read_b128 v[84:87], v6 offset:19456
    v_mov_b64 v[88:89], 0
    v_mov_b64 v[90:91], 0
    v_mov_b64 v[92:93], 0
    v_mov_b64 v[94:95], 0
    v_mov_b64 v[96:97], 0
    v_mov_b64 v[98:99], 0
    v_mov_b64 v[100:101], 0
    v_mov_b64 v[102:103], 0
    v_mov_b64 v[104:105], 0
    v_mov_b64 v[106:107], 0
    v_mov_b64 v[108:109], 0
    v_mov_b64 v[110:111], 0
    s_add_u32 s34, s34, 262144
    s_addc_u32 s35, s35, 0
    s_add_u32 s36, s36, 262144
    s_addc_u32 s37, s37, 0
    s_add_u32 s38, s38, 131072
    s_addc_u32 s39, s39, 0
    s_add_u32 s5, s5, 1
    s_waitcnt lgkmcnt(8)
    s_sleep 2
h1_111:
    global_load_dwordx4 v[32:35], v4, s[26:27] offset:0 sc1
    global_load_dwordx4 v[36:39], v4, s[26:27] offset:1024 sc1
    s_waitcnt vmcnt(0)
    v_or_b32 v14, v32, v36
    v_and_b32 v14, 1, v14
    v_cmp_ne_u32 vcc, 0, v14
    s_cbranch_vccz h1a_112
    s_add_u32 s40, s40, 1
    s_sub_u32 s6, s6, 1
    s_cbranch_scc0 h1_111
    s_mov_b32 s6, 0
h1a_112:
    v_mfma_f32_16x16x32_bf16 v[40:43], v[48:51], v[32:35], 0
    v_mfma_f32_16x16x32_bf16 v[40:43], v[48:51], v[36:39], v[40:43]
    v_add_u32 v16, s43, v4
    v_xor_b32 v15, 16, v9
    v_add_u32 v17, s43, v13
    v_add_u32 v48, s93, v4
    v_add_u32 v52, s94, v4
    v_add_u32 v53, s95, v4
    s_nop 1
    v_add_f32_dpp v44, v40, v40 row_ror:8 row_mask:0xf bank_mask:0x3
    v_add_f32_dpp v45, v41, v41 row_ror:8 row_mask:0xf bank_mask:0x3
    s_nop 0
    v_add_f32_dpp v44, v42, v42 row_ror:8 row_mask:0xf bank_mask:0xc
    v_add_f32_dpp v45, v43, v43 row_ror:8 row_mask:0xf bank_mask:0xc
    v_mov_b32 v39, -1
    v_add_f32_dpp v46, v44, v44 row_shl:4 row_mask:0xf bank_mask:0x5
    s_nop 1
    v_add_f32_dpp v46, v45, v45 row_shr:4 row_mask:0xf bank_mask:0xa
    s_mov_b64 s[60:61], s[28:29]
    s_nop 0
    v_mov_b32_dpp v47, v46 quad_perm:[1,0,3,2] row_mask:0xf bank_mask:0xf
    v_cvt_pk_bf16_f32 v46, v46, v47
    v_min_u32 v46, -2, v46
    s_mov_b64 exec, s[46:47]
    global_store_dword v12, v46, s[28:29] sc1
    global_store_dword v12, v39, s[30:31] sc1
    s_mov_b64 exec, -1
    v_cmp_gt_u32 vcc, 32, v22
    s_cbranch_vccnz kvslow_113
kvback_114:
    s_mov_b64 s[28:29], s[30:31]
    s_mov_b64 s[30:31], s[32:33]
    s_mov_b64 s[32:33], s[60:61]
    s_sleep 5
h2_115:
    global_load_dwordx4 v[24:27], v16, s[32:33] sc1
    global_load_dwordx4 v[28:31], v16, s[32:33] offset:1024 sc1
    s_waitcnt vmcnt(0)
    v_max3_u32 v40, v24, v25, v26
    v_max3_u32 v41, v27, v28, v29
    v_max3_u32 v40, v30, v31, v40
    v_max_u32 v40, v40, v41
    v_cmp_eq_u32 vcc, -1, v40
    s_cbranch_vccz h2a_116
    s_add_u32 s41, s41, 1
    s_sub_u32 s6, s6, 1
    s_cbranch_scc0 h2_115
    s_mov_b32 s6, 0
h2a_116:
    s_waitcnt lgkmcnt(0)
    ds_write_b128 v17, v[24:27] offset:16384
    ds_write_b128 v17, v[28:31] offset:17408
    v_smfmac_f32_16x16x64_bf16 v[88:91], v[24:27], v[128:135], v5
    v_add_u32 v14, s90, v6
    v_smfmac_f32_16x16x64_bf16 v[92:95], v[24:27], v[192:199], v5
    v_smfmac_f32_16x16x64_bf16 v[96:99], v[24:27], v[56:63], v5
    v_smfmac_f32_16x16x64_bf16 v[100:103], v[24:27], v[64:71], v5
    ds_read_b128 v[56:59], v14 offset:0
    ds_read_b128 v[60:63], v14 offset:1024
    v_smfmac_f32_16x16x64_bf16 v[104:107], v[24:27], a[0:7], v5
    ds_read_b128 v[64:67], v14 offset:2048
    ds_read_b128 v[68:71], v14 offset:3072
    v_smfmac_f32_16x16x64_bf16 v[108:111], v[24:27], a[64:71], v5
    s_waitcnt lgkmcnt(4)
    s_barrier
    ds_read_b128 v[32:35], v48 offset:0
    ds_read_b128 v[36:39], v48 offset:1024
    ds_read_b128 v[40:43], v52 offset:0
    ds_read_b128 v[44:47], v52 offset:1024
    ds_read_b128 v[48:51], v53 offset:0
    ds_read_b128 v[52:55], v53 offset:1024
    v_smfmac_f32_16x16x64_bf16 v[88:91], v[28:31], v[136:143], v5
    v_smfmac_f32_16x16x64_bf16 v[92:95], v[28:31], v[200:207], v5
    v_mov_b32 v17, s5
    global_store_dword v1, v17, s[100:101] sc1
    v_smfmac_f32_16x16x64_bf16 v[96:99], v[28:31], v[72:79], v5
    v_smfmac_f32_16x16x64_bf16 v[100:103], v[28:31], v[80:87], v5
    ds_read_b128 v[72:75], v14 offset:16384
    ds_read_b128 v[76:79], v14 offset:17408
    v_smfmac_f32_16x16x64_bf16 v[104:107], v[28:31], a[8:15], v5
    ds_read_b128 v[80:83], v14 offset:18432
    ds_read_b128 v[84:87], v14 offset:19456
    ds_read_b128 v[24:27], v13 offset:8192
    v_smfmac_f32_16x16x64_bf16 v[108:111], v[28:31], a[72:79], v5
    s_waitcnt lgkmcnt(10)
    v_smfmac_f32_16x16x64_bf16 v[88:91], v[32:35], v[144:151], v5
    v_add_u32 v14, s91, v6
    v_smfmac_f32_16x16x64_bf16 v[92:95], v[32:35], v[208:215], v5
    global_load_dwordx4 v[112:115], v4, s[36:37] sc1
    v_smfmac_f32_16x16x64_bf16 v[96:99], v[32:35], v[56:63], v5
    v_smfmac_f32_16x16x64_bf16 v[100:103], v[32:35], v[64:71], v5
    ds_read_b128 v[56:59], v14 offset:0
    ds_read_b128 v[60:63], v14 offset:1024
    v_smfmac_f32_16x16x64_bf16 v[104:107], v[32:35], a[16:23], v5
    ds_read_b128 v[64:67], v14 offset:2048
    ds_read_b128 v[68:71], v14 offset:3072
    ds_read_b128 v[28:31], v13 offset:12288
    v_smfmac_f32_16x16x64_bf16 v[108:111], v[32:35], a[80:87], v5
    s_waitcnt lgkmcnt(14)
    v_smfmac_f32_16x16x64_bf16 v[88:91], v[36:39], v[152:159], v5
    v_smfmac_f32_16x16x64_bf16 v[92:95], v[36:39], v[216:223], v5
    global_load_dwordx4 v[116:119], v4, s[36:37] offset:1024 sc1
    s_waitcnt lgkmcnt(8)
    v_smfmac_f32_16x16x64_bf16 v[96:99], v[36:39], v[72:79], v5
    s_waitcnt lgkmcnt(6)
    v_smfmac_f32_16x16x64_bf16 v[100:103], v[36:39], v[80:87], v5
    ds_read_b128 v[72:75], v14 offset:16384
    ds_read_b128 v[76:79], v14 offset:17408
    v_smfmac_f32_16x16x64_bf16 v[104:107], v[36:39], a[24:31], v5
    ds_read_b128 v[80:83], v14 offset:18432
    ds_read_b128 v[84:87], v14 offset:19456
    ds_read_b128 v[32:35], v13 offset:9216
    v_smfmac_f32_16x16x64_bf16 v[108:111], v[36:39], a[88:95], v5
    v_smfmac_f32_16x16x64_bf16 v[88:91], v[40:43], v[160:167], v5
    v_add_u32 v14, s92, v6
    v_smfmac_f32_16x16x64_bf16 v[92:95], v[40:43], v[224:231], v5
    s_add_u32 m0, s42, 0
    s_nop 0
    global_load_lds_dwordx4 v4, s[34:35] sc1
    s_waitcnt lgkmcnt(8)
    v_smfmac_f32_16x16x64_bf16 v[96:99], v[40:43], v[56:63], v5
    s_waitcnt lgkmcnt(6)
    v_smfmac_f32_16x16x64_bf16 v[100:103], v[40:43], v[64:71], v5
    ds_read_b128 v[56:59], v14 offset:0
    ds_read_b128 v[60:63], v14 offset:1024
    v_smfmac_f32_16x16x64_bf16 v[104:107], v[40:43], a[32:39], v5
    ds_read_b128 v[64:67], v14 offset:2048
    ds_read_b128 v[68:71], v14 offset:3072
    ds_read_b128 v[36:39], v13 offset:13312
    v_smfmac_f32_16x16x64_bf16 v[108:111], v[40:43], a[96:103], v5
    v_smfmac_f32_16x16x64_bf16 v[88:91], v[44:47], v[168:175], v5
    v_smfmac_f32_16x16x64_bf16 v[92:95], v[44:47], v[232:239], v5
    global_load_lds_dwordx4 v4, s[34:35] offset:1024 sc1
    s_waitcnt lgkmcnt(8)
    v_smfmac_f32_16x16x64_bf16 v[96:99], v[44:47], v[72:79], v5
    s_waitcnt lgkmcnt(6)
    v_smfmac_f32_16x16x64_bf16 v[100:103], v[44:47], v[80:87], v5
    ds_read_b128 v[72:75], v14 offset:16384
    ds_read_b128 v[76:79], v14 offset:17408
    v_smfmac_f32_16x16x64_bf16 v[104:107], v[44:47], a[40:47], v5
    ds_read_b128 v[80:83], v14 offset:18432
    ds_read_b128 v[84:87], v14 offset:19456
    ds_read_b128 v[40:43], v13 offset:10240
    v_smfmac_f32_16x16x64_bf16 v[108:111], v[44:47], a[104:111], v5
    v_smfmac_f32_16x16x64_bf16 v[88:91], v[48:51], v[176:183], v5
    v_smfmac_f32_16x16x64_bf16 v[92:95], v[48:51], v[240:247], v5
    global_store_dwordx4 v4, v[18:21], s[38:39] sc1
    s_waitcnt lgkmcnt(8)
    v_smfmac_f32_16x16x64_bf16 v[96:99], v[48:51], v[56:63], v5
    s_waitcnt lgkmcnt(6)
    v_smfmac_f32_16x16x64_bf16 v[100:103], v[48:51], v[64:71], v5
    ds_read_b128 v[44:47], v13 offset:14336
    v_smfmac_f32_16x16x64_bf16 v[88:91], v[52:55], v[184:191], v5
    v_smfmac_f32_16x16x64_bf16 v[92:95], v[52:55], v[248:255], v5
    s_waitcnt lgkmcnt(4)
    v_smfmac_f32_16x16x64_bf16 v[96:99], v[52:55], v[72:79], v5
    s_waitcnt lgkmcnt(2)
    v_smfmac_f32_16x16x64_bf16 v[100:103], v[52:55], v[80:87], v5
    v_smfmac_f32_16x16x64_bf16 v[104:107], v[48:51], a[48:55], v5
    v_smfmac_f32_16x16x64_bf16 v[108:111], v[48:51], a[112:119], v5
    v_smfmac_f32_16x16x64_bf16 v[104:107], v[52:55], a[56:63], v5
    v_smfmac_f32_16x16x64_bf16 v[108:111], v[52:55], a[120:127], v5
    v_add_f32 v88, v88, v90
    v_add_f32 v89, v89, v91
    v_add_f32 v92, v92, v94
    v_add_f32 v93, v93, v95
    v_cvt_pk_bf16_f32 v16, v88, v89
    v_cvt_pk_bf16_f32 v17, v92, v93
    ds_write2_b32 v7, v16, v17 offset0:0 offset1:64
    v_add_f32 v96, v96, v98
    v_add_f32 v97, v97, v99
    v_add_f32 v100, v100, v102
    v_add_f32 v101, v101, v103
    v_cvt_pk_bf16_f32 v18, v96, v97
    v_cvt_pk_bf16_f32 v19, v100, v101
    ds_write2_b32 v23, v18, v19 offset0:0 offset1:128
    ds_read_b128 v[48:51], v13 offset:11264
    ds_read_b128 v[52:55], v13 offset:15360
    v_add_f32 v104, v104, v106
    v_add_f32 v105, v105, v107
    v_add_f32 v108, v108, v110
    v_add_f32 v109, v109, v111
    v_cvt_pk_bf16_f32 v20, v104, v105
    v_cvt_pk_bf16_f32 v21, v108, v109
    v_mov_b32 v100, 0x3f803f80
    v_mov_b32 v101, 0x3f803f80
    s_waitcnt lgkmcnt(2)
    s_barrier
    ds_read_b64_tr_b16 v[56:57], v8 offset:0
    ds_read_b64_tr_b16 v[58:59], v8 offset:128
    ds_read_b64_tr_b16 v[72:73], v9 offset:0
    ds_read_b64_tr_b16 v[74:75], v15 offset:256
    ds_read_b64_tr_b16 v[60:61], v8 offset:512
    ds_read_b64_tr_b16 v[62:63], v8 offset:640
    ds_read_b64_tr_b16 v[76:77], v9 offset:1024
    ds_read_b64_tr_b16 v[78:79], v15 offset:1280
    ds_read_b64_tr_b16 v[64:65], v8 offset:1024
    ds_read_b64_tr_b16 v[66:67], v8 offset:1152
    ds_read_b64_tr_b16 v[80:81], v9 offset:2048
    ds_read_b64_tr_b16 v[82:83], v15 offset:2304
    ds_read_b64_tr_b16 v[68:69], v8 offset:1536
    ds_read_b64_tr_b16 v[70:71], v8 offset:1664
    ds_read_b64_tr_b16 v[84:85], v9 offset:3072
    ds_read_b64_tr_b16 v[86:87], v15 offset:3328
    s_cmp_eq_u32 s5, 63
    s_cbranch_scc1 chain_exit_110
    s_waitcnt lgkmcnt(14)
    v_mfma_f32_16x16x32_bf16 v[92:95], v[24:27], v[56:59], 0
    v_mfma_f32_16x16x32_bf16 v[96:99], v[28:31], v[56:59], 0
    s_waitcnt lgkmcnt(12)
    v_mfma_f32_16x16x32_bf16 v[88:91], v[72:75], v[56:59], 0
    s_waitcnt lgkmcnt(10)
    v_mfma_f32_16x16x32_bf16 v[92:95], v[32:35], v[60:63], v[92:95]
    v_mfma_f32_16x16x32_bf16 v[96:99], v[36:39], v[60:63], v[96:99]
    s_waitcnt lgkmcnt(8)
    v_mfma_f32_16x16x32_bf16 v[88:91], v[76:79], v[60:63], v[88:91]
    s_waitcnt lgkmcnt(6)
    v_mfma_f32_16x16x32_bf16 v[92:95], v[40:43], v[64:67], v[92:95]
    v_mfma_f32_16x16x32_bf16 v[96:99], v[44:47], v[64:67], v[96:99]
    s_waitcnt lgkmcnt(4)
    v_mfma_f32_16x16x32_bf16 v[88:91], v[80:83], v[64:67], v[88:91]
    v_mov_b32 v102, 0x3f803f80
    v_mov_b32 v103, 0x3f803f80
    s_waitcnt lgkmcnt(2)
    v_mfma_f32_16x16x32_bf16 v[92:95], v[48:51], v[68:71], v[92:95]
    v_mfma_f32_16x16x32_bf16 v[96:99], v[52:55], v[68:71], v[96:99]
    s_waitcnt lgkmcnt(0)
    v_mfma_f32_16x16x32_bf16 v[88:91], v[84:87], v[68:71], v[88:91]
    s_nop 4
    v_max3_f32 v24, v92, v93, v94
    v_max3_f32 v25, v95, v96, v97
    v_max3_f32 v24, v98, v99, v24
    v_max3_f32 v25, v88, v89, v25
    v_max_f32 v24, v24, v25
    v_mov_b32 v25, v24
    v_mov_b64 v[56:57], 0
    v_mov_b64 v[58:59], 0
    v_permlane32_swap_b32 v24, v25
    v_max_f32 v24, v24, v25
    v_mov_b32 v25, v24
    v_mov_b64 v[60:61], 0
    v_mov_b64 v[62:63], 0
    v_permlane16_swap_b32 v24, v25
    v_max_f32 v24, v24, v25
    v_mul_f32 v24, s44, v24
    v_pk_fma_f32 v[88:89], v[88:89], s[44:45], v[24:25] op_sel_hi:[1,1,0] neg_lo:[0,0,1] neg_hi:[0,0,1]
    v_pk_fma_f32 v[92:93], v[92:93], s[44:45], v[24:25] op_sel_hi:[1,1,0] neg_lo:[0,0,1] neg_hi:[0,0,1]
    v_pk_fma_f32 v[94:95], v[94:95], s[44:45], v[24:25] op_sel_hi:[1,1,0] neg_lo:[0,0,1] neg_hi:[0,0,1]
    v_pk_fma_f32 v[96:97], v[96:97], s[44:45], v[24:25] op_sel_hi:[1,1,0] neg_lo:[0,0,1] neg_hi:[0,0,1]
    v_pk_fma_f32 v[98:99], v[98:99], s[44:45], v[24:25] op_sel_hi:[1,1,0] neg_lo:[0,0,1] neg_hi:[0,0,1]
    v_exp_f32 v88, v88
    v_exp_f32 v89, v89
    v_exp_f32 v92, v92
    v_cvt_pk_bf16_f32 v0, v88, v89
    v_exp_f32 v93, v93
    v_mov_b32 v3, v0
    v_exp_f32 v94, v94
    v_mfma_f32_16x16x16_bf16 v[40:43], v[100:101], v[0:1], 0
    v_exp_f32 v95, v95
    v_cvt_pk_bf16_f32 v28, v92, v93
    v_mfma_f32_16x16x16_bf16 v[32:35], v[20:21], v[0:1], 0
    v_exp_f32 v96, v96
    v_cvt_pk_bf16_f32 v29, v94, v95
    v_mfma_f32_16x16x16_bf16 v[36:39], v[20:21], v[2:3], 0
    v_exp_f32 v97, v97
    v_exp_f32 v98, v98
    v_exp_f32 v99, v99
    v_cvt_pk_bf16_f32 v30, v96, v97
    v_cvt_pk_bf16_f32 v31, v98, v99
    v_mov_b64 v[64:65], 0
    v_mov_b64 v[66:67], 0
    v_mfma_f32_16x16x32_bf16 v[40:43], v[100:103], v[28:31], v[40:43]
    v_mov_b64 v[68:69], 0
    v_mfma_f32_16x16x32_bf16 v[32:35], v[120:123], v[28:31], v[32:35]
    v_mov_b64 v[70:71], 0
    v_mfma_f32_16x16x32_bf16 v[36:39], v[124:127], v[28:31], v[36:39]
    v_mov_b64 v[72:73], 0
    v_mov_b64 v[74:75], 0
    v_mov_b64 v[76:77], 0
    v_mov_b64 v[78:79], 0
    v_rcp_f32 v24, v40
    v_mov_b64 v[80:81], 0
    v_mul_f32 v32, v24, v32
    v_mul_f32 v33, v24, v33
    v_mul_f32 v34, v24, v34
    v_mul_f32 v35, v24, v35
    v_cvt_pk_bf16_f32 v44, v32, v33
    v_cvt_pk_bf16_f32 v45, v34, v35
    v_mul_f32 v36, v24, v36
    v_mul_f32 v37, v24, v37
    v_mul_f32 v38, v24, v38
    v_mul_f32 v39, v24, v39
    v_cvt_pk_bf16_f32 v46, v36, v37
    v_cvt_pk_bf16_f32 v47, v38, v39
    ds_write_b128 v10, v[44:47]
    v_mov_b64 v[82:83], 0
    v_mov_b64 v[84:85], 0
    v_mov_b64 v[86:87], 0
    s_waitcnt lgkmcnt(0)
    s_barrier
    ds_read_b128 v[48:51], v13 offset:16384
    ds_read_b128 v[52:55], v13 offset:17408
    s_waitcnt lgkmcnt(0)
    v_smfmac_f32_16x16x64_bf16 v[56:59], v[48:51], a[128:135], v5
    v_smfmac_f32_16x16x64_bf16 v[56:59], v[52:55], a[136:143], v5
    v_smfmac_f32_16x16x64_bf16 v[60:63], v[48:51], a[144:151], v5
    v_smfmac_f32_16x16x64_bf16 v[60:63], v[52:55], a[152:159], v5
    v_smfmac_f32_16x16x64_bf16 v[64:67], v[48:51], a[160:167], v5
    v_smfmac_f32_16x16x64_bf16 v[64:67], v[52:55], a[168:175], v5
    v_smfmac_f32_16x16x64_bf16 v[68:71], v[48:51], a[176:183], v5
    v_smfmac_f32_16x16x64_bf16 v[68:71], v[52:55], a[184:191], v5
    v_smfmac_f32_16x16x64_bf16 v[72:75], v[48:51], a[192:199], v5
    v_smfmac_f32_16x16x64_bf16 v[72:75], v[52:55], a[200:207], v5
    v_add_f32 v56, v56, v58
    v_add_f32 v57, v57, v59
    v_smfmac_f32_16x16x64_bf16 v[76:79], v[48:51], a[208:215], v5
    v_cvt_pk_bf16_f32 v24, v56, v57
    v_add_f32 v60, v60, v62
    v_smfmac_f32_16x16x64_bf16 v[76:79], v[52:55], a[216:223], v5
    v_add_f32 v61, v61, v63
    v_cvt_pk_bf16_f32 v25, v60, v61
    v_smfmac_f32_16x16x64_bf16 v[80:83], v[48:51], a[224:231], v5
    v_add_f32 v64, v64, v66
    v_add_f32 v65, v65, v67
    v_smfmac_f32_16x16x64_bf16 v[80:83], v[52:55], a[232:239], v5
    v_cvt_pk_bf16_f32 v26, v64, v65
    v_add_f32 v68, v68, v70
    v_smfmac_f32_16x16x64_bf16 v[84:87], v[48:51], a[240:247], v5
    v_add_f32 v69, v69, v71
    v_cvt_pk_bf16_f32 v27, v68, v69
    v_smfmac_f32_16x16x64_bf16 v[84:87], v[52:55], a[248:255], v5
    v_or_b32 v24, 1, v24
    global_store_dwordx4 v11, v[24:27], s[22:23] sc1
    v_add_f32 v72, v72, v74
    v_add_f32 v73, v73, v75
    v_cvt_pk_bf16_f32 v28, v72, v73
    v_add_f32 v76, v76, v78
    v_add_f32 v77, v77, v79
    v_cvt_pk_bf16_f32 v29, v76, v77
    v_add_f32 v80, v80, v82
    v_add_f32 v81, v81, v83
    v_cvt_pk_bf16_f32 v30, v80, v81
    v_add_f32 v84, v84, v86
    v_add_f32 v85, v85, v87
    v_cvt_pk_bf16_f32 v31, v84, v85
    v_or_b32 v28, 1, v28
    global_store_dwordx4 v11, v[28:31], s[24:25] sc1
    v_add_u32 v14, 161792, v4
    ds_read_b128 v[48:51], v14
    ds_read_b128 v[56:59], v6 offset:0
    ds_read_b128 v[60:63], v6 offset:1024
    ds_read_b128 v[64:67], v6 offset:2048
    ds_read_b128 v[68:71], v6 offset:3072
    ds_read_b128 v[72:75], v6 offset:16384
    ds_read_b128 v[76:79], v6 offset:17408
    ds_read_b128 v[80:83], v6 offset:18432
    ds_read_b128 v[84:87], v6 offset:19456
    v_mov_b64 v[88:89], 0
    v_mov_b64 v[90:91], 0
    v_mov_b64 v[92:93], 0
    v_mov_b64 v[94:95], 0
    v_mov_b64 v[96:97], 0
    v_mov_b64 v[98:99], 0
    v_mov_b64 v[100:101], 0
    v_mov_b64 v[102:103], 0
    v_mov_b64 v[104:105], 0
    v_mov_b64 v[106:107], 0
    v_mov_b64 v[108:109], 0
    v_mov_b64 v[110:111], 0
    s_add_u32 s34, s34, 262144
    s_addc_u32 s35, s35, 0
    s_add_u32 s36, s36, 262144
    s_addc_u32 s37, s37, 0
    s_add_u32 s38, s38, 131072
    s_addc_u32 s39, s39, 0
    s_add_u32 s5, s5, 1
    s_add_u32 s54, s5, 2
    s_lshr_b32 s54, s54, 2
    s_min_u32 s54, s54, 15
    s_lshl_b32 s54, s54, 7
    s_add_u32 s49, s54, 2048
    s_add_u32 s86, s52, s49
    s_addc_u32 s87, s53, 0
    s_waitcnt lgkmcnt(8)
    s_sleep 2
h1_117:
    global_load_dwordx4 v[32:35], v4, s[26:27] offset:0 sc1
    global_load_dwordx4 v[36:39], v4, s[26:27] offset:1024 sc1
    s_waitcnt vmcnt(0)
    v_and_b32 v14, v32, v36
    v_and_b32 v14, 1, v14
    v_cmp_eq_u32 vcc, 0, v14
    s_cbranch_vccz h1a_118
    s_add_u32 s40, s40, 1
    s_sub_u32 s6, s6, 1
    s_cbranch_scc0 h1_117
    s_mov_b32 s6, 0
h1a_118:
    v_mfma_f32_16x16x32_bf16 v[40:43], v[48:51], v[32:35], 0
    v_mfma_f32_16x16x32_bf16 v[40:43], v[48:51], v[36:39], v[40:43]
    v_add_u32 v16, s43, v4
    v_xor_b32 v15, 16, v9
    v_add_u32 v17, s43, v13
    v_add_u32 v48, s93, v4
    v_add_u32 v52, s94, v4
    v_add_u32 v53, s95, v4
    s_nop 1
    v_add_f32_dpp v44, v40, v40 row_ror:8 row_mask:0xf bank_mask:0x3
    v_add_f32_dpp v45, v41, v41 row_ror:8 row_mask:0xf bank_mask:0x3
    s_nop 0
    v_add_f32_dpp v44, v42, v42 row_ror:8 row_mask:0xf bank_mask:0xc
    v_add_f32_dpp v45, v43, v43 row_ror:8 row_mask:0xf bank_mask:0xc
    v_mov_b32 v39, -1
    v_add_f32_dpp v46, v44, v44 row_shl:4 row_mask:0xf bank_mask:0x5
    s_nop 1
    v_add_f32_dpp v46, v45, v45 row_shr:4 row_mask:0xf bank_mask:0xa
    s_mov_b64 s[60:61], s[28:29]
    s_nop 0
    v_mov_b32_dpp v47, v46 quad_perm:[1,0,3,2] row_mask:0xf bank_mask:0xf
    v_cvt_pk_bf16_f32 v46, v46, v47
    v_min_u32 v46, -2, v46
    s_mov_b64 exec, s[46:47]
    global_store_dword v12, v46, s[28:29] sc1
    global_store_dword v12, v39, s[30:31] sc1
    s_mov_b64 exec, -1
    s_mov_b64 s[28:29], s[30:31]
    s_mov_b64 s[30:31], s[32:33]
    s_mov_b64 s[32:33], s[60:61]
    s_sleep 5
h2_119:
    global_load_dwordx4 v[24:27], v16, s[32:33] sc1
    global_load_dwordx4 v[28:31], v16, s[32:33] offset:1024 sc1
    s_waitcnt vmcnt(0)
    v_max3_u32 v40, v24, v25, v26
    v_max3_u32 v41, v27, v28, v29
    v_max3_u32 v40, v30, v31, v40
    v_max_u32 v40, v40, v41
    v_cmp_eq_u32 vcc, -1, v40
    s_cbranch_vccz h2a_120
    s_add_u32 s41, s41, 1
    s_sub_u32 s6, s6, 1
    s_cbranch_scc0 h2_119
    s_mov_b32 s6, 0
h2a_120:
    s_waitcnt lgkmcnt(0)
    s_branch chain_loop_109
kvslow_113:
    v_mov_b32 v42, s49
wf_121:
    global_load_dword v43, v42, s[52:53] sc1
    s_waitcnt vmcnt(0)
    v_readfirstlane_b32 s54, v43
    s_cmp_ge_u32 s54, 32
    s_cbranch_scc1 wfd_122
    s_sub_u32 s6, s6, 1
    s_cbranch_scc1 wfd_122_x
    s_sleep 2
    s_branch wf_121
wfd_122_x:
    s_mov_b32 s6, 0
wfd_122:
    s_branch kvback_114
chain_exit_110:
    s_add_u32 s38, s38, 131072
    s_addc_u32 s39, s39, 0
    global_store_dwordx4 v4, v[18:21], s[38:39] sc1
    s_waitcnt vmcnt(0)
    s_barrier
    v_mov_b32 v17, 66
    s_mov_b64 exec, 1
    global_store_dword v1, v17, s[100:101] sc1
    s_mov_b64 exec, -1
chain_end:
    s_waitcnt vmcnt(0) lgkmcnt(0)
    s_branch mega_done
mega_worker:
    s_load_dwordx2 s[60:61], s[0:1], 0
    s_load_dwordx2 s[62:63], s[0:1], 16
    s_load_dwordx2 s[64:65], s[0:1], 24
    s_load_dwordx2 s[66:67], s[0:1], 32
    s_load_dwordx2 s[68:69], s[0:1], 40
    s_load_dwordx2 s[70:71], s[0:1], 64
    s_load_dwordx2 s[72:73], s[0:1], 72
    s_load_dwordx2 s[74:75], s[0:1], 80
    s_load_dwordx2 s[76:77], s[0:1], 88
    s_load_dwordx2 s[78:79], s[0:1], 96
    s_load_dwordx2 s[80:81], s[0:1], 104
    v_and_b32 v1, 63, v0
    v_lshrrev_b32 v13, 6, v0
    v_lshlrev_b32 v2, 4, v1
    v_readfirstlane_b32 s4, v13
    s_and_b32 s87, s2, 7
    s_sub_u32 s87, s87, 1
    s_lshl_b32 s87, s87, 5
    s_lshr_b32 s88, s2, 3
    s_add_u32 s84, s87, s88
    s_mov_b32 s86, 0x100000
    s_waitcnt lgkmcnt(0)
    s_add_u32 s82, s80, 61603840
    s_addc_u32 s83, s81, 0
    s_cmp_lg_u32 s84, 0
    s_cbranch_scc1 nozero_123
    v_mov_b32 v40, 0
    v_mov_b32 v41, 0
    v_mov_b32 v42, 0
    v_mov_b32 v43, 0
    s_lshl_b32 s87, s4, 12
    v_add_u32 v44, s87, v2
    global_store_dwordx4 v44, v[40:43], s[82:83] offset:0 sc1
    global_store_dwordx4 v44, v[40:43], s[82:83] offset:1024 sc1
    global_store_dwordx4 v44, v[40:43], s[82:83] offset:2048 sc1
    global_store_dwordx4 v44, v[40:43], s[82:83] offset:3072 sc1
    s_waitcnt vmcnt(0)
    s_barrier
    v_mov_b32 v40, 0
    v_mov_b32 v41, 1
    s_mov_b64 exec, 1
    global_store_dword v40, v41, s[78:79] offset:192 sc1
    s_mov_b64 exec, -1
nozero_123:
    s_mul_hi_u32 s53, s84, 613566757
    s_mul_i32 s87, s53, 7
    s_sub_u32 s52, s84, s87
    s_mov_b32 s26, 8192
    s_mov_b32 s28, 1
    s_lshl_b32 s36, s52, 1
    s_mul_i32 s34, s53, 5
    s_add_u32 s36, s36, s34
    s_and_b32 s36, s36, 15
    s_mov_b32 s31, 16
    v_lshrrev_b32 v13, 4, v1
    v_and_b32 v14, 15, v1
    v_lshlrev_b32 v15, 2, v13
    v_xor_b32 v14, v14, v15
    v_lshlrev_b32 v14, 4, v14
    v_mul_lo_u32 v15, v13, s26
    v_add_u32 v3, v15, v14
    s_lshl_b32 s14, s26, 2
    v_add_u32 v4, s14, v3
    v_add_u32 v5, s14, v4
    v_add_u32 v6, s14, v5
    s_lshl_b32 s27, s26, 5
    v_lshrrev_b32 v13, 4, v1
    v_bfe_u32 v14, v1, 2, 2
    v_and_b32 v15, 3, v1
    v_lshrrev_b32 v16, 1, v13
    v_lshl_add_u32 v16, v16, 3, v14
    v_and_b32 v17, 1, v13
    v_lshlrev_b32 v17, 1, v17
    v_lshrrev_b32 v18, 1, v15
    v_add_u32 v17, v17, v18
    v_and_b32 v18, 1, v15
    v_lshlrev_b32 v18, 3, v18
    v_lshl_add_u32 v18, v16, 8, v18
    v_xor_b32 v19, 0, v14
    v_lshl_add_u32 v19, v19, 2, v17
    v_lshl_add_u32 v7, v19, 4, v18
    v_xor_b32 v19, 1, v14
    v_lshl_add_u32 v19, v19, 2, v17
    v_lshl_add_u32 v8, v19, 4, v18
    v_xor_b32 v19, 2, v14
    v_lshl_add_u32 v19, v19, 2, v17
    v_lshl_add_u32 v9, v19, 4, v18
    v_xor_b32 v19, 3, v14
    v_lshl_add_u32 v19, v19, 2, v17
    v_lshl_add_u32 v10, v19, 4, v18
    s_lshl_b32 s12, s4, 12
    s_lshl_b32 s15, s53, 8
    s_add_u32 s22, s64, s15
    s_addc_u32 s23, s65, 0
    s_add_u32 s24, s66, s15
    s_addc_u32 s25, s67, 0
    s_cmp_ge_u32 s4, 2
    s_cselect_b32 s10, s24, s22
    s_cselect_b32 s11, s25, s23
    s_and_b32 s14, s4, 1
    s_mul_i32 s14, s14, s26
    s_lshl_b32 s14, s14, 4
    s_add_u32 s10, s10, s14
    s_addc_u32 s11, s11, 0
    s_mov_b32 s30, s36
    s_mul_i32 s34, s36, s27
    s_add_u32 s10, s10, s34
    s_addc_u32 s11, s11, 0
    s_mul_i32 s34, s31, s27
    s_sub_u32 s33, s27, s34
    s_mov_b32 s55, 1
    s_cmp_lg_u32 s4, 3
    s_cbranch_scc1 w3_126
    s_barrier
    s_lshl_b32 s15, s53, 8
    s_add_u32 s10, s64, s15
    s_addc_u32 s11, s65, 0
    s_mov_b32 s30, s36
    s_mul_i32 s34, s36, s27
    s_add_u32 s10, s10, s34
    s_addc_u32 s11, s11, 0
    s_mul_i32 s34, s31, s27
    s_sub_u32 s33, s27, s34
    s_mov_b32 s12, 0
    s_add_u32 m0, s12, 0
    s_nop 0
    global_load_lds_dwordx4 v3, s[10:11]
    s_add_u32 m0, s12, 1024
    s_nop 0
    global_load_lds_dwordx4 v4, s[10:11]
    s_add_u32 m0, s12, 2048
    s_nop 0
    global_load_lds_dwordx4 v5, s[10:11]
    s_add_u32 m0, s12, 3072
    s_nop 0
    global_load_lds_dwordx4 v6, s[10:11]
    s_add_u32 s30, s30, 1
    s_cmp_eq_u32 s30, s31
    s_cselect_b32 s34, s33, s27
    s_cselect_b32 s35, -1, 0
    s_cselect_b32 s30, 0, s30
    s_add_u32 s10, s10, s34
    s_addc_u32 s11, s11, s35
    s_add_u32 m0, s12, 16384
    s_nop 0
    global_load_lds_dwordx4 v3, s[10:11]
    s_add_u32 m0, s12, 17408
    s_nop 0
    global_load_lds_dwordx4 v4, s[10:11]
    s_add_u32 m0, s12, 18432
    s_nop 0
    global_load_lds_dwordx4 v5, s[10:11]
    s_add_u32 m0, s12, 19456
    s_nop 0
    global_load_lds_dwordx4 v6, s[10:11]
    s_add_u32 s30, s30, 1
    s_cmp_eq_u32 s30, s31
    s_cselect_b32 s34, s33, s27
    s_cselect_b32 s35, -1, 0
    s_cselect_b32 s30, 0, s30
    s_add_u32 s10, s10, s34
    s_addc_u32 s11, s11, s35
    s_add_u32 m0, s12, 32768
    s_nop 0
    global_load_lds_dwordx4 v3, s[10:11]
    s_add_u32 m0, s12, 33792
    s_nop 0
    global_load_lds_dwordx4 v4, s[10:11]
    s_add_u32 m0, s12, 34816
    s_nop 0
    global_load_lds_dwordx4 v5, s[10:11]
    s_add_u32 m0, s12, 35840
    s_nop 0
    global_load_lds_dwordx4 v6, s[10:11]
    s_add_u32 s30, s30, 1
    s_cmp_eq_u32 s30, s31
    s_cselect_b32 s34, s33, s27
    s_cselect_b32 s35, -1, 0
    s_cselect_b32 s30, 0, s30
    s_add_u32 s10, s10, s34
    s_addc_u32 s11, s11, s35
    s_add_u32 m0, s12, 49152
    s_nop 0
    global_load_lds_dwordx4 v3, s[10:11]
    s_add_u32 m0, s12, 50176
    s_nop 0
    global_load_lds_dwordx4 v4, s[10:11]
    s_add_u32 m0, s12, 51200
    s_nop 0
    global_load_lds_dwordx4 v5, s[10:11]
    s_add_u32 m0, s12, 52224
    s_nop 0
    global_load_lds_dwordx4 v6, s[10:11]
    s_add_u32 s30, s30, 1
    s_cmp_eq_u32 s30, s31
    s_cselect_b32 s34, s33, s27
    s_cselect_b32 s35, -1, 0
    s_cselect_b32 s30, 0, s30
    s_add_u32 s10, s10, s34
    s_addc_u32 s11, s11, s35
    s_add_u32 m0, s12, 65536
    s_nop 0
    global_load_lds_dwordx4 v3, s[10:11]
    s_add_u32 m0, s12, 66560
    s_nop 0
    global_load_lds_dwordx4 v4, s[10:11]
    s_add_u32 m0, s12, 67584
    s_nop 0
    global_load_lds_dwordx4 v5, s[10:11]
    s_add_u32 m0, s12, 68608
    s_nop 0
    global_load_lds_dwordx4 v6, s[10:11]
    s_add_u32 s30, s30, 1
    s_cmp_eq_u32 s30, s31
    s_cselect_b32 s34, s33, s27
    s_cselect_b32 s35, -1, 0
    s_cselect_b32 s30, 0, s30
    s_add_u32 s10, s10, s34
    s_addc_u32 s11, s11, s35
    s_add_u32 m0, s12, 81920
    s_nop 0
    global_load_lds_dwordx4 v3, s[10:11]
    s_add_u32 m0, s12, 82944
    s_nop 0
    global_load_lds_dwordx4 v4, s[10:11]
    s_add_u32 m0, s12, 83968
    s_nop 0
    global_load_lds_dwordx4 v5, s[10:11]
    s_add_u32 m0, s12, 84992
    s_nop 0
    global_load_lds_dwordx4 v6, s[10:11]
    s_add_u32 s30, s30, 1
    s_cmp_eq_u32 s30, s31
    s_cselect_b32 s34, s33, s27
    s_cselect_b32 s35, -1, 0
    s_cselect_b32 s30, 0, s30
    s_add_u32 s10, s10, s34
    s_addc_u32 s11, s11, s35
    s_add_u32 m0, s12, 98304
    s_nop 0
    global_load_lds_dwordx4 v3, s[10:11]
    s_add_u32 m0, s12, 99328
    s_nop 0
    global_load_lds_dwordx4 v4, s[10:11]
    s_add_u32 m0, s12, 100352
    s_nop 0
    global_load_lds_dwordx4 v5, s[10:11]
    s_add_u32 m0, s12, 101376
    s_nop 0
    global_load_lds_dwordx4 v6, s[10:11]
    s_add_u32 s30, s30, 1
    s_cmp_eq_u32 s30, s31
    s_cselect_b32 s34, s33, s27
    s_cselect_b32 s35, -1, 0
    s_cselect_b32 s30, 0, s30
    s_add_u32 s10, s10, s34
    s_addc_u32 s11, s11, s35
    s_lshl_b32 s15, s53, 8
    s_add_u32 s10, s64, s15
    s_addc_u32 s11, s65, 0
    s_add_u32 s10, s10, 131072
    s_addc_u32 s11, s11, 0
    s_mov_b32 s30, s36
    s_mul_i32 s34, s36, s27
    s_add_u32 s10, s10, s34
    s_addc_u32 s11, s11, 0
    s_mul_i32 s34, s31, s27
    s_sub_u32 s33, s27, s34
    s_mov_b32 s12, 4096
    s_add_u32 m0, s12, 0
    s_nop 0
    global_load_lds_dwordx4 v3, s[10:11]
    s_add_u32 m0, s12, 1024
    s_nop 0
    global_load_lds_dwordx4 v4, s[10:11]
    s_add_u32 m0, s12, 2048
    s_nop 0
    global_load_lds_dwordx4 v5, s[10:11]
    s_add_u32 m0, s12, 3072
    s_nop 0
    global_load_lds_dwordx4 v6, s[10:11]
    s_add_u32 s30, s30, 1
    s_cmp_eq_u32 s30, s31
    s_cselect_b32 s34, s33, s27
    s_cselect_b32 s35, -1, 0
    s_cselect_b32 s30, 0, s30
    s_add_u32 s10, s10, s34
    s_addc_u32 s11, s11, s35
    s_add_u32 m0, s12, 16384
    s_nop 0
    global_load_lds_dwordx4 v3, s[10:11]
    s_add_u32 m0, s12, 17408
    s_nop 0
    global_load_lds_dwordx4 v4, s[10:11]
    s_add_u32 m0, s12, 18432
    s_nop 0
    global_load_lds_dwordx4 v5, s[10:11]
    s_add_u32 m0, s12, 19456
    s_nop 0
    global_load_lds_dwordx4 v6, s[10:11]
    s_add_u32 s30, s30, 1
    s_cmp_eq_u32 s30, s31
    s_cselect_b32 s34, s33, s27
    s_cselect_b32 s35, -1, 0
    s_cselect_b32 s30, 0, s30
    s_add_u32 s10, s10, s34
    s_addc_u32 s11, s11, s35
    s_add_u32 m0, s12, 32768
    s_nop 0
    global_load_lds_dwordx4 v3, s[10:11]
    s_add_u32 m0, s12, 33792
    s_nop 0
    global_load_lds_dwordx4 v4, s[10:11]
    s_add_u32 m0, s12, 34816
    s_nop 0
    global_load_lds_dwordx4 v5, s[10:11]
    s_add_u32 m0, s12, 35840
    s_nop 0
    global_load_lds_dwordx4 v6, s[10:11]
    s_add_u32 s30, s30, 1
    s_cmp_eq_u32 s30, s31
    s_cselect_b32 s34, s33, s27
    s_cselect_b32 s35, -1, 0
    s_cselect_b32 s30, 0, s30
    s_add_u32 s10, s10, s34
    s_addc_u32 s11, s11, s35
    s_add_u32 m0, s12, 49152
    s_nop 0
    global_load_lds_dwordx4 v3, s[10:11]
    s_add_u32 m0, s12, 50176
    s_nop 0
    global_load_lds_dwordx4 v4, s[10:11]
    s_add_u32 m0, s12, 51200
    s_nop 0
    global_load_lds_dwordx4 v5, s[10:11]
    s_add_u32 m0, s12, 52224
    s_nop 0
    global_load_lds_dwordx4 v6, s[10:11]
    s_add_u32 s30, s30, 1
    s_cmp_eq_u32 s30, s31
    s_cselect_b32 s34, s33, s27
    s_cselect_b32 s35, -1, 0
    s_cselect_b32 s30, 0, s30
    s_add_u32 s10, s10, s34
    s_addc_u32 s11, s11, s35
    s_add_u32 m0, s12, 65536
    s_nop 0
    global_load_lds_dwordx4 v3, s[10:11]
    s_add_u32 m0, s12, 66560
    s_nop 0
    global_load_lds_dwordx4 v4, s[10:11]
    s_add_u32 m0, s12, 67584
    s_nop 0
    global_load_lds_dwordx4 v5, s[10:11]
    s_add_u32 m0, s12, 68608
    s_nop 0
    global_load_lds_dwordx4 v6, s[10:11]
    s_add_u32 s30, s30, 1
    s_cmp_eq_u32 s30, s31
    s_cselect_b32 s34, s33, s27
    s_cselect_b32 s35, -1, 0
    s_cselect_b32 s30, 0, s30
    s_add_u32 s10, s10, s34
    s_addc_u32 s11, s11, s35
    s_add_u32 m0, s12, 81920
    s_nop 0
    global_load_lds_dwordx4 v3, s[10:11]
    s_add_u32 m0, s12, 82944
    s_nop 0
    global_load_lds_dwordx4 v4, s[10:11]
    s_add_u32 m0, s12, 83968
    s_nop 0
    global_load_lds_dwordx4 v5, s[10:11]
    s_add_u32 m0, s12, 84992
    s_nop 0
    global_load_lds_dwordx4 v6, s[10:11]
    s_add_u32 s30, s30, 1
    s_cmp_eq_u32 s30, s31
    s_cselect_b32 s34, s33, s27
    s_cselect_b32 s35, -1, 0
    s_cselect_b32 s30, 0, s30
    s_add_u32 s10, s10, s34
    s_addc_u32 s11, s11, s35
    s_add_u32 m0, s12, 98304
    s_nop 0
    global_load_lds_dwordx4 v3, s[10:11]
    s_add_u32 m0, s12, 99328
    s_nop 0
    global_load_lds_dwordx4 v4, s[10:11]
    s_add_u32 m0, s12, 100352
    s_nop 0
    global_load_lds_dwordx4 v5, s[10:11]
    s_add_u32 m0, s12, 101376
    s_nop 0
    global_load_lds_dwordx4 v6, s[10:11]
    s_add_u32 s30, s30, 1
    s_cmp_eq_u32 s30, s31
    s_cselect_b32 s34, s33, s27
    s_cselect_b32 s35, -1, 0
    s_cselect_b32 s30, 0, s30
    s_add_u32 s10, s10, s34
    s_addc_u32 s11, s11, s35
    s_lshl_b32 s15, s53, 8
    s_add_u32 s10, s66, s15
    s_addc_u32 s11, s67, 0
    s_mov_b32 s30, s36
    s_mul_i32 s34, s36, s27
    s_add_u32 s10, s10, s34
    s_addc_u32 s11, s11, 0
    s_mul_i32 s34, s31, s27
    s_sub_u32 s33, s27, s34
    s_mov_b32 s12, 8192
    s_add_u32 m0, s12, 0
    s_nop 0
    global_load_lds_dwordx4 v3, s[10:11]
    s_add_u32 m0, s12, 1024
    s_nop 0
    global_load_lds_dwordx4 v4, s[10:11]
    s_add_u32 m0, s12, 2048
    s_nop 0
    global_load_lds_dwordx4 v5, s[10:11]
    s_add_u32 m0, s12, 3072
    s_nop 0
    global_load_lds_dwordx4 v6, s[10:11]
    s_add_u32 s30, s30, 1
    s_cmp_eq_u32 s30, s31
    s_cselect_b32 s34, s33, s27
    s_cselect_b32 s35, -1, 0
    s_cselect_b32 s30, 0, s30
    s_add_u32 s10, s10, s34
    s_addc_u32 s11, s11, s35
    s_add_u32 m0, s12, 16384
    s_nop 0
    global_load_lds_dwordx4 v3, s[10:11]
    s_add_u32 m0, s12, 17408
    s_nop 0
    global_load_lds_dwordx4 v4, s[10:11]
    s_add_u32 m0, s12, 18432
    s_nop 0
    global_load_lds_dwordx4 v5, s[10:11]
    s_add_u32 m0, s12, 19456
    s_nop 0
    global_load_lds_dwordx4 v6, s[10:11]
    s_add_u32 s30, s30, 1
    s_cmp_eq_u32 s30, s31
    s_cselect_b32 s34, s33, s27
    s_cselect_b32 s35, -1, 0
    s_cselect_b32 s30, 0, s30
    s_add_u32 s10, s10, s34
    s_addc_u32 s11, s11, s35
    s_add_u32 m0, s12, 32768
    s_nop 0
    global_load_lds_dwordx4 v3, s[10:11]
    s_add_u32 m0, s12, 33792
    s_nop 0
    global_load_lds_dwordx4 v4, s[10:11]
    s_add_u32 m0, s12, 34816
    s_nop 0
    global_load_lds_dwordx4 v5, s[10:11]
    s_add_u32 m0, s12, 35840
    s_nop 0
    global_load_lds_dwordx4 v6, s[10:11]
    s_add_u32 s30, s30, 1
    s_cmp_eq_u32 s30, s31
    s_cselect_b32 s34, s33, s27
    s_cselect_b32 s35, -1, 0
    s_cselect_b32 s30, 0, s30
    s_add_u32 s10, s10, s34
    s_addc_u32 s11, s11, s35
    s_add_u32 m0, s12, 49152
    s_nop 0
    global_load_lds_dwordx4 v3, s[10:11]
    s_add_u32 m0, s12, 50176
    s_nop 0
    global_load_lds_dwordx4 v4, s[10:11]
    s_add_u32 m0, s12, 51200
    s_nop 0
    global_load_lds_dwordx4 v5, s[10:11]
    s_add_u32 m0, s12, 52224
    s_nop 0
    global_load_lds_dwordx4 v6, s[10:11]
    s_add_u32 s30, s30, 1
    s_cmp_eq_u32 s30, s31
    s_cselect_b32 s34, s33, s27
    s_cselect_b32 s35, -1, 0
    s_cselect_b32 s30, 0, s30
    s_add_u32 s10, s10, s34
    s_addc_u32 s11, s11, s35
    s_add_u32 m0, s12, 65536
    s_nop 0
    global_load_lds_dwordx4 v3, s[10:11]
    s_add_u32 m0, s12, 66560
    s_nop 0
    global_load_lds_dwordx4 v4, s[10:11]
    s_add_u32 m0, s12, 67584
    s_nop 0
    global_load_lds_dwordx4 v5, s[10:11]
    s_add_u32 m0, s12, 68608
    s_nop 0
    global_load_lds_dwordx4 v6, s[10:11]
    s_add_u32 s30, s30, 1
    s_cmp_eq_u32 s30, s31
    s_cselect_b32 s34, s33, s27
    s_cselect_b32 s35, -1, 0
    s_cselect_b32 s30, 0, s30
    s_add_u32 s10, s10, s34
    s_addc_u32 s11, s11, s35
    s_add_u32 m0, s12, 81920
    s_nop 0
    global_load_lds_dwordx4 v3, s[10:11]
    s_add_u32 m0, s12, 82944
    s_nop 0
    global_load_lds_dwordx4 v4, s[10:11]
    s_add_u32 m0, s12, 83968
    s_nop 0
    global_load_lds_dwordx4 v5, s[10:11]
    s_add_u32 m0, s12, 84992
    s_nop 0
    global_load_lds_dwordx4 v6, s[10:11]
    s_add_u32 s30, s30, 1
    s_cmp_eq_u32 s30, s31
    s_cselect_b32 s34, s33, s27
    s_cselect_b32 s35, -1, 0
    s_cselect_b32 s30, 0, s30
    s_add_u32 s10, s10, s34
    s_addc_u32 s11, s11, s35
    s_add_u32 m0, s12, 98304
    s_nop 0
    global_load_lds_dwordx4 v3, s[10:11]
    s_add_u32 m0, s12, 99328
    s_nop 0
    global_load_lds_dwordx4 v4, s[10:11]
    s_add_u32 m0, s12, 100352
    s_nop 0
    global_load_lds_dwordx4 v5, s[10:11]
    s_add_u32 m0, s12, 101376
    s_nop 0
    global_load_lds_dwordx4 v6, s[10:11]
    s_add_u32 s30, s30, 1
    s_cmp_eq_u32 s30, s31
    s_cselect_b32 s34, s33, s27
    s_cselect_b32 s35, -1, 0
    s_cselect_b32 s30, 0, s30
    s_add_u32 s10, s10, s34
    s_addc_u32 s11, s11, s35
    s_lshl_b32 s15, s53, 8
    s_add_u32 s10, s66, s15
    s_addc_u32 s11, s67, 0
    s_add_u32 s10, s10, 131072
    s_addc_u32 s11, s11, 0
    s_mov_b32 s30, s36
    s_mul_i32 s34, s36, s27
    s_add_u32 s10, s10, s34
    s_addc_u32 s11, s11, 0
    s_mul_i32 s34, s31, s27
    s_sub_u32 s33, s27, s34
    s_mov_b32 s12, 12288
    s_add_u32 m0, s12, 0
    s_nop 0
    global_load_lds_dwordx4 v3, s[10:11]
    s_add_u32 m0, s12, 1024
    s_nop 0
    global_load_lds_dwordx4 v4, s[10:11]
    s_add_u32 m0, s12, 2048
    s_nop 0
    global_load_lds_dwordx4 v5, s[10:11]
    s_add_u32 m0, s12, 3072
    s_nop 0
    global_load_lds_dwordx4 v6, s[10:11]
    s_add_u32 s30, s30, 1
    s_cmp_eq_u32 s30, s31
    s_cselect_b32 s34, s33, s27
    s_cselect_b32 s35, -1, 0
    s_cselect_b32 s30, 0, s30
    s_add_u32 s10, s10, s34
    s_addc_u32 s11, s11, s35
    s_add_u32 m0, s12, 16384
    s_nop 0
    global_load_lds_dwordx4 v3, s[10:11]
    s_add_u32 m0, s12, 17408
    s_nop 0
    global_load_lds_dwordx4 v4, s[10:11]
    s_add_u32 m0, s12, 18432
    s_nop 0
    global_load_lds_dwordx4 v5, s[10:11]
    s_add_u32 m0, s12, 19456
    s_nop 0
    global_load_lds_dwordx4 v6, s[10:11]
    s_add_u32 s30, s30, 1
    s_cmp_eq_u32 s30, s31
    s_cselect_b32 s34, s33, s27
    s_cselect_b32 s35, -1, 0
    s_cselect_b32 s30, 0, s30
    s_add_u32 s10, s10, s34
    s_addc_u32 s11, s11, s35
    s_add_u32 m0, s12, 32768
    s_nop 0
    global_load_lds_dwordx4 v3, s[10:11]
    s_add_u32 m0, s12, 33792
    s_nop 0
    global_load_lds_dwordx4 v4, s[10:11]
    s_add_u32 m0, s12, 34816
    s_nop 0
    global_load_lds_dwordx4 v5, s[10:11]
    s_add_u32 m0, s12, 35840
    s_nop 0
    global_load_lds_dwordx4 v6, s[10:11]
    s_add_u32 s30, s30, 1
    s_cmp_eq_u32 s30, s31
    s_cselect_b32 s34, s33, s27
    s_cselect_b32 s35, -1, 0
    s_cselect_b32 s30, 0, s30
    s_add_u32 s10, s10, s34
    s_addc_u32 s11, s11, s35
    s_add_u32 m0, s12, 49152
    s_nop 0
    global_load_lds_dwordx4 v3, s[10:11]
    s_add_u32 m0, s12, 50176
    s_nop 0
    global_load_lds_dwordx4 v4, s[10:11]
    s_add_u32 m0, s12, 51200
    s_nop 0
    global_load_lds_dwordx4 v5, s[10:11]
    s_add_u32 m0, s12, 52224
    s_nop 0
    global_load_lds_dwordx4 v6, s[10:11]
    s_add_u32 s30, s30, 1
    s_cmp_eq_u32 s30, s31
    s_cselect_b32 s34, s33, s27
    s_cselect_b32 s35, -1, 0
    s_cselect_b32 s30, 0, s30
    s_add_u32 s10, s10, s34
    s_addc_u32 s11, s11, s35
    s_add_u32 m0, s12, 65536
    s_nop 0
    global_load_lds_dwordx4 v3, s[10:11]
    s_add_u32 m0, s12, 66560
    s_nop 0
    global_load_lds_dwordx4 v4, s[10:11]
    s_add_u32 m0, s12, 67584
    s_nop 0
    global_load_lds_dwordx4 v5, s[10:11]
    s_add_u32 m0, s12, 68608
    s_nop 0
    global_load_lds_dwordx4 v6, s[10:11]
    s_add_u32 s30, s30, 1
    s_cmp_eq_u32 s30, s31
    s_cselect_b32 s34, s33, s27
    s_cselect_b32 s35, -1, 0
    s_cselect_b32 s30, 0, s30
    s_add_u32 s10, s10, s34
    s_addc_u32 s11, s11, s35
    s_add_u32 m0, s12, 81920
    s_nop 0
    global_load_lds_dwordx4 v3, s[10:11]
    s_add_u32 m0, s12, 82944
    s_nop 0
    global_load_lds_dwordx4 v4, s[10:11]
    s_add_u32 m0, s12, 83968
    s_nop 0
    global_load_lds_dwordx4 v5, s[10:11]
    s_add_u32 m0, s12, 84992
    s_nop 0
    global_load_lds_dwordx4 v6, s[10:11]
    s_add_u32 s30, s30, 1
    s_cmp_eq_u32 s30, s31
    s_cselect_b32 s34, s33, s27
    s_cselect_b32 s35, -1, 0
    s_cselect_b32 s30, 0, s30
    s_add_u32 s10, s10, s34
    s_addc_u32 s11, s11, s35
    s_add_u32 m0, s12, 98304
    s_nop 0
    global_load_lds_dwordx4 v3, s[10:11]
    s_add_u32 m0, s12, 99328
    s_nop 0
    global_load_lds_dwordx4 v4, s[10:11]
    s_add_u32 m0, s12, 100352
    s_nop 0
    global_load_lds_dwordx4 v5, s[10:11]
    s_add_u32 m0, s12, 101376
    s_nop 0
    global_load_lds_dwordx4 v6, s[10:11]
    s_add_u32 s30, s30, 1
    s_cmp_eq_u32 s30, s31
    s_cselect_b32 s34, s33, s27
    s_cselect_b32 s35, -1, 0
    s_cselect_b32 s30, 0, s30
    s_add_u32 s10, s10, s34
    s_addc_u32 s11, s11, s35
nodma_128:
    s_cmp_ge_u32 s84, 64
    s_cbranch_scc1 nf_129
    v_mov_b32 v44, -1
    v_mov_b32 v45, -1
    v_mov_b32 v46, -1
    v_mov_b32 v47, -1
    s_lshl_b32 s14, s84, 12
    s_add_u32 s14, s14, 58589184
    s_add_u32 s96, s80, s14
    s_addc_u32 s97, s81, 0
    global_store_dwordx4 v2, v[44:47], s[96:97] offset:0 sc1
    global_store_dwordx4 v2, v[44:47], s[96:97] offset:1024 sc1
    global_store_dwordx4 v2, v[44:47], s[96:97] offset:2048 sc1
    global_store_dwordx4 v2, v[44:47], s[96:97] offset:3072 sc1
nf_129:
    s_mul_hi_u32 s14, s84, 57266231
    s_mul_i32 s15, s14, 75
    s_sub_u32 s15, s84, s15
    s_mul_i32 s15, s15, 57344
    s_min_u32 s15, s15, 4136960
    s_cmp_eq_u32 s14, 1
    s_cselect_b32 s96, s68, s66
    s_cselect_b32 s97, s69, s67
    s_cmp_eq_u32 s14, 2
    s_cselect_b32 s96, s64, s96
    s_cselect_b32 s97, s65, s97
    s_add_u32 s96, s96, s15
    s_addc_u32 s97, s97, 0
    global_load_dwordx4 v[128:131], v2, s[96:97] offset:0
    global_load_dwordx4 v[132:135], v2, s[96:97] offset:1024
    global_load_dwordx4 v[136:139], v2, s[96:97] offset:2048
    global_load_dwordx4 v[140:143], v2, s[96:97] offset:3072
    s_add_u32 s96, s96, 4096
    s_addc_u32 s97, s97, 0
    global_load_dwordx4 v[144:147], v2, s[96:97] offset:0
    global_load_dwordx4 v[148:151], v2, s[96:97] offset:1024
    global_load_dwordx4 v[152:155], v2, s[96:97] offset:2048
    global_load_dwordx4 v[156:159], v2, s[96:97] offset:3072
    s_add_u32 s96, s96, 4096
    s_addc_u32 s97, s97, 0
    global_load_dwordx4 v[160:163], v2, s[96:97] offset:0
    global_load_dwordx4 v[164:167], v2, s[96:97] offset:1024
    global_load_dwordx4 v[168:171], v2, s[96:97] offset:2048
    global_load_dwordx4 v[172:175], v2, s[96:97] offset:3072
    s_add_u32 s96, s96, 4096
    s_addc_u32 s97, s97, 0
    global_load_dwordx4 v[176:179], v2, s[96:97] offset:0
    global_load_dwordx4 v[180:183], v2, s[96:97] offset:1024
    global_load_dwordx4 v[184:187], v2, s[96:97] offset:2048
    global_load_dwordx4 v[188:191], v2, s[96:97] offset:3072
    s_add_u32 s96, s96, 4096
    s_addc_u32 s97, s97, 0
    global_load_dwordx4 v[192:195], v2, s[96:97] offset:0
    global_load_dwordx4 v[196:199], v2, s[96:97] offset:1024
    global_load_dwordx4 v[200:203], v2, s[96:97] offset:2048
    global_load_dwordx4 v[204:207], v2, s[96:97] offset:3072
    s_add_u32 s96, s96, 4096
    s_addc_u32 s97, s97, 0
    global_load_dwordx4 v[208:211], v2, s[96:97] offset:0
    global_load_dwordx4 v[212:215], v2, s[96:97] offset:1024
    global_load_dwordx4 v[216:219], v2, s[96:97] offset:2048
    global_load_dwordx4 v[220:223], v2, s[96:97] offset:3072
    s_add_u32 s96, s96, 4096
    s_addc_u32 s97, s97, 0
    global_load_dwordx4 v[224:227], v2, s[96:97] offset:0
    global_load_dwordx4 v[228:231], v2, s[96:97] offset:1024
    global_load_dwordx4 v[232:235], v2, s[96:97] offset:2048
    global_load_dwordx4 v[236:239], v2, s[96:97] offset:3072
    s_add_u32 s96, s96, 4096
    s_addc_u32 s97, s97, 0
    global_load_dwordx4 v[128:131], v2, s[96:97] offset:0
    global_load_dwordx4 v[132:135], v2, s[96:97] offset:1024
    global_load_dwordx4 v[136:139], v2, s[96:97] offset:2048
    global_load_dwordx4 v[140:143], v2, s[96:97] offset:3072
    s_add_u32 s96, s96, 4096
    s_addc_u32 s97, s97, 0
    global_load_dwordx4 v[144:147], v2, s[96:97] offset:0
    global_load_dwordx4 v[148:151], v2, s[96:97] offset:1024
    global_load_dwordx4 v[152:155], v2, s[96:97] offset:2048
    global_load_dwordx4 v[156:159], v2, s[96:97] offset:3072
    s_add_u32 s96, s96, 4096
    s_addc_u32 s97, s97, 0
    global_load_dwordx4 v[160:163], v2, s[96:97] offset:0
    global_load_dwordx4 v[164:167], v2, s[96:97] offset:1024
    global_load_dwordx4 v[168:171], v2, s[96:97] offset:2048
    global_load_dwordx4 v[172:175], v2, s[96:97] offset:3072
    s_add_u32 s96, s96, 4096
    s_addc_u32 s97, s97, 0
    global_load_dwordx4 v[176:179], v2, s[96:97] offset:0
    global_load_dwordx4 v[180:183], v2, s[96:97] offset:1024
    global_load_dwordx4 v[184:187], v2, s[96:97] offset:2048
    global_load_dwordx4 v[188:191], v2, s[96:97] offset:3072
    s_add_u32 s96, s96, 4096
    s_addc_u32 s97, s97, 0
    global_load_dwordx4 v[192:195], v2, s[96:97] offset:0
    global_load_dwordx4 v[196:199], v2, s[96:97] offset:1024
    global_load_dwordx4 v[200:203], v2, s[96:97] offset:2048
    global_load_dwordx4 v[204:207], v2, s[96:97] offset:3072
    s_add_u32 s96, s96, 4096
    s_addc_u32 s97, s97, 0
    global_load_dwordx4 v[208:211], v2, s[96:97] offset:0
    global_load_dwordx4 v[212:215], v2, s[96:97] offset:1024
    global_load_dwordx4 v[216:219], v2, s[96:97] offset:2048
    global_load_dwordx4 v[220:223], v2, s[96:97] offset:3072
    s_add_u32 s96, s96, 4096
    s_addc_u32 s97, s97, 0
    global_load_dwordx4 v[224:227], v2, s[96:97] offset:0
    global_load_dwordx4 v[228:231], v2, s[96:97] offset:1024
    global_load_dwordx4 v[232:235], v2, s[96:97] offset:2048
    global_load_dwordx4 v[236:239], v2, s[96:97] offset:3072
    s_branch w3j_127
w3_126:
    s_add_u32 s30, s30, 1
    s_cmp_eq_u32 s30, s31
    s_cselect_b32 s34, s33, s27
    s_cselect_b32 s35, -1, 0
    s_cselect_b32 s30, 0, s30
    s_add_u32 s10, s10, s34
    s_addc_u32 s11, s11, s35
    s_add_u32 s30, s30, 1
    s_cmp_eq_u32 s30, s31
    s_cselect_b32 s34, s33, s27
    s_cselect_b32 s35, -1, 0
    s_cselect_b32 s30, 0, s30
    s_add_u32 s10, s10, s34
    s_addc_u32 s11, s11, s35
    s_add_u32 s30, s30, 1
    s_cmp_eq_u32 s30, s31
    s_cselect_b32 s34, s33, s27
    s_cselect_b32 s35, -1, 0
    s_cselect_b32 s30, 0, s30
    s_add_u32 s10, s10, s34
    s_addc_u32 s11, s11, s35
    s_add_u32 s30, s30, 1
    s_cmp_eq_u32 s30, s31
    s_cselect_b32 s34, s33, s27
    s_cselect_b32 s35, -1, 0
    s_cselect_b32 s30, 0, s30
    s_add_u32 s10, s10, s34
    s_addc_u32 s11, s11, s35
    s_add_u32 s30, s30, 1
    s_cmp_eq_u32 s30, s31
    s_cselect_b32 s34, s33, s27
    s_cselect_b32 s35, -1, 0
    s_cselect_b32 s30, 0, s30
    s_add_u32 s10, s10, s34
    s_addc_u32 s11, s11, s35
    s_add_u32 s30, s30, 1
    s_cmp_eq_u32 s30, s31
    s_cselect_b32 s34, s33, s27
    s_cselect_b32 s35, -1, 0
    s_cselect_b32 s30, 0, s30
    s_add_u32 s10, s10, s34
    s_addc_u32 s11, s11, s35
    s_add_u32 s30, s30, 1
    s_cmp_eq_u32 s30, s31
    s_cselect_b32 s34, s33, s27
    s_cselect_b32 s35, -1, 0
    s_cselect_b32 s30, 0, s30
    s_add_u32 s10, s10, s34
    s_addc_u32 s11, s11, s35
w3j_127:
    s_mul_i32 s87, s4, 224
    s_add_u32 s87, s87, s84
    s_cmp_ge_u32 s87, 512
    s_cbranch_scc1 noln_124
    s_lshl_b32 s88, s87, 2
    s_add_u32 s94, s80, 61865984
    s_addc_u32 s95, s81, 0
    s_mov_b32 s89, s88
    v_lshrrev_b32 v82, 4, v1
    v_and_b32 v83, 15, v1
    v_add_u32 v84, s89, v82
    v_lshlrev_b32 v80, 10, v84
    v_lshl_add_u32 v80, v83, 4, v80
    global_load_dwordx4 v[32:35], v80, s[60:61] offset:0
    global_load_dwordx4 v[36:39], v80, s[60:61] offset:256
    global_load_dwordx4 v[40:43], v80, s[60:61] offset:512
    global_load_dwordx4 v[44:47], v80, s[60:61] offset:768
    s_barrier
    v_lshrrev_b32 v81, 5, v84
    v_lshlrev_b32 v81, 15, v81
    v_lshrrev_b32 v85, 1, v83
    v_lshl_add_u32 v81, v85, 10, v81
    v_and_b32 v85, 1, v83
    v_lshl_add_u32 v81, v85, 9, v81
    v_and_b32 v85, 31, v84
    v_lshl_add_u32 v81, v85, 4, v81
    s_waitcnt vmcnt(0)
    v_lshlrev_b32 v48, 16, v32
    v_and_b32 v49, 0xffff0000, v32
    v_lshlrev_b32 v50, 16, v33
    v_and_b32 v51, 0xffff0000, v33
    v_lshlrev_b32 v52, 16, v34
    v_and_b32 v53, 0xffff0000, v34
    v_lshlrev_b32 v54, 16, v35
    v_and_b32 v55, 0xffff0000, v35
    v_lshlrev_b32 v56, 16, v36
    v_and_b32 v57, 0xffff0000, v36
    v_lshlrev_b32 v58, 16, v37
    v_and_b32 v59, 0xffff0000, v37
    v_lshlrev_b32 v60, 16, v38
    v_and_b32 v61, 0xffff0000, v38
    v_lshlrev_b32 v62, 16, v39
    v_and_b32 v63, 0xffff0000, v39
    v_lshlrev_b32 v64, 16, v40
    v_and_b32 v65, 0xffff0000, v40
    v_lshlrev_b32 v66, 16, v41
    v_and_b32 v67, 0xffff0000, v41
    v_lshlrev_b32 v68, 16, v42
    v_and_b32 v69, 0xffff0000, v42
    v_lshlrev_b32 v70, 16, v43
    v_and_b32 v71, 0xffff0000, v43
    v_lshlrev_b32 v72, 16, v44
    v_and_b32 v73, 0xffff0000, v44
    v_lshlrev_b32 v74, 16, v45
    v_and_b32 v75, 0xffff0000, v45
    v_lshlrev_b32 v76, 16, v46
    v_and_b32 v77, 0xffff0000, v46
    v_lshlrev_b32 v78, 16, v47
    v_and_b32 v79, 0xffff0000, v47
    v_add_f32 v86, v48, v52
    v_add_f32 v87, v49, v53
    v_add_f32 v88, v50, v54
    v_add_f32 v89, v51, v55
    v_add_f32 v86, v86, v56
    v_add_f32 v87, v87, v57
    v_add_f32 v88, v88, v58
    v_add_f32 v89, v89, v59
    v_add_f32 v86, v86, v60
    v_add_f32 v87, v87, v61
    v_add_f32 v88, v88, v62
    v_add_f32 v89, v89, v63
    v_add_f32 v86, v86, v64
    v_add_f32 v87, v87, v65
    v_add_f32 v88, v88, v66
    v_add_f32 v89, v89, v67
    v_add_f32 v86, v86, v68
    v_add_f32 v87, v87, v69
    v_add_f32 v88, v88, v70
    v_add_f32 v89, v89, v71
    v_add_f32 v86, v86, v72
    v_add_f32 v87, v87, v73
    v_add_f32 v88, v88, v74
    v_add_f32 v89, v89, v75
    v_add_f32 v86, v86, v76
    v_add_f32 v87, v87, v77
    v_add_f32 v88, v88, v78
    v_add_f32 v89, v89, v79
    v_add_f32 v86, v86, v87
    v_add_f32 v88, v88, v89
    v_add_f32 v86, v86, v88
    s_nop 1
    v_add_f32_dpp v86, v86, v86 quad_perm:[1,0,3,2] row_mask:0xf bank_mask:0xf
    s_nop 1
    v_add_f32_dpp v86, v86, v86 quad_perm:[2,3,0,1] row_mask:0xf bank_mask:0xf
    s_nop 1
    v_add_f32_dpp v86, v86, v86 row_half_mirror row_mask:0xf bank_mask:0xf
    s_nop 1
    v_add_f32_dpp v86, v86, v86 row_mirror row_mask:0xf bank_mask:0xf
    v_mul_f32 v90, 0x3b000000, v86
    v_mov_b32 v86, 0
    v_mov_b32 v87, 0
    v_mov_b32 v88, 0
    v_mov_b32 v89, 0
    v_sub_f32 v91, v48, v90
    v_sub_f32 v92, v49, v90
    v_sub_f32 v93, v50, v90
    v_sub_f32 v94, v51, v90
    v_fmac_f32 v86, v91, v91
    v_fmac_f32 v87, v92, v92
    v_fmac_f32 v88, v93, v93
    v_fmac_f32 v89, v94, v94
    v_sub_f32 v91, v52, v90
    v_sub_f32 v92, v53, v90
    v_sub_f32 v93, v54, v90
    v_sub_f32 v94, v55, v90
    v_fmac_f32 v86, v91, v91
    v_fmac_f32 v87, v92, v92
    v_fmac_f32 v88, v93, v93
    v_fmac_f32 v89, v94, v94
    v_sub_f32 v91, v56, v90
    v_sub_f32 v92, v57, v90
    v_sub_f32 v93, v58, v90
    v_sub_f32 v94, v59, v90
    v_fmac_f32 v86, v91, v91
    v_fmac_f32 v87, v92, v92
    v_fmac_f32 v88, v93, v93
    v_fmac_f32 v89, v94, v94
    v_sub_f32 v91, v60, v90
    v_sub_f32 v92, v61, v90
    v_sub_f32 v93, v62, v90
    v_sub_f32 v94, v63, v90
    v_fmac_f32 v86, v91, v91
    v_fmac_f32 v87, v92, v92
    v_fmac_f32 v88, v93, v93
    v_fmac_f32 v89, v94, v94
    v_sub_f32 v91, v64, v90
    v_sub_f32 v92, v65, v90
    v_sub_f32 v93, v66, v90
    v_sub_f32 v94, v67, v90
    v_fmac_f32 v86, v91, v91
    v_fmac_f32 v87, v92, v92
    v_fmac_f32 v88, v93, v93
    v_fmac_f32 v89, v94, v94
    v_sub_f32 v91, v68, v90
    v_sub_f32 v92, v69, v90
    v_sub_f32 v93, v70, v90
    v_sub_f32 v94, v71, v90
    v_fmac_f32 v86, v91, v91
    v_fmac_f32 v87, v92, v92
    v_fmac_f32 v88, v93, v93
    v_fmac_f32 v89, v94, v94
    v_sub_f32 v91, v72, v90
    v_sub_f32 v92, v73, v90
    v_sub_f32 v93, v74, v90
    v_sub_f32 v94, v75, v90
    v_fmac_f32 v86, v91, v91
    v_fmac_f32 v87, v92, v92
    v_fmac_f32 v88, v93, v93
    v_fmac_f32 v89, v94, v94
    v_sub_f32 v91, v76, v90
    v_sub_f32 v92, v77, v90
    v_sub_f32 v93, v78, v90
    v_sub_f32 v94, v79, v90
    v_fmac_f32 v86, v91, v91
    v_fmac_f32 v87, v92, v92
    v_fmac_f32 v88, v93, v93
    v_fmac_f32 v89, v94, v94
    v_add_f32 v86, v86, v87
    v_add_f32 v88, v88, v89
    v_add_f32 v86, v86, v88
    s_nop 1
    v_add_f32_dpp v86, v86, v86 quad_perm:[1,0,3,2] row_mask:0xf bank_mask:0xf
    s_nop 1
    v_add_f32_dpp v86, v86, v86 quad_perm:[2,3,0,1] row_mask:0xf bank_mask:0xf
    s_nop 1
    v_add_f32_dpp v86, v86, v86 row_half_mirror row_mask:0xf bank_mask:0xf
    s_nop 1
    v_add_f32_dpp v86, v86, v86 row_mirror row_mask:0xf bank_mask:0xf
    v_mul_f32 v95, 0x3b000000, v86
    v_cvt_pk_bf16_f32 v91, v90, v95
    v_lshlrev_b32 v96, 16, v91
    v_and_b32 v95, 0xffff0000, v91
    v_add_f32 v95, 0x3727c5ac, v95
    v_cvt_pk_bf16_f32 v91, v95, v95
    v_lshlrev_b32 v95, 16, v91
    v_sqrt_f32 v97, v95
    s_nop 0
    v_cvt_pk_bf16_f32 v91, v97, v97
    v_lshlrev_b32 v97, 16, v91
    v_rcp_f32 v98, v97
    s_nop 0
    v_sub_f32 v48, v48, v96
    v_sub_f32 v49, v49, v96
    v_cvt_pk_bf16_f32 v91, v48, v49
    v_lshlrev_b32 v48, 16, v91
    v_and_b32 v49, 0xffff0000, v91
    v_mul_f32 v92, v48, v98
    v_mul_f32 v93, v49, v98
    v_fma_f32 v48, -v92, v97, v48
    v_fma_f32 v49, -v93, v97, v49
    v_fma_f32 v48, v48, v98, v92
    v_fma_f32 v49, v49, v98, v93
    v_cvt_pk_bf16_f32 v32, v48, v49
    v_sub_f32 v50, v50, v96
    v_sub_f32 v51, v51, v96
    v_cvt_pk_bf16_f32 v91, v50, v51
    v_lshlrev_b32 v50, 16, v91
    v_and_b32 v51, 0xffff0000, v91
    v_mul_f32 v92, v50, v98
    v_mul_f32 v93, v51, v98
    v_fma_f32 v50, -v92, v97, v50
    v_fma_f32 v51, -v93, v97, v51
    v_fma_f32 v50, v50, v98, v92
    v_fma_f32 v51, v51, v98, v93
    v_cvt_pk_bf16_f32 v33, v50, v51
    v_sub_f32 v52, v52, v96
    v_sub_f32 v53, v53, v96
    v_cvt_pk_bf16_f32 v91, v52, v53
    v_lshlrev_b32 v52, 16, v91
    v_and_b32 v53, 0xffff0000, v91
    v_mul_f32 v92, v52, v98
    v_mul_f32 v93, v53, v98
    v_fma_f32 v52, -v92, v97, v52
    v_fma_f32 v53, -v93, v97, v53
    v_fma_f32 v52, v52, v98, v92
    v_fma_f32 v53, v53, v98, v93
    v_cvt_pk_bf16_f32 v34, v52, v53
    v_sub_f32 v54, v54, v96
    v_sub_f32 v55, v55, v96
    v_cvt_pk_bf16_f32 v91, v54, v55
    v_lshlrev_b32 v54, 16, v91
    v_and_b32 v55, 0xffff0000, v91
    v_mul_f32 v92, v54, v98
    v_mul_f32 v93, v55, v98
    v_fma_f32 v54, -v92, v97, v54
    v_fma_f32 v55, -v93, v97, v55
    v_fma_f32 v54, v54, v98, v92
    v_fma_f32 v55, v55, v98, v93
    v_cvt_pk_bf16_f32 v35, v54, v55
    v_sub_f32 v56, v56, v96
    v_sub_f32 v57, v57, v96
    v_cvt_pk_bf16_f32 v91, v56, v57
    v_lshlrev_b32 v56, 16, v91
    v_and_b32 v57, 0xffff0000, v91
    v_mul_f32 v92, v56, v98
    v_mul_f32 v93, v57, v98
    v_fma_f32 v56, -v92, v97, v56
    v_fma_f32 v57, -v93, v97, v57
    v_fma_f32 v56, v56, v98, v92
    v_fma_f32 v57, v57, v98, v93
    v_cvt_pk_bf16_f32 v36, v56, v57
    v_sub_f32 v58, v58, v96
    v_sub_f32 v59, v59, v96
    v_cvt_pk_bf16_f32 v91, v58, v59
    v_lshlrev_b32 v58, 16, v91
    v_and_b32 v59, 0xffff0000, v91
    v_mul_f32 v92, v58, v98
    v_mul_f32 v93, v59, v98
    v_fma_f32 v58, -v92, v97, v58
    v_fma_f32 v59, -v93, v97, v59
    v_fma_f32 v58, v58, v98, v92
    v_fma_f32 v59, v59, v98, v93
    v_cvt_pk_bf16_f32 v37, v58, v59
    v_sub_f32 v60, v60, v96
    v_sub_f32 v61, v61, v96
    v_cvt_pk_bf16_f32 v91, v60, v61
    v_lshlrev_b32 v60, 16, v91
    v_and_b32 v61, 0xffff0000, v91
    v_mul_f32 v92, v60, v98
    v_mul_f32 v93, v61, v98
    v_fma_f32 v60, -v92, v97, v60
    v_fma_f32 v61, -v93, v97, v61
    v_fma_f32 v60, v60, v98, v92
    v_fma_f32 v61, v61, v98, v93
    v_cvt_pk_bf16_f32 v38, v60, v61
    v_sub_f32 v62, v62, v96
    v_sub_f32 v63, v63, v96
    v_cvt_pk_bf16_f32 v91, v62, v63
    v_lshlrev_b32 v62, 16, v91
    v_and_b32 v63, 0xffff0000, v91
    v_mul_f32 v92, v62, v98
    v_mul_f32 v93, v63, v98
    v_fma_f32 v62, -v92, v97, v62
    v_fma_f32 v63, -v93, v97, v63
    v_fma_f32 v62, v62, v98, v92
    v_fma_f32 v63, v63, v98, v93
    v_cvt_pk_bf16_f32 v39, v62, v63
    v_sub_f32 v64, v64, v96
    v_sub_f32 v65, v65, v96
    v_cvt_pk_bf16_f32 v91, v64, v65
    v_lshlrev_b32 v64, 16, v91
    v_and_b32 v65, 0xffff0000, v91
    v_mul_f32 v92, v64, v98
    v_mul_f32 v93, v65, v98
    v_fma_f32 v64, -v92, v97, v64
    v_fma_f32 v65, -v93, v97, v65
    v_fma_f32 v64, v64, v98, v92
    v_fma_f32 v65, v65, v98, v93
    v_cvt_pk_bf16_f32 v40, v64, v65
    v_sub_f32 v66, v66, v96
    v_sub_f32 v67, v67, v96
    v_cvt_pk_bf16_f32 v91, v66, v67
    v_lshlrev_b32 v66, 16, v91
    v_and_b32 v67, 0xffff0000, v91
    v_mul_f32 v92, v66, v98
    v_mul_f32 v93, v67, v98
    v_fma_f32 v66, -v92, v97, v66
    v_fma_f32 v67, -v93, v97, v67
    v_fma_f32 v66, v66, v98, v92
    v_fma_f32 v67, v67, v98, v93
    v_cvt_pk_bf16_f32 v41, v66, v67
    v_sub_f32 v68, v68, v96
    v_sub_f32 v69, v69, v96
    v_cvt_pk_bf16_f32 v91, v68, v69
    v_lshlrev_b32 v68, 16, v91
    v_and_b32 v69, 0xffff0000, v91
    v_mul_f32 v92, v68, v98
    v_mul_f32 v93, v69, v98
    v_fma_f32 v68, -v92, v97, v68
    v_fma_f32 v69, -v93, v97, v69
    v_fma_f32 v68, v68, v98, v92
    v_fma_f32 v69, v69, v98, v93
    v_cvt_pk_bf16_f32 v42, v68, v69
    v_sub_f32 v70, v70, v96
    v_sub_f32 v71, v71, v96
    v_cvt_pk_bf16_f32 v91, v70, v71
    v_lshlrev_b32 v70, 16, v91
    v_and_b32 v71, 0xffff0000, v91
    v_mul_f32 v92, v70, v98
    v_mul_f32 v93, v71, v98
    v_fma_f32 v70, -v92, v97, v70
    v_fma_f32 v71, -v93, v97, v71
    v_fma_f32 v70, v70, v98, v92
    v_fma_f32 v71, v71, v98, v93
    v_cvt_pk_bf16_f32 v43, v70, v71
    v_sub_f32 v72, v72, v96
    v_sub_f32 v73, v73, v96
    v_cvt_pk_bf16_f32 v91, v72, v73
    v_lshlrev_b32 v72, 16, v91
    v_and_b32 v73, 0xffff0000, v91
    v_mul_f32 v92, v72, v98
    v_mul_f32 v93, v73, v98
    v_fma_f32 v72, -v92, v97, v72
    v_fma_f32 v73, -v93, v97, v73
    v_fma_f32 v72, v72, v98, v92
    v_fma_f32 v73, v73, v98, v93
    v_cvt_pk_bf16_f32 v44, v72, v73
    v_sub_f32 v74, v74, v96
    v_sub_f32 v75, v75, v96
    v_cvt_pk_bf16_f32 v91, v74, v75
    v_lshlrev_b32 v74, 16, v91
    v_and_b32 v75, 0xffff0000, v91
    v_mul_f32 v92, v74, v98
    v_mul_f32 v93, v75, v98
    v_fma_f32 v74, -v92, v97, v74
    v_fma_f32 v75, -v93, v97, v75
    v_fma_f32 v74, v74, v98, v92
    v_fma_f32 v75, v75, v98, v93
    v_cvt_pk_bf16_f32 v45, v74, v75
    v_sub_f32 v76, v76, v96
    v_sub_f32 v77, v77, v96
    v_cvt_pk_bf16_f32 v91, v76, v77
    v_lshlrev_b32 v76, 16, v91
    v_and_b32 v77, 0xffff0000, v91
    v_mul_f32 v92, v76, v98
    v_mul_f32 v93, v77, v98
    v_fma_f32 v76, -v92, v97, v76
    v_fma_f32 v77, -v93, v97, v77
    v_fma_f32 v76, v76, v98, v92
    v_fma_f32 v77, v77, v98, v93
    v_cvt_pk_bf16_f32 v46, v76, v77
    v_sub_f32 v78, v78, v96
    v_sub_f32 v79, v79, v96
    v_cvt_pk_bf16_f32 v91, v78, v79
    v_lshlrev_b32 v78, 16, v91
    v_and_b32 v79, 0xffff0000, v91
    v_mul_f32 v92, v78, v98
    v_mul_f32 v93, v79, v98
    v_fma_f32 v78, -v92, v97, v78
    v_fma_f32 v79, -v93, v97, v79
    v_fma_f32 v78, v78, v98, v92
    v_fma_f32 v79, v79, v98, v93
    v_cvt_pk_bf16_f32 v47, v78, v79
    global_store_dwordx4 v81, v[32:35], s[94:95] sc1
    v_add_u32 v81, 8192, v81
    global_store_dwordx4 v81, v[36:39], s[94:95] sc1
    v_add_u32 v81, 8192, v81
    global_store_dwordx4 v81, v[40:43], s[94:95] sc1
    v_add_u32 v81, 8192, v81
    global_store_dwordx4 v81, v[44:47], s[94:95] sc1
    s_mov_b32 s88, 192
    v_mov_b32 v13, s88
wf_130:
    global_load_dword v14, v13, s[78:79] sc1
    s_waitcnt vmcnt(0)
    v_readfirstlane_b32 s87, v14
    s_cmp_ge_u32 s87, 1
    s_cbranch_scc1 wfd_131
    s_sub_u32 s86, s86, 1
    s_cbranch_scc1 wfd_131_x
    s_sleep 4
    s_branch wf_130
wfd_131_x:
    s_mov_b32 s86, 0
wfd_131:
    s_lshr_b32 s88, s89, 7
    s_lshl_b32 s88, s88, 7
    s_add_u32 s88, s88, 0
    v_mov_b32 v13, s88
    v_mov_b32 v14, 1
    s_mov_b64 exec, 1
    global_atomic_add v13, v14, s[82:83] sc1
    s_mov_b64 exec, -1
    s_branch lnj_125
noln_124:
    s_cmp_eq_u32 s4, 3
    s_cbranch_scc1 nb_132
    s_barrier
nb_132:
lnj_125:
    s_mov_b32 s85, 0
round_133:
    s_cmp_ge_u32 s85, 2
    s_cbranch_scc1 r2_142
    s_mul_hi_u32 s53, s84, 613566757
    s_mul_i32 s87, s53, 7
    s_sub_u32 s52, s84, s87
    s_mul_i32 s87, s85, 7
    s_add_u32 s52, s52, s87
    s_branch tkv_136
r2_142:
    s_sub_u32 s87, s85, 2
    s_mul_i32 s87, s87, 224
    s_add_u32 s87, s87, s84
    s_cmp_ge_u32 s87, 64
    s_cbranch_scc1 la_143
    s_lshr_b32 s52, s87, 5
    s_add_u32 s52, s52, 14
    s_and_b32 s53, s87, 31
    s_branch tkv_136
la_143:
    s_cmp_ge_u32 s87, 288
    s_cbranch_scc1 lb_144
    s_sub_u32 s87, s87, 64
    s_lshr_b32 s53, s87, 4
    s_and_b32 s52, s87, 15
    s_branch tgu_137
lb_144:
    s_cmp_ge_u32 s87, 544
    s_cbranch_scc1 lc_145
    s_sub_u32 s87, s87, 288
    s_lshr_b32 s53, s87, 4
    s_and_b32 s52, s87, 15
    s_branch tq_138
lc_145:
    s_cmp_ge_u32 s84, 128
    s_cbranch_scc1 tail_134
    s_sub_u32 s87, s84, 96
    s_lshr_b32 s52, s87, 1
    s_and_b32 s53, s87, 1
    s_branch tdn_140
tkv_136:
    s_lshl_b32 s88, s52, 7
    s_add_u32 s88, s88, 0
    s_waitcnt vmcnt(0)
    s_cmp_lg_u32 s4, 0
    s_cbranch_scc1 wg_146
    v_mov_b32 v13, s88
wf_147:
    global_load_dword v14, v13, s[82:83] sc1
    s_waitcnt vmcnt(0)
    v_readfirstlane_b32 s87, v14
    s_cmp_ge_u32 s87, 32
    s_cbranch_scc1 wfd_148
    s_sub_u32 s86, s86, 1
    s_cbranch_scc1 wfd_148_x
    s_sleep 4
    s_branch wf_147
wfd_148_x:
    s_mov_b32 s86, 0
wfd_148:
wg_146:
    s_barrier
    s_cmp_lg_u32 s55, 0
    s_cbranch_scc1 kvB_149
    s_mov_b32 s26, 8192
    s_mov_b32 s28, 1
    s_lshl_b32 s36, s52, 1
    s_mul_i32 s34, s53, 5
    s_add_u32 s36, s36, s34
    s_and_b32 s36, s36, 15
    s_mov_b32 s31, 16
    v_lshrrev_b32 v13, 4, v1
    v_and_b32 v14, 15, v1
    v_lshlrev_b32 v15, 2, v13
    v_xor_b32 v14, v14, v15
    v_lshlrev_b32 v14, 4, v14
    v_mul_lo_u32 v15, v13, s26
    v_add_u32 v3, v15, v14
    s_lshl_b32 s14, s26, 2
    v_add_u32 v4, s14, v3
    v_add_u32 v5, s14, v4
    v_add_u32 v6, s14, v5
    s_lshl_b32 s27, s26, 5
    v_lshrrev_b32 v13, 4, v1
    v_bfe_u32 v14, v1, 2, 2
    v_and_b32 v15, 3, v1
    v_lshrrev_b32 v16, 1, v13
    v_lshl_add_u32 v16, v16, 3, v14
    v_and_b32 v17, 1, v13
    v_lshlrev_b32 v17, 1, v17
    v_lshrrev_b32 v18, 1, v15
    v_add_u32 v17, v17, v18
    v_and_b32 v18, 1, v15
    v_lshlrev_b32 v18, 3, v18
    v_lshl_add_u32 v18, v16, 8, v18
    v_xor_b32 v19, 0, v14
    v_lshl_add_u32 v19, v19, 2, v17
    v_lshl_add_u32 v7, v19, 4, v18
    v_xor_b32 v19, 1, v14
    v_lshl_add_u32 v19, v19, 2, v17
    v_lshl_add_u32 v8, v19, 4, v18
    v_xor_b32 v19, 2, v14
    v_lshl_add_u32 v19, v19, 2, v17
    v_lshl_add_u32 v9, v19, 4, v18
    v_xor_b32 v19, 3, v14
    v_lshl_add_u32 v19, v19, 2, v17
    v_lshl_add_u32 v10, v19, 4, v18
    s_lshl_b32 s12, s4, 12
    s_lshl_b32 s15, s53, 8
    s_add_u32 s22, s64, s15
    s_addc_u32 s23, s65, 0
    s_add_u32 s24, s66, s15
    s_addc_u32 s25, s67, 0
    s_cmp_ge_u32 s4, 2
    s_cselect_b32 s10, s24, s22
    s_cselect_b32 s11, s25, s23
    s_and_b32 s14, s4, 1
    s_mul_i32 s14, s14, s26
    s_lshl_b32 s14, s14, 4
    s_add_u32 s10, s10, s14
    s_addc_u32 s11, s11, 0
    s_mov_b32 s30, s36
    s_mul_i32 s34, s36, s27
    s_add_u32 s10, s10, s34
    s_addc_u32 s11, s11, 0
    s_mul_i32 s34, s31, s27
    s_sub_u32 s33, s27, s34
kvB_149:
    v_bfe_u32 v13, v1, 4, 1
    v_lshlrev_b32 v13, 3, v13
    v_and_b32 v14, 7, v1
    v_add_u32 v13, v13, v14
    v_lshrrev_b32 v14, 5, v1
    v_lshl_add_u32 v13, v14, 4, v13
    v_lshlrev_b32 v13, 4, v13
    v_bfe_u32 v14, v1, 3, 1
    v_lshl_add_u32 v11, v14, 12, v13
    v_and_b32 v13, 15, v1
    v_lshrrev_b32 v14, 5, v1
    v_lshl_add_u32 v13, v14, 4, v13
    v_lshlrev_b32 v13, 4, v13
    v_bfe_u32 v14, v1, 4, 1
    v_lshl_add_u32 v12, v14, 10, v13
    s_lshl_b32 s15, s52, 2
    s_add_u32 s15, s15, s4
    s_lshl_b32 s16, s15, 15
    s_add_u32 s16, s16, 61865984
    s_add_u32 s8, s80, s16
    s_addc_u32 s9, s81, 0
    s_mov_b32 s29, s36
    s_lshl_b32 s34, s36, 11
    s_add_u32 s8, s8, s34
    s_addc_u32 s9, s9, 0
    s_lshl_b32 s34, s31, 11
    s_sub_u32 s32, 2048, s34
    s_lshl_b32 s16, s15, 5
    s_add_u32 s16, s16, s53
    s_lshl_b32 s16, s16, 13
    s_add_u32 s18, s80, s16
    s_addc_u32 s19, s81, 0
    s_add_u32 s16, s16, 16781312
    s_add_u32 s20, s80, s16
    s_addc_u32 s21, s81, 0
    v_add_u32 v21, 0x10000, v7
    v_add_u32 v22, 0x10000, v8
    v_add_u32 v23, 0x10000, v9
    v_add_u32 v24, 0x10000, v10
    v_mov_b64 v[128:129], 0
    v_mov_b64 v[130:131], 0
    v_mov_b64 v[132:133], 0
    v_mov_b64 v[134:135], 0
    v_mov_b64 v[136:137], 0
    v_mov_b64 v[138:139], 0
    v_mov_b64 v[140:141], 0
    v_mov_b64 v[142:143], 0
    v_mov_b64 v[144:145], 0
    v_mov_b64 v[146:147], 0
    v_mov_b64 v[148:149], 0
    v_mov_b64 v[150:151], 0
    v_mov_b64 v[152:153], 0
    v_mov_b64 v[154:155], 0
    v_mov_b64 v[156:157], 0
    v_mov_b64 v[158:159], 0
    v_mov_b64 v[160:161], 0
    v_mov_b64 v[162:163], 0
    v_mov_b64 v[164:165], 0
    v_mov_b64 v[166:167], 0
    v_mov_b64 v[168:169], 0
    v_mov_b64 v[170:171], 0
    v_mov_b64 v[172:173], 0
    v_mov_b64 v[174:175], 0
    v_mov_b64 v[176:177], 0
    v_mov_b64 v[178:179], 0
    v_mov_b64 v[180:181], 0
    v_mov_b64 v[182:183], 0
    v_mov_b64 v[184:185], 0
    v_mov_b64 v[186:187], 0
    v_mov_b64 v[188:189], 0
    v_mov_b64 v[190:191], 0
    v_mov_b64 v[192:193], 0
    v_mov_b64 v[194:195], 0
    v_mov_b64 v[196:197], 0
    v_mov_b64 v[198:199], 0
    v_mov_b64 v[200:201], 0
    v_mov_b64 v[202:203], 0
    v_mov_b64 v[204:205], 0
    v_mov_b64 v[206:207], 0
    v_mov_b64 v[208:209], 0
    v_mov_b64 v[210:211], 0
    v_mov_b64 v[212:213], 0
    v_mov_b64 v[214:215], 0
    v_mov_b64 v[216:217], 0
    v_mov_b64 v[218:219], 0
    v_mov_b64 v[220:221], 0
    v_mov_b64 v[222:223], 0
    v_mov_b64 v[224:225], 0
    v_mov_b64 v[226:227], 0
    v_mov_b64 v[228:229], 0
    v_mov_b64 v[230:231], 0
    v_mov_b64 v[232:233], 0
    v_mov_b64 v[234:235], 0
    v_mov_b64 v[236:237], 0
    v_mov_b64 v[238:239], 0
    v_mov_b64 v[240:241], 0
    v_mov_b64 v[242:243], 0
    v_mov_b64 v[244:245], 0
    v_mov_b64 v[246:247], 0
    v_mov_b64 v[248:249], 0
    v_mov_b64 v[250:251], 0
    v_mov_b64 v[252:253], 0
    v_mov_b64 v[254:255], 0
    global_load_dwordx4 a[0:3], v2, s[8:9] offset:0 sc1
    global_load_dwordx4 a[4:7], v2, s[8:9] offset:1024 sc1
    s_add_u32 s29, s29, 1
    s_cmp_eq_u32 s29, s31
    s_cselect_b32 s34, s32, 2048
    s_cselect_b32 s35, -1, 0
    s_cselect_b32 s29, 0, s29
    s_add_u32 s8, s8, s34
    s_addc_u32 s9, s9, s35
    global_load_dwordx4 a[8:11], v2, s[8:9] offset:0 sc1
    global_load_dwordx4 a[12:15], v2, s[8:9] offset:1024 sc1
    s_add_u32 s29, s29, 1
    s_cmp_eq_u32 s29, s31
    s_cselect_b32 s34, s32, 2048
    s_cselect_b32 s35, -1, 0
    s_cselect_b32 s29, 0, s29
    s_add_u32 s8, s8, s34
    s_addc_u32 s9, s9, s35
    global_load_dwordx4 a[16:19], v2, s[8:9] offset:0 sc1
    global_load_dwordx4 a[20:23], v2, s[8:9] offset:1024 sc1
    s_add_u32 s29, s29, 1
    s_cmp_eq_u32 s29, s31
    s_cselect_b32 s34, s32, 2048
    s_cselect_b32 s35, -1, 0
    s_cselect_b32 s29, 0, s29
    s_add_u32 s8, s8, s34
    s_addc_u32 s9, s9, s35
    global_load_dwordx4 a[24:27], v2, s[8:9] offset:0 sc1
    global_load_dwordx4 a[28:31], v2, s[8:9] offset:1024 sc1
    s_add_u32 s29, s29, 1
    s_cmp_eq_u32 s29, s31
    s_cselect_b32 s34, s32, 2048
    s_cselect_b32 s35, -1, 0
    s_cselect_b32 s29, 0, s29
    s_add_u32 s8, s8, s34
    s_addc_u32 s9, s9, s35
    global_load_dwordx4 a[32:35], v2, s[8:9] offset:0 sc1
    global_load_dwordx4 a[36:39], v2, s[8:9] offset:1024 sc1
    s_add_u32 s29, s29, 1
    s_cmp_eq_u32 s29, s31
    s_cselect_b32 s34, s32, 2048
    s_cselect_b32 s35, -1, 0
    s_cselect_b32 s29, 0, s29
    s_add_u32 s8, s8, s34
    s_addc_u32 s9, s9, s35
    global_load_dwordx4 a[40:43], v2, s[8:9] offset:0 sc1
    global_load_dwordx4 a[44:47], v2, s[8:9] offset:1024 sc1
    s_add_u32 s29, s29, 1
    s_cmp_eq_u32 s29, s31
    s_cselect_b32 s34, s32, 2048
    s_cselect_b32 s35, -1, 0
    s_cselect_b32 s29, 0, s29
    s_add_u32 s8, s8, s34
    s_addc_u32 s9, s9, s35
    global_load_dwordx4 a[48:51], v2, s[8:9] offset:0 sc1
    global_load_dwordx4 a[52:55], v2, s[8:9] offset:1024 sc1
    s_add_u32 s29, s29, 1
    s_cmp_eq_u32 s29, s31
    s_cselect_b32 s34, s32, 2048
    s_cselect_b32 s35, -1, 0
    s_cselect_b32 s29, 0, s29
    s_add_u32 s8, s8, s34
    s_addc_u32 s9, s9, s35
    s_cmp_lg_u32 s55, 0
    s_cbranch_scc1 early_150
    s_add_u32 m0, s12, 0
    s_nop 0
    global_load_lds_dwordx4 v3, s[10:11]
    s_add_u32 m0, s12, 1024
    s_nop 0
    global_load_lds_dwordx4 v4, s[10:11]
    s_add_u32 m0, s12, 2048
    s_nop 0
    global_load_lds_dwordx4 v5, s[10:11]
    s_add_u32 m0, s12, 3072
    s_nop 0
    global_load_lds_dwordx4 v6, s[10:11]
    s_add_u32 s30, s30, 1
    s_cmp_eq_u32 s30, s31
    s_cselect_b32 s34, s33, s27
    s_cselect_b32 s35, -1, 0
    s_cselect_b32 s30, 0, s30
    s_add_u32 s10, s10, s34
    s_addc_u32 s11, s11, s35
    s_add_u32 m0, s12, 16384
    s_nop 0
    global_load_lds_dwordx4 v3, s[10:11]
    s_add_u32 m0, s12, 17408
    s_nop 0
    global_load_lds_dwordx4 v4, s[10:11]
    s_add_u32 m0, s12, 18432
    s_nop 0
    global_load_lds_dwordx4 v5, s[10:11]
    s_add_u32 m0, s12, 19456
    s_nop 0
    global_load_lds_dwordx4 v6, s[10:11]
    s_add_u32 s30, s30, 1
    s_cmp_eq_u32 s30, s31
    s_cselect_b32 s34, s33, s27
    s_cselect_b32 s35, -1, 0
    s_cselect_b32 s30, 0, s30
    s_add_u32 s10, s10, s34
    s_addc_u32 s11, s11, s35
    s_add_u32 m0, s12, 32768
    s_nop 0
    global_load_lds_dwordx4 v3, s[10:11]
    s_add_u32 m0, s12, 33792
    s_nop 0
    global_load_lds_dwordx4 v4, s[10:11]
    s_add_u32 m0, s12, 34816
    s_nop 0
    global_load_lds_dwordx4 v5, s[10:11]
    s_add_u32 m0, s12, 35840
    s_nop 0
    global_load_lds_dwordx4 v6, s[10:11]
    s_add_u32 s30, s30, 1
    s_cmp_eq_u32 s30, s31
    s_cselect_b32 s34, s33, s27
    s_cselect_b32 s35, -1, 0
    s_cselect_b32 s30, 0, s30
    s_add_u32 s10, s10, s34
    s_addc_u32 s11, s11, s35
    s_add_u32 m0, s12, 49152
    s_nop 0
    global_load_lds_dwordx4 v3, s[10:11]
    s_add_u32 m0, s12, 50176
    s_nop 0
    global_load_lds_dwordx4 v4, s[10:11]
    s_add_u32 m0, s12, 51200
    s_nop 0
    global_load_lds_dwordx4 v5, s[10:11]
    s_add_u32 m0, s12, 52224
    s_nop 0
    global_load_lds_dwordx4 v6, s[10:11]
    s_add_u32 s30, s30, 1
    s_cmp_eq_u32 s30, s31
    s_cselect_b32 s34, s33, s27
    s_cselect_b32 s35, -1, 0
    s_cselect_b32 s30, 0, s30
    s_add_u32 s10, s10, s34
    s_addc_u32 s11, s11, s35
    s_add_u32 m0, s12, 65536
    s_nop 0
    global_load_lds_dwordx4 v3, s[10:11]
    s_add_u32 m0, s12, 66560
    s_nop 0
    global_load_lds_dwordx4 v4, s[10:11]
    s_add_u32 m0, s12, 67584
    s_nop 0
    global_load_lds_dwordx4 v5, s[10:11]
    s_add_u32 m0, s12, 68608
    s_nop 0
    global_load_lds_dwordx4 v6, s[10:11]
    s_add_u32 s30, s30, 1
    s_cmp_eq_u32 s30, s31
    s_cselect_b32 s34, s33, s27
    s_cselect_b32 s35, -1, 0
    s_cselect_b32 s30, 0, s30
    s_add_u32 s10, s10, s34
    s_addc_u32 s11, s11, s35
    s_add_u32 m0, s12, 81920
    s_nop 0
    global_load_lds_dwordx4 v3, s[10:11]
    s_add_u32 m0, s12, 82944
    s_nop 0
    global_load_lds_dwordx4 v4, s[10:11]
    s_add_u32 m0, s12, 83968
    s_nop 0
    global_load_lds_dwordx4 v5, s[10:11]
    s_add_u32 m0, s12, 84992
    s_nop 0
    global_load_lds_dwordx4 v6, s[10:11]
    s_add_u32 s30, s30, 1
    s_cmp_eq_u32 s30, s31
    s_cselect_b32 s34, s33, s27
    s_cselect_b32 s35, -1, 0
    s_cselect_b32 s30, 0, s30
    s_add_u32 s10, s10, s34
    s_addc_u32 s11, s11, s35
    s_add_u32 m0, s12, 98304
    s_nop 0
    global_load_lds_dwordx4 v3, s[10:11]
    s_add_u32 m0, s12, 99328
    s_nop 0
    global_load_lds_dwordx4 v4, s[10:11]
    s_add_u32 m0, s12, 100352
    s_nop 0
    global_load_lds_dwordx4 v5, s[10:11]
    s_add_u32 m0, s12, 101376
    s_nop 0
    global_load_lds_dwordx4 v6, s[10:11]
    s_add_u32 s30, s30, 1
    s_cmp_eq_u32 s30, s31
    s_cselect_b32 s34, s33, s27
    s_cselect_b32 s35, -1, 0
    s_cselect_b32 s30, 0, s30
    s_add_u32 s10, s10, s34
    s_addc_u32 s11, s11, s35
    s_branch earlyj_151
early_150:
    s_waitcnt vmcnt(0)
earlyj_151:
    s_waitcnt vmcnt(24)
    s_barrier
    ds_read_b64_tr_b16 v[60:61], v7 offset:0
    ds_read_b64_tr_b16 v[62:63], v7 offset:1024
    ds_read_b64_tr_b16 v[64:65], v8 offset:0
    ds_read_b64_tr_b16 v[66:67], v8 offset:1024
    ds_read_b64_tr_b16 v[68:69], v9 offset:0
    ds_read_b64_tr_b16 v[70:71], v9 offset:1024
    ds_read_b64_tr_b16 v[72:73], v10 offset:0
    ds_read_b64_tr_b16 v[74:75], v10 offset:1024
    ds_read_b64_tr_b16 v[76:77], v7 offset:8192
    ds_read_b64_tr_b16 v[78:79], v7 offset:9216
    ds_read_b64_tr_b16 v[80:81], v8 offset:8192
    ds_read_b64_tr_b16 v[82:83], v8 offset:9216
    ds_read_b64_tr_b16 v[84:85], v9 offset:8192
    ds_read_b64_tr_b16 v[86:87], v9 offset:9216
    ds_read_b64_tr_b16 v[88:89], v10 offset:8192
    ds_read_b64_tr_b16 v[90:91], v10 offset:9216
    s_mov_b32 s13, s28
gl_152:
    s_waitcnt lgkmcnt(14)
    v_mfma_f32_32x32x16_bf16 v[128:143], v[60:63], a[0:3], v[128:143]
    ds_read_b64_tr_b16 v[92:93], v7 offset:4096
    ds_read_b64_tr_b16 v[94:95], v7 offset:5120
    s_waitcnt lgkmcnt(14)
    v_mfma_f32_32x32x16_bf16 v[144:159], v[64:67], a[0:3], v[144:159]
    ds_read_b64_tr_b16 v[96:97], v8 offset:4096
    ds_read_b64_tr_b16 v[98:99], v8 offset:5120
    s_waitcnt lgkmcnt(14)
    v_mfma_f32_32x32x16_bf16 v[160:175], v[68:71], a[0:3], v[160:175]
    ds_read_b64_tr_b16 v[100:101], v9 offset:4096
    ds_read_b64_tr_b16 v[102:103], v9 offset:5120
    s_waitcnt lgkmcnt(14)
    v_mfma_f32_32x32x16_bf16 v[176:191], v[72:75], a[0:3], v[176:191]
    ds_read_b64_tr_b16 v[104:105], v10 offset:4096
    ds_read_b64_tr_b16 v[106:107], v10 offset:5120
    s_waitcnt lgkmcnt(14)
    v_mfma_f32_32x32x16_bf16 v[192:207], a[0:3], v[76:79], v[192:207]
    ds_read_b64_tr_b16 v[108:109], v7 offset:12288
    ds_read_b64_tr_b16 v[110:111], v7 offset:13312
    s_waitcnt lgkmcnt(14)
    v_mfma_f32_32x32x16_bf16 v[208:223], a[0:3], v[80:83], v[208:223]
    ds_read_b64_tr_b16 v[112:113], v8 offset:12288
    ds_read_b64_tr_b16 v[114:115], v8 offset:13312
    s_waitcnt lgkmcnt(14)
    v_mfma_f32_32x32x16_bf16 v[224:239], a[0:3], v[84:87], v[224:239]
    ds_read_b64_tr_b16 v[116:117], v9 offset:12288
    ds_read_b64_tr_b16 v[118:119], v9 offset:13312
    s_waitcnt lgkmcnt(14)
    v_mfma_f32_32x32x16_bf16 v[240:255], a[0:3], v[88:91], v[240:255]
    ds_read_b64_tr_b16 v[120:121], v10 offset:12288
    ds_read_b64_tr_b16 v[122:123], v10 offset:13312
    s_waitcnt vmcnt(20)
    s_barrier
    s_waitcnt lgkmcnt(14)
    v_mfma_f32_32x32x16_bf16 v[128:143], v[92:95], a[4:7], v[128:143]
    ds_read_b64_tr_b16 v[60:61], v7 offset:16384
    ds_read_b64_tr_b16 v[62:63], v7 offset:17408
    global_load_dwordx4 a[56:59], v2, s[8:9] offset:0 sc1
    s_waitcnt lgkmcnt(14)
    v_mfma_f32_32x32x16_bf16 v[144:159], v[96:99], a[4:7], v[144:159]
    ds_read_b64_tr_b16 v[64:65], v8 offset:16384
    ds_read_b64_tr_b16 v[66:67], v8 offset:17408
    global_load_dwordx4 a[60:63], v2, s[8:9] offset:1024 sc1
    s_add_u32 s29, s29, 1
    s_cmp_eq_u32 s29, s31
    s_cselect_b32 s34, s32, 2048
    s_cselect_b32 s35, -1, 0
    s_cselect_b32 s29, 0, s29
    s_add_u32 s8, s8, s34
    s_addc_u32 s9, s9, s35
    s_waitcnt lgkmcnt(14)
    v_mfma_f32_32x32x16_bf16 v[160:175], v[100:103], a[4:7], v[160:175]
    ds_read_b64_tr_b16 v[68:69], v9 offset:16384
    ds_read_b64_tr_b16 v[70:71], v9 offset:17408
    s_add_u32 m0, s12, 114688
    s_nop 0
    global_load_lds_dwordx4 v3, s[10:11]
    s_waitcnt lgkmcnt(14)
    v_mfma_f32_32x32x16_bf16 v[176:191], v[104:107], a[4:7], v[176:191]
    ds_read_b64_tr_b16 v[72:73], v10 offset:16384
    ds_read_b64_tr_b16 v[74:75], v10 offset:17408
    s_add_u32 m0, s12, 115712
    s_nop 0
    global_load_lds_dwordx4 v4, s[10:11]
    s_waitcnt lgkmcnt(14)
    v_mfma_f32_32x32x16_bf16 v[192:207], a[4:7], v[108:111], v[192:207]
    ds_read_b64_tr_b16 v[76:77], v7 offset:24576
    ds_read_b64_tr_b16 v[78:79], v7 offset:25600
    s_add_u32 m0, s12, 116736
    s_nop 0
    global_load_lds_dwordx4 v5, s[10:11]
    s_waitcnt lgkmcnt(14)
    v_mfma_f32_32x32x16_bf16 v[208:223], a[4:7], v[112:115], v[208:223]
    ds_read_b64_tr_b16 v[80:81], v8 offset:24576
    ds_read_b64_tr_b16 v[82:83], v8 offset:25600
    s_add_u32 m0, s12, 117760
    s_nop 0
    global_load_lds_dwordx4 v6, s[10:11]
    s_add_u32 s30, s30, 1
    s_cmp_eq_u32 s30, s31
    s_cselect_b32 s34, s33, s27
    s_cselect_b32 s35, -1, 0
    s_cselect_b32 s30, 0, s30
    s_add_u32 s10, s10, s34
    s_addc_u32 s11, s11, s35
    s_waitcnt lgkmcnt(14)
    v_mfma_f32_32x32x16_bf16 v[224:239], a[4:7], v[116:119], v[224:239]
    ds_read_b64_tr_b16 v[84:85], v9 offset:24576
    ds_read_b64_tr_b16 v[86:87], v9 offset:25600
    s_waitcnt lgkmcnt(14)
    v_mfma_f32_32x32x16_bf16 v[240:255], a[4:7], v[120:123], v[240:255]
    ds_read_b64_tr_b16 v[88:89], v10 offset:24576
    ds_read_b64_tr_b16 v[90:91], v10 offset:25600
    s_waitcnt lgkmcnt(14)
    v_mfma_f32_32x32x16_bf16 v[128:143], v[60:63], a[8:11], v[128:143]
    ds_read_b64_tr_b16 v[92:93], v7 offset:20480
    ds_read_b64_tr_b16 v[94:95], v7 offset:21504
    s_waitcnt lgkmcnt(14)
    v_mfma_f32_32x32x16_bf16 v[144:159], v[64:67], a[8:11], v[144:159]
    ds_read_b64_tr_b16 v[96:97], v8 offset:20480
    ds_read_b64_tr_b16 v[98:99], v8 offset:21504
    s_waitcnt lgkmcnt(14)
    v_mfma_f32_32x32x16_bf16 v[160:175], v[68:71], a[8:11], v[160:175]
    ds_read_b64_tr_b16 v[100:101], v9 offset:20480
    ds_read_b64_tr_b16 v[102:103], v9 offset:21504
    s_waitcnt lgkmcnt(14)
    v_mfma_f32_32x32x16_bf16 v[176:191], v[72:75], a[8:11], v[176:191]
    ds_read_b64_tr_b16 v[104:105], v10 offset:20480
    ds_read_b64_tr_b16 v[106:107], v10 offset:21504
    s_waitcnt lgkmcnt(14)
    v_mfma_f32_32x32x16_bf16 v[192:207], a[8:11], v[76:79], v[192:207]
    ds_read_b64_tr_b16 v[108:109], v7 offset:28672
    ds_read_b64_tr_b16 v[110:111], v7 offset:29696
    s_waitcnt lgkmcnt(14)
    v_mfma_f32_32x32x16_bf16 v[208:223], a[8:11], v[80:83], v[208:223]
    ds_read_b64_tr_b16 v[112:113], v8 offset:28672
    ds_read_b64_tr_b16 v[114:115], v8 offset:29696
    s_waitcnt lgkmcnt(14)
    v_mfma_f32_32x32x16_bf16 v[224:239], a[8:11], v[84:87], v[224:239]
    ds_read_b64_tr_b16 v[116:117], v9 offset:28672
    ds_read_b64_tr_b16 v[118:119], v9 offset:29696
    s_waitcnt lgkmcnt(14)
    v_mfma_f32_32x32x16_bf16 v[240:255], a[8:11], v[88:91], v[240:255]
    ds_read_b64_tr_b16 v[120:121], v10 offset:28672
    ds_read_b64_tr_b16 v[122:123], v10 offset:29696
    s_waitcnt vmcnt(22)
    s_barrier
    s_waitcnt lgkmcnt(14)
    v_mfma_f32_32x32x16_bf16 v[128:143], v[92:95], a[12:15], v[128:143]
    ds_read_b64_tr_b16 v[60:61], v7 offset:32768
    ds_read_b64_tr_b16 v[62:63], v7 offset:33792
    global_load_dwordx4 a[0:3], v2, s[8:9] offset:0 sc1
    s_waitcnt lgkmcnt(14)
    v_mfma_f32_32x32x16_bf16 v[144:159], v[96:99], a[12:15], v[144:159]
    ds_read_b64_tr_b16 v[64:65], v8 offset:32768
    ds_read_b64_tr_b16 v[66:67], v8 offset:33792
    global_load_dwordx4 a[4:7], v2, s[8:9] offset:1024 sc1
    s_add_u32 s29, s29, 1
    s_cmp_eq_u32 s29, s31
    s_cselect_b32 s34, s32, 2048
    s_cselect_b32 s35, -1, 0
    s_cselect_b32 s29, 0, s29
    s_add_u32 s8, s8, s34
    s_addc_u32 s9, s9, s35
    s_waitcnt lgkmcnt(14)
    v_mfma_f32_32x32x16_bf16 v[160:175], v[100:103], a[12:15], v[160:175]
    ds_read_b64_tr_b16 v[68:69], v9 offset:32768
    ds_read_b64_tr_b16 v[70:71], v9 offset:33792
    s_add_u32 m0, s12, 0
    s_nop 0
    global_load_lds_dwordx4 v3, s[10:11]
    s_waitcnt lgkmcnt(14)
    v_mfma_f32_32x32x16_bf16 v[176:191], v[104:107], a[12:15], v[176:191]
    ds_read_b64_tr_b16 v[72:73], v10 offset:32768
    ds_read_b64_tr_b16 v[74:75], v10 offset:33792
    s_add_u32 m0, s12, 1024
    s_nop 0
    global_load_lds_dwordx4 v4, s[10:11]
    s_waitcnt lgkmcnt(14)
    v_mfma_f32_32x32x16_bf16 v[192:207], a[12:15], v[108:111], v[192:207]
    ds_read_b64_tr_b16 v[76:77], v7 offset:40960
    ds_read_b64_tr_b16 v[78:79], v7 offset:41984
    s_add_u32 m0, s12, 2048
    s_nop 0
    global_load_lds_dwordx4 v5, s[10:11]
    s_waitcnt lgkmcnt(14)
    v_mfma_f32_32x32x16_bf16 v[208:223], a[12:15], v[112:115], v[208:223]
    ds_read_b64_tr_b16 v[80:81], v8 offset:40960
    ds_read_b64_tr_b16 v[82:83], v8 offset:41984
    s_add_u32 m0, s12, 3072
    s_nop 0
    global_load_lds_dwordx4 v6, s[10:11]
    s_add_u32 s30, s30, 1
    s_cmp_eq_u32 s30, s31
    s_cselect_b32 s34, s33, s27
    s_cselect_b32 s35, -1, 0
    s_cselect_b32 s30, 0, s30
    s_add_u32 s10, s10, s34
    s_addc_u32 s11, s11, s35
    s_waitcnt lgkmcnt(14)
    v_mfma_f32_32x32x16_bf16 v[224:239], a[12:15], v[116:119], v[224:239]
    ds_read_b64_tr_b16 v[84:85], v9 offset:40960
    ds_read_b64_tr_b16 v[86:87], v9 offset:41984
    s_waitcnt lgkmcnt(14)
    v_mfma_f32_32x32x16_bf16 v[240:255], a[12:15], v[120:123], v[240:255]
    ds_read_b64_tr_b16 v[88:89], v10 offset:40960
    ds_read_b64_tr_b16 v[90:91], v10 offset:41984
    s_waitcnt lgkmcnt(14)
    v_mfma_f32_32x32x16_bf16 v[128:143], v[60:63], a[16:19], v[128:143]
    ds_read_b64_tr_b16 v[92:93], v7 offset:36864
    ds_read_b64_tr_b16 v[94:95], v7 offset:37888
    s_waitcnt lgkmcnt(14)
    v_mfma_f32_32x32x16_bf16 v[144:159], v[64:67], a[16:19], v[144:159]
    ds_read_b64_tr_b16 v[96:97], v8 offset:36864
    ds_read_b64_tr_b16 v[98:99], v8 offset:37888
    s_waitcnt lgkmcnt(14)
    v_mfma_f32_32x32x16_bf16 v[160:175], v[68:71], a[16:19], v[160:175]
    ds_read_b64_tr_b16 v[100:101], v9 offset:36864
    ds_read_b64_tr_b16 v[102:103], v9 offset:37888
    s_waitcnt lgkmcnt(14)
    v_mfma_f32_32x32x16_bf16 v[176:191], v[72:75], a[16:19], v[176:191]
    ds_read_b64_tr_b16 v[104:105], v10 offset:36864
    ds_read_b64_tr_b16 v[106:107], v10 offset:37888
    s_waitcnt lgkmcnt(14)
    v_mfma_f32_32x32x16_bf16 v[192:207], a[16:19], v[76:79], v[192:207]
    ds_read_b64_tr_b16 v[108:109], v7 offset:45056
    ds_read_b64_tr_b16 v[110:111], v7 offset:46080
    s_waitcnt lgkmcnt(14)
    v_mfma_f32_32x32x16_bf16 v[208:223], a[16:19], v[80:83], v[208:223]
    ds_read_b64_tr_b16 v[112:113], v8 offset:45056
    ds_read_b64_tr_b16 v[114:115], v8 offset:46080
    s_waitcnt lgkmcnt(14)
    v_mfma_f32_32x32x16_bf16 v[224:239], a[16:19], v[84:87], v[224:239]
    ds_read_b64_tr_b16 v[116:117], v9 offset:45056
    ds_read_b64_tr_b16 v[118:119], v9 offset:46080
    s_waitcnt lgkmcnt(14)
    v_mfma_f32_32x32x16_bf16 v[240:255], a[16:19], v[88:91], v[240:255]
    ds_read_b64_tr_b16 v[120:121], v10 offset:45056
    ds_read_b64_tr_b16 v[122:123], v10 offset:46080
    s_waitcnt vmcnt(24)
    s_barrier
    s_waitcnt lgkmcnt(14)
    v_mfma_f32_32x32x16_bf16 v[128:143], v[92:95], a[20:23], v[128:143]
    ds_read_b64_tr_b16 v[60:61], v7 offset:49152
    ds_read_b64_tr_b16 v[62:63], v7 offset:50176
    global_load_dwordx4 a[8:11], v2, s[8:9] offset:0 sc1
    s_waitcnt lgkmcnt(14)
    v_mfma_f32_32x32x16_bf16 v[144:159], v[96:99], a[20:23], v[144:159]
    ds_read_b64_tr_b16 v[64:65], v8 offset:49152
    ds_read_b64_tr_b16 v[66:67], v8 offset:50176
    global_load_dwordx4 a[12:15], v2, s[8:9] offset:1024 sc1
    s_add_u32 s29, s29, 1
    s_cmp_eq_u32 s29, s31
    s_cselect_b32 s34, s32, 2048
    s_cselect_b32 s35, -1, 0
    s_cselect_b32 s29, 0, s29
    s_add_u32 s8, s8, s34
    s_addc_u32 s9, s9, s35
    s_waitcnt lgkmcnt(14)
    v_mfma_f32_32x32x16_bf16 v[160:175], v[100:103], a[20:23], v[160:175]
    ds_read_b64_tr_b16 v[68:69], v9 offset:49152
    ds_read_b64_tr_b16 v[70:71], v9 offset:50176
    s_add_u32 m0, s12, 16384
    s_nop 0
    global_load_lds_dwordx4 v3, s[10:11]
    s_waitcnt lgkmcnt(14)
    v_mfma_f32_32x32x16_bf16 v[176:191], v[104:107], a[20:23], v[176:191]
    ds_read_b64_tr_b16 v[72:73], v10 offset:49152
    ds_read_b64_tr_b16 v[74:75], v10 offset:50176
    s_add_u32 m0, s12, 17408
    s_nop 0
    global_load_lds_dwordx4 v4, s[10:11]
    s_waitcnt lgkmcnt(14)
    v_mfma_f32_32x32x16_bf16 v[192:207], a[20:23], v[108:111], v[192:207]
    ds_read_b64_tr_b16 v[76:77], v7 offset:57344
    ds_read_b64_tr_b16 v[78:79], v7 offset:58368
    s_add_u32 m0, s12, 18432
    s_nop 0
    global_load_lds_dwordx4 v5, s[10:11]
    s_waitcnt lgkmcnt(14)
    v_mfma_f32_32x32x16_bf16 v[208:223], a[20:23], v[112:115], v[208:223]
    ds_read_b64_tr_b16 v[80:81], v8 offset:57344
    ds_read_b64_tr_b16 v[82:83], v8 offset:58368
    s_add_u32 m0, s12, 19456
    s_nop 0
    global_load_lds_dwordx4 v6, s[10:11]
    s_add_u32 s30, s30, 1
    s_cmp_eq_u32 s30, s31
    s_cselect_b32 s34, s33, s27
    s_cselect_b32 s35, -1, 0
    s_cselect_b32 s30, 0, s30
    s_add_u32 s10, s10, s34
    s_addc_u32 s11, s11, s35
    s_waitcnt lgkmcnt(14)
    v_mfma_f32_32x32x16_bf16 v[224:239], a[20:23], v[116:119], v[224:239]
    ds_read_b64_tr_b16 v[84:85], v9 offset:57344
    ds_read_b64_tr_b16 v[86:87], v9 offset:58368
    s_waitcnt lgkmcnt(14)
    v_mfma_f32_32x32x16_bf16 v[240:255], a[20:23], v[120:123], v[240:255]
    ds_read_b64_tr_b16 v[88:89], v10 offset:57344
    ds_read_b64_tr_b16 v[90:91], v10 offset:58368
    s_waitcnt lgkmcnt(14)
    v_mfma_f32_32x32x16_bf16 v[128:143], v[60:63], a[24:27], v[128:143]
    ds_read_b64_tr_b16 v[92:93], v7 offset:53248
    ds_read_b64_tr_b16 v[94:95], v7 offset:54272
    s_waitcnt lgkmcnt(14)
    v_mfma_f32_32x32x16_bf16 v[144:159], v[64:67], a[24:27], v[144:159]
    ds_read_b64_tr_b16 v[96:97], v8 offset:53248
    ds_read_b64_tr_b16 v[98:99], v8 offset:54272
    s_waitcnt lgkmcnt(14)
    v_mfma_f32_32x32x16_bf16 v[160:175], v[68:71], a[24:27], v[160:175]
    ds_read_b64_tr_b16 v[100:101], v9 offset:53248
    ds_read_b64_tr_b16 v[102:103], v9 offset:54272
    s_waitcnt lgkmcnt(14)
    v_mfma_f32_32x32x16_bf16 v[176:191], v[72:75], a[24:27], v[176:191]
    ds_read_b64_tr_b16 v[104:105], v10 offset:53248
    ds_read_b64_tr_b16 v[106:107], v10 offset:54272
    s_waitcnt lgkmcnt(14)
    v_mfma_f32_32x32x16_bf16 v[192:207], a[24:27], v[76:79], v[192:207]
    ds_read_b64_tr_b16 v[108:109], v7 offset:61440
    ds_read_b64_tr_b16 v[110:111], v7 offset:62464
    s_waitcnt lgkmcnt(14)
    v_mfma_f32_32x32x16_bf16 v[208:223], a[24:27], v[80:83], v[208:223]
    ds_read_b64_tr_b16 v[112:113], v8 offset:61440
    ds_read_b64_tr_b16 v[114:115], v8 offset:62464
    s_waitcnt lgkmcnt(14)
    v_mfma_f32_32x32x16_bf16 v[224:239], a[24:27], v[84:87], v[224:239]
    ds_read_b64_tr_b16 v[116:117], v9 offset:61440
    ds_read_b64_tr_b16 v[118:119], v9 offset:62464
    s_waitcnt lgkmcnt(14)
    v_mfma_f32_32x32x16_bf16 v[240:255], a[24:27], v[88:91], v[240:255]
    ds_read_b64_tr_b16 v[120:121], v10 offset:61440
    ds_read_b64_tr_b16 v[122:123], v10 offset:62464
    s_waitcnt vmcnt(26)
    s_barrier
    s_waitcnt lgkmcnt(14)
    v_mfma_f32_32x32x16_bf16 v[128:143], v[92:95], a[28:31], v[128:143]
    ds_read_b64_tr_b16 v[60:61], v21 offset:0
    ds_read_b64_tr_b16 v[62:63], v21 offset:1024
    global_load_dwordx4 a[16:19], v2, s[8:9] offset:0 sc1
    s_waitcnt lgkmcnt(14)
    v_mfma_f32_32x32x16_bf16 v[144:159], v[96:99], a[28:31], v[144:159]
    ds_read_b64_tr_b16 v[64:65], v22 offset:0
    ds_read_b64_tr_b16 v[66:67], v22 offset:1024
    global_load_dwordx4 a[20:23], v2, s[8:9] offset:1024 sc1
    s_add_u32 s29, s29, 1
    s_cmp_eq_u32 s29, s31
    s_cselect_b32 s34, s32, 2048
    s_cselect_b32 s35, -1, 0
    s_cselect_b32 s29, 0, s29
    s_add_u32 s8, s8, s34
    s_addc_u32 s9, s9, s35
    s_waitcnt lgkmcnt(14)
    v_mfma_f32_32x32x16_bf16 v[160:175], v[100:103], a[28:31], v[160:175]
    ds_read_b64_tr_b16 v[68:69], v23 offset:0
    ds_read_b64_tr_b16 v[70:71], v23 offset:1024
    s_add_u32 m0, s12, 32768
    s_nop 0
    global_load_lds_dwordx4 v3, s[10:11]
    s_waitcnt lgkmcnt(14)
    v_mfma_f32_32x32x16_bf16 v[176:191], v[104:107], a[28:31], v[176:191]
    ds_read_b64_tr_b16 v[72:73], v24 offset:0
    ds_read_b64_tr_b16 v[74:75], v24 offset:1024
    s_add_u32 m0, s12, 33792
    s_nop 0
    global_load_lds_dwordx4 v4, s[10:11]
    s_waitcnt lgkmcnt(14)
    v_mfma_f32_32x32x16_bf16 v[192:207], a[28:31], v[108:111], v[192:207]
    ds_read_b64_tr_b16 v[76:77], v21 offset:8192
    ds_read_b64_tr_b16 v[78:79], v21 offset:9216
    s_add_u32 m0, s12, 34816
    s_nop 0
    global_load_lds_dwordx4 v5, s[10:11]
    s_waitcnt lgkmcnt(14)
    v_mfma_f32_32x32x16_bf16 v[208:223], a[28:31], v[112:115], v[208:223]
    ds_read_b64_tr_b16 v[80:81], v22 offset:8192
    ds_read_b64_tr_b16 v[82:83], v22 offset:9216
    s_add_u32 m0, s12, 35840
    s_nop 0
    global_load_lds_dwordx4 v6, s[10:11]
    s_add_u32 s30, s30, 1
    s_cmp_eq_u32 s30, s31
    s_cselect_b32 s34, s33, s27
    s_cselect_b32 s35, -1, 0
    s_cselect_b32 s30, 0, s30
    s_add_u32 s10, s10, s34
    s_addc_u32 s11, s11, s35
    s_waitcnt lgkmcnt(14)
    v_mfma_f32_32x32x16_bf16 v[224:239], a[28:31], v[116:119], v[224:239]
    ds_read_b64_tr_b16 v[84:85], v23 offset:8192
    ds_read_b64_tr_b16 v[86:87], v23 offset:9216
    s_waitcnt lgkmcnt(14)
    v_mfma_f32_32x32x16_bf16 v[240:255], a[28:31], v[120:123], v[240:255]
    ds_read_b64_tr_b16 v[88:89], v24 offset:8192
    ds_read_b64_tr_b16 v[90:91], v24 offset:9216
    s_waitcnt lgkmcnt(14)
    v_mfma_f32_32x32x16_bf16 v[128:143], v[60:63], a[32:35], v[128:143]
    ds_read_b64_tr_b16 v[92:93], v21 offset:4096
    ds_read_b64_tr_b16 v[94:95], v21 offset:5120
    s_waitcnt lgkmcnt(14)
    v_mfma_f32_32x32x16_bf16 v[144:159], v[64:67], a[32:35], v[144:159]
    ds_read_b64_tr_b16 v[96:97], v22 offset:4096
    ds_read_b64_tr_b16 v[98:99], v22 offset:5120
    s_waitcnt lgkmcnt(14)
    v_mfma_f32_32x32x16_bf16 v[160:175], v[68:71], a[32:35], v[160:175]
    ds_read_b64_tr_b16 v[100:101], v23 offset:4096
    ds_read_b64_tr_b16 v[102:103], v23 offset:5120
    s_waitcnt lgkmcnt(14)
    v_mfma_f32_32x32x16_bf16 v[176:191], v[72:75], a[32:35], v[176:191]
    ds_read_b64_tr_b16 v[104:105], v24 offset:4096
    ds_read_b64_tr_b16 v[106:107], v24 offset:5120
    s_waitcnt lgkmcnt(14)
    v_mfma_f32_32x32x16_bf16 v[192:207], a[32:35], v[76:79], v[192:207]
    ds_read_b64_tr_b16 v[108:109], v21 offset:12288
    ds_read_b64_tr_b16 v[110:111], v21 offset:13312
    s_waitcnt lgkmcnt(14)
    v_mfma_f32_32x32x16_bf16 v[208:223], a[32:35], v[80:83], v[208:223]
    ds_read_b64_tr_b16 v[112:113], v22 offset:12288
    ds_read_b64_tr_b16 v[114:115], v22 offset:13312
    s_waitcnt lgkmcnt(14)
    v_mfma_f32_32x32x16_bf16 v[224:239], a[32:35], v[84:87], v[224:239]
    ds_read_b64_tr_b16 v[116:117], v23 offset:12288
    ds_read_b64_tr_b16 v[118:119], v23 offset:13312
    s_waitcnt lgkmcnt(14)
    v_mfma_f32_32x32x16_bf16 v[240:255], a[32:35], v[88:91], v[240:255]
    ds_read_b64_tr_b16 v[120:121], v24 offset:12288
    ds_read_b64_tr_b16 v[122:123], v24 offset:13312
    s_waitcnt vmcnt(28)
    s_barrier
    s_waitcnt lgkmcnt(14)
    v_mfma_f32_32x32x16_bf16 v[128:143], v[92:95], a[36:39], v[128:143]
    ds_read_b64_tr_b16 v[60:61], v21 offset:16384
    ds_read_b64_tr_b16 v[62:63], v21 offset:17408
    global_load_dwordx4 a[24:27], v2, s[8:9] offset:0 sc1
    s_waitcnt lgkmcnt(14)
    v_mfma_f32_32x32x16_bf16 v[144:159], v[96:99], a[36:39], v[144:159]
    ds_read_b64_tr_b16 v[64:65], v22 offset:16384
    ds_read_b64_tr_b16 v[66:67], v22 offset:17408
    global_load_dwordx4 a[28:31], v2, s[8:9] offset:1024 sc1
    s_add_u32 s29, s29, 1
    s_cmp_eq_u32 s29, s31
    s_cselect_b32 s34, s32, 2048
    s_cselect_b32 s35, -1, 0
    s_cselect_b32 s29, 0, s29
    s_add_u32 s8, s8, s34
    s_addc_u32 s9, s9, s35
    s_waitcnt lgkmcnt(14)
    v_mfma_f32_32x32x16_bf16 v[160:175], v[100:103], a[36:39], v[160:175]
    ds_read_b64_tr_b16 v[68:69], v23 offset:16384
    ds_read_b64_tr_b16 v[70:71], v23 offset:17408
    s_add_u32 m0, s12, 49152
    s_nop 0
    global_load_lds_dwordx4 v3, s[10:11]
    s_waitcnt lgkmcnt(14)
    v_mfma_f32_32x32x16_bf16 v[176:191], v[104:107], a[36:39], v[176:191]
    ds_read_b64_tr_b16 v[72:73], v24 offset:16384
    ds_read_b64_tr_b16 v[74:75], v24 offset:17408
    s_add_u32 m0, s12, 50176
    s_nop 0
    global_load_lds_dwordx4 v4, s[10:11]
    s_waitcnt lgkmcnt(14)
    v_mfma_f32_32x32x16_bf16 v[192:207], a[36:39], v[108:111], v[192:207]
    ds_read_b64_tr_b16 v[76:77], v21 offset:24576
    ds_read_b64_tr_b16 v[78:79], v21 offset:25600
    s_add_u32 m0, s12, 51200
    s_nop 0
    global_load_lds_dwordx4 v5, s[10:11]
    s_waitcnt lgkmcnt(14)
    v_mfma_f32_32x32x16_bf16 v[208:223], a[36:39], v[112:115], v[208:223]
    ds_read_b64_tr_b16 v[80:81], v22 offset:24576
    ds_read_b64_tr_b16 v[82:83], v22 offset:25600
    s_add_u32 m0, s12, 52224
    s_nop 0
    global_load_lds_dwordx4 v6, s[10:11]
    s_add_u32 s30, s30, 1
    s_cmp_eq_u32 s30, s31
    s_cselect_b32 s34, s33, s27
    s_cselect_b32 s35, -1, 0
    s_cselect_b32 s30, 0, s30
    s_add_u32 s10, s10, s34
    s_addc_u32 s11, s11, s35
    s_waitcnt lgkmcnt(14)
    v_mfma_f32_32x32x16_bf16 v[224:239], a[36:39], v[116:119], v[224:239]
    ds_read_b64_tr_b16 v[84:85], v23 offset:24576
    ds_read_b64_tr_b16 v[86:87], v23 offset:25600
    s_waitcnt lgkmcnt(14)
    v_mfma_f32_32x32x16_bf16 v[240:255], a[36:39], v[120:123], v[240:255]
    ds_read_b64_tr_b16 v[88:89], v24 offset:24576
    ds_read_b64_tr_b16 v[90:91], v24 offset:25600
    s_waitcnt lgkmcnt(14)
    v_mfma_f32_32x32x16_bf16 v[128:143], v[60:63], a[40:43], v[128:143]
    ds_read_b64_tr_b16 v[92:93], v21 offset:20480
    ds_read_b64_tr_b16 v[94:95], v21 offset:21504
    s_waitcnt lgkmcnt(14)
    v_mfma_f32_32x32x16_bf16 v[144:159], v[64:67], a[40:43], v[144:159]
    ds_read_b64_tr_b16 v[96:97], v22 offset:20480
    ds_read_b64_tr_b16 v[98:99], v22 offset:21504
    s_waitcnt lgkmcnt(14)
    v_mfma_f32_32x32x16_bf16 v[160:175], v[68:71], a[40:43], v[160:175]
    ds_read_b64_tr_b16 v[100:101], v23 offset:20480
    ds_read_b64_tr_b16 v[102:103], v23 offset:21504
    s_waitcnt lgkmcnt(14)
    v_mfma_f32_32x32x16_bf16 v[176:191], v[72:75], a[40:43], v[176:191]
    ds_read_b64_tr_b16 v[104:105], v24 offset:20480
    ds_read_b64_tr_b16 v[106:107], v24 offset:21504
    s_waitcnt lgkmcnt(14)
    v_mfma_f32_32x32x16_bf16 v[192:207], a[40:43], v[76:79], v[192:207]
    ds_read_b64_tr_b16 v[108:109], v21 offset:28672
    ds_read_b64_tr_b16 v[110:111], v21 offset:29696
    s_waitcnt lgkmcnt(14)
    v_mfma_f32_32x32x16_bf16 v[208:223], a[40:43], v[80:83], v[208:223]
    ds_read_b64_tr_b16 v[112:113], v22 offset:28672
    ds_read_b64_tr_b16 v[114:115], v22 offset:29696
    s_waitcnt lgkmcnt(14)
    v_mfma_f32_32x32x16_bf16 v[224:239], a[40:43], v[84:87], v[224:239]
    ds_read_b64_tr_b16 v[116:117], v23 offset:28672
    ds_read_b64_tr_b16 v[118:119], v23 offset:29696
    s_waitcnt lgkmcnt(14)
    v_mfma_f32_32x32x16_bf16 v[240:255], a[40:43], v[88:91], v[240:255]
    ds_read_b64_tr_b16 v[120:121], v24 offset:28672
    ds_read_b64_tr_b16 v[122:123], v24 offset:29696
    s_waitcnt vmcnt(30)
    s_barrier
    s_waitcnt lgkmcnt(14)
    v_mfma_f32_32x32x16_bf16 v[128:143], v[92:95], a[44:47], v[128:143]
    ds_read_b64_tr_b16 v[60:61], v21 offset:32768
    ds_read_b64_tr_b16 v[62:63], v21 offset:33792
    global_load_dwordx4 a[32:35], v2, s[8:9] offset:0 sc1
    s_waitcnt lgkmcnt(14)
    v_mfma_f32_32x32x16_bf16 v[144:159], v[96:99], a[44:47], v[144:159]
    ds_read_b64_tr_b16 v[64:65], v22 offset:32768
    ds_read_b64_tr_b16 v[66:67], v22 offset:33792
    global_load_dwordx4 a[36:39], v2, s[8:9] offset:1024 sc1
    s_add_u32 s29, s29, 1
    s_cmp_eq_u32 s29, s31
    s_cselect_b32 s34, s32, 2048
    s_cselect_b32 s35, -1, 0
    s_cselect_b32 s29, 0, s29
    s_add_u32 s8, s8, s34
    s_addc_u32 s9, s9, s35
    s_waitcnt lgkmcnt(14)
    v_mfma_f32_32x32x16_bf16 v[160:175], v[100:103], a[44:47], v[160:175]
    ds_read_b64_tr_b16 v[68:69], v23 offset:32768
    ds_read_b64_tr_b16 v[70:71], v23 offset:33792
    s_add_u32 m0, s12, 65536
    s_nop 0
    global_load_lds_dwordx4 v3, s[10:11]
    s_waitcnt lgkmcnt(14)
    v_mfma_f32_32x32x16_bf16 v[176:191], v[104:107], a[44:47], v[176:191]
    ds_read_b64_tr_b16 v[72:73], v24 offset:32768
    ds_read_b64_tr_b16 v[74:75], v24 offset:33792
    s_add_u32 m0, s12, 66560
    s_nop 0
    global_load_lds_dwordx4 v4, s[10:11]
    s_waitcnt lgkmcnt(14)
    v_mfma_f32_32x32x16_bf16 v[192:207], a[44:47], v[108:111], v[192:207]
    ds_read_b64_tr_b16 v[76:77], v21 offset:40960
    ds_read_b64_tr_b16 v[78:79], v21 offset:41984
    s_add_u32 m0, s12, 67584
    s_nop 0
    global_load_lds_dwordx4 v5, s[10:11]
    s_waitcnt lgkmcnt(14)
    v_mfma_f32_32x32x16_bf16 v[208:223], a[44:47], v[112:115], v[208:223]
    ds_read_b64_tr_b16 v[80:81], v22 offset:40960
    ds_read_b64_tr_b16 v[82:83], v22 offset:41984
    s_add_u32 m0, s12, 68608
    s_nop 0
    global_load_lds_dwordx4 v6, s[10:11]
    s_add_u32 s30, s30, 1
    s_cmp_eq_u32 s30, s31
    s_cselect_b32 s34, s33, s27
    s_cselect_b32 s35, -1, 0
    s_cselect_b32 s30, 0, s30
    s_add_u32 s10, s10, s34
    s_addc_u32 s11, s11, s35
    s_waitcnt lgkmcnt(14)
    v_mfma_f32_32x32x16_bf16 v[224:239], a[44:47], v[116:119], v[224:239]
    ds_read_b64_tr_b16 v[84:85], v23 offset:40960
    ds_read_b64_tr_b16 v[86:87], v23 offset:41984
    s_waitcnt lgkmcnt(14)
    v_mfma_f32_32x32x16_bf16 v[240:255], a[44:47], v[120:123], v[240:255]
    ds_read_b64_tr_b16 v[88:89], v24 offset:40960
    ds_read_b64_tr_b16 v[90:91], v24 offset:41984
    s_waitcnt lgkmcnt(14)
    v_mfma_f32_32x32x16_bf16 v[128:143], v[60:63], a[48:51], v[128:143]
    ds_read_b64_tr_b16 v[92:93], v21 offset:36864
    ds_read_b64_tr_b16 v[94:95], v21 offset:37888
    s_waitcnt lgkmcnt(14)
    v_mfma_f32_32x32x16_bf16 v[144:159], v[64:67], a[48:51], v[144:159]
    ds_read_b64_tr_b16 v[96:97], v22 offset:36864
    ds_read_b64_tr_b16 v[98:99], v22 offset:37888
    s_waitcnt lgkmcnt(14)
    v_mfma_f32_32x32x16_bf16 v[160:175], v[68:71], a[48:51], v[160:175]
    ds_read_b64_tr_b16 v[100:101], v23 offset:36864
    ds_read_b64_tr_b16 v[102:103], v23 offset:37888
    s_waitcnt lgkmcnt(14)
    v_mfma_f32_32x32x16_bf16 v[176:191], v[72:75], a[48:51], v[176:191]
    ds_read_b64_tr_b16 v[104:105], v24 offset:36864
    ds_read_b64_tr_b16 v[106:107], v24 offset:37888
    s_waitcnt lgkmcnt(14)
    v_mfma_f32_32x32x16_bf16 v[192:207], a[48:51], v[76:79], v[192:207]
    ds_read_b64_tr_b16 v[108:109], v21 offset:45056
    ds_read_b64_tr_b16 v[110:111], v21 offset:46080
    s_waitcnt lgkmcnt(14)
    v_mfma_f32_32x32x16_bf16 v[208:223], a[48:51], v[80:83], v[208:223]
    ds_read_b64_tr_b16 v[112:113], v22 offset:45056
    ds_read_b64_tr_b16 v[114:115], v22 offset:46080
    s_waitcnt lgkmcnt(14)
    v_mfma_f32_32x32x16_bf16 v[224:239], a[48:51], v[84:87], v[224:239]
    ds_read_b64_tr_b16 v[116:117], v23 offset:45056
    ds_read_b64_tr_b16 v[118:119], v23 offset:46080
    s_waitcnt lgkmcnt(14)
    v_mfma_f32_32x32x16_bf16 v[240:255], a[48:51], v[88:91], v[240:255]
    ds_read_b64_tr_b16 v[120:121], v24 offset:45056
    ds_read_b64_tr_b16 v[122:123], v24 offset:46080
    s_waitcnt vmcnt(30)
    s_barrier
    s_waitcnt lgkmcnt(14)
    v_mfma_f32_32x32x16_bf16 v[128:143], v[92:95], a[52:55], v[128:143]
    ds_read_b64_tr_b16 v[60:61], v21 offset:49152
    ds_read_b64_tr_b16 v[62:63], v21 offset:50176
    global_load_dwordx4 a[40:43], v2, s[8:9] offset:0 sc1
    s_waitcnt lgkmcnt(14)
    v_mfma_f32_32x32x16_bf16 v[144:159], v[96:99], a[52:55], v[144:159]
    ds_read_b64_tr_b16 v[64:65], v22 offset:49152
    ds_read_b64_tr_b16 v[66:67], v22 offset:50176
    global_load_dwordx4 a[44:47], v2, s[8:9] offset:1024 sc1
    s_add_u32 s29, s29, 1
    s_cmp_eq_u32 s29, s31
    s_cselect_b32 s34, s32, 2048
    s_cselect_b32 s35, -1, 0
    s_cselect_b32 s29, 0, s29
    s_add_u32 s8, s8, s34
    s_addc_u32 s9, s9, s35
    s_waitcnt lgkmcnt(14)
    v_mfma_f32_32x32x16_bf16 v[160:175], v[100:103], a[52:55], v[160:175]
    ds_read_b64_tr_b16 v[68:69], v23 offset:49152
    ds_read_b64_tr_b16 v[70:71], v23 offset:50176
    s_add_u32 m0, s12, 81920
    s_nop 0
    global_load_lds_dwordx4 v3, s[10:11]
    s_waitcnt lgkmcnt(14)
    v_mfma_f32_32x32x16_bf16 v[176:191], v[104:107], a[52:55], v[176:191]
    ds_read_b64_tr_b16 v[72:73], v24 offset:49152
    ds_read_b64_tr_b16 v[74:75], v24 offset:50176
    s_add_u32 m0, s12, 82944
    s_nop 0
    global_load_lds_dwordx4 v4, s[10:11]
    s_waitcnt lgkmcnt(14)
    v_mfma_f32_32x32x16_bf16 v[192:207], a[52:55], v[108:111], v[192:207]
    ds_read_b64_tr_b16 v[76:77], v21 offset:57344
    ds_read_b64_tr_b16 v[78:79], v21 offset:58368
    s_add_u32 m0, s12, 83968
    s_nop 0
    global_load_lds_dwordx4 v5, s[10:11]
    s_waitcnt lgkmcnt(14)
    v_mfma_f32_32x32x16_bf16 v[208:223], a[52:55], v[112:115], v[208:223]
    ds_read_b64_tr_b16 v[80:81], v22 offset:57344
    ds_read_b64_tr_b16 v[82:83], v22 offset:58368
    s_add_u32 m0, s12, 84992
    s_nop 0
    global_load_lds_dwordx4 v6, s[10:11]
    s_add_u32 s30, s30, 1
    s_cmp_eq_u32 s30, s31
    s_cselect_b32 s34, s33, s27
    s_cselect_b32 s35, -1, 0
    s_cselect_b32 s30, 0, s30
    s_add_u32 s10, s10, s34
    s_addc_u32 s11, s11, s35
    s_waitcnt lgkmcnt(14)
    v_mfma_f32_32x32x16_bf16 v[224:239], a[52:55], v[116:119], v[224:239]
    ds_read_b64_tr_b16 v[84:85], v23 offset:57344
    ds_read_b64_tr_b16 v[86:87], v23 offset:58368
    s_waitcnt lgkmcnt(14)
    v_mfma_f32_32x32x16_bf16 v[240:255], a[52:55], v[120:123], v[240:255]
    ds_read_b64_tr_b16 v[88:89], v24 offset:57344
    ds_read_b64_tr_b16 v[90:91], v24 offset:58368
    s_waitcnt lgkmcnt(14)
    v_mfma_f32_32x32x16_bf16 v[128:143], v[60:63], a[56:59], v[128:143]
    ds_read_b64_tr_b16 v[92:93], v21 offset:53248
    ds_read_b64_tr_b16 v[94:95], v21 offset:54272
    s_waitcnt lgkmcnt(14)
    v_mfma_f32_32x32x16_bf16 v[144:159], v[64:67], a[56:59], v[144:159]
    ds_read_b64_tr_b16 v[96:97], v22 offset:53248
    ds_read_b64_tr_b16 v[98:99], v22 offset:54272
    s_waitcnt lgkmcnt(14)
    v_mfma_f32_32x32x16_bf16 v[160:175], v[68:71], a[56:59], v[160:175]
    ds_read_b64_tr_b16 v[100:101], v23 offset:53248
    ds_read_b64_tr_b16 v[102:103], v23 offset:54272
    s_waitcnt lgkmcnt(14)
    v_mfma_f32_32x32x16_bf16 v[176:191], v[72:75], a[56:59], v[176:191]
    ds_read_b64_tr_b16 v[104:105], v24 offset:53248
    ds_read_b64_tr_b16 v[106:107], v24 offset:54272
    s_waitcnt lgkmcnt(14)
    v_mfma_f32_32x32x16_bf16 v[192:207], a[56:59], v[76:79], v[192:207]
    ds_read_b64_tr_b16 v[108:109], v21 offset:61440
    ds_read_b64_tr_b16 v[110:111], v21 offset:62464
    s_waitcnt lgkmcnt(14)
    v_mfma_f32_32x32x16_bf16 v[208:223], a[56:59], v[80:83], v[208:223]
    ds_read_b64_tr_b16 v[112:113], v22 offset:61440
    ds_read_b64_tr_b16 v[114:115], v22 offset:62464
    s_waitcnt lgkmcnt(14)
    v_mfma_f32_32x32x16_bf16 v[224:239], a[56:59], v[84:87], v[224:239]
    ds_read_b64_tr_b16 v[116:117], v23 offset:61440
    ds_read_b64_tr_b16 v[118:119], v23 offset:62464
    s_waitcnt lgkmcnt(14)
    v_mfma_f32_32x32x16_bf16 v[240:255], a[56:59], v[88:91], v[240:255]
    ds_read_b64_tr_b16 v[120:121], v24 offset:61440
    ds_read_b64_tr_b16 v[122:123], v24 offset:62464
    s_waitcnt vmcnt(30)
    s_barrier
    s_waitcnt lgkmcnt(14)
    v_mfma_f32_32x32x16_bf16 v[128:143], v[92:95], a[60:63], v[128:143]
    ds_read_b64_tr_b16 v[60:61], v7 offset:0
    ds_read_b64_tr_b16 v[62:63], v7 offset:1024
    global_load_dwordx4 a[48:51], v2, s[8:9] offset:0 sc1
    s_waitcnt lgkmcnt(14)
    v_mfma_f32_32x32x16_bf16 v[144:159], v[96:99], a[60:63], v[144:159]
    ds_read_b64_tr_b16 v[64:65], v8 offset:0
    ds_read_b64_tr_b16 v[66:67], v8 offset:1024
    global_load_dwordx4 a[52:55], v2, s[8:9] offset:1024 sc1
    s_add_u32 s29, s29, 1
    s_cmp_eq_u32 s29, s31
    s_cselect_b32 s34, s32, 2048
    s_cselect_b32 s35, -1, 0
    s_cselect_b32 s29, 0, s29
    s_add_u32 s8, s8, s34
    s_addc_u32 s9, s9, s35
    s_waitcnt lgkmcnt(14)
    v_mfma_f32_32x32x16_bf16 v[160:175], v[100:103], a[60:63], v[160:175]
    ds_read_b64_tr_b16 v[68:69], v9 offset:0
    ds_read_b64_tr_b16 v[70:71], v9 offset:1024
    s_add_u32 m0, s12, 98304
    s_nop 0
    global_load_lds_dwordx4 v3, s[10:11]
    s_waitcnt lgkmcnt(14)
    v_mfma_f32_32x32x16_bf16 v[176:191], v[104:107], a[60:63], v[176:191]
    ds_read_b64_tr_b16 v[72:73], v10 offset:0
    ds_read_b64_tr_b16 v[74:75], v10 offset:1024
    s_add_u32 m0, s12, 99328
    s_nop 0
    global_load_lds_dwordx4 v4, s[10:11]
    s_waitcnt lgkmcnt(14)
    v_mfma_f32_32x32x16_bf16 v[192:207], a[60:63], v[108:111], v[192:207]
    ds_read_b64_tr_b16 v[76:77], v7 offset:8192
    ds_read_b64_tr_b16 v[78:79], v7 offset:9216
    s_add_u32 m0, s12, 100352
    s_nop 0
    global_load_lds_dwordx4 v5, s[10:11]
    s_waitcnt lgkmcnt(14)
    v_mfma_f32_32x32x16_bf16 v[208:223], a[60:63], v[112:115], v[208:223]
    ds_read_b64_tr_b16 v[80:81], v8 offset:8192
    ds_read_b64_tr_b16 v[82:83], v8 offset:9216
    s_add_u32 m0, s12, 101376
    s_nop 0
    global_load_lds_dwordx4 v6, s[10:11]
    s_add_u32 s30, s30, 1
    s_cmp_eq_u32 s30, s31
    s_cselect_b32 s34, s33, s27
    s_cselect_b32 s35, -1, 0
    s_cselect_b32 s30, 0, s30
    s_add_u32 s10, s10, s34
    s_addc_u32 s11, s11, s35
    s_waitcnt lgkmcnt(14)
    v_mfma_f32_32x32x16_bf16 v[224:239], a[60:63], v[116:119], v[224:239]
    ds_read_b64_tr_b16 v[84:85], v9 offset:8192
    ds_read_b64_tr_b16 v[86:87], v9 offset:9216
    s_waitcnt lgkmcnt(14)
    v_mfma_f32_32x32x16_bf16 v[240:255], a[60:63], v[120:123], v[240:255]
    ds_read_b64_tr_b16 v[88:89], v10 offset:8192
    ds_read_b64_tr_b16 v[90:91], v10 offset:9216
    s_sub_u32 s13, s13, 1
    s_cmp_lg_u32 s13, 0
    s_cbranch_scc1 gl_152
    s_waitcnt lgkmcnt(14)
    v_mfma_f32_32x32x16_bf16 v[128:143], v[60:63], a[0:3], v[128:143]
    ds_read_b64_tr_b16 v[92:93], v7 offset:4096
    ds_read_b64_tr_b16 v[94:95], v7 offset:5120
    s_waitcnt lgkmcnt(14)
    v_mfma_f32_32x32x16_bf16 v[144:159], v[64:67], a[0:3], v[144:159]
    ds_read_b64_tr_b16 v[96:97], v8 offset:4096
    ds_read_b64_tr_b16 v[98:99], v8 offset:5120
    s_waitcnt lgkmcnt(14)
    v_mfma_f32_32x32x16_bf16 v[160:175], v[68:71], a[0:3], v[160:175]
    ds_read_b64_tr_b16 v[100:101], v9 offset:4096
    ds_read_b64_tr_b16 v[102:103], v9 offset:5120
    s_waitcnt lgkmcnt(14)
    v_mfma_f32_32x32x16_bf16 v[176:191], v[72:75], a[0:3], v[176:191]
    ds_read_b64_tr_b16 v[104:105], v10 offset:4096
    ds_read_b64_tr_b16 v[106:107], v10 offset:5120
    s_waitcnt lgkmcnt(14)
    v_mfma_f32_32x32x16_bf16 v[192:207], a[0:3], v[76:79], v[192:207]
    ds_read_b64_tr_b16 v[108:109], v7 offset:12288
    ds_read_b64_tr_b16 v[110:111], v7 offset:13312
    s_waitcnt lgkmcnt(14)
    v_mfma_f32_32x32x16_bf16 v[208:223], a[0:3], v[80:83], v[208:223]
    ds_read_b64_tr_b16 v[112:113], v8 offset:12288
    ds_read_b64_tr_b16 v[114:115], v8 offset:13312
    s_waitcnt lgkmcnt(14)
    v_mfma_f32_32x32x16_bf16 v[224:239], a[0:3], v[84:87], v[224:239]
    ds_read_b64_tr_b16 v[116:117], v9 offset:12288
    ds_read_b64_tr_b16 v[118:119], v9 offset:13312
    s_waitcnt lgkmcnt(14)
    v_mfma_f32_32x32x16_bf16 v[240:255], a[0:3], v[88:91], v[240:255]
    ds_read_b64_tr_b16 v[120:121], v10 offset:12288
    ds_read_b64_tr_b16 v[122:123], v10 offset:13312
    s_waitcnt vmcnt(30)
    s_barrier
    s_waitcnt lgkmcnt(14)
    v_mfma_f32_32x32x16_bf16 v[128:143], v[92:95], a[4:7], v[128:143]
    ds_read_b64_tr_b16 v[60:61], v7 offset:16384
    ds_read_b64_tr_b16 v[62:63], v7 offset:17408
    global_load_dwordx4 a[56:59], v2, s[8:9] offset:0 sc1
    s_waitcnt lgkmcnt(14)
    v_mfma_f32_32x32x16_bf16 v[144:159], v[96:99], a[4:7], v[144:159]
    ds_read_b64_tr_b16 v[64:65], v8 offset:16384
    ds_read_b64_tr_b16 v[66:67], v8 offset:17408
    global_load_dwordx4 a[60:63], v2, s[8:9] offset:1024 sc1
    s_add_u32 s29, s29, 1
    s_cmp_eq_u32 s29, s31
    s_cselect_b32 s34, s32, 2048
    s_cselect_b32 s35, -1, 0
    s_cselect_b32 s29, 0, s29
    s_add_u32 s8, s8, s34
    s_addc_u32 s9, s9, s35
    s_waitcnt lgkmcnt(14)
    v_mfma_f32_32x32x16_bf16 v[160:175], v[100:103], a[4:7], v[160:175]
    ds_read_b64_tr_b16 v[68:69], v9 offset:16384
    ds_read_b64_tr_b16 v[70:71], v9 offset:17408
    s_add_u32 m0, s12, 114688
    s_nop 0
    global_load_lds_dwordx4 v3, s[10:11]
    s_waitcnt lgkmcnt(14)
    v_mfma_f32_32x32x16_bf16 v[176:191], v[104:107], a[4:7], v[176:191]
    ds_read_b64_tr_b16 v[72:73], v10 offset:16384
    ds_read_b64_tr_b16 v[74:75], v10 offset:17408
    s_add_u32 m0, s12, 115712
    s_nop 0
    global_load_lds_dwordx4 v4, s[10:11]
    s_waitcnt lgkmcnt(14)
    v_mfma_f32_32x32x16_bf16 v[192:207], a[4:7], v[108:111], v[192:207]
    ds_read_b64_tr_b16 v[76:77], v7 offset:24576
    ds_read_b64_tr_b16 v[78:79], v7 offset:25600
    s_add_u32 m0, s12, 116736
    s_nop 0
    global_load_lds_dwordx4 v5, s[10:11]
    s_waitcnt lgkmcnt(14)
    v_mfma_f32_32x32x16_bf16 v[208:223], a[4:7], v[112:115], v[208:223]
    ds_read_b64_tr_b16 v[80:81], v8 offset:24576
    ds_read_b64_tr_b16 v[82:83], v8 offset:25600
    s_add_u32 m0, s12, 117760
    s_nop 0
    global_load_lds_dwordx4 v6, s[10:11]
    s_add_u32 s30, s30, 1
    s_cmp_eq_u32 s30, s31
    s_cselect_b32 s34, s33, s27
    s_cselect_b32 s35, -1, 0
    s_cselect_b32 s30, 0, s30
    s_add_u32 s10, s10, s34
    s_addc_u32 s11, s11, s35
    s_waitcnt lgkmcnt(14)
    v_mfma_f32_32x32x16_bf16 v[224:239], a[4:7], v[116:119], v[224:239]
    ds_read_b64_tr_b16 v[84:85], v9 offset:24576
    ds_read_b64_tr_b16 v[86:87], v9 offset:25600
    s_waitcnt lgkmcnt(14)
    v_mfma_f32_32x32x16_bf16 v[240:255], a[4:7], v[120:123], v[240:255]
    ds_read_b64_tr_b16 v[88:89], v10 offset:24576
    ds_read_b64_tr_b16 v[90:91], v10 offset:25600
    s_waitcnt lgkmcnt(14)
    v_mfma_f32_32x32x16_bf16 v[128:143], v[60:63], a[8:11], v[128:143]
    ds_read_b64_tr_b16 v[92:93], v7 offset:20480
    ds_read_b64_tr_b16 v[94:95], v7 offset:21504
    s_waitcnt lgkmcnt(14)
    v_mfma_f32_32x32x16_bf16 v[144:159], v[64:67], a[8:11], v[144:159]
    ds_read_b64_tr_b16 v[96:97], v8 offset:20480
    ds_read_b64_tr_b16 v[98:99], v8 offset:21504
    s_waitcnt lgkmcnt(14)
    v_mfma_f32_32x32x16_bf16 v[160:175], v[68:71], a[8:11], v[160:175]
    ds_read_b64_tr_b16 v[100:101], v9 offset:20480
    ds_read_b64_tr_b16 v[102:103], v9 offset:21504
    s_waitcnt lgkmcnt(14)
    v_mfma_f32_32x32x16_bf16 v[176:191], v[72:75], a[8:11], v[176:191]
    ds_read_b64_tr_b16 v[104:105], v10 offset:20480
    ds_read_b64_tr_b16 v[106:107], v10 offset:21504
    s_waitcnt lgkmcnt(14)
    v_mfma_f32_32x32x16_bf16 v[192:207], a[8:11], v[76:79], v[192:207]
    ds_read_b64_tr_b16 v[108:109], v7 offset:28672
    ds_read_b64_tr_b16 v[110:111], v7 offset:29696
    s_waitcnt lgkmcnt(14)
    v_mfma_f32_32x32x16_bf16 v[208:223], a[8:11], v[80:83], v[208:223]
    ds_read_b64_tr_b16 v[112:113], v8 offset:28672
    ds_read_b64_tr_b16 v[114:115], v8 offset:29696
    s_waitcnt lgkmcnt(14)
    v_mfma_f32_32x32x16_bf16 v[224:239], a[8:11], v[84:87], v[224:239]
    ds_read_b64_tr_b16 v[116:117], v9 offset:28672
    ds_read_b64_tr_b16 v[118:119], v9 offset:29696
    s_waitcnt lgkmcnt(14)
    v_mfma_f32_32x32x16_bf16 v[240:255], a[8:11], v[88:91], v[240:255]
    ds_read_b64_tr_b16 v[120:121], v10 offset:28672
    ds_read_b64_tr_b16 v[122:123], v10 offset:29696
    s_waitcnt vmcnt(30)
    s_barrier
    s_waitcnt lgkmcnt(14)
    v_mfma_f32_32x32x16_bf16 v[128:143], v[92:95], a[12:15], v[128:143]
    ds_read_b64_tr_b16 v[60:61], v7 offset:32768
    ds_read_b64_tr_b16 v[62:63], v7 offset:33792
    s_waitcnt lgkmcnt(14)
    v_mfma_f32_32x32x16_bf16 v[144:159], v[96:99], a[12:15], v[144:159]
    ds_read_b64_tr_b16 v[64:65], v8 offset:32768
    ds_read_b64_tr_b16 v[66:67], v8 offset:33792
    s_waitcnt lgkmcnt(14)
    v_mfma_f32_32x32x16_bf16 v[160:175], v[100:103], a[12:15], v[160:175]
    ds_read_b64_tr_b16 v[68:69], v9 offset:32768
    ds_read_b64_tr_b16 v[70:71], v9 offset:33792
    s_waitcnt lgkmcnt(14)
    v_mfma_f32_32x32x16_bf16 v[176:191], v[104:107], a[12:15], v[176:191]
    ds_read_b64_tr_b16 v[72:73], v10 offset:32768
    ds_read_b64_tr_b16 v[74:75], v10 offset:33792
    s_waitcnt lgkmcnt(14)
    v_mfma_f32_32x32x16_bf16 v[192:207], a[12:15], v[108:111], v[192:207]
    ds_read_b64_tr_b16 v[76:77], v7 offset:40960
    ds_read_b64_tr_b16 v[78:79], v7 offset:41984
    s_waitcnt lgkmcnt(14)
    v_mfma_f32_32x32x16_bf16 v[208:223], a[12:15], v[112:115], v[208:223]
    ds_read_b64_tr_b16 v[80:81], v8 offset:40960
    ds_read_b64_tr_b16 v[82:83], v8 offset:41984
    s_waitcnt lgkmcnt(14)
    v_mfma_f32_32x32x16_bf16 v[224:239], a[12:15], v[116:119], v[224:239]
    ds_read_b64_tr_b16 v[84:85], v9 offset:40960
    ds_read_b64_tr_b16 v[86:87], v9 offset:41984
    s_waitcnt lgkmcnt(14)
    v_mfma_f32_32x32x16_bf16 v[240:255], a[12:15], v[120:123], v[240:255]
    ds_read_b64_tr_b16 v[88:89], v10 offset:40960
    ds_read_b64_tr_b16 v[90:91], v10 offset:41984
    s_waitcnt lgkmcnt(14)
    v_mfma_f32_32x32x16_bf16 v[128:143], v[60:63], a[16:19], v[128:143]
    ds_read_b64_tr_b16 v[92:93], v7 offset:36864
    ds_read_b64_tr_b16 v[94:95], v7 offset:37888
    s_waitcnt lgkmcnt(14)
    v_mfma_f32_32x32x16_bf16 v[144:159], v[64:67], a[16:19], v[144:159]
    ds_read_b64_tr_b16 v[96:97], v8 offset:36864
    ds_read_b64_tr_b16 v[98:99], v8 offset:37888
    s_waitcnt lgkmcnt(14)
    v_mfma_f32_32x32x16_bf16 v[160:175], v[68:71], a[16:19], v[160:175]
    ds_read_b64_tr_b16 v[100:101], v9 offset:36864
    ds_read_b64_tr_b16 v[102:103], v9 offset:37888
    s_waitcnt lgkmcnt(14)
    v_mfma_f32_32x32x16_bf16 v[176:191], v[72:75], a[16:19], v[176:191]
    ds_read_b64_tr_b16 v[104:105], v10 offset:36864
    ds_read_b64_tr_b16 v[106:107], v10 offset:37888
    s_waitcnt lgkmcnt(14)
    v_mfma_f32_32x32x16_bf16 v[192:207], a[16:19], v[76:79], v[192:207]
    ds_read_b64_tr_b16 v[108:109], v7 offset:45056
    ds_read_b64_tr_b16 v[110:111], v7 offset:46080
    s_waitcnt lgkmcnt(14)
    v_mfma_f32_32x32x16_bf16 v[208:223], a[16:19], v[80:83], v[208:223]
    ds_read_b64_tr_b16 v[112:113], v8 offset:45056
    ds_read_b64_tr_b16 v[114:115], v8 offset:46080
    s_waitcnt lgkmcnt(14)
    v_mfma_f32_32x32x16_bf16 v[224:239], a[16:19], v[84:87], v[224:239]
    ds_read_b64_tr_b16 v[116:117], v9 offset:45056
    ds_read_b64_tr_b16 v[118:119], v9 offset:46080
    s_waitcnt lgkmcnt(14)
    v_mfma_f32_32x32x16_bf16 v[240:255], a[16:19], v[88:91], v[240:255]
    ds_read_b64_tr_b16 v[120:121], v10 offset:45056
    ds_read_b64_tr_b16 v[122:123], v10 offset:46080
    s_waitcnt vmcnt(24)
    s_barrier
    s_waitcnt lgkmcnt(14)
    v_mfma_f32_32x32x16_bf16 v[128:143], v[92:95], a[20:23], v[128:143]
    ds_read_b64_tr_b16 v[60:61], v7 offset:49152
    ds_read_b64_tr_b16 v[62:63], v7 offset:50176
    s_waitcnt lgkmcnt(14)
    v_mfma_f32_32x32x16_bf16 v[144:159], v[96:99], a[20:23], v[144:159]
    ds_read_b64_tr_b16 v[64:65], v8 offset:49152
    ds_read_b64_tr_b16 v[66:67], v8 offset:50176
    s_waitcnt lgkmcnt(14)
    v_mfma_f32_32x32x16_bf16 v[160:175], v[100:103], a[20:23], v[160:175]
    ds_read_b64_tr_b16 v[68:69], v9 offset:49152
    ds_read_b64_tr_b16 v[70:71], v9 offset:50176
    s_waitcnt lgkmcnt(14)
    v_mfma_f32_32x32x16_bf16 v[176:191], v[104:107], a[20:23], v[176:191]
    ds_read_b64_tr_b16 v[72:73], v10 offset:49152
    ds_read_b64_tr_b16 v[74:75], v10 offset:50176
    s_waitcnt lgkmcnt(14)
    v_mfma_f32_32x32x16_bf16 v[192:207], a[20:23], v[108:111], v[192:207]
    ds_read_b64_tr_b16 v[76:77], v7 offset:57344
    ds_read_b64_tr_b16 v[78:79], v7 offset:58368
    s_waitcnt lgkmcnt(14)
    v_mfma_f32_32x32x16_bf16 v[208:223], a[20:23], v[112:115], v[208:223]
    ds_read_b64_tr_b16 v[80:81], v8 offset:57344
    ds_read_b64_tr_b16 v[82:83], v8 offset:58368
    s_waitcnt lgkmcnt(14)
    v_mfma_f32_32x32x16_bf16 v[224:239], a[20:23], v[116:119], v[224:239]
    ds_read_b64_tr_b16 v[84:85], v9 offset:57344
    ds_read_b64_tr_b16 v[86:87], v9 offset:58368
    s_waitcnt lgkmcnt(14)
    v_mfma_f32_32x32x16_bf16 v[240:255], a[20:23], v[120:123], v[240:255]
    ds_read_b64_tr_b16 v[88:89], v10 offset:57344
    ds_read_b64_tr_b16 v[90:91], v10 offset:58368
    s_waitcnt lgkmcnt(14)
    v_mfma_f32_32x32x16_bf16 v[128:143], v[60:63], a[24:27], v[128:143]
    ds_read_b64_tr_b16 v[92:93], v7 offset:53248
    ds_read_b64_tr_b16 v[94:95], v7 offset:54272
    s_waitcnt lgkmcnt(14)
    v_mfma_f32_32x32x16_bf16 v[144:159], v[64:67], a[24:27], v[144:159]
    ds_read_b64_tr_b16 v[96:97], v8 offset:53248
    ds_read_b64_tr_b16 v[98:99], v8 offset:54272
    s_waitcnt lgkmcnt(14)
    v_mfma_f32_32x32x16_bf16 v[160:175], v[68:71], a[24:27], v[160:175]
    ds_read_b64_tr_b16 v[100:101], v9 offset:53248
    ds_read_b64_tr_b16 v[102:103], v9 offset:54272
    s_waitcnt lgkmcnt(14)
    v_mfma_f32_32x32x16_bf16 v[176:191], v[72:75], a[24:27], v[176:191]
    ds_read_b64_tr_b16 v[104:105], v10 offset:53248
    ds_read_b64_tr_b16 v[106:107], v10 offset:54272
    s_waitcnt lgkmcnt(14)
    v_mfma_f32_32x32x16_bf16 v[192:207], a[24:27], v[76:79], v[192:207]
    ds_read_b64_tr_b16 v[108:109], v7 offset:61440
    ds_read_b64_tr_b16 v[110:111], v7 offset:62464
    s_waitcnt lgkmcnt(14)
    v_mfma_f32_32x32x16_bf16 v[208:223], a[24:27], v[80:83], v[208:223]
    ds_read_b64_tr_b16 v[112:113], v8 offset:61440
    ds_read_b64_tr_b16 v[114:115], v8 offset:62464
    s_waitcnt lgkmcnt(14)
    v_mfma_f32_32x32x16_bf16 v[224:239], a[24:27], v[84:87], v[224:239]
    ds_read_b64_tr_b16 v[116:117], v9 offset:61440
    ds_read_b64_tr_b16 v[118:119], v9 offset:62464
    s_waitcnt lgkmcnt(14)
    v_mfma_f32_32x32x16_bf16 v[240:255], a[24:27], v[88:91], v[240:255]
    ds_read_b64_tr_b16 v[120:121], v10 offset:61440
    ds_read_b64_tr_b16 v[122:123], v10 offset:62464
    s_waitcnt vmcnt(18)
    s_barrier
    s_waitcnt lgkmcnt(14)
    v_mfma_f32_32x32x16_bf16 v[128:143], v[92:95], a[28:31], v[128:143]
    ds_read_b64_tr_b16 v[60:61], v21 offset:0
    ds_read_b64_tr_b16 v[62:63], v21 offset:1024
    s_waitcnt lgkmcnt(14)
    v_mfma_f32_32x32x16_bf16 v[144:159], v[96:99], a[28:31], v[144:159]
    ds_read_b64_tr_b16 v[64:65], v22 offset:0
    ds_read_b64_tr_b16 v[66:67], v22 offset:1024
    s_waitcnt lgkmcnt(14)
    v_mfma_f32_32x32x16_bf16 v[160:175], v[100:103], a[28:31], v[160:175]
    ds_read_b64_tr_b16 v[68:69], v23 offset:0
    ds_read_b64_tr_b16 v[70:71], v23 offset:1024
    s_waitcnt lgkmcnt(14)
    v_mfma_f32_32x32x16_bf16 v[176:191], v[104:107], a[28:31], v[176:191]
    ds_read_b64_tr_b16 v[72:73], v24 offset:0
    ds_read_b64_tr_b16 v[74:75], v24 offset:1024
    s_waitcnt lgkmcnt(14)
    v_mfma_f32_32x32x16_bf16 v[192:207], a[28:31], v[108:111], v[192:207]
    ds_read_b64_tr_b16 v[76:77], v21 offset:8192
    ds_read_b64_tr_b16 v[78:79], v21 offset:9216
    s_waitcnt lgkmcnt(14)
    v_mfma_f32_32x32x16_bf16 v[208:223], a[28:31], v[112:115], v[208:223]
    ds_read_b64_tr_b16 v[80:81], v22 offset:8192
    ds_read_b64_tr_b16 v[82:83], v22 offset:9216
    s_waitcnt lgkmcnt(14)
    v_mfma_f32_32x32x16_bf16 v[224:239], a[28:31], v[116:119], v[224:239]
    ds_read_b64_tr_b16 v[84:85], v23 offset:8192
    ds_read_b64_tr_b16 v[86:87], v23 offset:9216
    s_waitcnt lgkmcnt(14)
    v_mfma_f32_32x32x16_bf16 v[240:255], a[28:31], v[120:123], v[240:255]
    ds_read_b64_tr_b16 v[88:89], v24 offset:8192
    ds_read_b64_tr_b16 v[90:91], v24 offset:9216
    s_waitcnt lgkmcnt(14)
    v_mfma_f32_32x32x16_bf16 v[128:143], v[60:63], a[32:35], v[128:143]
    ds_read_b64_tr_b16 v[92:93], v21 offset:4096
    ds_read_b64_tr_b16 v[94:95], v21 offset:5120
    s_waitcnt lgkmcnt(14)
    v_mfma_f32_32x32x16_bf16 v[144:159], v[64:67], a[32:35], v[144:159]
    ds_read_b64_tr_b16 v[96:97], v22 offset:4096
    ds_read_b64_tr_b16 v[98:99], v22 offset:5120
    s_waitcnt lgkmcnt(14)
    v_mfma_f32_32x32x16_bf16 v[160:175], v[68:71], a[32:35], v[160:175]
    ds_read_b64_tr_b16 v[100:101], v23 offset:4096
    ds_read_b64_tr_b16 v[102:103], v23 offset:5120
    s_waitcnt lgkmcnt(14)
    v_mfma_f32_32x32x16_bf16 v[176:191], v[72:75], a[32:35], v[176:191]
    ds_read_b64_tr_b16 v[104:105], v24 offset:4096
    ds_read_b64_tr_b16 v[106:107], v24 offset:5120
    s_waitcnt lgkmcnt(14)
    v_mfma_f32_32x32x16_bf16 v[192:207], a[32:35], v[76:79], v[192:207]
    ds_read_b64_tr_b16 v[108:109], v21 offset:12288
    ds_read_b64_tr_b16 v[110:111], v21 offset:13312
    s_waitcnt lgkmcnt(14)
    v_mfma_f32_32x32x16_bf16 v[208:223], a[32:35], v[80:83], v[208:223]
    ds_read_b64_tr_b16 v[112:113], v22 offset:12288
    ds_read_b64_tr_b16 v[114:115], v22 offset:13312
    s_waitcnt lgkmcnt(14)
    v_mfma_f32_32x32x16_bf16 v[224:239], a[32:35], v[84:87], v[224:239]
    ds_read_b64_tr_b16 v[116:117], v23 offset:12288
    ds_read_b64_tr_b16 v[118:119], v23 offset:13312
    s_waitcnt lgkmcnt(14)
    v_mfma_f32_32x32x16_bf16 v[240:255], a[32:35], v[88:91], v[240:255]
    ds_read_b64_tr_b16 v[120:121], v24 offset:12288
    ds_read_b64_tr_b16 v[122:123], v24 offset:13312
    s_waitcnt vmcnt(12)
    s_barrier
    s_waitcnt lgkmcnt(14)
    v_mfma_f32_32x32x16_bf16 v[128:143], v[92:95], a[36:39], v[128:143]
    ds_read_b64_tr_b16 v[60:61], v21 offset:16384
    ds_read_b64_tr_b16 v[62:63], v21 offset:17408
    s_waitcnt lgkmcnt(14)
    v_mfma_f32_32x32x16_bf16 v[144:159], v[96:99], a[36:39], v[144:159]
    ds_read_b64_tr_b16 v[64:65], v22 offset:16384
    ds_read_b64_tr_b16 v[66:67], v22 offset:17408
    s_waitcnt lgkmcnt(14)
    v_mfma_f32_32x32x16_bf16 v[160:175], v[100:103], a[36:39], v[160:175]
    ds_read_b64_tr_b16 v[68:69], v23 offset:16384
    ds_read_b64_tr_b16 v[70:71], v23 offset:17408
    s_waitcnt lgkmcnt(14)
    v_mfma_f32_32x32x16_bf16 v[176:191], v[104:107], a[36:39], v[176:191]
    ds_read_b64_tr_b16 v[72:73], v24 offset:16384
    ds_read_b64_tr_b16 v[74:75], v24 offset:17408
    s_waitcnt lgkmcnt(14)
    v_mfma_f32_32x32x16_bf16 v[192:207], a[36:39], v[108:111], v[192:207]
    ds_read_b64_tr_b16 v[76:77], v21 offset:24576
    ds_read_b64_tr_b16 v[78:79], v21 offset:25600
    s_waitcnt lgkmcnt(14)
    v_mfma_f32_32x32x16_bf16 v[208:223], a[36:39], v[112:115], v[208:223]
    ds_read_b64_tr_b16 v[80:81], v22 offset:24576
    ds_read_b64_tr_b16 v[82:83], v22 offset:25600
    s_waitcnt lgkmcnt(14)
    v_mfma_f32_32x32x16_bf16 v[224:239], a[36:39], v[116:119], v[224:239]
    ds_read_b64_tr_b16 v[84:85], v23 offset:24576
    ds_read_b64_tr_b16 v[86:87], v23 offset:25600
    s_waitcnt lgkmcnt(14)
    v_mfma_f32_32x32x16_bf16 v[240:255], a[36:39], v[120:123], v[240:255]
    ds_read_b64_tr_b16 v[88:89], v24 offset:24576
    ds_read_b64_tr_b16 v[90:91], v24 offset:25600
    s_waitcnt lgkmcnt(14)
    v_mfma_f32_32x32x16_bf16 v[128:143], v[60:63], a[40:43], v[128:143]
    ds_read_b64_tr_b16 v[92:93], v21 offset:20480
    ds_read_b64_tr_b16 v[94:95], v21 offset:21504
    s_waitcnt lgkmcnt(14)
    v_mfma_f32_32x32x16_bf16 v[144:159], v[64:67], a[40:43], v[144:159]
    ds_read_b64_tr_b16 v[96:97], v22 offset:20480
    ds_read_b64_tr_b16 v[98:99], v22 offset:21504
    s_waitcnt lgkmcnt(14)
    v_mfma_f32_32x32x16_bf16 v[160:175], v[68:71], a[40:43], v[160:175]
    ds_read_b64_tr_b16 v[100:101], v23 offset:20480
    ds_read_b64_tr_b16 v[102:103], v23 offset:21504
    s_waitcnt lgkmcnt(14)
    v_mfma_f32_32x32x16_bf16 v[176:191], v[72:75], a[40:43], v[176:191]
    ds_read_b64_tr_b16 v[104:105], v24 offset:20480
    ds_read_b64_tr_b16 v[106:107], v24 offset:21504
    s_waitcnt lgkmcnt(14)
    v_mfma_f32_32x32x16_bf16 v[192:207], a[40:43], v[76:79], v[192:207]
    ds_read_b64_tr_b16 v[108:109], v21 offset:28672
    ds_read_b64_tr_b16 v[110:111], v21 offset:29696
    s_waitcnt lgkmcnt(14)
    v_mfma_f32_32x32x16_bf16 v[208:223], a[40:43], v[80:83], v[208:223]
    ds_read_b64_tr_b16 v[112:113], v22 offset:28672
    ds_read_b64_tr_b16 v[114:115], v22 offset:29696
    s_waitcnt lgkmcnt(14)
    v_mfma_f32_32x32x16_bf16 v[224:239], a[40:43], v[84:87], v[224:239]
    ds_read_b64_tr_b16 v[116:117], v23 offset:28672
    ds_read_b64_tr_b16 v[118:119], v23 offset:29696
    s_waitcnt lgkmcnt(14)
    v_mfma_f32_32x32x16_bf16 v[240:255], a[40:43], v[88:91], v[240:255]
    ds_read_b64_tr_b16 v[120:121], v24 offset:28672
    ds_read_b64_tr_b16 v[122:123], v24 offset:29696
    s_waitcnt vmcnt(6)
    s_barrier
    s_waitcnt lgkmcnt(14)
    v_mfma_f32_32x32x16_bf16 v[128:143], v[92:95], a[44:47], v[128:143]
    ds_read_b64_tr_b16 v[60:61], v21 offset:32768
    ds_read_b64_tr_b16 v[62:63], v21 offset:33792
    s_waitcnt lgkmcnt(14)
    v_mfma_f32_32x32x16_bf16 v[144:159], v[96:99], a[44:47], v[144:159]
    ds_read_b64_tr_b16 v[64:65], v22 offset:32768
    ds_read_b64_tr_b16 v[66:67], v22 offset:33792
    s_waitcnt lgkmcnt(14)
    v_mfma_f32_32x32x16_bf16 v[160:175], v[100:103], a[44:47], v[160:175]
    ds_read_b64_tr_b16 v[68:69], v23 offset:32768
    ds_read_b64_tr_b16 v[70:71], v23 offset:33792
    s_waitcnt lgkmcnt(14)
    v_mfma_f32_32x32x16_bf16 v[176:191], v[104:107], a[44:47], v[176:191]
    ds_read_b64_tr_b16 v[72:73], v24 offset:32768
    ds_read_b64_tr_b16 v[74:75], v24 offset:33792
    s_waitcnt lgkmcnt(14)
    v_mfma_f32_32x32x16_bf16 v[192:207], a[44:47], v[108:111], v[192:207]
    ds_read_b64_tr_b16 v[76:77], v21 offset:40960
    ds_read_b64_tr_b16 v[78:79], v21 offset:41984
    s_waitcnt lgkmcnt(14)
    v_mfma_f32_32x32x16_bf16 v[208:223], a[44:47], v[112:115], v[208:223]
    ds_read_b64_tr_b16 v[80:81], v22 offset:40960
    ds_read_b64_tr_b16 v[82:83], v22 offset:41984
    s_waitcnt lgkmcnt(14)
    v_mfma_f32_32x32x16_bf16 v[224:239], a[44:47], v[116:119], v[224:239]
    ds_read_b64_tr_b16 v[84:85], v23 offset:40960
    ds_read_b64_tr_b16 v[86:87], v23 offset:41984
    s_waitcnt lgkmcnt(14)
    v_mfma_f32_32x32x16_bf16 v[240:255], a[44:47], v[120:123], v[240:255]
    ds_read_b64_tr_b16 v[88:89], v24 offset:40960
    ds_read_b64_tr_b16 v[90:91], v24 offset:41984
    s_waitcnt lgkmcnt(14)
    v_mfma_f32_32x32x16_bf16 v[128:143], v[60:63], a[48:51], v[128:143]
    ds_read_b64_tr_b16 v[92:93], v21 offset:36864
    ds_read_b64_tr_b16 v[94:95], v21 offset:37888
    s_waitcnt lgkmcnt(14)
    v_mfma_f32_32x32x16_bf16 v[144:159], v[64:67], a[48:51], v[144:159]
    ds_read_b64_tr_b16 v[96:97], v22 offset:36864
    ds_read_b64_tr_b16 v[98:99], v22 offset:37888
    s_waitcnt lgkmcnt(14)
    v_mfma_f32_32x32x16_bf16 v[160:175], v[68:71], a[48:51], v[160:175]
    ds_read_b64_tr_b16 v[100:101], v23 offset:36864
    ds_read_b64_tr_b16 v[102:103], v23 offset:37888
    s_waitcnt lgkmcnt(14)
    v_mfma_f32_32x32x16_bf16 v[176:191], v[72:75], a[48:51], v[176:191]
    ds_read_b64_tr_b16 v[104:105], v24 offset:36864
    ds_read_b64_tr_b16 v[106:107], v24 offset:37888
    s_waitcnt lgkmcnt(14)
    v_mfma_f32_32x32x16_bf16 v[192:207], a[48:51], v[76:79], v[192:207]
    ds_read_b64_tr_b16 v[108:109], v21 offset:45056
    ds_read_b64_tr_b16 v[110:111], v21 offset:46080
    s_waitcnt lgkmcnt(14)
    v_mfma_f32_32x32x16_bf16 v[208:223], a[48:51], v[80:83], v[208:223]
    ds_read_b64_tr_b16 v[112:113], v22 offset:45056
    ds_read_b64_tr_b16 v[114:115], v22 offset:46080
    s_waitcnt lgkmcnt(14)
    v_mfma_f32_32x32x16_bf16 v[224:239], a[48:51], v[84:87], v[224:239]
    ds_read_b64_tr_b16 v[116:117], v23 offset:45056
    ds_read_b64_tr_b16 v[118:119], v23 offset:46080
    s_waitcnt lgkmcnt(14)
    v_mfma_f32_32x32x16_bf16 v[240:255], a[48:51], v[88:91], v[240:255]
    ds_read_b64_tr_b16 v[120:121], v24 offset:45056
    ds_read_b64_tr_b16 v[122:123], v24 offset:46080
    s_waitcnt vmcnt(0)
    s_barrier
    s_waitcnt lgkmcnt(14)
    v_mfma_f32_32x32x16_bf16 v[128:143], v[92:95], a[52:55], v[128:143]
    ds_read_b64_tr_b16 v[60:61], v21 offset:49152
    ds_read_b64_tr_b16 v[62:63], v21 offset:50176
    s_waitcnt lgkmcnt(14)
    v_mfma_f32_32x32x16_bf16 v[144:159], v[96:99], a[52:55], v[144:159]
    ds_read_b64_tr_b16 v[64:65], v22 offset:49152
    ds_read_b64_tr_b16 v[66:67], v22 offset:50176
    s_waitcnt lgkmcnt(14)
    v_mfma_f32_32x32x16_bf16 v[160:175], v[100:103], a[52:55], v[160:175]
    ds_read_b64_tr_b16 v[68:69], v23 offset:49152
    ds_read_b64_tr_b16 v[70:71], v23 offset:50176
    s_waitcnt lgkmcnt(14)
    v_mfma_f32_32x32x16_bf16 v[176:191], v[104:107], a[52:55], v[176:191]
    ds_read_b64_tr_b16 v[72:73], v24 offset:49152
    ds_read_b64_tr_b16 v[74:75], v24 offset:50176
    s_waitcnt lgkmcnt(14)
    v_mfma_f32_32x32x16_bf16 v[192:207], a[52:55], v[108:111], v[192:207]
    ds_read_b64_tr_b16 v[76:77], v21 offset:57344
    ds_read_b64_tr_b16 v[78:79], v21 offset:58368
    s_waitcnt lgkmcnt(14)
    v_mfma_f32_32x32x16_bf16 v[208:223], a[52:55], v[112:115], v[208:223]
    ds_read_b64_tr_b16 v[80:81], v22 offset:57344
    ds_read_b64_tr_b16 v[82:83], v22 offset:58368
    s_waitcnt lgkmcnt(14)
    v_mfma_f32_32x32x16_bf16 v[224:239], a[52:55], v[116:119], v[224:239]
    ds_read_b64_tr_b16 v[84:85], v23 offset:57344
    ds_read_b64_tr_b16 v[86:87], v23 offset:58368
    s_waitcnt lgkmcnt(14)
    v_mfma_f32_32x32x16_bf16 v[240:255], a[52:55], v[120:123], v[240:255]
    ds_read_b64_tr_b16 v[88:89], v24 offset:57344
    ds_read_b64_tr_b16 v[90:91], v24 offset:58368
    s_waitcnt lgkmcnt(14)
    v_mfma_f32_32x32x16_bf16 v[128:143], v[60:63], a[56:59], v[128:143]
    ds_read_b64_tr_b16 v[92:93], v21 offset:53248
    ds_read_b64_tr_b16 v[94:95], v21 offset:54272
    s_waitcnt lgkmcnt(14)
    v_mfma_f32_32x32x16_bf16 v[144:159], v[64:67], a[56:59], v[144:159]
    ds_read_b64_tr_b16 v[96:97], v22 offset:53248
    ds_read_b64_tr_b16 v[98:99], v22 offset:54272
    s_waitcnt lgkmcnt(14)
    v_mfma_f32_32x32x16_bf16 v[160:175], v[68:71], a[56:59], v[160:175]
    ds_read_b64_tr_b16 v[100:101], v23 offset:53248
    ds_read_b64_tr_b16 v[102:103], v23 offset:54272
    s_waitcnt lgkmcnt(14)
    v_mfma_f32_32x32x16_bf16 v[176:191], v[72:75], a[56:59], v[176:191]
    ds_read_b64_tr_b16 v[104:105], v24 offset:53248
    ds_read_b64_tr_b16 v[106:107], v24 offset:54272
    s_waitcnt lgkmcnt(14)
    v_mfma_f32_32x32x16_bf16 v[192:207], a[56:59], v[76:79], v[192:207]
    ds_read_b64_tr_b16 v[108:109], v21 offset:61440
    ds_read_b64_tr_b16 v[110:111], v21 offset:62464
    s_waitcnt lgkmcnt(14)
    v_mfma_f32_32x32x16_bf16 v[208:223], a[56:59], v[80:83], v[208:223]
    ds_read_b64_tr_b16 v[112:113], v22 offset:61440
    ds_read_b64_tr_b16 v[114:115], v22 offset:62464
    s_waitcnt lgkmcnt(14)
    v_mfma_f32_32x32x16_bf16 v[224:239], a[56:59], v[84:87], v[224:239]
    ds_read_b64_tr_b16 v[116:117], v23 offset:61440
    ds_read_b64_tr_b16 v[118:119], v23 offset:62464
    s_waitcnt lgkmcnt(14)
    v_mfma_f32_32x32x16_bf16 v[240:255], a[56:59], v[88:91], v[240:255]
    ds_read_b64_tr_b16 v[120:121], v24 offset:61440
    ds_read_b64_tr_b16 v[122:123], v24 offset:62464
    s_waitcnt lgkmcnt(14)
    v_mfma_f32_32x32x16_bf16 v[128:143], v[92:95], a[60:63], v[128:143]
    s_waitcnt lgkmcnt(12)
    v_mfma_f32_32x32x16_bf16 v[144:159], v[96:99], a[60:63], v[144:159]
    s_waitcnt lgkmcnt(10)
    v_mfma_f32_32x32x16_bf16 v[160:175], v[100:103], a[60:63], v[160:175]
    s_waitcnt lgkmcnt(8)
    v_mfma_f32_32x32x16_bf16 v[176:191], v[104:107], a[60:63], v[176:191]
    s_waitcnt lgkmcnt(6)
    v_mfma_f32_32x32x16_bf16 v[192:207], a[60:63], v[108:111], v[192:207]
    s_waitcnt lgkmcnt(4)
    v_mfma_f32_32x32x16_bf16 v[208:223], a[60:63], v[112:115], v[208:223]
    s_waitcnt lgkmcnt(2)
    v_mfma_f32_32x32x16_bf16 v[224:239], a[60:63], v[116:119], v[224:239]
    s_waitcnt lgkmcnt(0)
    v_mfma_f32_32x32x16_bf16 v[240:255], a[60:63], v[120:123], v[240:255]
    s_nop 11
    v_cvt_pk_bf16_f32 v60, v128, v129
    v_cvt_pk_bf16_f32 v61, v130, v131
    v_cvt_pk_bf16_f32 v62, v132, v133
    v_cvt_pk_bf16_f32 v63, v134, v135
    v_cvt_pk_bf16_f32 v64, v136, v137
    v_cvt_pk_bf16_f32 v65, v138, v139
    v_cvt_pk_bf16_f32 v66, v140, v141
    v_cvt_pk_bf16_f32 v67, v142, v143
    global_store_dwordx4 v11, v[60:63], s[18:19] offset:0 sc1
    global_store_dwordx4 v11, v[64:67], s[18:19] offset:512 sc1
    v_cvt_pk_bf16_f32 v68, v144, v145
    v_cvt_pk_bf16_f32 v69, v146, v147
    v_cvt_pk_bf16_f32 v70, v148, v149
    v_cvt_pk_bf16_f32 v71, v150, v151
    v_cvt_pk_bf16_f32 v72, v152, v153
    v_cvt_pk_bf16_f32 v73, v154, v155
    v_cvt_pk_bf16_f32 v74, v156, v157
    v_cvt_pk_bf16_f32 v75, v158, v159
    global_store_dwordx4 v11, v[68:71], s[18:19] offset:1024 sc1
    global_store_dwordx4 v11, v[72:75], s[18:19] offset:1536 sc1
    v_cvt_pk_bf16_f32 v76, v160, v161
    v_cvt_pk_bf16_f32 v77, v162, v163
    v_cvt_pk_bf16_f32 v78, v164, v165
    v_cvt_pk_bf16_f32 v79, v166, v167
    v_cvt_pk_bf16_f32 v80, v168, v169
    v_cvt_pk_bf16_f32 v81, v170, v171
    v_cvt_pk_bf16_f32 v82, v172, v173
    v_cvt_pk_bf16_f32 v83, v174, v175
    global_store_dwordx4 v11, v[76:79], s[18:19] offset:2048 sc1
    global_store_dwordx4 v11, v[80:83], s[18:19] offset:2560 sc1
    v_cvt_pk_bf16_f32 v84, v176, v177
    v_cvt_pk_bf16_f32 v85, v178, v179
    v_cvt_pk_bf16_f32 v86, v180, v181
    v_cvt_pk_bf16_f32 v87, v182, v183
    v_cvt_pk_bf16_f32 v88, v184, v185
    v_cvt_pk_bf16_f32 v89, v186, v187
    v_cvt_pk_bf16_f32 v90, v188, v189
    v_cvt_pk_bf16_f32 v91, v190, v191
    global_store_dwordx4 v11, v[84:87], s[18:19] offset:3072 sc1
    global_store_dwordx4 v11, v[88:91], s[18:19] offset:3584 sc1
    v_cvt_pk_bf16_f32 v92, v192, v193
    v_cvt_pk_bf16_f32 v93, v194, v195
    v_cvt_pk_bf16_f32 v94, v196, v197
    v_cvt_pk_bf16_f32 v95, v198, v199
    v_cvt_pk_bf16_f32 v96, v200, v201
    v_cvt_pk_bf16_f32 v97, v202, v203
    v_cvt_pk_bf16_f32 v98, v204, v205
    v_cvt_pk_bf16_f32 v99, v206, v207
    global_store_dwordx4 v12, v[92:95], s[20:21] offset:-4096 sc1
    global_store_dwordx4 v12, v[96:99], s[20:21] offset:-3584 sc1
    v_cvt_pk_bf16_f32 v100, v208, v209
    v_cvt_pk_bf16_f32 v101, v210, v211
    v_cvt_pk_bf16_f32 v102, v212, v213
    v_cvt_pk_bf16_f32 v103, v214, v215
    v_cvt_pk_bf16_f32 v104, v216, v217
    v_cvt_pk_bf16_f32 v105, v218, v219
    v_cvt_pk_bf16_f32 v106, v220, v221
    v_cvt_pk_bf16_f32 v107, v222, v223
    global_store_dwordx4 v12, v[100:103], s[20:21] offset:-2048 sc1
    global_store_dwordx4 v12, v[104:107], s[20:21] offset:-1536 sc1
    v_cvt_pk_bf16_f32 v108, v224, v225
    v_cvt_pk_bf16_f32 v109, v226, v227
    v_cvt_pk_bf16_f32 v110, v228, v229
    v_cvt_pk_bf16_f32 v111, v230, v231
    v_cvt_pk_bf16_f32 v112, v232, v233
    v_cvt_pk_bf16_f32 v113, v234, v235
    v_cvt_pk_bf16_f32 v114, v236, v237
    v_cvt_pk_bf16_f32 v115, v238, v239
    global_store_dwordx4 v12, v[108:111], s[20:21] offset:0 sc1
    global_store_dwordx4 v12, v[112:115], s[20:21] offset:512 sc1
    v_cvt_pk_bf16_f32 v116, v240, v241
    v_cvt_pk_bf16_f32 v117, v242, v243
    v_cvt_pk_bf16_f32 v118, v244, v245
    v_cvt_pk_bf16_f32 v119, v246, v247
    v_cvt_pk_bf16_f32 v120, v248, v249
    v_cvt_pk_bf16_f32 v121, v250, v251
    v_cvt_pk_bf16_f32 v122, v252, v253
    v_cvt_pk_bf16_f32 v123, v254, v255
    global_store_dwordx4 v12, v[116:119], s[20:21] offset:2048 sc1
    global_store_dwordx4 v12, v[120:123], s[20:21] offset:2560 sc1
    s_mov_b32 s55, 0
    s_lshl_b32 s88, s52, 7
    s_add_u32 s88, s88, 2048
    s_waitcnt vmcnt(0)
    s_barrier
    s_cmp_lg_u32 s4, 0
    s_cbranch_scc1 pub_153
    v_mov_b32 v13, s88
    v_mov_b32 v14, 1
    s_mov_b64 exec, 1
    global_atomic_add v13, v14, s[82:83] sc1
    v_mov_b32 v13, 15488
    global_atomic_add v13, v14, s[82:83] sc1
    s_mov_b64 exec, -1
pub_153:
    s_branch next_135
tgu_137:
    s_lshl_b32 s88, s52, 7
    s_add_u32 s88, s88, 0
    s_waitcnt vmcnt(0)
    s_cmp_lg_u32 s4, 0
    s_cbranch_scc1 wg_154
    v_mov_b32 v13, s88
wf_155:
    global_load_dword v14, v13, s[82:83] sc1
    s_waitcnt vmcnt(0)
    v_readfirstlane_b32 s87, v14
    s_cmp_ge_u32 s87, 32
    s_cbranch_scc1 wfd_156
    s_sub_u32 s86, s86, 1
    s_cbranch_scc1 wfd_156_x
    s_sleep 4
    s_branch wf_155
wfd_156_x:
    s_mov_b32 s86, 0
wfd_156:
wg_154:
    s_barrier
    s_mov_b32 s54, 1
    s_mov_b32 s26, 3584
    s_mov_b32 s28, 1
    s_lshl_b32 s36, s52, 1
    s_mul_i32 s34, s53, 5
    s_add_u32 s36, s36, s34
    s_and_b32 s36, s36, 15
    s_mov_b32 s31, 16
    s_lshl_b32 s15, s53, 8
    s_add_u32 s22, s70, s15
    s_addc_u32 s23, s71, 0
    s_add_u32 s24, s72, s15
    s_addc_u32 s25, s73, 0
    s_cmp_ge_u32 s4, 2
    s_cselect_b32 s10, s24, s22
    s_cselect_b32 s11, s25, s23
    s_and_b32 s14, s4, 1
    s_mul_i32 s14, s14, s26
    s_lshl_b32 s14, s14, 4
    s_add_u32 s10, s10, s14
    s_addc_u32 s11, s11, 0
    s_lshl_b32 s15, s52, 2
    s_add_u32 s15, s15, s4
    s_lshl_b32 s16, s15, 15
    s_add_u32 s16, s16, 61865984
    s_add_u32 s8, s80, s16
    s_addc_u32 s9, s81, 0
    s_mul_i32 s16, s15, 114688
    s_lshl_b32 s17, s53, 13
    s_add_u32 s16, s16, s17
    s_add_u32 s16, s16, 63967232
    s_add_u32 s18, s80, s16
    s_addc_u32 s19, s81, 0
    s_branch twf_139
tq_138:
    s_lshl_b32 s88, s52, 7
    s_add_u32 s88, s88, 0
    s_waitcnt vmcnt(0)
    s_cmp_lg_u32 s4, 0
    s_cbranch_scc1 wg_157
    v_mov_b32 v13, s88
wf_158:
    global_load_dword v14, v13, s[82:83] sc1
    s_waitcnt vmcnt(0)
    v_readfirstlane_b32 s87, v14
    s_cmp_ge_u32 s87, 32
    s_cbranch_scc1 wfd_159
    s_sub_u32 s86, s86, 1
    s_cbranch_scc1 wfd_159_x
    s_sleep 4
    s_branch wf_158
wfd_159_x:
    s_mov_b32 s86, 0
wfd_159:
wg_157:
    s_barrier
    s_mov_b32 s54, 0
    s_mov_b32 s26, 8192
    s_mov_b32 s28, 1
    s_lshl_b32 s36, s52, 1
    s_mul_i32 s34, s53, 5
    s_add_u32 s36, s36, s34
    s_and_b32 s36, s36, 15
    s_mov_b32 s31, 16
    s_lshl_b32 s15, s53, 9
    s_add_u32 s22, s62, s15
    s_addc_u32 s23, s63, 0
    s_add_u32 s24, s22, 256
    s_addc_u32 s25, s23, 0
    s_cmp_ge_u32 s4, 2
    s_cselect_b32 s10, s24, s22
    s_cselect_b32 s11, s25, s23
    s_and_b32 s14, s4, 1
    s_mul_i32 s14, s14, s26
    s_lshl_b32 s14, s14, 4
    s_add_u32 s10, s10, s14
    s_addc_u32 s11, s11, 0
    s_lshl_b32 s15, s52, 2
    s_add_u32 s15, s15, s4
    s_lshl_b32 s16, s15, 15
    s_add_u32 s16, s16, 61865984
    s_add_u32 s8, s80, s16
    s_addc_u32 s9, s81, 0
    s_lshl_b32 s16, s15, 5
    s_lshl_b32 s17, s53, 1
    s_add_u32 s16, s16, s17
    s_lshl_b32 s16, s16, 13
    s_add_u32 s16, s16, 33554432
    s_add_u32 s18, s80, s16
    s_addc_u32 s19, s81, 0
    s_add_u32 s20, s18, 8192
    s_addc_u32 s21, s19, 0
twf_139:
    v_lshrrev_b32 v13, 4, v1
    v_and_b32 v14, 15, v1
    v_lshlrev_b32 v15, 2, v13
    v_xor_b32 v14, v14, v15
    v_lshlrev_b32 v14, 4, v14
    v_mul_lo_u32 v15, v13, s26
    v_add_u32 v3, v15, v14
    s_lshl_b32 s14, s26, 2
    v_add_u32 v4, s14, v3
    v_add_u32 v5, s14, v4
    v_add_u32 v6, s14, v5
    s_lshl_b32 s27, s26, 5
    v_lshrrev_b32 v13, 4, v1
    v_bfe_u32 v14, v1, 2, 2
    v_and_b32 v15, 3, v1
    v_lshrrev_b32 v16, 1, v13
    v_lshl_add_u32 v16, v16, 3, v14
    v_and_b32 v17, 1, v13
    v_lshlrev_b32 v17, 1, v17
    v_lshrrev_b32 v18, 1, v15
    v_add_u32 v17, v17, v18
    v_and_b32 v18, 1, v15
    v_lshlrev_b32 v18, 3, v18
    v_lshl_add_u32 v18, v16, 8, v18
    v_xor_b32 v19, 0, v14
    v_lshl_add_u32 v19, v19, 2, v17
    v_lshl_add_u32 v7, v19, 4, v18
    v_xor_b32 v19, 1, v14
    v_lshl_add_u32 v19, v19, 2, v17
    v_lshl_add_u32 v8, v19, 4, v18
    v_xor_b32 v19, 2, v14
    v_lshl_add_u32 v19, v19, 2, v17
    v_lshl_add_u32 v9, v19, 4, v18
    v_xor_b32 v19, 3, v14
    v_lshl_add_u32 v19, v19, 2, v17
    v_lshl_add_u32 v10, v19, 4, v18
    s_lshl_b32 s12, s4, 12
    v_bfe_u32 v13, v1, 4, 1
    v_lshlrev_b32 v13, 3, v13
    v_and_b32 v14, 7, v1
    v_add_u32 v13, v13, v14
    v_lshrrev_b32 v14, 5, v1
    v_lshl_add_u32 v13, v14, 4, v13
    v_lshlrev_b32 v13, 4, v13
    v_bfe_u32 v14, v1, 3, 1
    v_lshl_add_u32 v11, v14, 12, v13
    s_mov_b32 s30, s36
    s_mul_i32 s34, s36, s27
    s_add_u32 s10, s10, s34
    s_addc_u32 s11, s11, 0
    s_mul_i32 s34, s31, s27
    s_sub_u32 s33, s27, s34
    s_mov_b32 s29, s36
    s_lshl_b32 s34, s36, 11
    s_add_u32 s8, s8, s34
    s_addc_u32 s9, s9, 0
    s_lshl_b32 s34, s31, 11
    s_sub_u32 s32, 2048, s34
    v_add_u32 v21, 0x10000, v7
    v_add_u32 v22, 0x10000, v8
    v_add_u32 v23, 0x10000, v9
    v_add_u32 v24, 0x10000, v10
    v_mov_b64 v[128:129], 0
    v_mov_b64 v[130:131], 0
    v_mov_b64 v[132:133], 0
    v_mov_b64 v[134:135], 0
    v_mov_b64 v[136:137], 0
    v_mov_b64 v[138:139], 0
    v_mov_b64 v[140:141], 0
    v_mov_b64 v[142:143], 0
    v_mov_b64 v[144:145], 0
    v_mov_b64 v[146:147], 0
    v_mov_b64 v[148:149], 0
    v_mov_b64 v[150:151], 0
    v_mov_b64 v[152:153], 0
    v_mov_b64 v[154:155], 0
    v_mov_b64 v[156:157], 0
    v_mov_b64 v[158:159], 0
    v_mov_b64 v[160:161], 0
    v_mov_b64 v[162:163], 0
    v_mov_b64 v[164:165], 0
    v_mov_b64 v[166:167], 0
    v_mov_b64 v[168:169], 0
    v_mov_b64 v[170:171], 0
    v_mov_b64 v[172:173], 0
    v_mov_b64 v[174:175], 0
    v_mov_b64 v[176:177], 0
    v_mov_b64 v[178:179], 0
    v_mov_b64 v[180:181], 0
    v_mov_b64 v[182:183], 0
    v_mov_b64 v[184:185], 0
    v_mov_b64 v[186:187], 0
    v_mov_b64 v[188:189], 0
    v_mov_b64 v[190:191], 0
    v_mov_b64 v[192:193], 0
    v_mov_b64 v[194:195], 0
    v_mov_b64 v[196:197], 0
    v_mov_b64 v[198:199], 0
    v_mov_b64 v[200:201], 0
    v_mov_b64 v[202:203], 0
    v_mov_b64 v[204:205], 0
    v_mov_b64 v[206:207], 0
    v_mov_b64 v[208:209], 0
    v_mov_b64 v[210:211], 0
    v_mov_b64 v[212:213], 0
    v_mov_b64 v[214:215], 0
    v_mov_b64 v[216:217], 0
    v_mov_b64 v[218:219], 0
    v_mov_b64 v[220:221], 0
    v_mov_b64 v[222:223], 0
    v_mov_b64 v[224:225], 0
    v_mov_b64 v[226:227], 0
    v_mov_b64 v[228:229], 0
    v_mov_b64 v[230:231], 0
    v_mov_b64 v[232:233], 0
    v_mov_b64 v[234:235], 0
    v_mov_b64 v[236:237], 0
    v_mov_b64 v[238:239], 0
    v_mov_b64 v[240:241], 0
    v_mov_b64 v[242:243], 0
    v_mov_b64 v[244:245], 0
    v_mov_b64 v[246:247], 0
    v_mov_b64 v[248:249], 0
    v_mov_b64 v[250:251], 0
    v_mov_b64 v[252:253], 0
    v_mov_b64 v[254:255], 0
    global_load_dwordx4 a[0:3], v2, s[8:9] offset:0 sc1
    global_load_dwordx4 a[4:7], v2, s[8:9] offset:1024 sc1
    s_add_u32 s29, s29, 1
    s_cmp_eq_u32 s29, s31
    s_cselect_b32 s34, s32, 2048
    s_cselect_b32 s35, -1, 0
    s_cselect_b32 s29, 0, s29
    s_add_u32 s8, s8, s34
    s_addc_u32 s9, s9, s35
    global_load_dwordx4 a[8:11], v2, s[8:9] offset:0 sc1
    global_load_dwordx4 a[12:15], v2, s[8:9] offset:1024 sc1
    s_add_u32 s29, s29, 1
    s_cmp_eq_u32 s29, s31
    s_cselect_b32 s34, s32, 2048
    s_cselect_b32 s35, -1, 0
    s_cselect_b32 s29, 0, s29
    s_add_u32 s8, s8, s34
    s_addc_u32 s9, s9, s35
    global_load_dwordx4 a[16:19], v2, s[8:9] offset:0 sc1
    global_load_dwordx4 a[20:23], v2, s[8:9] offset:1024 sc1
    s_add_u32 s29, s29, 1
    s_cmp_eq_u32 s29, s31
    s_cselect_b32 s34, s32, 2048
    s_cselect_b32 s35, -1, 0
    s_cselect_b32 s29, 0, s29
    s_add_u32 s8, s8, s34
    s_addc_u32 s9, s9, s35
    global_load_dwordx4 a[24:27], v2, s[8:9] offset:0 sc1
    global_load_dwordx4 a[28:31], v2, s[8:9] offset:1024 sc1
    s_add_u32 s29, s29, 1
    s_cmp_eq_u32 s29, s31
    s_cselect_b32 s34, s32, 2048
    s_cselect_b32 s35, -1, 0
    s_cselect_b32 s29, 0, s29
    s_add_u32 s8, s8, s34
    s_addc_u32 s9, s9, s35
    global_load_dwordx4 a[32:35], v2, s[8:9] offset:0 sc1
    global_load_dwordx4 a[36:39], v2, s[8:9] offset:1024 sc1
    s_add_u32 s29, s29, 1
    s_cmp_eq_u32 s29, s31
    s_cselect_b32 s34, s32, 2048
    s_cselect_b32 s35, -1, 0
    s_cselect_b32 s29, 0, s29
    s_add_u32 s8, s8, s34
    s_addc_u32 s9, s9, s35
    global_load_dwordx4 a[40:43], v2, s[8:9] offset:0 sc1
    global_load_dwordx4 a[44:47], v2, s[8:9] offset:1024 sc1
    s_add_u32 s29, s29, 1
    s_cmp_eq_u32 s29, s31
    s_cselect_b32 s34, s32, 2048
    s_cselect_b32 s35, -1, 0
    s_cselect_b32 s29, 0, s29
    s_add_u32 s8, s8, s34
    s_addc_u32 s9, s9, s35
    global_load_dwordx4 a[48:51], v2, s[8:9] offset:0 sc1
    global_load_dwordx4 a[52:55], v2, s[8:9] offset:1024 sc1
    s_add_u32 s29, s29, 1
    s_cmp_eq_u32 s29, s31
    s_cselect_b32 s34, s32, 2048
    s_cselect_b32 s35, -1, 0
    s_cselect_b32 s29, 0, s29
    s_add_u32 s8, s8, s34
    s_addc_u32 s9, s9, s35
    s_add_u32 m0, s12, 0
    s_nop 0
    global_load_lds_dwordx4 v3, s[10:11]
    s_add_u32 m0, s12, 1024
    s_nop 0
    global_load_lds_dwordx4 v4, s[10:11]
    s_add_u32 m0, s12, 2048
    s_nop 0
    global_load_lds_dwordx4 v5, s[10:11]
    s_add_u32 m0, s12, 3072
    s_nop 0
    global_load_lds_dwordx4 v6, s[10:11]
    s_add_u32 s30, s30, 1
    s_cmp_eq_u32 s30, s31
    s_cselect_b32 s34, s33, s27
    s_cselect_b32 s35, -1, 0
    s_cselect_b32 s30, 0, s30
    s_add_u32 s10, s10, s34
    s_addc_u32 s11, s11, s35
    s_add_u32 m0, s12, 16384
    s_nop 0
    global_load_lds_dwordx4 v3, s[10:11]
    s_add_u32 m0, s12, 17408
    s_nop 0
    global_load_lds_dwordx4 v4, s[10:11]
    s_add_u32 m0, s12, 18432
    s_nop 0
    global_load_lds_dwordx4 v5, s[10:11]
    s_add_u32 m0, s12, 19456
    s_nop 0
    global_load_lds_dwordx4 v6, s[10:11]
    s_add_u32 s30, s30, 1
    s_cmp_eq_u32 s30, s31
    s_cselect_b32 s34, s33, s27
    s_cselect_b32 s35, -1, 0
    s_cselect_b32 s30, 0, s30
    s_add_u32 s10, s10, s34
    s_addc_u32 s11, s11, s35
    s_add_u32 m0, s12, 32768
    s_nop 0
    global_load_lds_dwordx4 v3, s[10:11]
    s_add_u32 m0, s12, 33792
    s_nop 0
    global_load_lds_dwordx4 v4, s[10:11]
    s_add_u32 m0, s12, 34816
    s_nop 0
    global_load_lds_dwordx4 v5, s[10:11]
    s_add_u32 m0, s12, 35840
    s_nop 0
    global_load_lds_dwordx4 v6, s[10:11]
    s_add_u32 s30, s30, 1
    s_cmp_eq_u32 s30, s31
    s_cselect_b32 s34, s33, s27
    s_cselect_b32 s35, -1, 0
    s_cselect_b32 s30, 0, s30
    s_add_u32 s10, s10, s34
    s_addc_u32 s11, s11, s35
    s_add_u32 m0, s12, 49152
    s_nop 0
    global_load_lds_dwordx4 v3, s[10:11]
    s_add_u32 m0, s12, 50176
    s_nop 0
    global_load_lds_dwordx4 v4, s[10:11]
    s_add_u32 m0, s12, 51200
    s_nop 0
    global_load_lds_dwordx4 v5, s[10:11]
    s_add_u32 m0, s12, 52224
    s_nop 0
    global_load_lds_dwordx4 v6, s[10:11]
    s_add_u32 s30, s30, 1
    s_cmp_eq_u32 s30, s31
    s_cselect_b32 s34, s33, s27
    s_cselect_b32 s35, -1, 0
    s_cselect_b32 s30, 0, s30
    s_add_u32 s10, s10, s34
    s_addc_u32 s11, s11, s35
    s_add_u32 m0, s12, 65536
    s_nop 0
    global_load_lds_dwordx4 v3, s[10:11]
    s_add_u32 m0, s12, 66560
    s_nop 0
    global_load_lds_dwordx4 v4, s[10:11]
    s_add_u32 m0, s12, 67584
    s_nop 0
    global_load_lds_dwordx4 v5, s[10:11]
    s_add_u32 m0, s12, 68608
    s_nop 0
    global_load_lds_dwordx4 v6, s[10:11]
    s_add_u32 s30, s30, 1
    s_cmp_eq_u32 s30, s31
    s_cselect_b32 s34, s33, s27
    s_cselect_b32 s35, -1, 0
    s_cselect_b32 s30, 0, s30
    s_add_u32 s10, s10, s34
    s_addc_u32 s11, s11, s35
    s_add_u32 m0, s12, 81920
    s_nop 0
    global_load_lds_dwordx4 v3, s[10:11]
    s_add_u32 m0, s12, 82944
    s_nop 0
    global_load_lds_dwordx4 v4, s[10:11]
    s_add_u32 m0, s12, 83968
    s_nop 0
    global_load_lds_dwordx4 v5, s[10:11]
    s_add_u32 m0, s12, 84992
    s_nop 0
    global_load_lds_dwordx4 v6, s[10:11]
    s_add_u32 s30, s30, 1
    s_cmp_eq_u32 s30, s31
    s_cselect_b32 s34, s33, s27
    s_cselect_b32 s35, -1, 0
    s_cselect_b32 s30, 0, s30
    s_add_u32 s10, s10, s34
    s_addc_u32 s11, s11, s35
    s_add_u32 m0, s12, 98304
    s_nop 0
    global_load_lds_dwordx4 v3, s[10:11]
    s_add_u32 m0, s12, 99328
    s_nop 0
    global_load_lds_dwordx4 v4, s[10:11]
    s_add_u32 m0, s12, 100352
    s_nop 0
    global_load_lds_dwordx4 v5, s[10:11]
    s_add_u32 m0, s12, 101376
    s_nop 0
    global_load_lds_dwordx4 v6, s[10:11]
    s_add_u32 s30, s30, 1
    s_cmp_eq_u32 s30, s31
    s_cselect_b32 s34, s33, s27
    s_cselect_b32 s35, -1, 0
    s_cselect_b32 s30, 0, s30
    s_add_u32 s10, s10, s34
    s_addc_u32 s11, s11, s35
    s_waitcnt vmcnt(24)
    s_barrier
    ds_read_b64_tr_b16 v[60:61], v7 offset:0
    ds_read_b64_tr_b16 v[62:63], v7 offset:1024
    ds_read_b64_tr_b16 v[64:65], v8 offset:0
    ds_read_b64_tr_b16 v[66:67], v8 offset:1024
    ds_read_b64_tr_b16 v[68:69], v9 offset:0
    ds_read_b64_tr_b16 v[70:71], v9 offset:1024
    ds_read_b64_tr_b16 v[72:73], v10 offset:0
    ds_read_b64_tr_b16 v[74:75], v10 offset:1024
    ds_read_b64_tr_b16 v[76:77], v7 offset:8192
    ds_read_b64_tr_b16 v[78:79], v7 offset:9216
    ds_read_b64_tr_b16 v[80:81], v8 offset:8192
    ds_read_b64_tr_b16 v[82:83], v8 offset:9216
    ds_read_b64_tr_b16 v[84:85], v9 offset:8192
    ds_read_b64_tr_b16 v[86:87], v9 offset:9216
    ds_read_b64_tr_b16 v[88:89], v10 offset:8192
    ds_read_b64_tr_b16 v[90:91], v10 offset:9216
    s_mov_b32 s13, s28
gl_160:
    s_waitcnt lgkmcnt(14)
    v_mfma_f32_32x32x16_bf16 v[128:143], v[60:63], a[0:3], v[128:143]
    ds_read_b64_tr_b16 v[92:93], v7 offset:4096
    ds_read_b64_tr_b16 v[94:95], v7 offset:5120
    s_waitcnt lgkmcnt(14)
    v_mfma_f32_32x32x16_bf16 v[144:159], v[64:67], a[0:3], v[144:159]
    ds_read_b64_tr_b16 v[96:97], v8 offset:4096
    ds_read_b64_tr_b16 v[98:99], v8 offset:5120
    s_waitcnt lgkmcnt(14)
    v_mfma_f32_32x32x16_bf16 v[160:175], v[68:71], a[0:3], v[160:175]
    ds_read_b64_tr_b16 v[100:101], v9 offset:4096
    ds_read_b64_tr_b16 v[102:103], v9 offset:5120
    s_waitcnt lgkmcnt(14)
    v_mfma_f32_32x32x16_bf16 v[176:191], v[72:75], a[0:3], v[176:191]
    ds_read_b64_tr_b16 v[104:105], v10 offset:4096
    ds_read_b64_tr_b16 v[106:107], v10 offset:5120
    s_waitcnt lgkmcnt(14)
    v_mfma_f32_32x32x16_bf16 v[192:207], v[76:79], a[0:3], v[192:207]
    ds_read_b64_tr_b16 v[108:109], v7 offset:12288
    ds_read_b64_tr_b16 v[110:111], v7 offset:13312
    s_waitcnt lgkmcnt(14)
    v_mfma_f32_32x32x16_bf16 v[208:223], v[80:83], a[0:3], v[208:223]
    ds_read_b64_tr_b16 v[112:113], v8 offset:12288
    ds_read_b64_tr_b16 v[114:115], v8 offset:13312
    s_waitcnt lgkmcnt(14)
    v_mfma_f32_32x32x16_bf16 v[224:239], v[84:87], a[0:3], v[224:239]
    ds_read_b64_tr_b16 v[116:117], v9 offset:12288
    ds_read_b64_tr_b16 v[118:119], v9 offset:13312
    s_waitcnt lgkmcnt(14)
    v_mfma_f32_32x32x16_bf16 v[240:255], v[88:91], a[0:3], v[240:255]
    ds_read_b64_tr_b16 v[120:121], v10 offset:12288
    ds_read_b64_tr_b16 v[122:123], v10 offset:13312
    s_waitcnt vmcnt(20)
    s_barrier
    s_waitcnt lgkmcnt(14)
    v_mfma_f32_32x32x16_bf16 v[128:143], v[92:95], a[4:7], v[128:143]
    ds_read_b64_tr_b16 v[60:61], v7 offset:16384
    ds_read_b64_tr_b16 v[62:63], v7 offset:17408
    global_load_dwordx4 a[56:59], v2, s[8:9] offset:0 sc1
    s_waitcnt lgkmcnt(14)
    v_mfma_f32_32x32x16_bf16 v[144:159], v[96:99], a[4:7], v[144:159]
    ds_read_b64_tr_b16 v[64:65], v8 offset:16384
    ds_read_b64_tr_b16 v[66:67], v8 offset:17408
    global_load_dwordx4 a[60:63], v2, s[8:9] offset:1024 sc1
    s_add_u32 s29, s29, 1
    s_cmp_eq_u32 s29, s31
    s_cselect_b32 s34, s32, 2048
    s_cselect_b32 s35, -1, 0
    s_cselect_b32 s29, 0, s29
    s_add_u32 s8, s8, s34
    s_addc_u32 s9, s9, s35
    s_waitcnt lgkmcnt(14)
    v_mfma_f32_32x32x16_bf16 v[160:175], v[100:103], a[4:7], v[160:175]
    ds_read_b64_tr_b16 v[68:69], v9 offset:16384
    ds_read_b64_tr_b16 v[70:71], v9 offset:17408
    s_add_u32 m0, s12, 114688
    s_nop 0
    global_load_lds_dwordx4 v3, s[10:11]
    s_waitcnt lgkmcnt(14)
    v_mfma_f32_32x32x16_bf16 v[176:191], v[104:107], a[4:7], v[176:191]
    ds_read_b64_tr_b16 v[72:73], v10 offset:16384
    ds_read_b64_tr_b16 v[74:75], v10 offset:17408
    s_add_u32 m0, s12, 115712
    s_nop 0
    global_load_lds_dwordx4 v4, s[10:11]
    s_waitcnt lgkmcnt(14)
    v_mfma_f32_32x32x16_bf16 v[192:207], v[108:111], a[4:7], v[192:207]
    ds_read_b64_tr_b16 v[76:77], v7 offset:24576
    ds_read_b64_tr_b16 v[78:79], v7 offset:25600
    s_add_u32 m0, s12, 116736
    s_nop 0
    global_load_lds_dwordx4 v5, s[10:11]
    s_waitcnt lgkmcnt(14)
    v_mfma_f32_32x32x16_bf16 v[208:223], v[112:115], a[4:7], v[208:223]
    ds_read_b64_tr_b16 v[80:81], v8 offset:24576
    ds_read_b64_tr_b16 v[82:83], v8 offset:25600
    s_add_u32 m0, s12, 117760
    s_nop 0
    global_load_lds_dwordx4 v6, s[10:11]
    s_add_u32 s30, s30, 1
    s_cmp_eq_u32 s30, s31
    s_cselect_b32 s34, s33, s27
    s_cselect_b32 s35, -1, 0
    s_cselect_b32 s30, 0, s30
    s_add_u32 s10, s10, s34
    s_addc_u32 s11, s11, s35
    s_waitcnt lgkmcnt(14)
    v_mfma_f32_32x32x16_bf16 v[224:239], v[116:119], a[4:7], v[224:239]
    ds_read_b64_tr_b16 v[84:85], v9 offset:24576
    ds_read_b64_tr_b16 v[86:87], v9 offset:25600
    s_waitcnt lgkmcnt(14)
    v_mfma_f32_32x32x16_bf16 v[240:255], v[120:123], a[4:7], v[240:255]
    ds_read_b64_tr_b16 v[88:89], v10 offset:24576
    ds_read_b64_tr_b16 v[90:91], v10 offset:25600
    s_waitcnt lgkmcnt(14)
    v_mfma_f32_32x32x16_bf16 v[128:143], v[60:63], a[8:11], v[128:143]
    ds_read_b64_tr_b16 v[92:93], v7 offset:20480
    ds_read_b64_tr_b16 v[94:95], v7 offset:21504
    s_waitcnt lgkmcnt(14)
    v_mfma_f32_32x32x16_bf16 v[144:159], v[64:67], a[8:11], v[144:159]
    ds_read_b64_tr_b16 v[96:97], v8 offset:20480
    ds_read_b64_tr_b16 v[98:99], v8 offset:21504
    s_waitcnt lgkmcnt(14)
    v_mfma_f32_32x32x16_bf16 v[160:175], v[68:71], a[8:11], v[160:175]
    ds_read_b64_tr_b16 v[100:101], v9 offset:20480
    ds_read_b64_tr_b16 v[102:103], v9 offset:21504
    s_waitcnt lgkmcnt(14)
    v_mfma_f32_32x32x16_bf16 v[176:191], v[72:75], a[8:11], v[176:191]
    ds_read_b64_tr_b16 v[104:105], v10 offset:20480
    ds_read_b64_tr_b16 v[106:107], v10 offset:21504
    s_waitcnt lgkmcnt(14)
    v_mfma_f32_32x32x16_bf16 v[192:207], v[76:79], a[8:11], v[192:207]
    ds_read_b64_tr_b16 v[108:109], v7 offset:28672
    ds_read_b64_tr_b16 v[110:111], v7 offset:29696
    s_waitcnt lgkmcnt(14)
    v_mfma_f32_32x32x16_bf16 v[208:223], v[80:83], a[8:11], v[208:223]
    ds_read_b64_tr_b16 v[112:113], v8 offset:28672
    ds_read_b64_tr_b16 v[114:115], v8 offset:29696
    s_waitcnt lgkmcnt(14)
    v_mfma_f32_32x32x16_bf16 v[224:239], v[84:87], a[8:11], v[224:239]
    ds_read_b64_tr_b16 v[116:117], v9 offset:28672
    ds_read_b64_tr_b16 v[118:119], v9 offset:29696
    s_waitcnt lgkmcnt(14)
    v_mfma_f32_32x32x16_bf16 v[240:255], v[88:91], a[8:11], v[240:255]
    ds_read_b64_tr_b16 v[120:121], v10 offset:28672
    ds_read_b64_tr_b16 v[122:123], v10 offset:29696
    s_waitcnt vmcnt(22)
    s_barrier
    s_waitcnt lgkmcnt(14)
    v_mfma_f32_32x32x16_bf16 v[128:143], v[92:95], a[12:15], v[128:143]
    ds_read_b64_tr_b16 v[60:61], v7 offset:32768
    ds_read_b64_tr_b16 v[62:63], v7 offset:33792
    global_load_dwordx4 a[0:3], v2, s[8:9] offset:0 sc1
    s_waitcnt lgkmcnt(14)
    v_mfma_f32_32x32x16_bf16 v[144:159], v[96:99], a[12:15], v[144:159]
    ds_read_b64_tr_b16 v[64:65], v8 offset:32768
    ds_read_b64_tr_b16 v[66:67], v8 offset:33792
    global_load_dwordx4 a[4:7], v2, s[8:9] offset:1024 sc1
    s_add_u32 s29, s29, 1
    s_cmp_eq_u32 s29, s31
    s_cselect_b32 s34, s32, 2048
    s_cselect_b32 s35, -1, 0
    s_cselect_b32 s29, 0, s29
    s_add_u32 s8, s8, s34
    s_addc_u32 s9, s9, s35
    s_waitcnt lgkmcnt(14)
    v_mfma_f32_32x32x16_bf16 v[160:175], v[100:103], a[12:15], v[160:175]
    ds_read_b64_tr_b16 v[68:69], v9 offset:32768
    ds_read_b64_tr_b16 v[70:71], v9 offset:33792
    s_add_u32 m0, s12, 0
    s_nop 0
    global_load_lds_dwordx4 v3, s[10:11]
    s_waitcnt lgkmcnt(14)
    v_mfma_f32_32x32x16_bf16 v[176:191], v[104:107], a[12:15], v[176:191]
    ds_read_b64_tr_b16 v[72:73], v10 offset:32768
    ds_read_b64_tr_b16 v[74:75], v10 offset:33792
    s_add_u32 m0, s12, 1024
    s_nop 0
    global_load_lds_dwordx4 v4, s[10:11]
    s_waitcnt lgkmcnt(14)
    v_mfma_f32_32x32x16_bf16 v[192:207], v[108:111], a[12:15], v[192:207]
    ds_read_b64_tr_b16 v[76:77], v7 offset:40960
    ds_read_b64_tr_b16 v[78:79], v7 offset:41984
    s_add_u32 m0, s12, 2048
    s_nop 0
    global_load_lds_dwordx4 v5, s[10:11]
    s_waitcnt lgkmcnt(14)
    v_mfma_f32_32x32x16_bf16 v[208:223], v[112:115], a[12:15], v[208:223]
    ds_read_b64_tr_b16 v[80:81], v8 offset:40960
    ds_read_b64_tr_b16 v[82:83], v8 offset:41984
    s_add_u32 m0, s12, 3072
    s_nop 0
    global_load_lds_dwordx4 v6, s[10:11]
    s_add_u32 s30, s30, 1
    s_cmp_eq_u32 s30, s31
    s_cselect_b32 s34, s33, s27
    s_cselect_b32 s35, -1, 0
    s_cselect_b32 s30, 0, s30
    s_add_u32 s10, s10, s34
    s_addc_u32 s11, s11, s35
    s_waitcnt lgkmcnt(14)
    v_mfma_f32_32x32x16_bf16 v[224:239], v[116:119], a[12:15], v[224:239]
    ds_read_b64_tr_b16 v[84:85], v9 offset:40960
    ds_read_b64_tr_b16 v[86:87], v9 offset:41984
    s_waitcnt lgkmcnt(14)
    v_mfma_f32_32x32x16_bf16 v[240:255], v[120:123], a[12:15], v[240:255]
    ds_read_b64_tr_b16 v[88:89], v10 offset:40960
    ds_read_b64_tr_b16 v[90:91], v10 offset:41984
    s_waitcnt lgkmcnt(14)
    v_mfma_f32_32x32x16_bf16 v[128:143], v[60:63], a[16:19], v[128:143]
    ds_read_b64_tr_b16 v[92:93], v7 offset:36864
    ds_read_b64_tr_b16 v[94:95], v7 offset:37888
    s_waitcnt lgkmcnt(14)
    v_mfma_f32_32x32x16_bf16 v[144:159], v[64:67], a[16:19], v[144:159]
    ds_read_b64_tr_b16 v[96:97], v8 offset:36864
    ds_read_b64_tr_b16 v[98:99], v8 offset:37888
    s_waitcnt lgkmcnt(14)
    v_mfma_f32_32x32x16_bf16 v[160:175], v[68:71], a[16:19], v[160:175]
    ds_read_b64_tr_b16 v[100:101], v9 offset:36864
    ds_read_b64_tr_b16 v[102:103], v9 offset:37888
    s_waitcnt lgkmcnt(14)
    v_mfma_f32_32x32x16_bf16 v[176:191], v[72:75], a[16:19], v[176:191]
    ds_read_b64_tr_b16 v[104:105], v10 offset:36864
    ds_read_b64_tr_b16 v[106:107], v10 offset:37888
    s_waitcnt lgkmcnt(14)
    v_mfma_f32_32x32x16_bf16 v[192:207], v[76:79], a[16:19], v[192:207]
    ds_read_b64_tr_b16 v[108:109], v7 offset:45056
    ds_read_b64_tr_b16 v[110:111], v7 offset:46080
    s_waitcnt lgkmcnt(14)
    v_mfma_f32_32x32x16_bf16 v[208:223], v[80:83], a[16:19], v[208:223]
    ds_read_b64_tr_b16 v[112:113], v8 offset:45056
    ds_read_b64_tr_b16 v[114:115], v8 offset:46080
    s_waitcnt lgkmcnt(14)
    v_mfma_f32_32x32x16_bf16 v[224:239], v[84:87], a[16:19], v[224:239]
    ds_read_b64_tr_b16 v[116:117], v9 offset:45056
    ds_read_b64_tr_b16 v[118:119], v9 offset:46080
    s_waitcnt lgkmcnt(14)
    v_mfma_f32_32x32x16_bf16 v[240:255], v[88:91], a[16:19], v[240:255]
    ds_read_b64_tr_b16 v[120:121], v10 offset:45056
    ds_read_b64_tr_b16 v[122:123], v10 offset:46080
    s_waitcnt vmcnt(24)
    s_barrier
    s_waitcnt lgkmcnt(14)
    v_mfma_f32_32x32x16_bf16 v[128:143], v[92:95], a[20:23], v[128:143]
    ds_read_b64_tr_b16 v[60:61], v7 offset:49152
    ds_read_b64_tr_b16 v[62:63], v7 offset:50176
    global_load_dwordx4 a[8:11], v2, s[8:9] offset:0 sc1
    s_waitcnt lgkmcnt(14)
    v_mfma_f32_32x32x16_bf16 v[144:159], v[96:99], a[20:23], v[144:159]
    ds_read_b64_tr_b16 v[64:65], v8 offset:49152
    ds_read_b64_tr_b16 v[66:67], v8 offset:50176
    global_load_dwordx4 a[12:15], v2, s[8:9] offset:1024 sc1
    s_add_u32 s29, s29, 1
    s_cmp_eq_u32 s29, s31
    s_cselect_b32 s34, s32, 2048
    s_cselect_b32 s35, -1, 0
    s_cselect_b32 s29, 0, s29
    s_add_u32 s8, s8, s34
    s_addc_u32 s9, s9, s35
    s_waitcnt lgkmcnt(14)
    v_mfma_f32_32x32x16_bf16 v[160:175], v[100:103], a[20:23], v[160:175]
    ds_read_b64_tr_b16 v[68:69], v9 offset:49152
    ds_read_b64_tr_b16 v[70:71], v9 offset:50176
    s_add_u32 m0, s12, 16384
    s_nop 0
    global_load_lds_dwordx4 v3, s[10:11]
    s_waitcnt lgkmcnt(14)
    v_mfma_f32_32x32x16_bf16 v[176:191], v[104:107], a[20:23], v[176:191]
    ds_read_b64_tr_b16 v[72:73], v10 offset:49152
    ds_read_b64_tr_b16 v[74:75], v10 offset:50176
    s_add_u32 m0, s12, 17408
    s_nop 0
    global_load_lds_dwordx4 v4, s[10:11]
    s_waitcnt lgkmcnt(14)
    v_mfma_f32_32x32x16_bf16 v[192:207], v[108:111], a[20:23], v[192:207]
    ds_read_b64_tr_b16 v[76:77], v7 offset:57344
    ds_read_b64_tr_b16 v[78:79], v7 offset:58368
    s_add_u32 m0, s12, 18432
    s_nop 0
    global_load_lds_dwordx4 v5, s[10:11]
    s_waitcnt lgkmcnt(14)
    v_mfma_f32_32x32x16_bf16 v[208:223], v[112:115], a[20:23], v[208:223]
    ds_read_b64_tr_b16 v[80:81], v8 offset:57344
    ds_read_b64_tr_b16 v[82:83], v8 offset:58368
    s_add_u32 m0, s12, 19456
    s_nop 0
    global_load_lds_dwordx4 v6, s[10:11]
    s_add_u32 s30, s30, 1
    s_cmp_eq_u32 s30, s31
    s_cselect_b32 s34, s33, s27
    s_cselect_b32 s35, -1, 0
    s_cselect_b32 s30, 0, s30
    s_add_u32 s10, s10, s34
    s_addc_u32 s11, s11, s35
    s_waitcnt lgkmcnt(14)
    v_mfma_f32_32x32x16_bf16 v[224:239], v[116:119], a[20:23], v[224:239]
    ds_read_b64_tr_b16 v[84:85], v9 offset:57344
    ds_read_b64_tr_b16 v[86:87], v9 offset:58368
    s_waitcnt lgkmcnt(14)
    v_mfma_f32_32x32x16_bf16 v[240:255], v[120:123], a[20:23], v[240:255]
    ds_read_b64_tr_b16 v[88:89], v10 offset:57344
    ds_read_b64_tr_b16 v[90:91], v10 offset:58368
    s_waitcnt lgkmcnt(14)
    v_mfma_f32_32x32x16_bf16 v[128:143], v[60:63], a[24:27], v[128:143]
    ds_read_b64_tr_b16 v[92:93], v7 offset:53248
    ds_read_b64_tr_b16 v[94:95], v7 offset:54272
    s_waitcnt lgkmcnt(14)
    v_mfma_f32_32x32x16_bf16 v[144:159], v[64:67], a[24:27], v[144:159]
    ds_read_b64_tr_b16 v[96:97], v8 offset:53248
    ds_read_b64_tr_b16 v[98:99], v8 offset:54272
    s_waitcnt lgkmcnt(14)
    v_mfma_f32_32x32x16_bf16 v[160:175], v[68:71], a[24:27], v[160:175]
    ds_read_b64_tr_b16 v[100:101], v9 offset:53248
    ds_read_b64_tr_b16 v[102:103], v9 offset:54272
    s_waitcnt lgkmcnt(14)
    v_mfma_f32_32x32x16_bf16 v[176:191], v[72:75], a[24:27], v[176:191]
    ds_read_b64_tr_b16 v[104:105], v10 offset:53248
    ds_read_b64_tr_b16 v[106:107], v10 offset:54272
    s_waitcnt lgkmcnt(14)
    v_mfma_f32_32x32x16_bf16 v[192:207], v[76:79], a[24:27], v[192:207]
    ds_read_b64_tr_b16 v[108:109], v7 offset:61440
    ds_read_b64_tr_b16 v[110:111], v7 offset:62464
    s_waitcnt lgkmcnt(14)
    v_mfma_f32_32x32x16_bf16 v[208:223], v[80:83], a[24:27], v[208:223]
    ds_read_b64_tr_b16 v[112:113], v8 offset:61440
    ds_read_b64_tr_b16 v[114:115], v8 offset:62464
    s_waitcnt lgkmcnt(14)
    v_mfma_f32_32x32x16_bf16 v[224:239], v[84:87], a[24:27], v[224:239]
    ds_read_b64_tr_b16 v[116:117], v9 offset:61440
    ds_read_b64_tr_b16 v[118:119], v9 offset:62464
    s_waitcnt lgkmcnt(14)
    v_mfma_f32_32x32x16_bf16 v[240:255], v[88:91], a[24:27], v[240:255]
    ds_read_b64_tr_b16 v[120:121], v10 offset:61440
    ds_read_b64_tr_b16 v[122:123], v10 offset:62464
    s_waitcnt vmcnt(26)
    s_barrier
    s_waitcnt lgkmcnt(14)
    v_mfma_f32_32x32x16_bf16 v[128:143], v[92:95], a[28:31], v[128:143]
    ds_read_b64_tr_b16 v[60:61], v21 offset:0
    ds_read_b64_tr_b16 v[62:63], v21 offset:1024
    global_load_dwordx4 a[16:19], v2, s[8:9] offset:0 sc1
    s_waitcnt lgkmcnt(14)
    v_mfma_f32_32x32x16_bf16 v[144:159], v[96:99], a[28:31], v[144:159]
    ds_read_b64_tr_b16 v[64:65], v22 offset:0
    ds_read_b64_tr_b16 v[66:67], v22 offset:1024
    global_load_dwordx4 a[20:23], v2, s[8:9] offset:1024 sc1
    s_add_u32 s29, s29, 1
    s_cmp_eq_u32 s29, s31
    s_cselect_b32 s34, s32, 2048
    s_cselect_b32 s35, -1, 0
    s_cselect_b32 s29, 0, s29
    s_add_u32 s8, s8, s34
    s_addc_u32 s9, s9, s35
    s_waitcnt lgkmcnt(14)
    v_mfma_f32_32x32x16_bf16 v[160:175], v[100:103], a[28:31], v[160:175]
    ds_read_b64_tr_b16 v[68:69], v23 offset:0
    ds_read_b64_tr_b16 v[70:71], v23 offset:1024
    s_add_u32 m0, s12, 32768
    s_nop 0
    global_load_lds_dwordx4 v3, s[10:11]
    s_waitcnt lgkmcnt(14)
    v_mfma_f32_32x32x16_bf16 v[176:191], v[104:107], a[28:31], v[176:191]
    ds_read_b64_tr_b16 v[72:73], v24 offset:0
    ds_read_b64_tr_b16 v[74:75], v24 offset:1024
    s_add_u32 m0, s12, 33792
    s_nop 0
    global_load_lds_dwordx4 v4, s[10:11]
    s_waitcnt lgkmcnt(14)
    v_mfma_f32_32x32x16_bf16 v[192:207], v[108:111], a[28:31], v[192:207]
    ds_read_b64_tr_b16 v[76:77], v21 offset:8192
    ds_read_b64_tr_b16 v[78:79], v21 offset:9216
    s_add_u32 m0, s12, 34816
    s_nop 0
    global_load_lds_dwordx4 v5, s[10:11]
    s_waitcnt lgkmcnt(14)
    v_mfma_f32_32x32x16_bf16 v[208:223], v[112:115], a[28:31], v[208:223]
    ds_read_b64_tr_b16 v[80:81], v22 offset:8192
    ds_read_b64_tr_b16 v[82:83], v22 offset:9216
    s_add_u32 m0, s12, 35840
    s_nop 0
    global_load_lds_dwordx4 v6, s[10:11]
    s_add_u32 s30, s30, 1
    s_cmp_eq_u32 s30, s31
    s_cselect_b32 s34, s33, s27
    s_cselect_b32 s35, -1, 0
    s_cselect_b32 s30, 0, s30
    s_add_u32 s10, s10, s34
    s_addc_u32 s11, s11, s35
    s_waitcnt lgkmcnt(14)
    v_mfma_f32_32x32x16_bf16 v[224:239], v[116:119], a[28:31], v[224:239]
    ds_read_b64_tr_b16 v[84:85], v23 offset:8192
    ds_read_b64_tr_b16 v[86:87], v23 offset:9216
    s_waitcnt lgkmcnt(14)
    v_mfma_f32_32x32x16_bf16 v[240:255], v[120:123], a[28:31], v[240:255]
    ds_read_b64_tr_b16 v[88:89], v24 offset:8192
    ds_read_b64_tr_b16 v[90:91], v24 offset:9216
    s_waitcnt lgkmcnt(14)
    v_mfma_f32_32x32x16_bf16 v[128:143], v[60:63], a[32:35], v[128:143]
    ds_read_b64_tr_b16 v[92:93], v21 offset:4096
    ds_read_b64_tr_b16 v[94:95], v21 offset:5120
    s_waitcnt lgkmcnt(14)
    v_mfma_f32_32x32x16_bf16 v[144:159], v[64:67], a[32:35], v[144:159]
    ds_read_b64_tr_b16 v[96:97], v22 offset:4096
    ds_read_b64_tr_b16 v[98:99], v22 offset:5120
    s_waitcnt lgkmcnt(14)
    v_mfma_f32_32x32x16_bf16 v[160:175], v[68:71], a[32:35], v[160:175]
    ds_read_b64_tr_b16 v[100:101], v23 offset:4096
    ds_read_b64_tr_b16 v[102:103], v23 offset:5120
    s_waitcnt lgkmcnt(14)
    v_mfma_f32_32x32x16_bf16 v[176:191], v[72:75], a[32:35], v[176:191]
    ds_read_b64_tr_b16 v[104:105], v24 offset:4096
    ds_read_b64_tr_b16 v[106:107], v24 offset:5120
    s_waitcnt lgkmcnt(14)
    v_mfma_f32_32x32x16_bf16 v[192:207], v[76:79], a[32:35], v[192:207]
    ds_read_b64_tr_b16 v[108:109], v21 offset:12288
    ds_read_b64_tr_b16 v[110:111], v21 offset:13312
    s_waitcnt lgkmcnt(14)
    v_mfma_f32_32x32x16_bf16 v[208:223], v[80:83], a[32:35], v[208:223]
    ds_read_b64_tr_b16 v[112:113], v22 offset:12288
    ds_read_b64_tr_b16 v[114:115], v22 offset:13312
    s_waitcnt lgkmcnt(14)
    v_mfma_f32_32x32x16_bf16 v[224:239], v[84:87], a[32:35], v[224:239]
    ds_read_b64_tr_b16 v[116:117], v23 offset:12288
    ds_read_b64_tr_b16 v[118:119], v23 offset:13312
    s_waitcnt lgkmcnt(14)
    v_mfma_f32_32x32x16_bf16 v[240:255], v[88:91], a[32:35], v[240:255]
    ds_read_b64_tr_b16 v[120:121], v24 offset:12288
    ds_read_b64_tr_b16 v[122:123], v24 offset:13312
    s_waitcnt vmcnt(28)
    s_barrier
    s_waitcnt lgkmcnt(14)
    v_mfma_f32_32x32x16_bf16 v[128:143], v[92:95], a[36:39], v[128:143]
    ds_read_b64_tr_b16 v[60:61], v21 offset:16384
    ds_read_b64_tr_b16 v[62:63], v21 offset:17408
    global_load_dwordx4 a[24:27], v2, s[8:9] offset:0 sc1
    s_waitcnt lgkmcnt(14)
    v_mfma_f32_32x32x16_bf16 v[144:159], v[96:99], a[36:39], v[144:159]
    ds_read_b64_tr_b16 v[64:65], v22 offset:16384
    ds_read_b64_tr_b16 v[66:67], v22 offset:17408
    global_load_dwordx4 a[28:31], v2, s[8:9] offset:1024 sc1
    s_add_u32 s29, s29, 1
    s_cmp_eq_u32 s29, s31
    s_cselect_b32 s34, s32, 2048
    s_cselect_b32 s35, -1, 0
    s_cselect_b32 s29, 0, s29
    s_add_u32 s8, s8, s34
    s_addc_u32 s9, s9, s35
    s_waitcnt lgkmcnt(14)
    v_mfma_f32_32x32x16_bf16 v[160:175], v[100:103], a[36:39], v[160:175]
    ds_read_b64_tr_b16 v[68:69], v23 offset:16384
    ds_read_b64_tr_b16 v[70:71], v23 offset:17408
    s_add_u32 m0, s12, 49152
    s_nop 0
    global_load_lds_dwordx4 v3, s[10:11]
    s_waitcnt lgkmcnt(14)
    v_mfma_f32_32x32x16_bf16 v[176:191], v[104:107], a[36:39], v[176:191]
    ds_read_b64_tr_b16 v[72:73], v24 offset:16384
    ds_read_b64_tr_b16 v[74:75], v24 offset:17408
    s_add_u32 m0, s12, 50176
    s_nop 0
    global_load_lds_dwordx4 v4, s[10:11]
    s_waitcnt lgkmcnt(14)
    v_mfma_f32_32x32x16_bf16 v[192:207], v[108:111], a[36:39], v[192:207]
    ds_read_b64_tr_b16 v[76:77], v21 offset:24576
    ds_read_b64_tr_b16 v[78:79], v21 offset:25600
    s_add_u32 m0, s12, 51200
    s_nop 0
    global_load_lds_dwordx4 v5, s[10:11]
    s_waitcnt lgkmcnt(14)
    v_mfma_f32_32x32x16_bf16 v[208:223], v[112:115], a[36:39], v[208:223]
    ds_read_b64_tr_b16 v[80:81], v22 offset:24576
    ds_read_b64_tr_b16 v[82:83], v22 offset:25600
    s_add_u32 m0, s12, 52224
    s_nop 0
    global_load_lds_dwordx4 v6, s[10:11]
    s_add_u32 s30, s30, 1
    s_cmp_eq_u32 s30, s31
    s_cselect_b32 s34, s33, s27
    s_cselect_b32 s35, -1, 0
    s_cselect_b32 s30, 0, s30
    s_add_u32 s10, s10, s34
    s_addc_u32 s11, s11, s35
    s_waitcnt lgkmcnt(14)
    v_mfma_f32_32x32x16_bf16 v[224:239], v[116:119], a[36:39], v[224:239]
    ds_read_b64_tr_b16 v[84:85], v23 offset:24576
    ds_read_b64_tr_b16 v[86:87], v23 offset:25600
    s_waitcnt lgkmcnt(14)
    v_mfma_f32_32x32x16_bf16 v[240:255], v[120:123], a[36:39], v[240:255]
    ds_read_b64_tr_b16 v[88:89], v24 offset:24576
    ds_read_b64_tr_b16 v[90:91], v24 offset:25600
    s_waitcnt lgkmcnt(14)
    v_mfma_f32_32x32x16_bf16 v[128:143], v[60:63], a[40:43], v[128:143]
    ds_read_b64_tr_b16 v[92:93], v21 offset:20480
    ds_read_b64_tr_b16 v[94:95], v21 offset:21504
    s_waitcnt lgkmcnt(14)
    v_mfma_f32_32x32x16_bf16 v[144:159], v[64:67], a[40:43], v[144:159]
    ds_read_b64_tr_b16 v[96:97], v22 offset:20480
    ds_read_b64_tr_b16 v[98:99], v22 offset:21504
    s_waitcnt lgkmcnt(14)
    v_mfma_f32_32x32x16_bf16 v[160:175], v[68:71], a[40:43], v[160:175]
    ds_read_b64_tr_b16 v[100:101], v23 offset:20480
    ds_read_b64_tr_b16 v[102:103], v23 offset:21504
    s_waitcnt lgkmcnt(14)
    v_mfma_f32_32x32x16_bf16 v[176:191], v[72:75], a[40:43], v[176:191]
    ds_read_b64_tr_b16 v[104:105], v24 offset:20480
    ds_read_b64_tr_b16 v[106:107], v24 offset:21504
    s_waitcnt lgkmcnt(14)
    v_mfma_f32_32x32x16_bf16 v[192:207], v[76:79], a[40:43], v[192:207]
    ds_read_b64_tr_b16 v[108:109], v21 offset:28672
    ds_read_b64_tr_b16 v[110:111], v21 offset:29696
    s_waitcnt lgkmcnt(14)
    v_mfma_f32_32x32x16_bf16 v[208:223], v[80:83], a[40:43], v[208:223]
    ds_read_b64_tr_b16 v[112:113], v22 offset:28672
    ds_read_b64_tr_b16 v[114:115], v22 offset:29696
    s_waitcnt lgkmcnt(14)
    v_mfma_f32_32x32x16_bf16 v[224:239], v[84:87], a[40:43], v[224:239]
    ds_read_b64_tr_b16 v[116:117], v23 offset:28672
    ds_read_b64_tr_b16 v[118:119], v23 offset:29696
    s_waitcnt lgkmcnt(14)
    v_mfma_f32_32x32x16_bf16 v[240:255], v[88:91], a[40:43], v[240:255]
    ds_read_b64_tr_b16 v[120:121], v24 offset:28672
    ds_read_b64_tr_b16 v[122:123], v24 offset:29696
    s_waitcnt vmcnt(30)
    s_barrier
    s_waitcnt lgkmcnt(14)
    v_mfma_f32_32x32x16_bf16 v[128:143], v[92:95], a[44:47], v[128:143]
    ds_read_b64_tr_b16 v[60:61], v21 offset:32768
    ds_read_b64_tr_b16 v[62:63], v21 offset:33792
    global_load_dwordx4 a[32:35], v2, s[8:9] offset:0 sc1
    s_waitcnt lgkmcnt(14)
    v_mfma_f32_32x32x16_bf16 v[144:159], v[96:99], a[44:47], v[144:159]
    ds_read_b64_tr_b16 v[64:65], v22 offset:32768
    ds_read_b64_tr_b16 v[66:67], v22 offset:33792
    global_load_dwordx4 a[36:39], v2, s[8:9] offset:1024 sc1
    s_add_u32 s29, s29, 1
    s_cmp_eq_u32 s29, s31
    s_cselect_b32 s34, s32, 2048
    s_cselect_b32 s35, -1, 0
    s_cselect_b32 s29, 0, s29
    s_add_u32 s8, s8, s34
    s_addc_u32 s9, s9, s35
    s_waitcnt lgkmcnt(14)
    v_mfma_f32_32x32x16_bf16 v[160:175], v[100:103], a[44:47], v[160:175]
    ds_read_b64_tr_b16 v[68:69], v23 offset:32768
    ds_read_b64_tr_b16 v[70:71], v23 offset:33792
    s_add_u32 m0, s12, 65536
    s_nop 0
    global_load_lds_dwordx4 v3, s[10:11]
    s_waitcnt lgkmcnt(14)
    v_mfma_f32_32x32x16_bf16 v[176:191], v[104:107], a[44:47], v[176:191]
    ds_read_b64_tr_b16 v[72:73], v24 offset:32768
    ds_read_b64_tr_b16 v[74:75], v24 offset:33792
    s_add_u32 m0, s12, 66560
    s_nop 0
    global_load_lds_dwordx4 v4, s[10:11]
    s_waitcnt lgkmcnt(14)
    v_mfma_f32_32x32x16_bf16 v[192:207], v[108:111], a[44:47], v[192:207]
    ds_read_b64_tr_b16 v[76:77], v21 offset:40960
    ds_read_b64_tr_b16 v[78:79], v21 offset:41984
    s_add_u32 m0, s12, 67584
    s_nop 0
    global_load_lds_dwordx4 v5, s[10:11]
    s_waitcnt lgkmcnt(14)
    v_mfma_f32_32x32x16_bf16 v[208:223], v[112:115], a[44:47], v[208:223]
    ds_read_b64_tr_b16 v[80:81], v22 offset:40960
    ds_read_b64_tr_b16 v[82:83], v22 offset:41984
    s_add_u32 m0, s12, 68608
    s_nop 0
    global_load_lds_dwordx4 v6, s[10:11]
    s_add_u32 s30, s30, 1
    s_cmp_eq_u32 s30, s31
    s_cselect_b32 s34, s33, s27
    s_cselect_b32 s35, -1, 0
    s_cselect_b32 s30, 0, s30
    s_add_u32 s10, s10, s34
    s_addc_u32 s11, s11, s35
    s_waitcnt lgkmcnt(14)
    v_mfma_f32_32x32x16_bf16 v[224:239], v[116:119], a[44:47], v[224:239]
    ds_read_b64_tr_b16 v[84:85], v23 offset:40960
    ds_read_b64_tr_b16 v[86:87], v23 offset:41984
    s_waitcnt lgkmcnt(14)
    v_mfma_f32_32x32x16_bf16 v[240:255], v[120:123], a[44:47], v[240:255]
    ds_read_b64_tr_b16 v[88:89], v24 offset:40960
    ds_read_b64_tr_b16 v[90:91], v24 offset:41984
    s_waitcnt lgkmcnt(14)
    v_mfma_f32_32x32x16_bf16 v[128:143], v[60:63], a[48:51], v[128:143]
    ds_read_b64_tr_b16 v[92:93], v21 offset:36864
    ds_read_b64_tr_b16 v[94:95], v21 offset:37888
    s_waitcnt lgkmcnt(14)
    v_mfma_f32_32x32x16_bf16 v[144:159], v[64:67], a[48:51], v[144:159]
    ds_read_b64_tr_b16 v[96:97], v22 offset:36864
    ds_read_b64_tr_b16 v[98:99], v22 offset:37888
    s_waitcnt lgkmcnt(14)
    v_mfma_f32_32x32x16_bf16 v[160:175], v[68:71], a[48:51], v[160:175]
    ds_read_b64_tr_b16 v[100:101], v23 offset:36864
    ds_read_b64_tr_b16 v[102:103], v23 offset:37888
    s_waitcnt lgkmcnt(14)
    v_mfma_f32_32x32x16_bf16 v[176:191], v[72:75], a[48:51], v[176:191]
    ds_read_b64_tr_b16 v[104:105], v24 offset:36864
    ds_read_b64_tr_b16 v[106:107], v24 offset:37888
    s_waitcnt lgkmcnt(14)
    v_mfma_f32_32x32x16_bf16 v[192:207], v[76:79], a[48:51], v[192:207]
    ds_read_b64_tr_b16 v[108:109], v21 offset:45056
    ds_read_b64_tr_b16 v[110:111], v21 offset:46080
    s_waitcnt lgkmcnt(14)
    v_mfma_f32_32x32x16_bf16 v[208:223], v[80:83], a[48:51], v[208:223]
    ds_read_b64_tr_b16 v[112:113], v22 offset:45056
    ds_read_b64_tr_b16 v[114:115], v22 offset:46080
    s_waitcnt lgkmcnt(14)
    v_mfma_f32_32x32x16_bf16 v[224:239], v[84:87], a[48:51], v[224:239]
    ds_read_b64_tr_b16 v[116:117], v23 offset:45056
    ds_read_b64_tr_b16 v[118:119], v23 offset:46080
    s_waitcnt lgkmcnt(14)
    v_mfma_f32_32x32x16_bf16 v[240:255], v[88:91], a[48:51], v[240:255]
    ds_read_b64_tr_b16 v[120:121], v24 offset:45056
    ds_read_b64_tr_b16 v[122:123], v24 offset:46080
    s_waitcnt vmcnt(30)
    s_barrier
    s_waitcnt lgkmcnt(14)
    v_mfma_f32_32x32x16_bf16 v[128:143], v[92:95], a[52:55], v[128:143]
    ds_read_b64_tr_b16 v[60:61], v21 offset:49152
    ds_read_b64_tr_b16 v[62:63], v21 offset:50176
    global_load_dwordx4 a[40:43], v2, s[8:9] offset:0 sc1
    s_waitcnt lgkmcnt(14)
    v_mfma_f32_32x32x16_bf16 v[144:159], v[96:99], a[52:55], v[144:159]
    ds_read_b64_tr_b16 v[64:65], v22 offset:49152
    ds_read_b64_tr_b16 v[66:67], v22 offset:50176
    global_load_dwordx4 a[44:47], v2, s[8:9] offset:1024 sc1
    s_add_u32 s29, s29, 1
    s_cmp_eq_u32 s29, s31
    s_cselect_b32 s34, s32, 2048
    s_cselect_b32 s35, -1, 0
    s_cselect_b32 s29, 0, s29
    s_add_u32 s8, s8, s34
    s_addc_u32 s9, s9, s35
    s_waitcnt lgkmcnt(14)
    v_mfma_f32_32x32x16_bf16 v[160:175], v[100:103], a[52:55], v[160:175]
    ds_read_b64_tr_b16 v[68:69], v23 offset:49152
    ds_read_b64_tr_b16 v[70:71], v23 offset:50176
    s_add_u32 m0, s12, 81920
    s_nop 0
    global_load_lds_dwordx4 v3, s[10:11]
    s_waitcnt lgkmcnt(14)
    v_mfma_f32_32x32x16_bf16 v[176:191], v[104:107], a[52:55], v[176:191]
    ds_read_b64_tr_b16 v[72:73], v24 offset:49152
    ds_read_b64_tr_b16 v[74:75], v24 offset:50176
    s_add_u32 m0, s12, 82944
    s_nop 0
    global_load_lds_dwordx4 v4, s[10:11]
    s_waitcnt lgkmcnt(14)
    v_mfma_f32_32x32x16_bf16 v[192:207], v[108:111], a[52:55], v[192:207]
    ds_read_b64_tr_b16 v[76:77], v21 offset:57344
    ds_read_b64_tr_b16 v[78:79], v21 offset:58368
    s_add_u32 m0, s12, 83968
    s_nop 0
    global_load_lds_dwordx4 v5, s[10:11]
    s_waitcnt lgkmcnt(14)
    v_mfma_f32_32x32x16_bf16 v[208:223], v[112:115], a[52:55], v[208:223]
    ds_read_b64_tr_b16 v[80:81], v22 offset:57344
    ds_read_b64_tr_b16 v[82:83], v22 offset:58368
    s_add_u32 m0, s12, 84992
    s_nop 0
    global_load_lds_dwordx4 v6, s[10:11]
    s_add_u32 s30, s30, 1
    s_cmp_eq_u32 s30, s31
    s_cselect_b32 s34, s33, s27
    s_cselect_b32 s35, -1, 0
    s_cselect_b32 s30, 0, s30
    s_add_u32 s10, s10, s34
    s_addc_u32 s11, s11, s35
    s_waitcnt lgkmcnt(14)
    v_mfma_f32_32x32x16_bf16 v[224:239], v[116:119], a[52:55], v[224:239]
    ds_read_b64_tr_b16 v[84:85], v23 offset:57344
    ds_read_b64_tr_b16 v[86:87], v23 offset:58368
    s_waitcnt lgkmcnt(14)
    v_mfma_f32_32x32x16_bf16 v[240:255], v[120:123], a[52:55], v[240:255]
    ds_read_b64_tr_b16 v[88:89], v24 offset:57344
    ds_read_b64_tr_b16 v[90:91], v24 offset:58368
    s_waitcnt lgkmcnt(14)
    v_mfma_f32_32x32x16_bf16 v[128:143], v[60:63], a[56:59], v[128:143]
    ds_read_b64_tr_b16 v[92:93], v21 offset:53248
    ds_read_b64_tr_b16 v[94:95], v21 offset:54272
    s_waitcnt lgkmcnt(14)
    v_mfma_f32_32x32x16_bf16 v[144:159], v[64:67], a[56:59], v[144:159]
    ds_read_b64_tr_b16 v[96:97], v22 offset:53248
    ds_read_b64_tr_b16 v[98:99], v22 offset:54272
    s_waitcnt lgkmcnt(14)
    v_mfma_f32_32x32x16_bf16 v[160:175], v[68:71], a[56:59], v[160:175]
    ds_read_b64_tr_b16 v[100:101], v23 offset:53248
    ds_read_b64_tr_b16 v[102:103], v23 offset:54272
    s_waitcnt lgkmcnt(14)
    v_mfma_f32_32x32x16_bf16 v[176:191], v[72:75], a[56:59], v[176:191]
    ds_read_b64_tr_b16 v[104:105], v24 offset:53248
    ds_read_b64_tr_b16 v[106:107], v24 offset:54272
    s_waitcnt lgkmcnt(14)
    v_mfma_f32_32x32x16_bf16 v[192:207], v[76:79], a[56:59], v[192:207]
    ds_read_b64_tr_b16 v[108:109], v21 offset:61440
    ds_read_b64_tr_b16 v[110:111], v21 offset:62464
    s_waitcnt lgkmcnt(14)
    v_mfma_f32_32x32x16_bf16 v[208:223], v[80:83], a[56:59], v[208:223]
    ds_read_b64_tr_b16 v[112:113], v22 offset:61440
    ds_read_b64_tr_b16 v[114:115], v22 offset:62464
    s_waitcnt lgkmcnt(14)
    v_mfma_f32_32x32x16_bf16 v[224:239], v[84:87], a[56:59], v[224:239]
    ds_read_b64_tr_b16 v[116:117], v23 offset:61440
    ds_read_b64_tr_b16 v[118:119], v23 offset:62464
    s_waitcnt lgkmcnt(14)
    v_mfma_f32_32x32x16_bf16 v[240:255], v[88:91], a[56:59], v[240:255]
    ds_read_b64_tr_b16 v[120:121], v24 offset:61440
    ds_read_b64_tr_b16 v[122:123], v24 offset:62464
    s_waitcnt vmcnt(30)
    s_barrier
    s_waitcnt lgkmcnt(14)
    v_mfma_f32_32x32x16_bf16 v[128:143], v[92:95], a[60:63], v[128:143]
    ds_read_b64_tr_b16 v[60:61], v7 offset:0
    ds_read_b64_tr_b16 v[62:63], v7 offset:1024
    global_load_dwordx4 a[48:51], v2, s[8:9] offset:0 sc1
    s_waitcnt lgkmcnt(14)
    v_mfma_f32_32x32x16_bf16 v[144:159], v[96:99], a[60:63], v[144:159]
    ds_read_b64_tr_b16 v[64:65], v8 offset:0
    ds_read_b64_tr_b16 v[66:67], v8 offset:1024
    global_load_dwordx4 a[52:55], v2, s[8:9] offset:1024 sc1
    s_add_u32 s29, s29, 1
    s_cmp_eq_u32 s29, s31
    s_cselect_b32 s34, s32, 2048
    s_cselect_b32 s35, -1, 0
    s_cselect_b32 s29, 0, s29
    s_add_u32 s8, s8, s34
    s_addc_u32 s9, s9, s35
    s_waitcnt lgkmcnt(14)
    v_mfma_f32_32x32x16_bf16 v[160:175], v[100:103], a[60:63], v[160:175]
    ds_read_b64_tr_b16 v[68:69], v9 offset:0
    ds_read_b64_tr_b16 v[70:71], v9 offset:1024
    s_add_u32 m0, s12, 98304
    s_nop 0
    global_load_lds_dwordx4 v3, s[10:11]
    s_waitcnt lgkmcnt(14)
    v_mfma_f32_32x32x16_bf16 v[176:191], v[104:107], a[60:63], v[176:191]
    ds_read_b64_tr_b16 v[72:73], v10 offset:0
    ds_read_b64_tr_b16 v[74:75], v10 offset:1024
    s_add_u32 m0, s12, 99328
    s_nop 0
    global_load_lds_dwordx4 v4, s[10:11]
    s_waitcnt lgkmcnt(14)
    v_mfma_f32_32x32x16_bf16 v[192:207], v[108:111], a[60:63], v[192:207]
    ds_read_b64_tr_b16 v[76:77], v7 offset:8192
    ds_read_b64_tr_b16 v[78:79], v7 offset:9216
    s_add_u32 m0, s12, 100352
    s_nop 0
    global_load_lds_dwordx4 v5, s[10:11]
    s_waitcnt lgkmcnt(14)
    v_mfma_f32_32x32x16_bf16 v[208:223], v[112:115], a[60:63], v[208:223]
    ds_read_b64_tr_b16 v[80:81], v8 offset:8192
    ds_read_b64_tr_b16 v[82:83], v8 offset:9216
    s_add_u32 m0, s12, 101376
    s_nop 0
    global_load_lds_dwordx4 v6, s[10:11]
    s_add_u32 s30, s30, 1
    s_cmp_eq_u32 s30, s31
    s_cselect_b32 s34, s33, s27
    s_cselect_b32 s35, -1, 0
    s_cselect_b32 s30, 0, s30
    s_add_u32 s10, s10, s34
    s_addc_u32 s11, s11, s35
    s_waitcnt lgkmcnt(14)
    v_mfma_f32_32x32x16_bf16 v[224:239], v[116:119], a[60:63], v[224:239]
    ds_read_b64_tr_b16 v[84:85], v9 offset:8192
    ds_read_b64_tr_b16 v[86:87], v9 offset:9216
    s_waitcnt lgkmcnt(14)
    v_mfma_f32_32x32x16_bf16 v[240:255], v[120:123], a[60:63], v[240:255]
    ds_read_b64_tr_b16 v[88:89], v10 offset:8192
    ds_read_b64_tr_b16 v[90:91], v10 offset:9216
    s_sub_u32 s13, s13, 1
    s_cmp_lg_u32 s13, 0
    s_cbranch_scc1 gl_160
    s_waitcnt lgkmcnt(14)
    v_mfma_f32_32x32x16_bf16 v[128:143], v[60:63], a[0:3], v[128:143]
    ds_read_b64_tr_b16 v[92:93], v7 offset:4096
    ds_read_b64_tr_b16 v[94:95], v7 offset:5120
    s_waitcnt lgkmcnt(14)
    v_mfma_f32_32x32x16_bf16 v[144:159], v[64:67], a[0:3], v[144:159]
    ds_read_b64_tr_b16 v[96:97], v8 offset:4096
    ds_read_b64_tr_b16 v[98:99], v8 offset:5120
    s_waitcnt lgkmcnt(14)
    v_mfma_f32_32x32x16_bf16 v[160:175], v[68:71], a[0:3], v[160:175]
    ds_read_b64_tr_b16 v[100:101], v9 offset:4096
    ds_read_b64_tr_b16 v[102:103], v9 offset:5120
    s_waitcnt lgkmcnt(14)
    v_mfma_f32_32x32x16_bf16 v[176:191], v[72:75], a[0:3], v[176:191]
    ds_read_b64_tr_b16 v[104:105], v10 offset:4096
    ds_read_b64_tr_b16 v[106:107], v10 offset:5120
    s_waitcnt lgkmcnt(14)
    v_mfma_f32_32x32x16_bf16 v[192:207], v[76:79], a[0:3], v[192:207]
    ds_read_b64_tr_b16 v[108:109], v7 offset:12288
    ds_read_b64_tr_b16 v[110:111], v7 offset:13312
    s_waitcnt lgkmcnt(14)
    v_mfma_f32_32x32x16_bf16 v[208:223], v[80:83], a[0:3], v[208:223]
    ds_read_b64_tr_b16 v[112:113], v8 offset:12288
    ds_read_b64_tr_b16 v[114:115], v8 offset:13312
    s_waitcnt lgkmcnt(14)
    v_mfma_f32_32x32x16_bf16 v[224:239], v[84:87], a[0:3], v[224:239]
    ds_read_b64_tr_b16 v[116:117], v9 offset:12288
    ds_read_b64_tr_b16 v[118:119], v9 offset:13312
    s_waitcnt lgkmcnt(14)
    v_mfma_f32_32x32x16_bf16 v[240:255], v[88:91], a[0:3], v[240:255]
    ds_read_b64_tr_b16 v[120:121], v10 offset:12288
    ds_read_b64_tr_b16 v[122:123], v10 offset:13312
    s_waitcnt vmcnt(30)
    s_barrier
    s_waitcnt lgkmcnt(14)
    v_mfma_f32_32x32x16_bf16 v[128:143], v[92:95], a[4:7], v[128:143]
    ds_read_b64_tr_b16 v[60:61], v7 offset:16384
    ds_read_b64_tr_b16 v[62:63], v7 offset:17408
    global_load_dwordx4 a[56:59], v2, s[8:9] offset:0 sc1
    s_waitcnt lgkmcnt(14)
    v_mfma_f32_32x32x16_bf16 v[144:159], v[96:99], a[4:7], v[144:159]
    ds_read_b64_tr_b16 v[64:65], v8 offset:16384
    ds_read_b64_tr_b16 v[66:67], v8 offset:17408
    global_load_dwordx4 a[60:63], v2, s[8:9] offset:1024 sc1
    s_add_u32 s29, s29, 1
    s_cmp_eq_u32 s29, s31
    s_cselect_b32 s34, s32, 2048
    s_cselect_b32 s35, -1, 0
    s_cselect_b32 s29, 0, s29
    s_add_u32 s8, s8, s34
    s_addc_u32 s9, s9, s35
    s_waitcnt lgkmcnt(14)
    v_mfma_f32_32x32x16_bf16 v[160:175], v[100:103], a[4:7], v[160:175]
    ds_read_b64_tr_b16 v[68:69], v9 offset:16384
    ds_read_b64_tr_b16 v[70:71], v9 offset:17408
    s_add_u32 m0, s12, 114688
    s_nop 0
    global_load_lds_dwordx4 v3, s[10:11]
    s_waitcnt lgkmcnt(14)
    v_mfma_f32_32x32x16_bf16 v[176:191], v[104:107], a[4:7], v[176:191]
    ds_read_b64_tr_b16 v[72:73], v10 offset:16384
    ds_read_b64_tr_b16 v[74:75], v10 offset:17408
    s_add_u32 m0, s12, 115712
    s_nop 0
    global_load_lds_dwordx4 v4, s[10:11]
    s_waitcnt lgkmcnt(14)
    v_mfma_f32_32x32x16_bf16 v[192:207], v[108:111], a[4:7], v[192:207]
    ds_read_b64_tr_b16 v[76:77], v7 offset:24576
    ds_read_b64_tr_b16 v[78:79], v7 offset:25600
    s_add_u32 m0, s12, 116736
    s_nop 0
    global_load_lds_dwordx4 v5, s[10:11]
    s_waitcnt lgkmcnt(14)
    v_mfma_f32_32x32x16_bf16 v[208:223], v[112:115], a[4:7], v[208:223]
    ds_read_b64_tr_b16 v[80:81], v8 offset:24576
    ds_read_b64_tr_b16 v[82:83], v8 offset:25600
    s_add_u32 m0, s12, 117760
    s_nop 0
    global_load_lds_dwordx4 v6, s[10:11]
    s_add_u32 s30, s30, 1
    s_cmp_eq_u32 s30, s31
    s_cselect_b32 s34, s33, s27
    s_cselect_b32 s35, -1, 0
    s_cselect_b32 s30, 0, s30
    s_add_u32 s10, s10, s34
    s_addc_u32 s11, s11, s35
    s_waitcnt lgkmcnt(14)
    v_mfma_f32_32x32x16_bf16 v[224:239], v[116:119], a[4:7], v[224:239]
    ds_read_b64_tr_b16 v[84:85], v9 offset:24576
    ds_read_b64_tr_b16 v[86:87], v9 offset:25600
    s_waitcnt lgkmcnt(14)
    v_mfma_f32_32x32x16_bf16 v[240:255], v[120:123], a[4:7], v[240:255]
    ds_read_b64_tr_b16 v[88:89], v10 offset:24576
    ds_read_b64_tr_b16 v[90:91], v10 offset:25600
    s_waitcnt lgkmcnt(14)
    v_mfma_f32_32x32x16_bf16 v[128:143], v[60:63], a[8:11], v[128:143]
    ds_read_b64_tr_b16 v[92:93], v7 offset:20480
    ds_read_b64_tr_b16 v[94:95], v7 offset:21504
    s_waitcnt lgkmcnt(14)
    v_mfma_f32_32x32x16_bf16 v[144:159], v[64:67], a[8:11], v[144:159]
    ds_read_b64_tr_b16 v[96:97], v8 offset:20480
    ds_read_b64_tr_b16 v[98:99], v8 offset:21504
    s_waitcnt lgkmcnt(14)
    v_mfma_f32_32x32x16_bf16 v[160:175], v[68:71], a[8:11], v[160:175]
    ds_read_b64_tr_b16 v[100:101], v9 offset:20480
    ds_read_b64_tr_b16 v[102:103], v9 offset:21504
    s_waitcnt lgkmcnt(14)
    v_mfma_f32_32x32x16_bf16 v[176:191], v[72:75], a[8:11], v[176:191]
    ds_read_b64_tr_b16 v[104:105], v10 offset:20480
    ds_read_b64_tr_b16 v[106:107], v10 offset:21504
    s_waitcnt lgkmcnt(14)
    v_mfma_f32_32x32x16_bf16 v[192:207], v[76:79], a[8:11], v[192:207]
    ds_read_b64_tr_b16 v[108:109], v7 offset:28672
    ds_read_b64_tr_b16 v[110:111], v7 offset:29696
    s_waitcnt lgkmcnt(14)
    v_mfma_f32_32x32x16_bf16 v[208:223], v[80:83], a[8:11], v[208:223]
    ds_read_b64_tr_b16 v[112:113], v8 offset:28672
    ds_read_b64_tr_b16 v[114:115], v8 offset:29696
    s_waitcnt lgkmcnt(14)
    v_mfma_f32_32x32x16_bf16 v[224:239], v[84:87], a[8:11], v[224:239]
    ds_read_b64_tr_b16 v[116:117], v9 offset:28672
    ds_read_b64_tr_b16 v[118:119], v9 offset:29696
    s_waitcnt lgkmcnt(14)
    v_mfma_f32_32x32x16_bf16 v[240:255], v[88:91], a[8:11], v[240:255]
    ds_read_b64_tr_b16 v[120:121], v10 offset:28672
    ds_read_b64_tr_b16 v[122:123], v10 offset:29696
    s_waitcnt vmcnt(30)
    s_barrier
    s_waitcnt lgkmcnt(14)
    v_mfma_f32_32x32x16_bf16 v[128:143], v[92:95], a[12:15], v[128:143]
    ds_read_b64_tr_b16 v[60:61], v7 offset:32768
    ds_read_b64_tr_b16 v[62:63], v7 offset:33792
    s_waitcnt lgkmcnt(14)
    v_mfma_f32_32x32x16_bf16 v[144:159], v[96:99], a[12:15], v[144:159]
    ds_read_b64_tr_b16 v[64:65], v8 offset:32768
    ds_read_b64_tr_b16 v[66:67], v8 offset:33792
    s_waitcnt lgkmcnt(14)
    v_mfma_f32_32x32x16_bf16 v[160:175], v[100:103], a[12:15], v[160:175]
    ds_read_b64_tr_b16 v[68:69], v9 offset:32768
    ds_read_b64_tr_b16 v[70:71], v9 offset:33792
    s_waitcnt lgkmcnt(14)
    v_mfma_f32_32x32x16_bf16 v[176:191], v[104:107], a[12:15], v[176:191]
    ds_read_b64_tr_b16 v[72:73], v10 offset:32768
    ds_read_b64_tr_b16 v[74:75], v10 offset:33792
    s_waitcnt lgkmcnt(14)
    v_mfma_f32_32x32x16_bf16 v[192:207], v[108:111], a[12:15], v[192:207]
    ds_read_b64_tr_b16 v[76:77], v7 offset:40960
    ds_read_b64_tr_b16 v[78:79], v7 offset:41984
    s_waitcnt lgkmcnt(14)
    v_mfma_f32_32x32x16_bf16 v[208:223], v[112:115], a[12:15], v[208:223]
    ds_read_b64_tr_b16 v[80:81], v8 offset:40960
    ds_read_b64_tr_b16 v[82:83], v8 offset:41984
    s_waitcnt lgkmcnt(14)
    v_mfma_f32_32x32x16_bf16 v[224:239], v[116:119], a[12:15], v[224:239]
    ds_read_b64_tr_b16 v[84:85], v9 offset:40960
    ds_read_b64_tr_b16 v[86:87], v9 offset:41984
    s_waitcnt lgkmcnt(14)
    v_mfma_f32_32x32x16_bf16 v[240:255], v[120:123], a[12:15], v[240:255]
    ds_read_b64_tr_b16 v[88:89], v10 offset:40960
    ds_read_b64_tr_b16 v[90:91], v10 offset:41984
    s_waitcnt lgkmcnt(14)
    v_mfma_f32_32x32x16_bf16 v[128:143], v[60:63], a[16:19], v[128:143]
    ds_read_b64_tr_b16 v[92:93], v7 offset:36864
    ds_read_b64_tr_b16 v[94:95], v7 offset:37888
    s_waitcnt lgkmcnt(14)
    v_mfma_f32_32x32x16_bf16 v[144:159], v[64:67], a[16:19], v[144:159]
    ds_read_b64_tr_b16 v[96:97], v8 offset:36864
    ds_read_b64_tr_b16 v[98:99], v8 offset:37888
    s_waitcnt lgkmcnt(14)
    v_mfma_f32_32x32x16_bf16 v[160:175], v[68:71], a[16:19], v[160:175]
    ds_read_b64_tr_b16 v[100:101], v9 offset:36864
    ds_read_b64_tr_b16 v[102:103], v9 offset:37888
    s_waitcnt lgkmcnt(14)
    v_mfma_f32_32x32x16_bf16 v[176:191], v[72:75], a[16:19], v[176:191]
    ds_read_b64_tr_b16 v[104:105], v10 offset:36864
    ds_read_b64_tr_b16 v[106:107], v10 offset:37888
    s_waitcnt lgkmcnt(14)
    v_mfma_f32_32x32x16_bf16 v[192:207], v[76:79], a[16:19], v[192:207]
    ds_read_b64_tr_b16 v[108:109], v7 offset:45056
    ds_read_b64_tr_b16 v[110:111], v7 offset:46080
    s_waitcnt lgkmcnt(14)
    v_mfma_f32_32x32x16_bf16 v[208:223], v[80:83], a[16:19], v[208:223]
    ds_read_b64_tr_b16 v[112:113], v8 offset:45056
    ds_read_b64_tr_b16 v[114:115], v8 offset:46080
    s_waitcnt lgkmcnt(14)
    v_mfma_f32_32x32x16_bf16 v[224:239], v[84:87], a[16:19], v[224:239]
    ds_read_b64_tr_b16 v[116:117], v9 offset:45056
    ds_read_b64_tr_b16 v[118:119], v9 offset:46080
    s_waitcnt lgkmcnt(14)
    v_mfma_f32_32x32x16_bf16 v[240:255], v[88:91], a[16:19], v[240:255]
    ds_read_b64_tr_b16 v[120:121], v10 offset:45056
    ds_read_b64_tr_b16 v[122:123], v10 offset:46080
    s_waitcnt vmcnt(24)
    s_barrier
    s_waitcnt lgkmcnt(14)
    v_mfma_f32_32x32x16_bf16 v[128:143], v[92:95], a[20:23], v[128:143]
    ds_read_b64_tr_b16 v[60:61], v7 offset:49152
    ds_read_b64_tr_b16 v[62:63], v7 offset:50176
    s_waitcnt lgkmcnt(14)
    v_mfma_f32_32x32x16_bf16 v[144:159], v[96:99], a[20:23], v[144:159]
    ds_read_b64_tr_b16 v[64:65], v8 offset:49152
    ds_read_b64_tr_b16 v[66:67], v8 offset:50176
    s_waitcnt lgkmcnt(14)
    v_mfma_f32_32x32x16_bf16 v[160:175], v[100:103], a[20:23], v[160:175]
    ds_read_b64_tr_b16 v[68:69], v9 offset:49152
    ds_read_b64_tr_b16 v[70:71], v9 offset:50176
    s_waitcnt lgkmcnt(14)
    v_mfma_f32_32x32x16_bf16 v[176:191], v[104:107], a[20:23], v[176:191]
    ds_read_b64_tr_b16 v[72:73], v10 offset:49152
    ds_read_b64_tr_b16 v[74:75], v10 offset:50176
    s_waitcnt lgkmcnt(14)
    v_mfma_f32_32x32x16_bf16 v[192:207], v[108:111], a[20:23], v[192:207]
    ds_read_b64_tr_b16 v[76:77], v7 offset:57344
    ds_read_b64_tr_b16 v[78:79], v7 offset:58368
    s_waitcnt lgkmcnt(14)
    v_mfma_f32_32x32x16_bf16 v[208:223], v[112:115], a[20:23], v[208:223]
    ds_read_b64_tr_b16 v[80:81], v8 offset:57344
    ds_read_b64_tr_b16 v[82:83], v8 offset:58368
    s_waitcnt lgkmcnt(14)
    v_mfma_f32_32x32x16_bf16 v[224:239], v[116:119], a[20:23], v[224:239]
    ds_read_b64_tr_b16 v[84:85], v9 offset:57344
    ds_read_b64_tr_b16 v[86:87], v9 offset:58368
    s_waitcnt lgkmcnt(14)
    v_mfma_f32_32x32x16_bf16 v[240:255], v[120:123], a[20:23], v[240:255]
    ds_read_b64_tr_b16 v[88:89], v10 offset:57344
    ds_read_b64_tr_b16 v[90:91], v10 offset:58368
    s_waitcnt lgkmcnt(14)
    v_mfma_f32_32x32x16_bf16 v[128:143], v[60:63], a[24:27], v[128:143]
    ds_read_b64_tr_b16 v[92:93], v7 offset:53248
    ds_read_b64_tr_b16 v[94:95], v7 offset:54272
    s_waitcnt lgkmcnt(14)
    v_mfma_f32_32x32x16_bf16 v[144:159], v[64:67], a[24:27], v[144:159]
    ds_read_b64_tr_b16 v[96:97], v8 offset:53248
    ds_read_b64_tr_b16 v[98:99], v8 offset:54272
    s_waitcnt lgkmcnt(14)
    v_mfma_f32_32x32x16_bf16 v[160:175], v[68:71], a[24:27], v[160:175]
    ds_read_b64_tr_b16 v[100:101], v9 offset:53248
    ds_read_b64_tr_b16 v[102:103], v9 offset:54272
    s_waitcnt lgkmcnt(14)
    v_mfma_f32_32x32x16_bf16 v[176:191], v[72:75], a[24:27], v[176:191]
    ds_read_b64_tr_b16 v[104:105], v10 offset:53248
    ds_read_b64_tr_b16 v[106:107], v10 offset:54272
    s_waitcnt lgkmcnt(14)
    v_mfma_f32_32x32x16_bf16 v[192:207], v[76:79], a[24:27], v[192:207]
    ds_read_b64_tr_b16 v[108:109], v7 offset:61440
    ds_read_b64_tr_b16 v[110:111], v7 offset:62464
    s_waitcnt lgkmcnt(14)
    v_mfma_f32_32x32x16_bf16 v[208:223], v[80:83], a[24:27], v[208:223]
    ds_read_b64_tr_b16 v[112:113], v8 offset:61440
    ds_read_b64_tr_b16 v[114:115], v8 offset:62464
    s_waitcnt lgkmcnt(14)
    v_mfma_f32_32x32x16_bf16 v[224:239], v[84:87], a[24:27], v[224:239]
    ds_read_b64_tr_b16 v[116:117], v9 offset:61440
    ds_read_b64_tr_b16 v[118:119], v9 offset:62464
    s_waitcnt lgkmcnt(14)
    v_mfma_f32_32x32x16_bf16 v[240:255], v[88:91], a[24:27], v[240:255]
    ds_read_b64_tr_b16 v[120:121], v10 offset:61440
    ds_read_b64_tr_b16 v[122:123], v10 offset:62464
    s_waitcnt vmcnt(18)
    s_barrier
    s_waitcnt lgkmcnt(14)
    v_mfma_f32_32x32x16_bf16 v[128:143], v[92:95], a[28:31], v[128:143]
    ds_read_b64_tr_b16 v[60:61], v21 offset:0
    ds_read_b64_tr_b16 v[62:63], v21 offset:1024
    s_waitcnt lgkmcnt(14)
    v_mfma_f32_32x32x16_bf16 v[144:159], v[96:99], a[28:31], v[144:159]
    ds_read_b64_tr_b16 v[64:65], v22 offset:0
    ds_read_b64_tr_b16 v[66:67], v22 offset:1024
    s_waitcnt lgkmcnt(14)
    v_mfma_f32_32x32x16_bf16 v[160:175], v[100:103], a[28:31], v[160:175]
    ds_read_b64_tr_b16 v[68:69], v23 offset:0
    ds_read_b64_tr_b16 v[70:71], v23 offset:1024
    s_waitcnt lgkmcnt(14)
    v_mfma_f32_32x32x16_bf16 v[176:191], v[104:107], a[28:31], v[176:191]
    ds_read_b64_tr_b16 v[72:73], v24 offset:0
    ds_read_b64_tr_b16 v[74:75], v24 offset:1024
    s_waitcnt lgkmcnt(14)
    v_mfma_f32_32x32x16_bf16 v[192:207], v[108:111], a[28:31], v[192:207]
    ds_read_b64_tr_b16 v[76:77], v21 offset:8192
    ds_read_b64_tr_b16 v[78:79], v21 offset:9216
    s_waitcnt lgkmcnt(14)
    v_mfma_f32_32x32x16_bf16 v[208:223], v[112:115], a[28:31], v[208:223]
    ds_read_b64_tr_b16 v[80:81], v22 offset:8192
    ds_read_b64_tr_b16 v[82:83], v22 offset:9216
    s_waitcnt lgkmcnt(14)
    v_mfma_f32_32x32x16_bf16 v[224:239], v[116:119], a[28:31], v[224:239]
    ds_read_b64_tr_b16 v[84:85], v23 offset:8192
    ds_read_b64_tr_b16 v[86:87], v23 offset:9216
    s_waitcnt lgkmcnt(14)
    v_mfma_f32_32x32x16_bf16 v[240:255], v[120:123], a[28:31], v[240:255]
    ds_read_b64_tr_b16 v[88:89], v24 offset:8192
    ds_read_b64_tr_b16 v[90:91], v24 offset:9216
    s_waitcnt lgkmcnt(14)
    v_mfma_f32_32x32x16_bf16 v[128:143], v[60:63], a[32:35], v[128:143]
    ds_read_b64_tr_b16 v[92:93], v21 offset:4096
    ds_read_b64_tr_b16 v[94:95], v21 offset:5120
    s_waitcnt lgkmcnt(14)
    v_mfma_f32_32x32x16_bf16 v[144:159], v[64:67], a[32:35], v[144:159]
    ds_read_b64_tr_b16 v[96:97], v22 offset:4096
    ds_read_b64_tr_b16 v[98:99], v22 offset:5120
    s_waitcnt lgkmcnt(14)
    v_mfma_f32_32x32x16_bf16 v[160:175], v[68:71], a[32:35], v[160:175]
    ds_read_b64_tr_b16 v[100:101], v23 offset:4096
    ds_read_b64_tr_b16 v[102:103], v23 offset:5120
    s_waitcnt lgkmcnt(14)
    v_mfma_f32_32x32x16_bf16 v[176:191], v[72:75], a[32:35], v[176:191]
    ds_read_b64_tr_b16 v[104:105], v24 offset:4096
    ds_read_b64_tr_b16 v[106:107], v24 offset:5120
    s_waitcnt lgkmcnt(14)
    v_mfma_f32_32x32x16_bf16 v[192:207], v[76:79], a[32:35], v[192:207]
    ds_read_b64_tr_b16 v[108:109], v21 offset:12288
    ds_read_b64_tr_b16 v[110:111], v21 offset:13312
    s_waitcnt lgkmcnt(14)
    v_mfma_f32_32x32x16_bf16 v[208:223], v[80:83], a[32:35], v[208:223]
    ds_read_b64_tr_b16 v[112:113], v22 offset:12288
    ds_read_b64_tr_b16 v[114:115], v22 offset:13312
    s_waitcnt lgkmcnt(14)
    v_mfma_f32_32x32x16_bf16 v[224:239], v[84:87], a[32:35], v[224:239]
    ds_read_b64_tr_b16 v[116:117], v23 offset:12288
    ds_read_b64_tr_b16 v[118:119], v23 offset:13312
    s_waitcnt lgkmcnt(14)
    v_mfma_f32_32x32x16_bf16 v[240:255], v[88:91], a[32:35], v[240:255]
    ds_read_b64_tr_b16 v[120:121], v24 offset:12288
    ds_read_b64_tr_b16 v[122:123], v24 offset:13312
    s_waitcnt vmcnt(12)
    s_barrier
    s_waitcnt lgkmcnt(14)
    v_mfma_f32_32x32x16_bf16 v[128:143], v[92:95], a[36:39], v[128:143]
    ds_read_b64_tr_b16 v[60:61], v21 offset:16384
    ds_read_b64_tr_b16 v[62:63], v21 offset:17408
    s_waitcnt lgkmcnt(14)
    v_mfma_f32_32x32x16_bf16 v[144:159], v[96:99], a[36:39], v[144:159]
    ds_read_b64_tr_b16 v[64:65], v22 offset:16384
    ds_read_b64_tr_b16 v[66:67], v22 offset:17408
    s_waitcnt lgkmcnt(14)
    v_mfma_f32_32x32x16_bf16 v[160:175], v[100:103], a[36:39], v[160:175]
    ds_read_b64_tr_b16 v[68:69], v23 offset:16384
    ds_read_b64_tr_b16 v[70:71], v23 offset:17408
    s_waitcnt lgkmcnt(14)
    v_mfma_f32_32x32x16_bf16 v[176:191], v[104:107], a[36:39], v[176:191]
    ds_read_b64_tr_b16 v[72:73], v24 offset:16384
    ds_read_b64_tr_b16 v[74:75], v24 offset:17408
    s_waitcnt lgkmcnt(14)
    v_mfma_f32_32x32x16_bf16 v[192:207], v[108:111], a[36:39], v[192:207]
    ds_read_b64_tr_b16 v[76:77], v21 offset:24576
    ds_read_b64_tr_b16 v[78:79], v21 offset:25600
    s_waitcnt lgkmcnt(14)
    v_mfma_f32_32x32x16_bf16 v[208:223], v[112:115], a[36:39], v[208:223]
    ds_read_b64_tr_b16 v[80:81], v22 offset:24576
    ds_read_b64_tr_b16 v[82:83], v22 offset:25600
    s_waitcnt lgkmcnt(14)
    v_mfma_f32_32x32x16_bf16 v[224:239], v[116:119], a[36:39], v[224:239]
    ds_read_b64_tr_b16 v[84:85], v23 offset:24576
    ds_read_b64_tr_b16 v[86:87], v23 offset:25600
    s_waitcnt lgkmcnt(14)
    v_mfma_f32_32x32x16_bf16 v[240:255], v[120:123], a[36:39], v[240:255]
    ds_read_b64_tr_b16 v[88:89], v24 offset:24576
    ds_read_b64_tr_b16 v[90:91], v24 offset:25600
    s_waitcnt lgkmcnt(14)
    v_mfma_f32_32x32x16_bf16 v[128:143], v[60:63], a[40:43], v[128:143]
    ds_read_b64_tr_b16 v[92:93], v21 offset:20480
    ds_read_b64_tr_b16 v[94:95], v21 offset:21504
    s_waitcnt lgkmcnt(14)
    v_mfma_f32_32x32x16_bf16 v[144:159], v[64:67], a[40:43], v[144:159]
    ds_read_b64_tr_b16 v[96:97], v22 offset:20480
    ds_read_b64_tr_b16 v[98:99], v22 offset:21504
    s_waitcnt lgkmcnt(14)
    v_mfma_f32_32x32x16_bf16 v[160:175], v[68:71], a[40:43], v[160:175]
    ds_read_b64_tr_b16 v[100:101], v23 offset:20480
    ds_read_b64_tr_b16 v[102:103], v23 offset:21504
    s_waitcnt lgkmcnt(14)
    v_mfma_f32_32x32x16_bf16 v[176:191], v[72:75], a[40:43], v[176:191]
    ds_read_b64_tr_b16 v[104:105], v24 offset:20480
    ds_read_b64_tr_b16 v[106:107], v24 offset:21504
    s_waitcnt lgkmcnt(14)
    v_mfma_f32_32x32x16_bf16 v[192:207], v[76:79], a[40:43], v[192:207]
    ds_read_b64_tr_b16 v[108:109], v21 offset:28672
    ds_read_b64_tr_b16 v[110:111], v21 offset:29696
    s_waitcnt lgkmcnt(14)
    v_mfma_f32_32x32x16_bf16 v[208:223], v[80:83], a[40:43], v[208:223]
    ds_read_b64_tr_b16 v[112:113], v22 offset:28672
    ds_read_b64_tr_b16 v[114:115], v22 offset:29696
    s_waitcnt lgkmcnt(14)
    v_mfma_f32_32x32x16_bf16 v[224:239], v[84:87], a[40:43], v[224:239]
    ds_read_b64_tr_b16 v[116:117], v23 offset:28672
    ds_read_b64_tr_b16 v[118:119], v23 offset:29696
    s_waitcnt lgkmcnt(14)
    v_mfma_f32_32x32x16_bf16 v[240:255], v[88:91], a[40:43], v[240:255]
    ds_read_b64_tr_b16 v[120:121], v24 offset:28672
    ds_read_b64_tr_b16 v[122:123], v24 offset:29696
    s_waitcnt vmcnt(6)
    s_barrier
    s_waitcnt lgkmcnt(14)
    v_mfma_f32_32x32x16_bf16 v[128:143], v[92:95], a[44:47], v[128:143]
    ds_read_b64_tr_b16 v[60:61], v21 offset:32768
    ds_read_b64_tr_b16 v[62:63], v21 offset:33792
    s_waitcnt lgkmcnt(14)
    v_mfma_f32_32x32x16_bf16 v[144:159], v[96:99], a[44:47], v[144:159]
    ds_read_b64_tr_b16 v[64:65], v22 offset:32768
    ds_read_b64_tr_b16 v[66:67], v22 offset:33792
    s_waitcnt lgkmcnt(14)
    v_mfma_f32_32x32x16_bf16 v[160:175], v[100:103], a[44:47], v[160:175]
    ds_read_b64_tr_b16 v[68:69], v23 offset:32768
    ds_read_b64_tr_b16 v[70:71], v23 offset:33792
    s_waitcnt lgkmcnt(14)
    v_mfma_f32_32x32x16_bf16 v[176:191], v[104:107], a[44:47], v[176:191]
    ds_read_b64_tr_b16 v[72:73], v24 offset:32768
    ds_read_b64_tr_b16 v[74:75], v24 offset:33792
    s_waitcnt lgkmcnt(14)
    v_mfma_f32_32x32x16_bf16 v[192:207], v[108:111], a[44:47], v[192:207]
    ds_read_b64_tr_b16 v[76:77], v21 offset:40960
    ds_read_b64_tr_b16 v[78:79], v21 offset:41984
    s_waitcnt lgkmcnt(14)
    v_mfma_f32_32x32x16_bf16 v[208:223], v[112:115], a[44:47], v[208:223]
    ds_read_b64_tr_b16 v[80:81], v22 offset:40960
    ds_read_b64_tr_b16 v[82:83], v22 offset:41984
    s_waitcnt lgkmcnt(14)
    v_mfma_f32_32x32x16_bf16 v[224:239], v[116:119], a[44:47], v[224:239]
    ds_read_b64_tr_b16 v[84:85], v23 offset:40960
    ds_read_b64_tr_b16 v[86:87], v23 offset:41984
    s_waitcnt lgkmcnt(14)
    v_mfma_f32_32x32x16_bf16 v[240:255], v[120:123], a[44:47], v[240:255]
    ds_read_b64_tr_b16 v[88:89], v24 offset:40960
    ds_read_b64_tr_b16 v[90:91], v24 offset:41984
    s_waitcnt lgkmcnt(14)
    v_mfma_f32_32x32x16_bf16 v[128:143], v[60:63], a[48:51], v[128:143]
    ds_read_b64_tr_b16 v[92:93], v21 offset:36864
    ds_read_b64_tr_b16 v[94:95], v21 offset:37888
    s_waitcnt lgkmcnt(14)
    v_mfma_f32_32x32x16_bf16 v[144:159], v[64:67], a[48:51], v[144:159]
    ds_read_b64_tr_b16 v[96:97], v22 offset:36864
    ds_read_b64_tr_b16 v[98:99], v22 offset:37888
    s_waitcnt lgkmcnt(14)
    v_mfma_f32_32x32x16_bf16 v[160:175], v[68:71], a[48:51], v[160:175]
    ds_read_b64_tr_b16 v[100:101], v23 offset:36864
    ds_read_b64_tr_b16 v[102:103], v23 offset:37888
    s_waitcnt lgkmcnt(14)
    v_mfma_f32_32x32x16_bf16 v[176:191], v[72:75], a[48:51], v[176:191]
    ds_read_b64_tr_b16 v[104:105], v24 offset:36864
    ds_read_b64_tr_b16 v[106:107], v24 offset:37888
    s_waitcnt lgkmcnt(14)
    v_mfma_f32_32x32x16_bf16 v[192:207], v[76:79], a[48:51], v[192:207]
    ds_read_b64_tr_b16 v[108:109], v21 offset:45056
    ds_read_b64_tr_b16 v[110:111], v21 offset:46080
    s_waitcnt lgkmcnt(14)
    v_mfma_f32_32x32x16_bf16 v[208:223], v[80:83], a[48:51], v[208:223]
    ds_read_b64_tr_b16 v[112:113], v22 offset:45056
    ds_read_b64_tr_b16 v[114:115], v22 offset:46080
    s_waitcnt lgkmcnt(14)
    v_mfma_f32_32x32x16_bf16 v[224:239], v[84:87], a[48:51], v[224:239]
    ds_read_b64_tr_b16 v[116:117], v23 offset:45056
    ds_read_b64_tr_b16 v[118:119], v23 offset:46080
    s_waitcnt lgkmcnt(14)
    v_mfma_f32_32x32x16_bf16 v[240:255], v[88:91], a[48:51], v[240:255]
    ds_read_b64_tr_b16 v[120:121], v24 offset:45056
    ds_read_b64_tr_b16 v[122:123], v24 offset:46080
    s_waitcnt vmcnt(0)
    s_barrier
    s_waitcnt lgkmcnt(14)
    v_mfma_f32_32x32x16_bf16 v[128:143], v[92:95], a[52:55], v[128:143]
    ds_read_b64_tr_b16 v[60:61], v21 offset:49152
    ds_read_b64_tr_b16 v[62:63], v21 offset:50176
    s_waitcnt lgkmcnt(14)
    v_mfma_f32_32x32x16_bf16 v[144:159], v[96:99], a[52:55], v[144:159]
    ds_read_b64_tr_b16 v[64:65], v22 offset:49152
    ds_read_b64_tr_b16 v[66:67], v22 offset:50176
    s_waitcnt lgkmcnt(14)
    v_mfma_f32_32x32x16_bf16 v[160:175], v[100:103], a[52:55], v[160:175]
    ds_read_b64_tr_b16 v[68:69], v23 offset:49152
    ds_read_b64_tr_b16 v[70:71], v23 offset:50176
    s_waitcnt lgkmcnt(14)
    v_mfma_f32_32x32x16_bf16 v[176:191], v[104:107], a[52:55], v[176:191]
    ds_read_b64_tr_b16 v[72:73], v24 offset:49152
    ds_read_b64_tr_b16 v[74:75], v24 offset:50176
    s_waitcnt lgkmcnt(14)
    v_mfma_f32_32x32x16_bf16 v[192:207], v[108:111], a[52:55], v[192:207]
    ds_read_b64_tr_b16 v[76:77], v21 offset:57344
    ds_read_b64_tr_b16 v[78:79], v21 offset:58368
    s_waitcnt lgkmcnt(14)
    v_mfma_f32_32x32x16_bf16 v[208:223], v[112:115], a[52:55], v[208:223]
    ds_read_b64_tr_b16 v[80:81], v22 offset:57344
    ds_read_b64_tr_b16 v[82:83], v22 offset:58368
    s_waitcnt lgkmcnt(14)
    v_mfma_f32_32x32x16_bf16 v[224:239], v[116:119], a[52:55], v[224:239]
    ds_read_b64_tr_b16 v[84:85], v23 offset:57344
    ds_read_b64_tr_b16 v[86:87], v23 offset:58368
    s_waitcnt lgkmcnt(14)
    v_mfma_f32_32x32x16_bf16 v[240:255], v[120:123], a[52:55], v[240:255]
    ds_read_b64_tr_b16 v[88:89], v24 offset:57344
    ds_read_b64_tr_b16 v[90:91], v24 offset:58368
    s_waitcnt lgkmcnt(14)
    v_mfma_f32_32x32x16_bf16 v[128:143], v[60:63], a[56:59], v[128:143]
    ds_read_b64_tr_b16 v[92:93], v21 offset:53248
    ds_read_b64_tr_b16 v[94:95], v21 offset:54272
    s_waitcnt lgkmcnt(14)
    v_mfma_f32_32x32x16_bf16 v[144:159], v[64:67], a[56:59], v[144:159]
    ds_read_b64_tr_b16 v[96:97], v22 offset:53248
    ds_read_b64_tr_b16 v[98:99], v22 offset:54272
    s_waitcnt lgkmcnt(14)
    v_mfma_f32_32x32x16_bf16 v[160:175], v[68:71], a[56:59], v[160:175]
    ds_read_b64_tr_b16 v[100:101], v23 offset:53248
    ds_read_b64_tr_b16 v[102:103], v23 offset:54272
    s_waitcnt lgkmcnt(14)
    v_mfma_f32_32x32x16_bf16 v[176:191], v[72:75], a[56:59], v[176:191]
    ds_read_b64_tr_b16 v[104:105], v24 offset:53248
    ds_read_b64_tr_b16 v[106:107], v24 offset:54272
    s_waitcnt lgkmcnt(14)
    v_mfma_f32_32x32x16_bf16 v[192:207], v[76:79], a[56:59], v[192:207]
    ds_read_b64_tr_b16 v[108:109], v21 offset:61440
    ds_read_b64_tr_b16 v[110:111], v21 offset:62464
    s_waitcnt lgkmcnt(14)
    v_mfma_f32_32x32x16_bf16 v[208:223], v[80:83], a[56:59], v[208:223]
    ds_read_b64_tr_b16 v[112:113], v22 offset:61440
    ds_read_b64_tr_b16 v[114:115], v22 offset:62464
    s_waitcnt lgkmcnt(14)
    v_mfma_f32_32x32x16_bf16 v[224:239], v[84:87], a[56:59], v[224:239]
    ds_read_b64_tr_b16 v[116:117], v23 offset:61440
    ds_read_b64_tr_b16 v[118:119], v23 offset:62464
    s_waitcnt lgkmcnt(14)
    v_mfma_f32_32x32x16_bf16 v[240:255], v[88:91], a[56:59], v[240:255]
    ds_read_b64_tr_b16 v[120:121], v24 offset:61440
    ds_read_b64_tr_b16 v[122:123], v24 offset:62464
    s_waitcnt lgkmcnt(14)
    v_mfma_f32_32x32x16_bf16 v[128:143], v[92:95], a[60:63], v[128:143]
    s_waitcnt lgkmcnt(12)
    v_mfma_f32_32x32x16_bf16 v[144:159], v[96:99], a[60:63], v[144:159]
    s_waitcnt lgkmcnt(10)
    v_mfma_f32_32x32x16_bf16 v[160:175], v[100:103], a[60:63], v[160:175]
    s_waitcnt lgkmcnt(8)
    v_mfma_f32_32x32x16_bf16 v[176:191], v[104:107], a[60:63], v[176:191]
    s_waitcnt lgkmcnt(6)
    v_mfma_f32_32x32x16_bf16 v[192:207], v[108:111], a[60:63], v[192:207]
    s_waitcnt lgkmcnt(4)
    v_mfma_f32_32x32x16_bf16 v[208:223], v[112:115], a[60:63], v[208:223]
    s_waitcnt lgkmcnt(2)
    v_mfma_f32_32x32x16_bf16 v[224:239], v[116:119], a[60:63], v[224:239]
    s_waitcnt lgkmcnt(0)
    v_mfma_f32_32x32x16_bf16 v[240:255], v[120:123], a[60:63], v[240:255]
    s_nop 11
    s_cmp_eq_u32 s54, 1
    s_cbranch_scc1 epgu_141
    v_cvt_pk_bf16_f32 v60, v128, v129
    v_cvt_pk_bf16_f32 v61, v130, v131
    v_cvt_pk_bf16_f32 v62, v132, v133
    v_cvt_pk_bf16_f32 v63, v134, v135
    v_cvt_pk_bf16_f32 v64, v136, v137
    v_cvt_pk_bf16_f32 v65, v138, v139
    v_cvt_pk_bf16_f32 v66, v140, v141
    v_cvt_pk_bf16_f32 v67, v142, v143
    global_store_dwordx4 v11, v[60:63], s[18:19] offset:0 sc1
    global_store_dwordx4 v11, v[64:67], s[18:19] offset:512 sc1
    v_cvt_pk_bf16_f32 v68, v144, v145
    v_cvt_pk_bf16_f32 v69, v146, v147
    v_cvt_pk_bf16_f32 v70, v148, v149
    v_cvt_pk_bf16_f32 v71, v150, v151
    v_cvt_pk_bf16_f32 v72, v152, v153
    v_cvt_pk_bf16_f32 v73, v154, v155
    v_cvt_pk_bf16_f32 v74, v156, v157
    v_cvt_pk_bf16_f32 v75, v158, v159
    global_store_dwordx4 v11, v[68:71], s[18:19] offset:1024 sc1
    global_store_dwordx4 v11, v[72:75], s[18:19] offset:1536 sc1
    v_cvt_pk_bf16_f32 v76, v160, v161
    v_cvt_pk_bf16_f32 v77, v162, v163
    v_cvt_pk_bf16_f32 v78, v164, v165
    v_cvt_pk_bf16_f32 v79, v166, v167
    v_cvt_pk_bf16_f32 v80, v168, v169
    v_cvt_pk_bf16_f32 v81, v170, v171
    v_cvt_pk_bf16_f32 v82, v172, v173
    v_cvt_pk_bf16_f32 v83, v174, v175
    global_store_dwordx4 v11, v[76:79], s[18:19] offset:2048 sc1
    global_store_dwordx4 v11, v[80:83], s[18:19] offset:2560 sc1
    v_cvt_pk_bf16_f32 v84, v176, v177
    v_cvt_pk_bf16_f32 v85, v178, v179
    v_cvt_pk_bf16_f32 v86, v180, v181
    v_cvt_pk_bf16_f32 v87, v182, v183
    v_cvt_pk_bf16_f32 v88, v184, v185
    v_cvt_pk_bf16_f32 v89, v186, v187
    v_cvt_pk_bf16_f32 v90, v188, v189
    v_cvt_pk_bf16_f32 v91, v190, v191
    global_store_dwordx4 v11, v[84:87], s[18:19] offset:3072 sc1
    global_store_dwordx4 v11, v[88:91], s[18:19] offset:3584 sc1
    v_cvt_pk_bf16_f32 v60, v192, v193
    v_cvt_pk_bf16_f32 v61, v194, v195
    v_cvt_pk_bf16_f32 v62, v196, v197
    v_cvt_pk_bf16_f32 v63, v198, v199
    v_cvt_pk_bf16_f32 v64, v200, v201
    v_cvt_pk_bf16_f32 v65, v202, v203
    v_cvt_pk_bf16_f32 v66, v204, v205
    v_cvt_pk_bf16_f32 v67, v206, v207
    global_store_dwordx4 v11, v[60:63], s[20:21] offset:0 sc1
    global_store_dwordx4 v11, v[64:67], s[20:21] offset:512 sc1
    v_cvt_pk_bf16_f32 v68, v208, v209
    v_cvt_pk_bf16_f32 v69, v210, v211
    v_cvt_pk_bf16_f32 v70, v212, v213
    v_cvt_pk_bf16_f32 v71, v214, v215
    v_cvt_pk_bf16_f32 v72, v216, v217
    v_cvt_pk_bf16_f32 v73, v218, v219
    v_cvt_pk_bf16_f32 v74, v220, v221
    v_cvt_pk_bf16_f32 v75, v222, v223
    global_store_dwordx4 v11, v[68:71], s[20:21] offset:1024 sc1
    global_store_dwordx4 v11, v[72:75], s[20:21] offset:1536 sc1
    v_cvt_pk_bf16_f32 v76, v224, v225
    v_cvt_pk_bf16_f32 v77, v226, v227
    v_cvt_pk_bf16_f32 v78, v228, v229
    v_cvt_pk_bf16_f32 v79, v230, v231
    v_cvt_pk_bf16_f32 v80, v232, v233
    v_cvt_pk_bf16_f32 v81, v234, v235
    v_cvt_pk_bf16_f32 v82, v236, v237
    v_cvt_pk_bf16_f32 v83, v238, v239
    global_store_dwordx4 v11, v[76:79], s[20:21] offset:2048 sc1
    global_store_dwordx4 v11, v[80:83], s[20:21] offset:2560 sc1
    v_cvt_pk_bf16_f32 v84, v240, v241
    v_cvt_pk_bf16_f32 v85, v242, v243
    v_cvt_pk_bf16_f32 v86, v244, v245
    v_cvt_pk_bf16_f32 v87, v246, v247
    v_cvt_pk_bf16_f32 v88, v248, v249
    v_cvt_pk_bf16_f32 v89, v250, v251
    v_cvt_pk_bf16_f32 v90, v252, v253
    v_cvt_pk_bf16_f32 v91, v254, v255
    global_store_dwordx4 v11, v[84:87], s[20:21] offset:3072 sc1
    global_store_dwordx4 v11, v[88:91], s[20:21] offset:3584 sc1
    s_lshl_b32 s88, s52, 7
    s_add_u32 s88, s88, 4096
    s_waitcnt vmcnt(0)
    s_barrier
    s_cmp_lg_u32 s4, 0
    s_cbranch_scc1 pub_161
    v_mov_b32 v13, s88
    v_mov_b32 v14, 1
    s_mov_b64 exec, 1
    global_atomic_add v13, v14, s[82:83] sc1
    v_mov_b32 v13, 15488
    global_atomic_add v13, v14, s[82:83] sc1
    s_mov_b64 exec, -1
pub_161:
    s_branch next_135
epgu_141:
    v_cvt_pk_bf16_f32 v60, v128, v129
    v_lshlrev_b32 v128, 16, v60
    v_and_b32 v129, 0xffff0000, v60
    v_cvt_pk_bf16_f32 v61, v130, v131
    v_lshlrev_b32 v130, 16, v61
    v_and_b32 v131, 0xffff0000, v61
    v_cvt_pk_bf16_f32 v62, v132, v133
    v_lshlrev_b32 v132, 16, v62
    v_and_b32 v133, 0xffff0000, v62
    v_cvt_pk_bf16_f32 v63, v134, v135
    v_lshlrev_b32 v134, 16, v63
    v_and_b32 v135, 0xffff0000, v63
    v_cvt_pk_bf16_f32 v64, v136, v137
    v_lshlrev_b32 v136, 16, v64
    v_and_b32 v137, 0xffff0000, v64
    v_cvt_pk_bf16_f32 v65, v138, v139
    v_lshlrev_b32 v138, 16, v65
    v_and_b32 v139, 0xffff0000, v65
    v_cvt_pk_bf16_f32 v66, v140, v141
    v_lshlrev_b32 v140, 16, v66
    v_and_b32 v141, 0xffff0000, v66
    v_cvt_pk_bf16_f32 v67, v142, v143
    v_lshlrev_b32 v142, 16, v67
    v_and_b32 v143, 0xffff0000, v67
    v_mul_f32 v68, 0xbfb8aa3b, v128
    v_mul_f32 v69, 0xbfb8aa3b, v129
    v_mul_f32 v70, 0xbfb8aa3b, v130
    v_mul_f32 v71, 0xbfb8aa3b, v131
    v_mul_f32 v72, 0xbfb8aa3b, v132
    v_mul_f32 v73, 0xbfb8aa3b, v133
    v_mul_f32 v74, 0xbfb8aa3b, v134
    v_mul_f32 v75, 0xbfb8aa3b, v135
    v_mul_f32 v76, 0xbfb8aa3b, v136
    v_mul_f32 v77, 0xbfb8aa3b, v137
    v_mul_f32 v78, 0xbfb8aa3b, v138
    v_mul_f32 v79, 0xbfb8aa3b, v139
    v_mul_f32 v80, 0xbfb8aa3b, v140
    v_mul_f32 v81, 0xbfb8aa3b, v141
    v_mul_f32 v82, 0xbfb8aa3b, v142
    v_mul_f32 v83, 0xbfb8aa3b, v143
    v_exp_f32 v68, v68
    v_exp_f32 v69, v69
    v_exp_f32 v70, v70
    v_exp_f32 v71, v71
    v_exp_f32 v72, v72
    v_exp_f32 v73, v73
    v_exp_f32 v74, v74
    v_exp_f32 v75, v75
    v_exp_f32 v76, v76
    v_exp_f32 v77, v77
    v_exp_f32 v78, v78
    v_exp_f32 v79, v79
    v_exp_f32 v80, v80
    v_exp_f32 v81, v81
    v_exp_f32 v82, v82
    v_exp_f32 v83, v83
    v_add_f32 v68, 1.0, v68
    v_add_f32 v69, 1.0, v69
    v_add_f32 v70, 1.0, v70
    v_add_f32 v71, 1.0, v71
    v_add_f32 v72, 1.0, v72
    v_add_f32 v73, 1.0, v73
    v_add_f32 v74, 1.0, v74
    v_add_f32 v75, 1.0, v75
    v_add_f32 v76, 1.0, v76
    v_add_f32 v77, 1.0, v77
    v_add_f32 v78, 1.0, v78
    v_add_f32 v79, 1.0, v79
    v_add_f32 v80, 1.0, v80
    v_add_f32 v81, 1.0, v81
    v_add_f32 v82, 1.0, v82
    v_add_f32 v83, 1.0, v83
    v_rcp_f32 v68, v68
    v_rcp_f32 v69, v69
    v_rcp_f32 v70, v70
    v_rcp_f32 v71, v71
    v_rcp_f32 v72, v72
    v_rcp_f32 v73, v73
    v_rcp_f32 v74, v74
    v_rcp_f32 v75, v75
    v_rcp_f32 v76, v76
    v_rcp_f32 v77, v77
    v_rcp_f32 v78, v78
    v_rcp_f32 v79, v79
    v_rcp_f32 v80, v80
    v_rcp_f32 v81, v81
    v_rcp_f32 v82, v82
    v_rcp_f32 v83, v83
    v_mul_f32 v128, v128, v68
    v_mul_f32 v129, v129, v69
    v_mul_f32 v130, v130, v70
    v_mul_f32 v131, v131, v71
    v_mul_f32 v132, v132, v72
    v_mul_f32 v133, v133, v73
    v_mul_f32 v134, v134, v74
    v_mul_f32 v135, v135, v75
    v_mul_f32 v136, v136, v76
    v_mul_f32 v137, v137, v77
    v_mul_f32 v138, v138, v78
    v_mul_f32 v139, v139, v79
    v_mul_f32 v140, v140, v80
    v_mul_f32 v141, v141, v81
    v_mul_f32 v142, v142, v82
    v_mul_f32 v143, v143, v83
    v_cvt_pk_bf16_f32 v60, v128, v129
    v_lshlrev_b32 v128, 16, v60
    v_and_b32 v129, 0xffff0000, v60
    v_cvt_pk_bf16_f32 v61, v130, v131
    v_lshlrev_b32 v130, 16, v61
    v_and_b32 v131, 0xffff0000, v61
    v_cvt_pk_bf16_f32 v62, v132, v133
    v_lshlrev_b32 v132, 16, v62
    v_and_b32 v133, 0xffff0000, v62
    v_cvt_pk_bf16_f32 v63, v134, v135
    v_lshlrev_b32 v134, 16, v63
    v_and_b32 v135, 0xffff0000, v63
    v_cvt_pk_bf16_f32 v64, v136, v137
    v_lshlrev_b32 v136, 16, v64
    v_and_b32 v137, 0xffff0000, v64
    v_cvt_pk_bf16_f32 v65, v138, v139
    v_lshlrev_b32 v138, 16, v65
    v_and_b32 v139, 0xffff0000, v65
    v_cvt_pk_bf16_f32 v66, v140, v141
    v_lshlrev_b32 v140, 16, v66
    v_and_b32 v141, 0xffff0000, v66
    v_cvt_pk_bf16_f32 v67, v142, v143
    v_lshlrev_b32 v142, 16, v67
    v_and_b32 v143, 0xffff0000, v67
    v_cvt_pk_bf16_f32 v68, v192, v193
    v_lshlrev_b32 v192, 16, v68
    v_and_b32 v193, 0xffff0000, v68
    v_cvt_pk_bf16_f32 v69, v194, v195
    v_lshlrev_b32 v194, 16, v69
    v_and_b32 v195, 0xffff0000, v69
    v_cvt_pk_bf16_f32 v70, v196, v197
    v_lshlrev_b32 v196, 16, v70
    v_and_b32 v197, 0xffff0000, v70
    v_cvt_pk_bf16_f32 v71, v198, v199
    v_lshlrev_b32 v198, 16, v71
    v_and_b32 v199, 0xffff0000, v71
    v_cvt_pk_bf16_f32 v72, v200, v201
    v_lshlrev_b32 v200, 16, v72
    v_and_b32 v201, 0xffff0000, v72
    v_cvt_pk_bf16_f32 v73, v202, v203
    v_lshlrev_b32 v202, 16, v73
    v_and_b32 v203, 0xffff0000, v73
    v_cvt_pk_bf16_f32 v74, v204, v205
    v_lshlrev_b32 v204, 16, v74
    v_and_b32 v205, 0xffff0000, v74
    v_cvt_pk_bf16_f32 v75, v206, v207
    v_lshlrev_b32 v206, 16, v75
    v_and_b32 v207, 0xffff0000, v75
    v_mul_f32 v128, v128, v192
    v_mul_f32 v129, v129, v193
    v_mul_f32 v130, v130, v194
    v_mul_f32 v131, v131, v195
    v_mul_f32 v132, v132, v196
    v_mul_f32 v133, v133, v197
    v_mul_f32 v134, v134, v198
    v_mul_f32 v135, v135, v199
    v_mul_f32 v136, v136, v200
    v_mul_f32 v137, v137, v201
    v_mul_f32 v138, v138, v202
    v_mul_f32 v139, v139, v203
    v_mul_f32 v140, v140, v204
    v_mul_f32 v141, v141, v205
    v_mul_f32 v142, v142, v206
    v_mul_f32 v143, v143, v207
    v_cvt_pk_bf16_f32 v92, v128, v129
    v_cvt_pk_bf16_f32 v93, v130, v131
    v_cvt_pk_bf16_f32 v94, v132, v133
    v_cvt_pk_bf16_f32 v95, v134, v135
    v_cvt_pk_bf16_f32 v96, v136, v137
    v_cvt_pk_bf16_f32 v97, v138, v139
    v_cvt_pk_bf16_f32 v98, v140, v141
    v_cvt_pk_bf16_f32 v99, v142, v143
    global_store_dwordx4 v2, v[92:95], s[18:19] offset:-4096 sc1
    global_store_dwordx4 v2, v[96:99], s[18:19] offset:-3072 sc1
    v_cvt_pk_bf16_f32 v60, v144, v145
    v_lshlrev_b32 v144, 16, v60
    v_and_b32 v145, 0xffff0000, v60
    v_cvt_pk_bf16_f32 v61, v146, v147
    v_lshlrev_b32 v146, 16, v61
    v_and_b32 v147, 0xffff0000, v61
    v_cvt_pk_bf16_f32 v62, v148, v149
    v_lshlrev_b32 v148, 16, v62
    v_and_b32 v149, 0xffff0000, v62
    v_cvt_pk_bf16_f32 v63, v150, v151
    v_lshlrev_b32 v150, 16, v63
    v_and_b32 v151, 0xffff0000, v63
    v_cvt_pk_bf16_f32 v64, v152, v153
    v_lshlrev_b32 v152, 16, v64
    v_and_b32 v153, 0xffff0000, v64
    v_cvt_pk_bf16_f32 v65, v154, v155
    v_lshlrev_b32 v154, 16, v65
    v_and_b32 v155, 0xffff0000, v65
    v_cvt_pk_bf16_f32 v66, v156, v157
    v_lshlrev_b32 v156, 16, v66
    v_and_b32 v157, 0xffff0000, v66
    v_cvt_pk_bf16_f32 v67, v158, v159
    v_lshlrev_b32 v158, 16, v67
    v_and_b32 v159, 0xffff0000, v67
    v_mul_f32 v68, 0xbfb8aa3b, v144
    v_mul_f32 v69, 0xbfb8aa3b, v145
    v_mul_f32 v70, 0xbfb8aa3b, v146
    v_mul_f32 v71, 0xbfb8aa3b, v147
    v_mul_f32 v72, 0xbfb8aa3b, v148
    v_mul_f32 v73, 0xbfb8aa3b, v149
    v_mul_f32 v74, 0xbfb8aa3b, v150
    v_mul_f32 v75, 0xbfb8aa3b, v151
    v_mul_f32 v76, 0xbfb8aa3b, v152
    v_mul_f32 v77, 0xbfb8aa3b, v153
    v_mul_f32 v78, 0xbfb8aa3b, v154
    v_mul_f32 v79, 0xbfb8aa3b, v155
    v_mul_f32 v80, 0xbfb8aa3b, v156
    v_mul_f32 v81, 0xbfb8aa3b, v157
    v_mul_f32 v82, 0xbfb8aa3b, v158
    v_mul_f32 v83, 0xbfb8aa3b, v159
    v_exp_f32 v68, v68
    v_exp_f32 v69, v69
    v_exp_f32 v70, v70
    v_exp_f32 v71, v71
    v_exp_f32 v72, v72
    v_exp_f32 v73, v73
    v_exp_f32 v74, v74
    v_exp_f32 v75, v75
    v_exp_f32 v76, v76
    v_exp_f32 v77, v77
    v_exp_f32 v78, v78
    v_exp_f32 v79, v79
    v_exp_f32 v80, v80
    v_exp_f32 v81, v81
    v_exp_f32 v82, v82
    v_exp_f32 v83, v83
    v_add_f32 v68, 1.0, v68
    v_add_f32 v69, 1.0, v69
    v_add_f32 v70, 1.0, v70
    v_add_f32 v71, 1.0, v71
    v_add_f32 v72, 1.0, v72
    v_add_f32 v73, 1.0, v73
    v_add_f32 v74, 1.0, v74
    v_add_f32 v75, 1.0, v75
    v_add_f32 v76, 1.0, v76
    v_add_f32 v77, 1.0, v77
    v_add_f32 v78, 1.0, v78
    v_add_f32 v79, 1.0, v79
    v_add_f32 v80, 1.0, v80
    v_add_f32 v81, 1.0, v81
    v_add_f32 v82, 1.0, v82
    v_add_f32 v83, 1.0, v83
    v_rcp_f32 v68, v68
    v_rcp_f32 v69, v69
    v_rcp_f32 v70, v70
    v_rcp_f32 v71, v71
    v_rcp_f32 v72, v72
    v_rcp_f32 v73, v73
    v_rcp_f32 v74, v74
    v_rcp_f32 v75, v75
    v_rcp_f32 v76, v76
    v_rcp_f32 v77, v77
    v_rcp_f32 v78, v78
    v_rcp_f32 v79, v79
    v_rcp_f32 v80, v80
    v_rcp_f32 v81, v81
    v_rcp_f32 v82, v82
    v_rcp_f32 v83, v83
    v_mul_f32 v144, v144, v68
    v_mul_f32 v145, v145, v69
    v_mul_f32 v146, v146, v70
    v_mul_f32 v147, v147, v71
    v_mul_f32 v148, v148, v72
    v_mul_f32 v149, v149, v73
    v_mul_f32 v150, v150, v74
    v_mul_f32 v151, v151, v75
    v_mul_f32 v152, v152, v76
    v_mul_f32 v153, v153, v77
    v_mul_f32 v154, v154, v78
    v_mul_f32 v155, v155, v79
    v_mul_f32 v156, v156, v80
    v_mul_f32 v157, v157, v81
    v_mul_f32 v158, v158, v82
    v_mul_f32 v159, v159, v83
    v_cvt_pk_bf16_f32 v60, v144, v145
    v_lshlrev_b32 v144, 16, v60
    v_and_b32 v145, 0xffff0000, v60
    v_cvt_pk_bf16_f32 v61, v146, v147
    v_lshlrev_b32 v146, 16, v61
    v_and_b32 v147, 0xffff0000, v61
    v_cvt_pk_bf16_f32 v62, v148, v149
    v_lshlrev_b32 v148, 16, v62
    v_and_b32 v149, 0xffff0000, v62
    v_cvt_pk_bf16_f32 v63, v150, v151
    v_lshlrev_b32 v150, 16, v63
    v_and_b32 v151, 0xffff0000, v63
    v_cvt_pk_bf16_f32 v64, v152, v153
    v_lshlrev_b32 v152, 16, v64
    v_and_b32 v153, 0xffff0000, v64
    v_cvt_pk_bf16_f32 v65, v154, v155
    v_lshlrev_b32 v154, 16, v65
    v_and_b32 v155, 0xffff0000, v65
    v_cvt_pk_bf16_f32 v66, v156, v157
    v_lshlrev_b32 v156, 16, v66
    v_and_b32 v157, 0xffff0000, v66
    v_cvt_pk_bf16_f32 v67, v158, v159
    v_lshlrev_b32 v158, 16, v67
    v_and_b32 v159, 0xffff0000, v67
    v_cvt_pk_bf16_f32 v68, v208, v209
    v_lshlrev_b32 v208, 16, v68
    v_and_b32 v209, 0xffff0000, v68
    v_cvt_pk_bf16_f32 v69, v210, v211
    v_lshlrev_b32 v210, 16, v69
    v_and_b32 v211, 0xffff0000, v69
    v_cvt_pk_bf16_f32 v70, v212, v213
    v_lshlrev_b32 v212, 16, v70
    v_and_b32 v213, 0xffff0000, v70
    v_cvt_pk_bf16_f32 v71, v214, v215
    v_lshlrev_b32 v214, 16, v71
    v_and_b32 v215, 0xffff0000, v71
    v_cvt_pk_bf16_f32 v72, v216, v217
    v_lshlrev_b32 v216, 16, v72
    v_and_b32 v217, 0xffff0000, v72
    v_cvt_pk_bf16_f32 v73, v218, v219
    v_lshlrev_b32 v218, 16, v73
    v_and_b32 v219, 0xffff0000, v73
    v_cvt_pk_bf16_f32 v74, v220, v221
    v_lshlrev_b32 v220, 16, v74
    v_and_b32 v221, 0xffff0000, v74
    v_cvt_pk_bf16_f32 v75, v222, v223
    v_lshlrev_b32 v222, 16, v75
    v_and_b32 v223, 0xffff0000, v75
    v_mul_f32 v144, v144, v208
    v_mul_f32 v145, v145, v209
    v_mul_f32 v146, v146, v210
    v_mul_f32 v147, v147, v211
    v_mul_f32 v148, v148, v212
    v_mul_f32 v149, v149, v213
    v_mul_f32 v150, v150, v214
    v_mul_f32 v151, v151, v215
    v_mul_f32 v152, v152, v216
    v_mul_f32 v153, v153, v217
    v_mul_f32 v154, v154, v218
    v_mul_f32 v155, v155, v219
    v_mul_f32 v156, v156, v220
    v_mul_f32 v157, v157, v221
    v_mul_f32 v158, v158, v222
    v_mul_f32 v159, v159, v223
    v_cvt_pk_bf16_f32 v100, v144, v145
    v_cvt_pk_bf16_f32 v101, v146, v147
    v_cvt_pk_bf16_f32 v102, v148, v149
    v_cvt_pk_bf16_f32 v103, v150, v151
    v_cvt_pk_bf16_f32 v104, v152, v153
    v_cvt_pk_bf16_f32 v105, v154, v155
    v_cvt_pk_bf16_f32 v106, v156, v157
    v_cvt_pk_bf16_f32 v107, v158, v159
    global_store_dwordx4 v2, v[100:103], s[18:19] offset:-2048 sc1
    global_store_dwordx4 v2, v[104:107], s[18:19] offset:-1024 sc1
    v_cvt_pk_bf16_f32 v60, v160, v161
    v_lshlrev_b32 v160, 16, v60
    v_and_b32 v161, 0xffff0000, v60
    v_cvt_pk_bf16_f32 v61, v162, v163
    v_lshlrev_b32 v162, 16, v61
    v_and_b32 v163, 0xffff0000, v61
    v_cvt_pk_bf16_f32 v62, v164, v165
    v_lshlrev_b32 v164, 16, v62
    v_and_b32 v165, 0xffff0000, v62
    v_cvt_pk_bf16_f32 v63, v166, v167
    v_lshlrev_b32 v166, 16, v63
    v_and_b32 v167, 0xffff0000, v63
    v_cvt_pk_bf16_f32 v64, v168, v169
    v_lshlrev_b32 v168, 16, v64
    v_and_b32 v169, 0xffff0000, v64
    v_cvt_pk_bf16_f32 v65, v170, v171
    v_lshlrev_b32 v170, 16, v65
    v_and_b32 v171, 0xffff0000, v65
    v_cvt_pk_bf16_f32 v66, v172, v173
    v_lshlrev_b32 v172, 16, v66
    v_and_b32 v173, 0xffff0000, v66
    v_cvt_pk_bf16_f32 v67, v174, v175
    v_lshlrev_b32 v174, 16, v67
    v_and_b32 v175, 0xffff0000, v67
    v_mul_f32 v68, 0xbfb8aa3b, v160
    v_mul_f32 v69, 0xbfb8aa3b, v161
    v_mul_f32 v70, 0xbfb8aa3b, v162
    v_mul_f32 v71, 0xbfb8aa3b, v163
    v_mul_f32 v72, 0xbfb8aa3b, v164
    v_mul_f32 v73, 0xbfb8aa3b, v165
    v_mul_f32 v74, 0xbfb8aa3b, v166
    v_mul_f32 v75, 0xbfb8aa3b, v167
    v_mul_f32 v76, 0xbfb8aa3b, v168
    v_mul_f32 v77, 0xbfb8aa3b, v169
    v_mul_f32 v78, 0xbfb8aa3b, v170
    v_mul_f32 v79, 0xbfb8aa3b, v171
    v_mul_f32 v80, 0xbfb8aa3b, v172
    v_mul_f32 v81, 0xbfb8aa3b, v173
    v_mul_f32 v82, 0xbfb8aa3b, v174
    v_mul_f32 v83, 0xbfb8aa3b, v175
    v_exp_f32 v68, v68
    v_exp_f32 v69, v69
    v_exp_f32 v70, v70
    v_exp_f32 v71, v71
    v_exp_f32 v72, v72
    v_exp_f32 v73, v73
    v_exp_f32 v74, v74
    v_exp_f32 v75, v75
    v_exp_f32 v76, v76
    v_exp_f32 v77, v77
    v_exp_f32 v78, v78
    v_exp_f32 v79, v79
    v_exp_f32 v80, v80
    v_exp_f32 v81, v81
    v_exp_f32 v82, v82
    v_exp_f32 v83, v83
    v_add_f32 v68, 1.0, v68
    v_add_f32 v69, 1.0, v69
    v_add_f32 v70, 1.0, v70
    v_add_f32 v71, 1.0, v71
    v_add_f32 v72, 1.0, v72
    v_add_f32 v73, 1.0, v73
    v_add_f32 v74, 1.0, v74
    v_add_f32 v75, 1.0, v75
    v_add_f32 v76, 1.0, v76
    v_add_f32 v77, 1.0, v77
    v_add_f32 v78, 1.0, v78
    v_add_f32 v79, 1.0, v79
    v_add_f32 v80, 1.0, v80
    v_add_f32 v81, 1.0, v81
    v_add_f32 v82, 1.0, v82
    v_add_f32 v83, 1.0, v83
    v_rcp_f32 v68, v68
    v_rcp_f32 v69, v69
    v_rcp_f32 v70, v70
    v_rcp_f32 v71, v71
    v_rcp_f32 v72, v72
    v_rcp_f32 v73, v73
    v_rcp_f32 v74, v74
    v_rcp_f32 v75, v75
    v_rcp_f32 v76, v76
    v_rcp_f32 v77, v77
    v_rcp_f32 v78, v78
    v_rcp_f32 v79, v79
    v_rcp_f32 v80, v80
    v_rcp_f32 v81, v81
    v_rcp_f32 v82, v82
    v_rcp_f32 v83, v83
    v_mul_f32 v160, v160, v68
    v_mul_f32 v161, v161, v69
    v_mul_f32 v162, v162, v70
    v_mul_f32 v163, v163, v71
    v_mul_f32 v164, v164, v72
    v_mul_f32 v165, v165, v73
    v_mul_f32 v166, v166, v74
    v_mul_f32 v167, v167, v75
    v_mul_f32 v168, v168, v76
    v_mul_f32 v169, v169, v77
    v_mul_f32 v170, v170, v78
    v_mul_f32 v171, v171, v79
    v_mul_f32 v172, v172, v80
    v_mul_f32 v173, v173, v81
    v_mul_f32 v174, v174, v82
    v_mul_f32 v175, v175, v83
    v_cvt_pk_bf16_f32 v60, v160, v161
    v_lshlrev_b32 v160, 16, v60
    v_and_b32 v161, 0xffff0000, v60
    v_cvt_pk_bf16_f32 v61, v162, v163
    v_lshlrev_b32 v162, 16, v61
    v_and_b32 v163, 0xffff0000, v61
    v_cvt_pk_bf16_f32 v62, v164, v165
    v_lshlrev_b32 v164, 16, v62
    v_and_b32 v165, 0xffff0000, v62
    v_cvt_pk_bf16_f32 v63, v166, v167
    v_lshlrev_b32 v166, 16, v63
    v_and_b32 v167, 0xffff0000, v63
    v_cvt_pk_bf16_f32 v64, v168, v169
    v_lshlrev_b32 v168, 16, v64
    v_and_b32 v169, 0xffff0000, v64
    v_cvt_pk_bf16_f32 v65, v170, v171
    v_lshlrev_b32 v170, 16, v65
    v_and_b32 v171, 0xffff0000, v65
    v_cvt_pk_bf16_f32 v66, v172, v173
    v_lshlrev_b32 v172, 16, v66
    v_and_b32 v173, 0xffff0000, v66
    v_cvt_pk_bf16_f32 v67, v174, v175
    v_lshlrev_b32 v174, 16, v67
    v_and_b32 v175, 0xffff0000, v67
    v_cvt_pk_bf16_f32 v68, v224, v225
    v_lshlrev_b32 v224, 16, v68
    v_and_b32 v225, 0xffff0000, v68
    v_cvt_pk_bf16_f32 v69, v226, v227
    v_lshlrev_b32 v226, 16, v69
    v_and_b32 v227, 0xffff0000, v69
    v_cvt_pk_bf16_f32 v70, v228, v229
    v_lshlrev_b32 v228, 16, v70
    v_and_b32 v229, 0xffff0000, v70
    v_cvt_pk_bf16_f32 v71, v230, v231
    v_lshlrev_b32 v230, 16, v71
    v_and_b32 v231, 0xffff0000, v71
    v_cvt_pk_bf16_f32 v72, v232, v233
    v_lshlrev_b32 v232, 16, v72
    v_and_b32 v233, 0xffff0000, v72
    v_cvt_pk_bf16_f32 v73, v234, v235
    v_lshlrev_b32 v234, 16, v73
    v_and_b32 v235, 0xffff0000, v73
    v_cvt_pk_bf16_f32 v74, v236, v237
    v_lshlrev_b32 v236, 16, v74
    v_and_b32 v237, 0xffff0000, v74
    v_cvt_pk_bf16_f32 v75, v238, v239
    v_lshlrev_b32 v238, 16, v75
    v_and_b32 v239, 0xffff0000, v75
    v_mul_f32 v160, v160, v224
    v_mul_f32 v161, v161, v225
    v_mul_f32 v162, v162, v226
    v_mul_f32 v163, v163, v227
    v_mul_f32 v164, v164, v228
    v_mul_f32 v165, v165, v229
    v_mul_f32 v166, v166, v230
    v_mul_f32 v167, v167, v231
    v_mul_f32 v168, v168, v232
    v_mul_f32 v169, v169, v233
    v_mul_f32 v170, v170, v234
    v_mul_f32 v171, v171, v235
    v_mul_f32 v172, v172, v236
    v_mul_f32 v173, v173, v237
    v_mul_f32 v174, v174, v238
    v_mul_f32 v175, v175, v239
    v_cvt_pk_bf16_f32 v92, v160, v161
    v_cvt_pk_bf16_f32 v93, v162, v163
    v_cvt_pk_bf16_f32 v94, v164, v165
    v_cvt_pk_bf16_f32 v95, v166, v167
    v_cvt_pk_bf16_f32 v96, v168, v169
    v_cvt_pk_bf16_f32 v97, v170, v171
    v_cvt_pk_bf16_f32 v98, v172, v173
    v_cvt_pk_bf16_f32 v99, v174, v175
    global_store_dwordx4 v2, v[92:95], s[18:19] offset:0 sc1
    global_store_dwordx4 v2, v[96:99], s[18:19] offset:1024 sc1
    v_cvt_pk_bf16_f32 v60, v176, v177
    v_lshlrev_b32 v176, 16, v60
    v_and_b32 v177, 0xffff0000, v60
    v_cvt_pk_bf16_f32 v61, v178, v179
    v_lshlrev_b32 v178, 16, v61
    v_and_b32 v179, 0xffff0000, v61
    v_cvt_pk_bf16_f32 v62, v180, v181
    v_lshlrev_b32 v180, 16, v62
    v_and_b32 v181, 0xffff0000, v62
    v_cvt_pk_bf16_f32 v63, v182, v183
    v_lshlrev_b32 v182, 16, v63
    v_and_b32 v183, 0xffff0000, v63
    v_cvt_pk_bf16_f32 v64, v184, v185
    v_lshlrev_b32 v184, 16, v64
    v_and_b32 v185, 0xffff0000, v64
    v_cvt_pk_bf16_f32 v65, v186, v187
    v_lshlrev_b32 v186, 16, v65
    v_and_b32 v187, 0xffff0000, v65
    v_cvt_pk_bf16_f32 v66, v188, v189
    v_lshlrev_b32 v188, 16, v66
    v_and_b32 v189, 0xffff0000, v66
    v_cvt_pk_bf16_f32 v67, v190, v191
    v_lshlrev_b32 v190, 16, v67
    v_and_b32 v191, 0xffff0000, v67
    v_mul_f32 v68, 0xbfb8aa3b, v176
    v_mul_f32 v69, 0xbfb8aa3b, v177
    v_mul_f32 v70, 0xbfb8aa3b, v178
    v_mul_f32 v71, 0xbfb8aa3b, v179
    v_mul_f32 v72, 0xbfb8aa3b, v180
    v_mul_f32 v73, 0xbfb8aa3b, v181
    v_mul_f32 v74, 0xbfb8aa3b, v182
    v_mul_f32 v75, 0xbfb8aa3b, v183
    v_mul_f32 v76, 0xbfb8aa3b, v184
    v_mul_f32 v77, 0xbfb8aa3b, v185
    v_mul_f32 v78, 0xbfb8aa3b, v186
    v_mul_f32 v79, 0xbfb8aa3b, v187
    v_mul_f32 v80, 0xbfb8aa3b, v188
    v_mul_f32 v81, 0xbfb8aa3b, v189
    v_mul_f32 v82, 0xbfb8aa3b, v190
    v_mul_f32 v83, 0xbfb8aa3b, v191
    v_exp_f32 v68, v68
    v_exp_f32 v69, v69
    v_exp_f32 v70, v70
    v_exp_f32 v71, v71
    v_exp_f32 v72, v72
    v_exp_f32 v73, v73
    v_exp_f32 v74, v74
    v_exp_f32 v75, v75
    v_exp_f32 v76, v76
    v_exp_f32 v77, v77
    v_exp_f32 v78, v78
    v_exp_f32 v79, v79
    v_exp_f32 v80, v80
    v_exp_f32 v81, v81
    v_exp_f32 v82, v82
    v_exp_f32 v83, v83
    v_add_f32 v68, 1.0, v68
    v_add_f32 v69, 1.0, v69
    v_add_f32 v70, 1.0, v70
    v_add_f32 v71, 1.0, v71
    v_add_f32 v72, 1.0, v72
    v_add_f32 v73, 1.0, v73
    v_add_f32 v74, 1.0, v74
    v_add_f32 v75, 1.0, v75
    v_add_f32 v76, 1.0, v76
    v_add_f32 v77, 1.0, v77
    v_add_f32 v78, 1.0, v78
    v_add_f32 v79, 1.0, v79
    v_add_f32 v80, 1.0, v80
    v_add_f32 v81, 1.0, v81
    v_add_f32 v82, 1.0, v82
    v_add_f32 v83, 1.0, v83
    v_rcp_f32 v68, v68
    v_rcp_f32 v69, v69
    v_rcp_f32 v70, v70
    v_rcp_f32 v71, v71
    v_rcp_f32 v72, v72
    v_rcp_f32 v73, v73
    v_rcp_f32 v74, v74
    v_rcp_f32 v75, v75
    v_rcp_f32 v76, v76
    v_rcp_f32 v77, v77
    v_rcp_f32 v78, v78
    v_rcp_f32 v79, v79
    v_rcp_f32 v80, v80
    v_rcp_f32 v81, v81
    v_rcp_f32 v82, v82
    v_rcp_f32 v83, v83
    v_mul_f32 v176, v176, v68
    v_mul_f32 v177, v177, v69
    v_mul_f32 v178, v178, v70
    v_mul_f32 v179, v179, v71
    v_mul_f32 v180, v180, v72
    v_mul_f32 v181, v181, v73
    v_mul_f32 v182, v182, v74
    v_mul_f32 v183, v183, v75
    v_mul_f32 v184, v184, v76
    v_mul_f32 v185, v185, v77
    v_mul_f32 v186, v186, v78
    v_mul_f32 v187, v187, v79
    v_mul_f32 v188, v188, v80
    v_mul_f32 v189, v189, v81
    v_mul_f32 v190, v190, v82
    v_mul_f32 v191, v191, v83
    v_cvt_pk_bf16_f32 v60, v176, v177
    v_lshlrev_b32 v176, 16, v60
    v_and_b32 v177, 0xffff0000, v60
    v_cvt_pk_bf16_f32 v61, v178, v179
    v_lshlrev_b32 v178, 16, v61
    v_and_b32 v179, 0xffff0000, v61
    v_cvt_pk_bf16_f32 v62, v180, v181
    v_lshlrev_b32 v180, 16, v62
    v_and_b32 v181, 0xffff0000, v62
    v_cvt_pk_bf16_f32 v63, v182, v183
    v_lshlrev_b32 v182, 16, v63
    v_and_b32 v183, 0xffff0000, v63
    v_cvt_pk_bf16_f32 v64, v184, v185
    v_lshlrev_b32 v184, 16, v64
    v_and_b32 v185, 0xffff0000, v64
    v_cvt_pk_bf16_f32 v65, v186, v187
    v_lshlrev_b32 v186, 16, v65
    v_and_b32 v187, 0xffff0000, v65
    v_cvt_pk_bf16_f32 v66, v188, v189
    v_lshlrev_b32 v188, 16, v66
    v_and_b32 v189, 0xffff0000, v66
    v_cvt_pk_bf16_f32 v67, v190, v191
    v_lshlrev_b32 v190, 16, v67
    v_and_b32 v191, 0xffff0000, v67
    v_cvt_pk_bf16_f32 v68, v240, v241
    v_lshlrev_b32 v240, 16, v68
    v_and_b32 v241, 0xffff0000, v68
    v_cvt_pk_bf16_f32 v69, v242, v243
    v_lshlrev_b32 v242, 16, v69
    v_and_b32 v243, 0xffff0000, v69
    v_cvt_pk_bf16_f32 v70, v244, v245
    v_lshlrev_b32 v244, 16, v70
    v_and_b32 v245, 0xffff0000, v70
    v_cvt_pk_bf16_f32 v71, v246, v247
    v_lshlrev_b32 v246, 16, v71
    v_and_b32 v247, 0xffff0000, v71
    v_cvt_pk_bf16_f32 v72, v248, v249
    v_lshlrev_b32 v248, 16, v72
    v_and_b32 v249, 0xffff0000, v72
    v_cvt_pk_bf16_f32 v73, v250, v251
    v_lshlrev_b32 v250, 16, v73
    v_and_b32 v251, 0xffff0000, v73
    v_cvt_pk_bf16_f32 v74, v252, v253
    v_lshlrev_b32 v252, 16, v74
    v_and_b32 v253, 0xffff0000, v74
    v_cvt_pk_bf16_f32 v75, v254, v255
    v_lshlrev_b32 v254, 16, v75
    v_and_b32 v255, 0xffff0000, v75
    v_mul_f32 v176, v176, v240
    v_mul_f32 v177, v177, v241
    v_mul_f32 v178, v178, v242
    v_mul_f32 v179, v179, v243
    v_mul_f32 v180, v180, v244
    v_mul_f32 v181, v181, v245
    v_mul_f32 v182, v182, v246
    v_mul_f32 v183, v183, v247
    v_mul_f32 v184, v184, v248
    v_mul_f32 v185, v185, v249
    v_mul_f32 v186, v186, v250
    v_mul_f32 v187, v187, v251
    v_mul_f32 v188, v188, v252
    v_mul_f32 v189, v189, v253
    v_mul_f32 v190, v190, v254
    v_mul_f32 v191, v191, v255
    v_cvt_pk_bf16_f32 v100, v176, v177
    v_cvt_pk_bf16_f32 v101, v178, v179
    v_cvt_pk_bf16_f32 v102, v180, v181
    v_cvt_pk_bf16_f32 v103, v182, v183
    v_cvt_pk_bf16_f32 v104, v184, v185
    v_cvt_pk_bf16_f32 v105, v186, v187
    v_cvt_pk_bf16_f32 v106, v188, v189
    v_cvt_pk_bf16_f32 v107, v190, v191
    global_store_dwordx4 v2, v[100:103], s[18:19] offset:2048 sc1
    global_store_dwordx4 v2, v[104:107], s[18:19] offset:3072 sc1
    s_lshl_b32 s88, s52, 7
    s_add_u32 s88, s88, 6144
    s_waitcnt vmcnt(0)
    s_barrier
    s_cmp_lg_u32 s4, 0
    s_cbranch_scc1 pub_162
    v_mov_b32 v13, s88
    v_mov_b32 v14, 1
    s_mov_b64 exec, 1
    global_atomic_add v13, v14, s[82:83] sc1
    s_mov_b64 exec, -1
pub_162:
    s_branch next_135
tdn_140:
    s_lshl_b32 s88, s52, 7
    s_add_u32 s88, s88, 6144
    s_waitcnt vmcnt(0)
    s_cmp_lg_u32 s4, 0
    s_cbranch_scc1 wg_163
    v_mov_b32 v13, s88
wf_164:
    global_load_dword v14, v13, s[82:83] sc1
    s_waitcnt vmcnt(0)
    v_readfirstlane_b32 s87, v14
    s_cmp_ge_u32 s87, 14
    s_cbranch_scc1 wfd_165
    s_sub_u32 s86, s86, 1
    s_cbranch_scc1 wfd_165_x
    s_sleep 16
    s_branch wf_164
wfd_165_x:
    s_mov_b32 s86, 0
wfd_165:
wg_163:
    s_barrier
    s_mov_b32 s26, 1024
    s_mov_b32 s28, 6
    s_lshl_b32 s36, s52, 1
    s_mul_i32 s34, s53, 5
    s_add_u32 s36, s36, s34
    s_mul_i32 s36, s36, 3
    s_mul_hi_u32 s34, s36, 76695845
    s_mul_i32 s34, s34, 56
    s_sub_u32 s36, s36, s34
    s_mov_b32 s31, 56
    s_lshl_b32 s15, s53, 9
    s_add_u32 s22, s74, s15
    s_addc_u32 s23, s75, 0
    s_add_u32 s24, s22, 256
    s_addc_u32 s25, s23, 0
    s_cmp_ge_u32 s4, 2
    s_cselect_b32 s10, s24, s22
    s_cselect_b32 s11, s25, s23
    s_and_b32 s14, s4, 1
    s_mul_i32 s14, s14, s26
    s_lshl_b32 s14, s14, 4
    s_add_u32 s10, s10, s14
    s_addc_u32 s11, s11, 0
    s_lshl_b32 s15, s52, 2
    s_add_u32 s15, s15, s4
    s_mul_i32 s16, s15, 114688
    s_add_u32 s16, s16, 63963136
    s_add_u32 s8, s80, s16
    s_addc_u32 s9, s81, 0
    s_lshl_b32 s16, s15, 15
    s_lshl_b32 s17, s53, 14
    s_add_u32 s16, s16, s17
    s_add_u32 s16, s16, 72355840
    s_add_u32 s18, s80, s16
    s_addc_u32 s19, s81, 0
    s_add_u32 s20, s18, 8192
    s_addc_u32 s21, s19, 0
    v_lshrrev_b32 v13, 4, v1
    v_and_b32 v14, 15, v1
    v_lshlrev_b32 v15, 2, v13
    v_xor_b32 v14, v14, v15
    v_lshlrev_b32 v14, 4, v14
    v_mul_lo_u32 v15, v13, s26
    v_add_u32 v3, v15, v14
    s_lshl_b32 s14, s26, 2
    v_add_u32 v4, s14, v3
    v_add_u32 v5, s14, v4
    v_add_u32 v6, s14, v5
    s_lshl_b32 s27, s26, 5
    v_lshrrev_b32 v13, 4, v1
    v_bfe_u32 v14, v1, 2, 2
    v_and_b32 v15, 3, v1
    v_lshrrev_b32 v16, 1, v13
    v_lshl_add_u32 v16, v16, 2, v14
    v_and_b32 v17, 1, v13
    v_lshlrev_b32 v17, 1, v17
    v_lshrrev_b32 v18, 1, v15
    v_add_u32 v17, v17, v18
    v_and_b32 v18, 1, v15
    v_lshlrev_b32 v18, 3, v18
    v_lshl_add_u32 v18, v16, 8, v18
    v_xor_b32 v19, 0, v14
    v_lshl_add_u32 v19, v19, 2, v17
    v_lshl_add_u32 v7, v19, 4, v18
    v_xor_b32 v19, 1, v14
    v_lshl_add_u32 v19, v19, 2, v17
    v_lshl_add_u32 v8, v19, 4, v18
    v_xor_b32 v19, 2, v14
    v_lshl_add_u32 v19, v19, 2, v17
    v_lshl_add_u32 v9, v19, 4, v18
    v_xor_b32 v19, 3, v14
    v_lshl_add_u32 v19, v19, 2, v17
    v_lshl_add_u32 v10, v19, 4, v18
    s_lshl_b32 s12, s4, 12
    s_mov_b32 s30, s36
    s_mul_i32 s34, s36, s27
    s_add_u32 s10, s10, s34
    s_addc_u32 s11, s11, 0
    s_mul_i32 s34, s31, s27
    s_sub_u32 s33, s27, s34
    s_mov_b32 s29, s36
    s_lshl_b32 s34, s36, 11
    s_add_u32 s8, s8, s34
    s_addc_u32 s9, s9, 0
    s_lshl_b32 s34, s31, 11
    s_sub_u32 s32, 2048, s34
    v_add_u32 v21, 0x10000, v7
    v_add_u32 v22, 0x10000, v8
    v_add_u32 v23, 0x10000, v9
    v_add_u32 v24, 0x10000, v10
    v_mov_b64 v[128:129], 0
    v_mov_b64 v[130:131], 0
    v_mov_b64 v[132:133], 0
    v_mov_b64 v[134:135], 0
    v_mov_b64 v[136:137], 0
    v_mov_b64 v[138:139], 0
    v_mov_b64 v[140:141], 0
    v_mov_b64 v[142:143], 0
    v_mov_b64 v[144:145], 0
    v_mov_b64 v[146:147], 0
    v_mov_b64 v[148:149], 0
    v_mov_b64 v[150:151], 0
    v_mov_b64 v[152:153], 0
    v_mov_b64 v[154:155], 0
    v_mov_b64 v[156:157], 0
    v_mov_b64 v[158:159], 0
    v_mov_b64 v[160:161], 0
    v_mov_b64 v[162:163], 0
    v_mov_b64 v[164:165], 0
    v_mov_b64 v[166:167], 0
    v_mov_b64 v[168:169], 0
    v_mov_b64 v[170:171], 0
    v_mov_b64 v[172:173], 0
    v_mov_b64 v[174:175], 0
    v_mov_b64 v[176:177], 0
    v_mov_b64 v[178:179], 0
    v_mov_b64 v[180:181], 0
    v_mov_b64 v[182:183], 0
    v_mov_b64 v[184:185], 0
    v_mov_b64 v[186:187], 0
    v_mov_b64 v[188:189], 0
    v_mov_b64 v[190:191], 0
    v_mov_b64 v[192:193], 0
    v_mov_b64 v[194:195], 0
    v_mov_b64 v[196:197], 0
    v_mov_b64 v[198:199], 0
    v_mov_b64 v[200:201], 0
    v_mov_b64 v[202:203], 0
    v_mov_b64 v[204:205], 0
    v_mov_b64 v[206:207], 0
    v_mov_b64 v[208:209], 0
    v_mov_b64 v[210:211], 0
    v_mov_b64 v[212:213], 0
    v_mov_b64 v[214:215], 0
    v_mov_b64 v[216:217], 0
    v_mov_b64 v[218:219], 0
    v_mov_b64 v[220:221], 0
    v_mov_b64 v[222:223], 0
    v_mov_b64 v[224:225], 0
    v_mov_b64 v[226:227], 0
    v_mov_b64 v[228:229], 0
    v_mov_b64 v[230:231], 0
    v_mov_b64 v[232:233], 0
    v_mov_b64 v[234:235], 0
    v_mov_b64 v[236:237], 0
    v_mov_b64 v[238:239], 0
    v_mov_b64 v[240:241], 0
    v_mov_b64 v[242:243], 0
    v_mov_b64 v[244:245], 0
    v_mov_b64 v[246:247], 0
    v_mov_b64 v[248:249], 0
    v_mov_b64 v[250:251], 0
    v_mov_b64 v[252:253], 0
    v_mov_b64 v[254:255], 0
    global_load_dwordx4 a[0:3], v2, s[8:9] offset:0 sc1
    global_load_dwordx4 a[4:7], v2, s[8:9] offset:1024 sc1
    s_add_u32 s29, s29, 1
    s_cmp_eq_u32 s29, s31
    s_cselect_b32 s34, s32, 2048
    s_cselect_b32 s35, -1, 0
    s_cselect_b32 s29, 0, s29
    s_add_u32 s8, s8, s34
    s_addc_u32 s9, s9, s35
    global_load_dwordx4 a[8:11], v2, s[8:9] offset:0 sc1
    global_load_dwordx4 a[12:15], v2, s[8:9] offset:1024 sc1
    s_add_u32 s29, s29, 1
    s_cmp_eq_u32 s29, s31
    s_cselect_b32 s34, s32, 2048
    s_cselect_b32 s35, -1, 0
    s_cselect_b32 s29, 0, s29
    s_add_u32 s8, s8, s34
    s_addc_u32 s9, s9, s35
    global_load_dwordx4 a[16:19], v2, s[8:9] offset:0 sc1
    global_load_dwordx4 a[20:23], v2, s[8:9] offset:1024 sc1
    s_add_u32 s29, s29, 1
    s_cmp_eq_u32 s29, s31
    s_cselect_b32 s34, s32, 2048
    s_cselect_b32 s35, -1, 0
    s_cselect_b32 s29, 0, s29
    s_add_u32 s8, s8, s34
    s_addc_u32 s9, s9, s35
    global_load_dwordx4 a[24:27], v2, s[8:9] offset:0 sc1
    global_load_dwordx4 a[28:31], v2, s[8:9] offset:1024 sc1
    s_add_u32 s29, s29, 1
    s_cmp_eq_u32 s29, s31
    s_cselect_b32 s34, s32, 2048
    s_cselect_b32 s35, -1, 0
    s_cselect_b32 s29, 0, s29
    s_add_u32 s8, s8, s34
    s_addc_u32 s9, s9, s35
    global_load_dwordx4 a[32:35], v2, s[8:9] offset:0 sc1
    global_load_dwordx4 a[36:39], v2, s[8:9] offset:1024 sc1
    s_add_u32 s29, s29, 1
    s_cmp_eq_u32 s29, s31
    s_cselect_b32 s34, s32, 2048
    s_cselect_b32 s35, -1, 0
    s_cselect_b32 s29, 0, s29
    s_add_u32 s8, s8, s34
    s_addc_u32 s9, s9, s35
    global_load_dwordx4 a[40:43], v2, s[8:9] offset:0 sc1
    global_load_dwordx4 a[44:47], v2, s[8:9] offset:1024 sc1
    s_add_u32 s29, s29, 1
    s_cmp_eq_u32 s29, s31
    s_cselect_b32 s34, s32, 2048
    s_cselect_b32 s35, -1, 0
    s_cselect_b32 s29, 0, s29
    s_add_u32 s8, s8, s34
    s_addc_u32 s9, s9, s35
    global_load_dwordx4 a[48:51], v2, s[8:9] offset:0 sc1
    global_load_dwordx4 a[52:55], v2, s[8:9] offset:1024 sc1
    s_add_u32 s29, s29, 1
    s_cmp_eq_u32 s29, s31
    s_cselect_b32 s34, s32, 2048
    s_cselect_b32 s35, -1, 0
    s_cselect_b32 s29, 0, s29
    s_add_u32 s8, s8, s34
    s_addc_u32 s9, s9, s35
    s_add_u32 m0, s12, 0
    s_nop 0
    global_load_lds_dwordx4 v3, s[10:11]
    s_add_u32 m0, s12, 1024
    s_nop 0
    global_load_lds_dwordx4 v4, s[10:11]
    s_add_u32 m0, s12, 2048
    s_nop 0
    global_load_lds_dwordx4 v5, s[10:11]
    s_add_u32 m0, s12, 3072
    s_nop 0
    global_load_lds_dwordx4 v6, s[10:11]
    s_add_u32 s30, s30, 1
    s_cmp_eq_u32 s30, s31
    s_cselect_b32 s34, s33, s27
    s_cselect_b32 s35, -1, 0
    s_cselect_b32 s30, 0, s30
    s_add_u32 s10, s10, s34
    s_addc_u32 s11, s11, s35
    s_add_u32 m0, s12, 16384
    s_nop 0
    global_load_lds_dwordx4 v3, s[10:11]
    s_add_u32 m0, s12, 17408
    s_nop 0
    global_load_lds_dwordx4 v4, s[10:11]
    s_add_u32 m0, s12, 18432
    s_nop 0
    global_load_lds_dwordx4 v5, s[10:11]
    s_add_u32 m0, s12, 19456
    s_nop 0
    global_load_lds_dwordx4 v6, s[10:11]
    s_add_u32 s30, s30, 1
    s_cmp_eq_u32 s30, s31
    s_cselect_b32 s34, s33, s27
    s_cselect_b32 s35, -1, 0
    s_cselect_b32 s30, 0, s30
    s_add_u32 s10, s10, s34
    s_addc_u32 s11, s11, s35
    s_add_u32 m0, s12, 32768
    s_nop 0
    global_load_lds_dwordx4 v3, s[10:11]
    s_add_u32 m0, s12, 33792
    s_nop 0
    global_load_lds_dwordx4 v4, s[10:11]
    s_add_u32 m0, s12, 34816
    s_nop 0
    global_load_lds_dwordx4 v5, s[10:11]
    s_add_u32 m0, s12, 35840
    s_nop 0
    global_load_lds_dwordx4 v6, s[10:11]
    s_add_u32 s30, s30, 1
    s_cmp_eq_u32 s30, s31
    s_cselect_b32 s34, s33, s27
    s_cselect_b32 s35, -1, 0
    s_cselect_b32 s30, 0, s30
    s_add_u32 s10, s10, s34
    s_addc_u32 s11, s11, s35
    s_add_u32 m0, s12, 49152
    s_nop 0
    global_load_lds_dwordx4 v3, s[10:11]
    s_add_u32 m0, s12, 50176
    s_nop 0
    global_load_lds_dwordx4 v4, s[10:11]
    s_add_u32 m0, s12, 51200
    s_nop 0
    global_load_lds_dwordx4 v5, s[10:11]
    s_add_u32 m0, s12, 52224
    s_nop 0
    global_load_lds_dwordx4 v6, s[10:11]
    s_add_u32 s30, s30, 1
    s_cmp_eq_u32 s30, s31
    s_cselect_b32 s34, s33, s27
    s_cselect_b32 s35, -1, 0
    s_cselect_b32 s30, 0, s30
    s_add_u32 s10, s10, s34
    s_addc_u32 s11, s11, s35
    s_add_u32 m0, s12, 65536
    s_nop 0
    global_load_lds_dwordx4 v3, s[10:11]
    s_add_u32 m0, s12, 66560
    s_nop 0
    global_load_lds_dwordx4 v4, s[10:11]
    s_add_u32 m0, s12, 67584
    s_nop 0
    global_load_lds_dwordx4 v5, s[10:11]
    s_add_u32 m0, s12, 68608
    s_nop 0
    global_load_lds_dwordx4 v6, s[10:11]
    s_add_u32 s30, s30, 1
    s_cmp_eq_u32 s30, s31
    s_cselect_b32 s34, s33, s27
    s_cselect_b32 s35, -1, 0
    s_cselect_b32 s30, 0, s30
    s_add_u32 s10, s10, s34
    s_addc_u32 s11, s11, s35
    s_add_u32 m0, s12, 81920
    s_nop 0
    global_load_lds_dwordx4 v3, s[10:11]
    s_add_u32 m0, s12, 82944
    s_nop 0
    global_load_lds_dwordx4 v4, s[10:11]
    s_add_u32 m0, s12, 83968
    s_nop 0
    global_load_lds_dwordx4 v5, s[10:11]
    s_add_u32 m0, s12, 84992
    s_nop 0
    global_load_lds_dwordx4 v6, s[10:11]
    s_add_u32 s30, s30, 1
    s_cmp_eq_u32 s30, s31
    s_cselect_b32 s34, s33, s27
    s_cselect_b32 s35, -1, 0
    s_cselect_b32 s30, 0, s30
    s_add_u32 s10, s10, s34
    s_addc_u32 s11, s11, s35
    s_add_u32 m0, s12, 98304
    s_nop 0
    global_load_lds_dwordx4 v3, s[10:11]
    s_add_u32 m0, s12, 99328
    s_nop 0
    global_load_lds_dwordx4 v4, s[10:11]
    s_add_u32 m0, s12, 100352
    s_nop 0
    global_load_lds_dwordx4 v5, s[10:11]
    s_add_u32 m0, s12, 101376
    s_nop 0
    global_load_lds_dwordx4 v6, s[10:11]
    s_add_u32 s30, s30, 1
    s_cmp_eq_u32 s30, s31
    s_cselect_b32 s34, s33, s27
    s_cselect_b32 s35, -1, 0
    s_cselect_b32 s30, 0, s30
    s_add_u32 s10, s10, s34
    s_addc_u32 s11, s11, s35
    s_waitcnt vmcnt(24)
    s_barrier
    ds_read_b64_tr_b16 v[60:61], v7 offset:0
    ds_read_b64_tr_b16 v[62:63], v7 offset:2048
    ds_read_b64_tr_b16 v[64:65], v8 offset:0
    ds_read_b64_tr_b16 v[66:67], v8 offset:2048
    ds_read_b64_tr_b16 v[68:69], v9 offset:0
    ds_read_b64_tr_b16 v[70:71], v9 offset:2048
    ds_read_b64_tr_b16 v[72:73], v10 offset:0
    ds_read_b64_tr_b16 v[74:75], v10 offset:2048
    ds_read_b64_tr_b16 v[76:77], v7 offset:8192
    ds_read_b64_tr_b16 v[78:79], v7 offset:10240
    ds_read_b64_tr_b16 v[80:81], v8 offset:8192
    ds_read_b64_tr_b16 v[82:83], v8 offset:10240
    ds_read_b64_tr_b16 v[84:85], v9 offset:8192
    ds_read_b64_tr_b16 v[86:87], v9 offset:10240
    ds_read_b64_tr_b16 v[88:89], v10 offset:8192
    ds_read_b64_tr_b16 v[90:91], v10 offset:10240
    s_mov_b32 s13, s28
gl_166:
    s_waitcnt lgkmcnt(14)
    v_mfma_f32_32x32x16_bf16 v[128:143], v[60:63], a[0:3], v[128:143]
    ds_read_b64_tr_b16 v[92:93], v7 offset:4096
    ds_read_b64_tr_b16 v[94:95], v7 offset:6144
    s_waitcnt lgkmcnt(14)
    v_mfma_f32_32x32x16_bf16 v[144:159], v[64:67], a[0:3], v[144:159]
    ds_read_b64_tr_b16 v[96:97], v8 offset:4096
    ds_read_b64_tr_b16 v[98:99], v8 offset:6144
    s_waitcnt lgkmcnt(14)
    v_mfma_f32_32x32x16_bf16 v[160:175], v[68:71], a[0:3], v[160:175]
    ds_read_b64_tr_b16 v[100:101], v9 offset:4096
    ds_read_b64_tr_b16 v[102:103], v9 offset:6144
    s_waitcnt lgkmcnt(14)
    v_mfma_f32_32x32x16_bf16 v[176:191], v[72:75], a[0:3], v[176:191]
    ds_read_b64_tr_b16 v[104:105], v10 offset:4096
    ds_read_b64_tr_b16 v[106:107], v10 offset:6144
    s_waitcnt lgkmcnt(14)
    v_mfma_f32_32x32x16_bf16 v[192:207], v[76:79], a[0:3], v[192:207]
    ds_read_b64_tr_b16 v[108:109], v7 offset:12288
    ds_read_b64_tr_b16 v[110:111], v7 offset:14336
    s_waitcnt lgkmcnt(14)
    v_mfma_f32_32x32x16_bf16 v[208:223], v[80:83], a[0:3], v[208:223]
    ds_read_b64_tr_b16 v[112:113], v8 offset:12288
    ds_read_b64_tr_b16 v[114:115], v8 offset:14336
    s_waitcnt lgkmcnt(14)
    v_mfma_f32_32x32x16_bf16 v[224:239], v[84:87], a[0:3], v[224:239]
    ds_read_b64_tr_b16 v[116:117], v9 offset:12288
    ds_read_b64_tr_b16 v[118:119], v9 offset:14336
    s_waitcnt lgkmcnt(14)
    v_mfma_f32_32x32x16_bf16 v[240:255], v[88:91], a[0:3], v[240:255]
    ds_read_b64_tr_b16 v[120:121], v10 offset:12288
    ds_read_b64_tr_b16 v[122:123], v10 offset:14336
    s_waitcnt vmcnt(20)
    s_barrier
    s_waitcnt lgkmcnt(14)
    v_mfma_f32_32x32x16_bf16 v[128:143], v[92:95], a[4:7], v[128:143]
    ds_read_b64_tr_b16 v[60:61], v7 offset:16384
    ds_read_b64_tr_b16 v[62:63], v7 offset:18432
    global_load_dwordx4 a[56:59], v2, s[8:9] offset:0 sc1
    s_waitcnt lgkmcnt(14)
    v_mfma_f32_32x32x16_bf16 v[144:159], v[96:99], a[4:7], v[144:159]
    ds_read_b64_tr_b16 v[64:65], v8 offset:16384
    ds_read_b64_tr_b16 v[66:67], v8 offset:18432
    global_load_dwordx4 a[60:63], v2, s[8:9] offset:1024 sc1
    s_add_u32 s29, s29, 1
    s_cmp_eq_u32 s29, s31
    s_cselect_b32 s34, s32, 2048
    s_cselect_b32 s35, -1, 0
    s_cselect_b32 s29, 0, s29
    s_add_u32 s8, s8, s34
    s_addc_u32 s9, s9, s35
    s_waitcnt lgkmcnt(14)
    v_mfma_f32_32x32x16_bf16 v[160:175], v[100:103], a[4:7], v[160:175]
    ds_read_b64_tr_b16 v[68:69], v9 offset:16384
    ds_read_b64_tr_b16 v[70:71], v9 offset:18432
    s_add_u32 m0, s12, 114688
    s_nop 0
    global_load_lds_dwordx4 v3, s[10:11]
    s_waitcnt lgkmcnt(14)
    v_mfma_f32_32x32x16_bf16 v[176:191], v[104:107], a[4:7], v[176:191]
    ds_read_b64_tr_b16 v[72:73], v10 offset:16384
    ds_read_b64_tr_b16 v[74:75], v10 offset:18432
    s_add_u32 m0, s12, 115712
    s_nop 0
    global_load_lds_dwordx4 v4, s[10:11]
    s_waitcnt lgkmcnt(14)
    v_mfma_f32_32x32x16_bf16 v[192:207], v[108:111], a[4:7], v[192:207]
    ds_read_b64_tr_b16 v[76:77], v7 offset:24576
    ds_read_b64_tr_b16 v[78:79], v7 offset:26624
    s_add_u32 m0, s12, 116736
    s_nop 0
    global_load_lds_dwordx4 v5, s[10:11]
    s_waitcnt lgkmcnt(14)
    v_mfma_f32_32x32x16_bf16 v[208:223], v[112:115], a[4:7], v[208:223]
    ds_read_b64_tr_b16 v[80:81], v8 offset:24576
    ds_read_b64_tr_b16 v[82:83], v8 offset:26624
    s_add_u32 m0, s12, 117760
    s_nop 0
    global_load_lds_dwordx4 v6, s[10:11]
    s_add_u32 s30, s30, 1
    s_cmp_eq_u32 s30, s31
    s_cselect_b32 s34, s33, s27
    s_cselect_b32 s35, -1, 0
    s_cselect_b32 s30, 0, s30
    s_add_u32 s10, s10, s34
    s_addc_u32 s11, s11, s35
    s_waitcnt lgkmcnt(14)
    v_mfma_f32_32x32x16_bf16 v[224:239], v[116:119], a[4:7], v[224:239]
    ds_read_b64_tr_b16 v[84:85], v9 offset:24576
    ds_read_b64_tr_b16 v[86:87], v9 offset:26624
    s_waitcnt lgkmcnt(14)
    v_mfma_f32_32x32x16_bf16 v[240:255], v[120:123], a[4:7], v[240:255]
    ds_read_b64_tr_b16 v[88:89], v10 offset:24576
    ds_read_b64_tr_b16 v[90:91], v10 offset:26624
    s_waitcnt lgkmcnt(14)
    v_mfma_f32_32x32x16_bf16 v[128:143], v[60:63], a[8:11], v[128:143]
    ds_read_b64_tr_b16 v[92:93], v7 offset:20480
    ds_read_b64_tr_b16 v[94:95], v7 offset:22528
    s_waitcnt lgkmcnt(14)
    v_mfma_f32_32x32x16_bf16 v[144:159], v[64:67], a[8:11], v[144:159]
    ds_read_b64_tr_b16 v[96:97], v8 offset:20480
    ds_read_b64_tr_b16 v[98:99], v8 offset:22528
    s_waitcnt lgkmcnt(14)
    v_mfma_f32_32x32x16_bf16 v[160:175], v[68:71], a[8:11], v[160:175]
    ds_read_b64_tr_b16 v[100:101], v9 offset:20480
    ds_read_b64_tr_b16 v[102:103], v9 offset:22528
    s_waitcnt lgkmcnt(14)
    v_mfma_f32_32x32x16_bf16 v[176:191], v[72:75], a[8:11], v[176:191]
    ds_read_b64_tr_b16 v[104:105], v10 offset:20480
    ds_read_b64_tr_b16 v[106:107], v10 offset:22528
    s_waitcnt lgkmcnt(14)
    v_mfma_f32_32x32x16_bf16 v[192:207], v[76:79], a[8:11], v[192:207]
    ds_read_b64_tr_b16 v[108:109], v7 offset:28672
    ds_read_b64_tr_b16 v[110:111], v7 offset:30720
    s_waitcnt lgkmcnt(14)
    v_mfma_f32_32x32x16_bf16 v[208:223], v[80:83], a[8:11], v[208:223]
    ds_read_b64_tr_b16 v[112:113], v8 offset:28672
    ds_read_b64_tr_b16 v[114:115], v8 offset:30720
    s_waitcnt lgkmcnt(14)
    v_mfma_f32_32x32x16_bf16 v[224:239], v[84:87], a[8:11], v[224:239]
    ds_read_b64_tr_b16 v[116:117], v9 offset:28672
    ds_read_b64_tr_b16 v[118:119], v9 offset:30720
    s_waitcnt lgkmcnt(14)
    v_mfma_f32_32x32x16_bf16 v[240:255], v[88:91], a[8:11], v[240:255]
    ds_read_b64_tr_b16 v[120:121], v10 offset:28672
    ds_read_b64_tr_b16 v[122:123], v10 offset:30720
    s_waitcnt vmcnt(22)
    s_barrier
    s_waitcnt lgkmcnt(14)
    v_mfma_f32_32x32x16_bf16 v[128:143], v[92:95], a[12:15], v[128:143]
    ds_read_b64_tr_b16 v[60:61], v7 offset:32768
    ds_read_b64_tr_b16 v[62:63], v7 offset:34816
    global_load_dwordx4 a[0:3], v2, s[8:9] offset:0 sc1
    s_waitcnt lgkmcnt(14)
    v_mfma_f32_32x32x16_bf16 v[144:159], v[96:99], a[12:15], v[144:159]
    ds_read_b64_tr_b16 v[64:65], v8 offset:32768
    ds_read_b64_tr_b16 v[66:67], v8 offset:34816
    global_load_dwordx4 a[4:7], v2, s[8:9] offset:1024 sc1
    s_add_u32 s29, s29, 1
    s_cmp_eq_u32 s29, s31
    s_cselect_b32 s34, s32, 2048
    s_cselect_b32 s35, -1, 0
    s_cselect_b32 s29, 0, s29
    s_add_u32 s8, s8, s34
    s_addc_u32 s9, s9, s35
    s_waitcnt lgkmcnt(14)
    v_mfma_f32_32x32x16_bf16 v[160:175], v[100:103], a[12:15], v[160:175]
    ds_read_b64_tr_b16 v[68:69], v9 offset:32768
    ds_read_b64_tr_b16 v[70:71], v9 offset:34816
    s_add_u32 m0, s12, 0
    s_nop 0
    global_load_lds_dwordx4 v3, s[10:11]
    s_waitcnt lgkmcnt(14)
    v_mfma_f32_32x32x16_bf16 v[176:191], v[104:107], a[12:15], v[176:191]
    ds_read_b64_tr_b16 v[72:73], v10 offset:32768
    ds_read_b64_tr_b16 v[74:75], v10 offset:34816
    s_add_u32 m0, s12, 1024
    s_nop 0
    global_load_lds_dwordx4 v4, s[10:11]
    s_waitcnt lgkmcnt(14)
    v_mfma_f32_32x32x16_bf16 v[192:207], v[108:111], a[12:15], v[192:207]
    ds_read_b64_tr_b16 v[76:77], v7 offset:40960
    ds_read_b64_tr_b16 v[78:79], v7 offset:43008
    s_add_u32 m0, s12, 2048
    s_nop 0
    global_load_lds_dwordx4 v5, s[10:11]
    s_waitcnt lgkmcnt(14)
    v_mfma_f32_32x32x16_bf16 v[208:223], v[112:115], a[12:15], v[208:223]
    ds_read_b64_tr_b16 v[80:81], v8 offset:40960
    ds_read_b64_tr_b16 v[82:83], v8 offset:43008
    s_add_u32 m0, s12, 3072
    s_nop 0
    global_load_lds_dwordx4 v6, s[10:11]
    s_add_u32 s30, s30, 1
    s_cmp_eq_u32 s30, s31
    s_cselect_b32 s34, s33, s27
    s_cselect_b32 s35, -1, 0
    s_cselect_b32 s30, 0, s30
    s_add_u32 s10, s10, s34
    s_addc_u32 s11, s11, s35
    s_waitcnt lgkmcnt(14)
    v_mfma_f32_32x32x16_bf16 v[224:239], v[116:119], a[12:15], v[224:239]
    ds_read_b64_tr_b16 v[84:85], v9 offset:40960
    ds_read_b64_tr_b16 v[86:87], v9 offset:43008
    s_waitcnt lgkmcnt(14)
    v_mfma_f32_32x32x16_bf16 v[240:255], v[120:123], a[12:15], v[240:255]
    ds_read_b64_tr_b16 v[88:89], v10 offset:40960
    ds_read_b64_tr_b16 v[90:91], v10 offset:43008
    s_waitcnt lgkmcnt(14)
    v_mfma_f32_32x32x16_bf16 v[128:143], v[60:63], a[16:19], v[128:143]
    ds_read_b64_tr_b16 v[92:93], v7 offset:36864
    ds_read_b64_tr_b16 v[94:95], v7 offset:38912
    s_waitcnt lgkmcnt(14)
    v_mfma_f32_32x32x16_bf16 v[144:159], v[64:67], a[16:19], v[144:159]
    ds_read_b64_tr_b16 v[96:97], v8 offset:36864
    ds_read_b64_tr_b16 v[98:99], v8 offset:38912
    s_waitcnt lgkmcnt(14)
    v_mfma_f32_32x32x16_bf16 v[160:175], v[68:71], a[16:19], v[160:175]
    ds_read_b64_tr_b16 v[100:101], v9 offset:36864
    ds_read_b64_tr_b16 v[102:103], v9 offset:38912
    s_waitcnt lgkmcnt(14)
    v_mfma_f32_32x32x16_bf16 v[176:191], v[72:75], a[16:19], v[176:191]
    ds_read_b64_tr_b16 v[104:105], v10 offset:36864
    ds_read_b64_tr_b16 v[106:107], v10 offset:38912
    s_waitcnt lgkmcnt(14)
    v_mfma_f32_32x32x16_bf16 v[192:207], v[76:79], a[16:19], v[192:207]
    ds_read_b64_tr_b16 v[108:109], v7 offset:45056
    ds_read_b64_tr_b16 v[110:111], v7 offset:47104
    s_waitcnt lgkmcnt(14)
    v_mfma_f32_32x32x16_bf16 v[208:223], v[80:83], a[16:19], v[208:223]
    ds_read_b64_tr_b16 v[112:113], v8 offset:45056
    ds_read_b64_tr_b16 v[114:115], v8 offset:47104
    s_waitcnt lgkmcnt(14)
    v_mfma_f32_32x32x16_bf16 v[224:239], v[84:87], a[16:19], v[224:239]
    ds_read_b64_tr_b16 v[116:117], v9 offset:45056
    ds_read_b64_tr_b16 v[118:119], v9 offset:47104
    s_waitcnt lgkmcnt(14)
    v_mfma_f32_32x32x16_bf16 v[240:255], v[88:91], a[16:19], v[240:255]
    ds_read_b64_tr_b16 v[120:121], v10 offset:45056
    ds_read_b64_tr_b16 v[122:123], v10 offset:47104
    s_waitcnt vmcnt(24)
    s_barrier
    s_waitcnt lgkmcnt(14)
    v_mfma_f32_32x32x16_bf16 v[128:143], v[92:95], a[20:23], v[128:143]
    ds_read_b64_tr_b16 v[60:61], v7 offset:49152
    ds_read_b64_tr_b16 v[62:63], v7 offset:51200
    global_load_dwordx4 a[8:11], v2, s[8:9] offset:0 sc1
    s_waitcnt lgkmcnt(14)
    v_mfma_f32_32x32x16_bf16 v[144:159], v[96:99], a[20:23], v[144:159]
    ds_read_b64_tr_b16 v[64:65], v8 offset:49152
    ds_read_b64_tr_b16 v[66:67], v8 offset:51200
    global_load_dwordx4 a[12:15], v2, s[8:9] offset:1024 sc1
    s_add_u32 s29, s29, 1
    s_cmp_eq_u32 s29, s31
    s_cselect_b32 s34, s32, 2048
    s_cselect_b32 s35, -1, 0
    s_cselect_b32 s29, 0, s29
    s_add_u32 s8, s8, s34
    s_addc_u32 s9, s9, s35
    s_waitcnt lgkmcnt(14)
    v_mfma_f32_32x32x16_bf16 v[160:175], v[100:103], a[20:23], v[160:175]
    ds_read_b64_tr_b16 v[68:69], v9 offset:49152
    ds_read_b64_tr_b16 v[70:71], v9 offset:51200
    s_add_u32 m0, s12, 16384
    s_nop 0
    global_load_lds_dwordx4 v3, s[10:11]
    s_waitcnt lgkmcnt(14)
    v_mfma_f32_32x32x16_bf16 v[176:191], v[104:107], a[20:23], v[176:191]
    ds_read_b64_tr_b16 v[72:73], v10 offset:49152
    ds_read_b64_tr_b16 v[74:75], v10 offset:51200
    s_add_u32 m0, s12, 17408
    s_nop 0
    global_load_lds_dwordx4 v4, s[10:11]
    s_waitcnt lgkmcnt(14)
    v_mfma_f32_32x32x16_bf16 v[192:207], v[108:111], a[20:23], v[192:207]
    ds_read_b64_tr_b16 v[76:77], v7 offset:57344
    ds_read_b64_tr_b16 v[78:79], v7 offset:59392
    s_add_u32 m0, s12, 18432
    s_nop 0
    global_load_lds_dwordx4 v5, s[10:11]
    s_waitcnt lgkmcnt(14)
    v_mfma_f32_32x32x16_bf16 v[208:223], v[112:115], a[20:23], v[208:223]
    ds_read_b64_tr_b16 v[80:81], v8 offset:57344
    ds_read_b64_tr_b16 v[82:83], v8 offset:59392
    s_add_u32 m0, s12, 19456
    s_nop 0
    global_load_lds_dwordx4 v6, s[10:11]
    s_add_u32 s30, s30, 1
    s_cmp_eq_u32 s30, s31
    s_cselect_b32 s34, s33, s27
    s_cselect_b32 s35, -1, 0
    s_cselect_b32 s30, 0, s30
    s_add_u32 s10, s10, s34
    s_addc_u32 s11, s11, s35
    s_waitcnt lgkmcnt(14)
    v_mfma_f32_32x32x16_bf16 v[224:239], v[116:119], a[20:23], v[224:239]
    ds_read_b64_tr_b16 v[84:85], v9 offset:57344
    ds_read_b64_tr_b16 v[86:87], v9 offset:59392
    s_waitcnt lgkmcnt(14)
    v_mfma_f32_32x32x16_bf16 v[240:255], v[120:123], a[20:23], v[240:255]
    ds_read_b64_tr_b16 v[88:89], v10 offset:57344
    ds_read_b64_tr_b16 v[90:91], v10 offset:59392
    s_waitcnt lgkmcnt(14)
    v_mfma_f32_32x32x16_bf16 v[128:143], v[60:63], a[24:27], v[128:143]
    ds_read_b64_tr_b16 v[92:93], v7 offset:53248
    ds_read_b64_tr_b16 v[94:95], v7 offset:55296
    s_waitcnt lgkmcnt(14)
    v_mfma_f32_32x32x16_bf16 v[144:159], v[64:67], a[24:27], v[144:159]
    ds_read_b64_tr_b16 v[96:97], v8 offset:53248
    ds_read_b64_tr_b16 v[98:99], v8 offset:55296
    s_waitcnt lgkmcnt(14)
    v_mfma_f32_32x32x16_bf16 v[160:175], v[68:71], a[24:27], v[160:175]
    ds_read_b64_tr_b16 v[100:101], v9 offset:53248
    ds_read_b64_tr_b16 v[102:103], v9 offset:55296
    s_waitcnt lgkmcnt(14)
    v_mfma_f32_32x32x16_bf16 v[176:191], v[72:75], a[24:27], v[176:191]
    ds_read_b64_tr_b16 v[104:105], v10 offset:53248
    ds_read_b64_tr_b16 v[106:107], v10 offset:55296
    s_waitcnt lgkmcnt(14)
    v_mfma_f32_32x32x16_bf16 v[192:207], v[76:79], a[24:27], v[192:207]
    ds_read_b64_tr_b16 v[108:109], v7 offset:61440
    ds_read_b64_tr_b16 v[110:111], v7 offset:63488
    s_waitcnt lgkmcnt(14)
    v_mfma_f32_32x32x16_bf16 v[208:223], v[80:83], a[24:27], v[208:223]
    ds_read_b64_tr_b16 v[112:113], v8 offset:61440
    ds_read_b64_tr_b16 v[114:115], v8 offset:63488
    s_waitcnt lgkmcnt(14)
    v_mfma_f32_32x32x16_bf16 v[224:239], v[84:87], a[24:27], v[224:239]
    ds_read_b64_tr_b16 v[116:117], v9 offset:61440
    ds_read_b64_tr_b16 v[118:119], v9 offset:63488
    s_waitcnt lgkmcnt(14)
    v_mfma_f32_32x32x16_bf16 v[240:255], v[88:91], a[24:27], v[240:255]
    ds_read_b64_tr_b16 v[120:121], v10 offset:61440
    ds_read_b64_tr_b16 v[122:123], v10 offset:63488
    s_waitcnt vmcnt(26)
    s_barrier
    s_waitcnt lgkmcnt(14)
    v_mfma_f32_32x32x16_bf16 v[128:143], v[92:95], a[28:31], v[128:143]
    ds_read_b64_tr_b16 v[60:61], v21 offset:0
    ds_read_b64_tr_b16 v[62:63], v21 offset:2048
    global_load_dwordx4 a[16:19], v2, s[8:9] offset:0 sc1
    s_waitcnt lgkmcnt(14)
    v_mfma_f32_32x32x16_bf16 v[144:159], v[96:99], a[28:31], v[144:159]
    ds_read_b64_tr_b16 v[64:65], v22 offset:0
    ds_read_b64_tr_b16 v[66:67], v22 offset:2048
    global_load_dwordx4 a[20:23], v2, s[8:9] offset:1024 sc1
    s_add_u32 s29, s29, 1
    s_cmp_eq_u32 s29, s31
    s_cselect_b32 s34, s32, 2048
    s_cselect_b32 s35, -1, 0
    s_cselect_b32 s29, 0, s29
    s_add_u32 s8, s8, s34
    s_addc_u32 s9, s9, s35
    s_waitcnt lgkmcnt(14)
    v_mfma_f32_32x32x16_bf16 v[160:175], v[100:103], a[28:31], v[160:175]
    ds_read_b64_tr_b16 v[68:69], v23 offset:0
    ds_read_b64_tr_b16 v[70:71], v23 offset:2048
    s_add_u32 m0, s12, 32768
    s_nop 0
    global_load_lds_dwordx4 v3, s[10:11]
    s_waitcnt lgkmcnt(14)
    v_mfma_f32_32x32x16_bf16 v[176:191], v[104:107], a[28:31], v[176:191]
    ds_read_b64_tr_b16 v[72:73], v24 offset:0
    ds_read_b64_tr_b16 v[74:75], v24 offset:2048
    s_add_u32 m0, s12, 33792
    s_nop 0
    global_load_lds_dwordx4 v4, s[10:11]
    s_waitcnt lgkmcnt(14)
    v_mfma_f32_32x32x16_bf16 v[192:207], v[108:111], a[28:31], v[192:207]
    ds_read_b64_tr_b16 v[76:77], v21 offset:8192
    ds_read_b64_tr_b16 v[78:79], v21 offset:10240
    s_add_u32 m0, s12, 34816
    s_nop 0
    global_load_lds_dwordx4 v5, s[10:11]
    s_waitcnt lgkmcnt(14)
    v_mfma_f32_32x32x16_bf16 v[208:223], v[112:115], a[28:31], v[208:223]
    ds_read_b64_tr_b16 v[80:81], v22 offset:8192
    ds_read_b64_tr_b16 v[82:83], v22 offset:10240
    s_add_u32 m0, s12, 35840
    s_nop 0
    global_load_lds_dwordx4 v6, s[10:11]
    s_add_u32 s30, s30, 1
    s_cmp_eq_u32 s30, s31
    s_cselect_b32 s34, s33, s27
    s_cselect_b32 s35, -1, 0
    s_cselect_b32 s30, 0, s30
    s_add_u32 s10, s10, s34
    s_addc_u32 s11, s11, s35
    s_waitcnt lgkmcnt(14)
    v_mfma_f32_32x32x16_bf16 v[224:239], v[116:119], a[28:31], v[224:239]
    ds_read_b64_tr_b16 v[84:85], v23 offset:8192
    ds_read_b64_tr_b16 v[86:87], v23 offset:10240
    s_waitcnt lgkmcnt(14)
    v_mfma_f32_32x32x16_bf16 v[240:255], v[120:123], a[28:31], v[240:255]
    ds_read_b64_tr_b16 v[88:89], v24 offset:8192
    ds_read_b64_tr_b16 v[90:91], v24 offset:10240
    s_waitcnt lgkmcnt(14)
    v_mfma_f32_32x32x16_bf16 v[128:143], v[60:63], a[32:35], v[128:143]
    ds_read_b64_tr_b16 v[92:93], v21 offset:4096
    ds_read_b64_tr_b16 v[94:95], v21 offset:6144
    s_waitcnt lgkmcnt(14)
    v_mfma_f32_32x32x16_bf16 v[144:159], v[64:67], a[32:35], v[144:159]
    ds_read_b64_tr_b16 v[96:97], v22 offset:4096
    ds_read_b64_tr_b16 v[98:99], v22 offset:6144
    s_waitcnt lgkmcnt(14)
    v_mfma_f32_32x32x16_bf16 v[160:175], v[68:71], a[32:35], v[160:175]
    ds_read_b64_tr_b16 v[100:101], v23 offset:4096
    ds_read_b64_tr_b16 v[102:103], v23 offset:6144
    s_waitcnt lgkmcnt(14)
    v_mfma_f32_32x32x16_bf16 v[176:191], v[72:75], a[32:35], v[176:191]
    ds_read_b64_tr_b16 v[104:105], v24 offset:4096
    ds_read_b64_tr_b16 v[106:107], v24 offset:6144
    s_waitcnt lgkmcnt(14)
    v_mfma_f32_32x32x16_bf16 v[192:207], v[76:79], a[32:35], v[192:207]
    ds_read_b64_tr_b16 v[108:109], v21 offset:12288
    ds_read_b64_tr_b16 v[110:111], v21 offset:14336
    s_waitcnt lgkmcnt(14)
    v_mfma_f32_32x32x16_bf16 v[208:223], v[80:83], a[32:35], v[208:223]
    ds_read_b64_tr_b16 v[112:113], v22 offset:12288
    ds_read_b64_tr_b16 v[114:115], v22 offset:14336
    s_waitcnt lgkmcnt(14)
    v_mfma_f32_32x32x16_bf16 v[224:239], v[84:87], a[32:35], v[224:239]
    ds_read_b64_tr_b16 v[116:117], v23 offset:12288
    ds_read_b64_tr_b16 v[118:119], v23 offset:14336
    s_waitcnt lgkmcnt(14)
    v_mfma_f32_32x32x16_bf16 v[240:255], v[88:91], a[32:35], v[240:255]
    ds_read_b64_tr_b16 v[120:121], v24 offset:12288
    ds_read_b64_tr_b16 v[122:123], v24 offset:14336
    s_waitcnt vmcnt(28)
    s_barrier
    s_waitcnt lgkmcnt(14)
    v_mfma_f32_32x32x16_bf16 v[128:143], v[92:95], a[36:39], v[128:143]
    ds_read_b64_tr_b16 v[60:61], v21 offset:16384
    ds_read_b64_tr_b16 v[62:63], v21 offset:18432
    global_load_dwordx4 a[24:27], v2, s[8:9] offset:0 sc1
    s_waitcnt lgkmcnt(14)
    v_mfma_f32_32x32x16_bf16 v[144:159], v[96:99], a[36:39], v[144:159]
    ds_read_b64_tr_b16 v[64:65], v22 offset:16384
    ds_read_b64_tr_b16 v[66:67], v22 offset:18432
    global_load_dwordx4 a[28:31], v2, s[8:9] offset:1024 sc1
    s_add_u32 s29, s29, 1
    s_cmp_eq_u32 s29, s31
    s_cselect_b32 s34, s32, 2048
    s_cselect_b32 s35, -1, 0
    s_cselect_b32 s29, 0, s29
    s_add_u32 s8, s8, s34
    s_addc_u32 s9, s9, s35
    s_waitcnt lgkmcnt(14)
    v_mfma_f32_32x32x16_bf16 v[160:175], v[100:103], a[36:39], v[160:175]
    ds_read_b64_tr_b16 v[68:69], v23 offset:16384
    ds_read_b64_tr_b16 v[70:71], v23 offset:18432
    s_add_u32 m0, s12, 49152
    s_nop 0
    global_load_lds_dwordx4 v3, s[10:11]
    s_waitcnt lgkmcnt(14)
    v_mfma_f32_32x32x16_bf16 v[176:191], v[104:107], a[36:39], v[176:191]
    ds_read_b64_tr_b16 v[72:73], v24 offset:16384
    ds_read_b64_tr_b16 v[74:75], v24 offset:18432
    s_add_u32 m0, s12, 50176
    s_nop 0
    global_load_lds_dwordx4 v4, s[10:11]
    s_waitcnt lgkmcnt(14)
    v_mfma_f32_32x32x16_bf16 v[192:207], v[108:111], a[36:39], v[192:207]
    ds_read_b64_tr_b16 v[76:77], v21 offset:24576
    ds_read_b64_tr_b16 v[78:79], v21 offset:26624
    s_add_u32 m0, s12, 51200
    s_nop 0
    global_load_lds_dwordx4 v5, s[10:11]
    s_waitcnt lgkmcnt(14)
    v_mfma_f32_32x32x16_bf16 v[208:223], v[112:115], a[36:39], v[208:223]
    ds_read_b64_tr_b16 v[80:81], v22 offset:24576
    ds_read_b64_tr_b16 v[82:83], v22 offset:26624
    s_add_u32 m0, s12, 52224
    s_nop 0
    global_load_lds_dwordx4 v6, s[10:11]
    s_add_u32 s30, s30, 1
    s_cmp_eq_u32 s30, s31
    s_cselect_b32 s34, s33, s27
    s_cselect_b32 s35, -1, 0
    s_cselect_b32 s30, 0, s30
    s_add_u32 s10, s10, s34
    s_addc_u32 s11, s11, s35
    s_waitcnt lgkmcnt(14)
    v_mfma_f32_32x32x16_bf16 v[224:239], v[116:119], a[36:39], v[224:239]
    ds_read_b64_tr_b16 v[84:85], v23 offset:24576
    ds_read_b64_tr_b16 v[86:87], v23 offset:26624
    s_waitcnt lgkmcnt(14)
    v_mfma_f32_32x32x16_bf16 v[240:255], v[120:123], a[36:39], v[240:255]
    ds_read_b64_tr_b16 v[88:89], v24 offset:24576
    ds_read_b64_tr_b16 v[90:91], v24 offset:26624
    s_waitcnt lgkmcnt(14)
    v_mfma_f32_32x32x16_bf16 v[128:143], v[60:63], a[40:43], v[128:143]
    ds_read_b64_tr_b16 v[92:93], v21 offset:20480
    ds_read_b64_tr_b16 v[94:95], v21 offset:22528
    s_waitcnt lgkmcnt(14)
    v_mfma_f32_32x32x16_bf16 v[144:159], v[64:67], a[40:43], v[144:159]
    ds_read_b64_tr_b16 v[96:97], v22 offset:20480
    ds_read_b64_tr_b16 v[98:99], v22 offset:22528
    s_waitcnt lgkmcnt(14)
    v_mfma_f32_32x32x16_bf16 v[160:175], v[68:71], a[40:43], v[160:175]
    ds_read_b64_tr_b16 v[100:101], v23 offset:20480
    ds_read_b64_tr_b16 v[102:103], v23 offset:22528
    s_waitcnt lgkmcnt(14)
    v_mfma_f32_32x32x16_bf16 v[176:191], v[72:75], a[40:43], v[176:191]
    ds_read_b64_tr_b16 v[104:105], v24 offset:20480
    ds_read_b64_tr_b16 v[106:107], v24 offset:22528
    s_waitcnt lgkmcnt(14)
    v_mfma_f32_32x32x16_bf16 v[192:207], v[76:79], a[40:43], v[192:207]
    ds_read_b64_tr_b16 v[108:109], v21 offset:28672
    ds_read_b64_tr_b16 v[110:111], v21 offset:30720
    s_waitcnt lgkmcnt(14)
    v_mfma_f32_32x32x16_bf16 v[208:223], v[80:83], a[40:43], v[208:223]
    ds_read_b64_tr_b16 v[112:113], v22 offset:28672
    ds_read_b64_tr_b16 v[114:115], v22 offset:30720
    s_waitcnt lgkmcnt(14)
    v_mfma_f32_32x32x16_bf16 v[224:239], v[84:87], a[40:43], v[224:239]
    ds_read_b64_tr_b16 v[116:117], v23 offset:28672
    ds_read_b64_tr_b16 v[118:119], v23 offset:30720
    s_waitcnt lgkmcnt(14)
    v_mfma_f32_32x32x16_bf16 v[240:255], v[88:91], a[40:43], v[240:255]
    ds_read_b64_tr_b16 v[120:121], v24 offset:28672
    ds_read_b64_tr_b16 v[122:123], v24 offset:30720
    s_waitcnt vmcnt(30)
    s_barrier
    s_waitcnt lgkmcnt(14)
    v_mfma_f32_32x32x16_bf16 v[128:143], v[92:95], a[44:47], v[128:143]
    ds_read_b64_tr_b16 v[60:61], v21 offset:32768
    ds_read_b64_tr_b16 v[62:63], v21 offset:34816
    global_load_dwordx4 a[32:35], v2, s[8:9] offset:0 sc1
    s_waitcnt lgkmcnt(14)
    v_mfma_f32_32x32x16_bf16 v[144:159], v[96:99], a[44:47], v[144:159]
    ds_read_b64_tr_b16 v[64:65], v22 offset:32768
    ds_read_b64_tr_b16 v[66:67], v22 offset:34816
    global_load_dwordx4 a[36:39], v2, s[8:9] offset:1024 sc1
    s_add_u32 s29, s29, 1
    s_cmp_eq_u32 s29, s31
    s_cselect_b32 s34, s32, 2048
    s_cselect_b32 s35, -1, 0
    s_cselect_b32 s29, 0, s29
    s_add_u32 s8, s8, s34
    s_addc_u32 s9, s9, s35
    s_waitcnt lgkmcnt(14)
    v_mfma_f32_32x32x16_bf16 v[160:175], v[100:103], a[44:47], v[160:175]
    ds_read_b64_tr_b16 v[68:69], v23 offset:32768
    ds_read_b64_tr_b16 v[70:71], v23 offset:34816
    s_add_u32 m0, s12, 65536
    s_nop 0
    global_load_lds_dwordx4 v3, s[10:11]
    s_waitcnt lgkmcnt(14)
    v_mfma_f32_32x32x16_bf16 v[176:191], v[104:107], a[44:47], v[176:191]
    ds_read_b64_tr_b16 v[72:73], v24 offset:32768
    ds_read_b64_tr_b16 v[74:75], v24 offset:34816
    s_add_u32 m0, s12, 66560
    s_nop 0
    global_load_lds_dwordx4 v4, s[10:11]
    s_waitcnt lgkmcnt(14)
    v_mfma_f32_32x32x16_bf16 v[192:207], v[108:111], a[44:47], v[192:207]
    ds_read_b64_tr_b16 v[76:77], v21 offset:40960
    ds_read_b64_tr_b16 v[78:79], v21 offset:43008
    s_add_u32 m0, s12, 67584
    s_nop 0
    global_load_lds_dwordx4 v5, s[10:11]
    s_waitcnt lgkmcnt(14)
    v_mfma_f32_32x32x16_bf16 v[208:223], v[112:115], a[44:47], v[208:223]
    ds_read_b64_tr_b16 v[80:81], v22 offset:40960
    ds_read_b64_tr_b16 v[82:83], v22 offset:43008
    s_add_u32 m0, s12, 68608
    s_nop 0
    global_load_lds_dwordx4 v6, s[10:11]
    s_add_u32 s30, s30, 1
    s_cmp_eq_u32 s30, s31
    s_cselect_b32 s34, s33, s27
    s_cselect_b32 s35, -1, 0
    s_cselect_b32 s30, 0, s30
    s_add_u32 s10, s10, s34
    s_addc_u32 s11, s11, s35
    s_waitcnt lgkmcnt(14)
    v_mfma_f32_32x32x16_bf16 v[224:239], v[116:119], a[44:47], v[224:239]
    ds_read_b64_tr_b16 v[84:85], v23 offset:40960
    ds_read_b64_tr_b16 v[86:87], v23 offset:43008
    s_waitcnt lgkmcnt(14)
    v_mfma_f32_32x32x16_bf16 v[240:255], v[120:123], a[44:47], v[240:255]
    ds_read_b64_tr_b16 v[88:89], v24 offset:40960
    ds_read_b64_tr_b16 v[90:91], v24 offset:43008
    s_waitcnt lgkmcnt(14)
    v_mfma_f32_32x32x16_bf16 v[128:143], v[60:63], a[48:51], v[128:143]
    ds_read_b64_tr_b16 v[92:93], v21 offset:36864
    ds_read_b64_tr_b16 v[94:95], v21 offset:38912
    s_waitcnt lgkmcnt(14)
    v_mfma_f32_32x32x16_bf16 v[144:159], v[64:67], a[48:51], v[144:159]
    ds_read_b64_tr_b16 v[96:97], v22 offset:36864
    ds_read_b64_tr_b16 v[98:99], v22 offset:38912
    s_waitcnt lgkmcnt(14)
    v_mfma_f32_32x32x16_bf16 v[160:175], v[68:71], a[48:51], v[160:175]
    ds_read_b64_tr_b16 v[100:101], v23 offset:36864
    ds_read_b64_tr_b16 v[102:103], v23 offset:38912
    s_waitcnt lgkmcnt(14)
    v_mfma_f32_32x32x16_bf16 v[176:191], v[72:75], a[48:51], v[176:191]
    ds_read_b64_tr_b16 v[104:105], v24 offset:36864
    ds_read_b64_tr_b16 v[106:107], v24 offset:38912
    s_waitcnt lgkmcnt(14)
    v_mfma_f32_32x32x16_bf16 v[192:207], v[76:79], a[48:51], v[192:207]
    ds_read_b64_tr_b16 v[108:109], v21 offset:45056
    ds_read_b64_tr_b16 v[110:111], v21 offset:47104
    s_waitcnt lgkmcnt(14)
    v_mfma_f32_32x32x16_bf16 v[208:223], v[80:83], a[48:51], v[208:223]
    ds_read_b64_tr_b16 v[112:113], v22 offset:45056
    ds_read_b64_tr_b16 v[114:115], v22 offset:47104
    s_waitcnt lgkmcnt(14)
    v_mfma_f32_32x32x16_bf16 v[224:239], v[84:87], a[48:51], v[224:239]
    ds_read_b64_tr_b16 v[116:117], v23 offset:45056
    ds_read_b64_tr_b16 v[118:119], v23 offset:47104
    s_waitcnt lgkmcnt(14)
    v_mfma_f32_32x32x16_bf16 v[240:255], v[88:91], a[48:51], v[240:255]
    ds_read_b64_tr_b16 v[120:121], v24 offset:45056
    ds_read_b64_tr_b16 v[122:123], v24 offset:47104
    s_waitcnt vmcnt(30)
    s_barrier
    s_waitcnt lgkmcnt(14)
    v_mfma_f32_32x32x16_bf16 v[128:143], v[92:95], a[52:55], v[128:143]
    ds_read_b64_tr_b16 v[60:61], v21 offset:49152
    ds_read_b64_tr_b16 v[62:63], v21 offset:51200
    global_load_dwordx4 a[40:43], v2, s[8:9] offset:0 sc1
    s_waitcnt lgkmcnt(14)
    v_mfma_f32_32x32x16_bf16 v[144:159], v[96:99], a[52:55], v[144:159]
    ds_read_b64_tr_b16 v[64:65], v22 offset:49152
    ds_read_b64_tr_b16 v[66:67], v22 offset:51200
    global_load_dwordx4 a[44:47], v2, s[8:9] offset:1024 sc1
    s_add_u32 s29, s29, 1
    s_cmp_eq_u32 s29, s31
    s_cselect_b32 s34, s32, 2048
    s_cselect_b32 s35, -1, 0
    s_cselect_b32 s29, 0, s29
    s_add_u32 s8, s8, s34
    s_addc_u32 s9, s9, s35
    s_waitcnt lgkmcnt(14)
    v_mfma_f32_32x32x16_bf16 v[160:175], v[100:103], a[52:55], v[160:175]
    ds_read_b64_tr_b16 v[68:69], v23 offset:49152
    ds_read_b64_tr_b16 v[70:71], v23 offset:51200
    s_add_u32 m0, s12, 81920
    s_nop 0
    global_load_lds_dwordx4 v3, s[10:11]
    s_waitcnt lgkmcnt(14)
    v_mfma_f32_32x32x16_bf16 v[176:191], v[104:107], a[52:55], v[176:191]
    ds_read_b64_tr_b16 v[72:73], v24 offset:49152
    ds_read_b64_tr_b16 v[74:75], v24 offset:51200
    s_add_u32 m0, s12, 82944
    s_nop 0
    global_load_lds_dwordx4 v4, s[10:11]
    s_waitcnt lgkmcnt(14)
    v_mfma_f32_32x32x16_bf16 v[192:207], v[108:111], a[52:55], v[192:207]
    ds_read_b64_tr_b16 v[76:77], v21 offset:57344
    ds_read_b64_tr_b16 v[78:79], v21 offset:59392
    s_add_u32 m0, s12, 83968
    s_nop 0
    global_load_lds_dwordx4 v5, s[10:11]
    s_waitcnt lgkmcnt(14)
    v_mfma_f32_32x32x16_bf16 v[208:223], v[112:115], a[52:55], v[208:223]
    ds_read_b64_tr_b16 v[80:81], v22 offset:57344
    ds_read_b64_tr_b16 v[82:83], v22 offset:59392
    s_add_u32 m0, s12, 84992
    s_nop 0
    global_load_lds_dwordx4 v6, s[10:11]
    s_add_u32 s30, s30, 1
    s_cmp_eq_u32 s30, s31
    s_cselect_b32 s34, s33, s27
    s_cselect_b32 s35, -1, 0
    s_cselect_b32 s30, 0, s30
    s_add_u32 s10, s10, s34
    s_addc_u32 s11, s11, s35
    s_waitcnt lgkmcnt(14)
    v_mfma_f32_32x32x16_bf16 v[224:239], v[116:119], a[52:55], v[224:239]
    ds_read_b64_tr_b16 v[84:85], v23 offset:57344
    ds_read_b64_tr_b16 v[86:87], v23 offset:59392
    s_waitcnt lgkmcnt(14)
    v_mfma_f32_32x32x16_bf16 v[240:255], v[120:123], a[52:55], v[240:255]
    ds_read_b64_tr_b16 v[88:89], v24 offset:57344
    ds_read_b64_tr_b16 v[90:91], v24 offset:59392
    s_waitcnt lgkmcnt(14)
    v_mfma_f32_32x32x16_bf16 v[128:143], v[60:63], a[56:59], v[128:143]
    ds_read_b64_tr_b16 v[92:93], v21 offset:53248
    ds_read_b64_tr_b16 v[94:95], v21 offset:55296
    s_waitcnt lgkmcnt(14)
    v_mfma_f32_32x32x16_bf16 v[144:159], v[64:67], a[56:59], v[144:159]
    ds_read_b64_tr_b16 v[96:97], v22 offset:53248
    ds_read_b64_tr_b16 v[98:99], v22 offset:55296
    s_waitcnt lgkmcnt(14)
    v_mfma_f32_32x32x16_bf16 v[160:175], v[68:71], a[56:59], v[160:175]
    ds_read_b64_tr_b16 v[100:101], v23 offset:53248
    ds_read_b64_tr_b16 v[102:103], v23 offset:55296
    s_waitcnt lgkmcnt(14)
    v_mfma_f32_32x32x16_bf16 v[176:191], v[72:75], a[56:59], v[176:191]
    ds_read_b64_tr_b16 v[104:105], v24 offset:53248
    ds_read_b64_tr_b16 v[106:107], v24 offset:55296
    s_waitcnt lgkmcnt(14)
    v_mfma_f32_32x32x16_bf16 v[192:207], v[76:79], a[56:59], v[192:207]
    ds_read_b64_tr_b16 v[108:109], v21 offset:61440
    ds_read_b64_tr_b16 v[110:111], v21 offset:63488
    s_waitcnt lgkmcnt(14)
    v_mfma_f32_32x32x16_bf16 v[208:223], v[80:83], a[56:59], v[208:223]
    ds_read_b64_tr_b16 v[112:113], v22 offset:61440
    ds_read_b64_tr_b16 v[114:115], v22 offset:63488
    s_waitcnt lgkmcnt(14)
    v_mfma_f32_32x32x16_bf16 v[224:239], v[84:87], a[56:59], v[224:239]
    ds_read_b64_tr_b16 v[116:117], v23 offset:61440
    ds_read_b64_tr_b16 v[118:119], v23 offset:63488
    s_waitcnt lgkmcnt(14)
    v_mfma_f32_32x32x16_bf16 v[240:255], v[88:91], a[56:59], v[240:255]
    ds_read_b64_tr_b16 v[120:121], v24 offset:61440
    ds_read_b64_tr_b16 v[122:123], v24 offset:63488
    s_waitcnt vmcnt(30)
    s_barrier
    s_waitcnt lgkmcnt(14)
    v_mfma_f32_32x32x16_bf16 v[128:143], v[92:95], a[60:63], v[128:143]
    ds_read_b64_tr_b16 v[60:61], v7 offset:0
    ds_read_b64_tr_b16 v[62:63], v7 offset:2048
    global_load_dwordx4 a[48:51], v2, s[8:9] offset:0 sc1
    s_waitcnt lgkmcnt(14)
    v_mfma_f32_32x32x16_bf16 v[144:159], v[96:99], a[60:63], v[144:159]
    ds_read_b64_tr_b16 v[64:65], v8 offset:0
    ds_read_b64_tr_b16 v[66:67], v8 offset:2048
    global_load_dwordx4 a[52:55], v2, s[8:9] offset:1024 sc1
    s_add_u32 s29, s29, 1
    s_cmp_eq_u32 s29, s31
    s_cselect_b32 s34, s32, 2048
    s_cselect_b32 s35, -1, 0
    s_cselect_b32 s29, 0, s29
    s_add_u32 s8, s8, s34
    s_addc_u32 s9, s9, s35
    s_waitcnt lgkmcnt(14)
    v_mfma_f32_32x32x16_bf16 v[160:175], v[100:103], a[60:63], v[160:175]
    ds_read_b64_tr_b16 v[68:69], v9 offset:0
    ds_read_b64_tr_b16 v[70:71], v9 offset:2048
    s_add_u32 m0, s12, 98304
    s_nop 0
    global_load_lds_dwordx4 v3, s[10:11]
    s_waitcnt lgkmcnt(14)
    v_mfma_f32_32x32x16_bf16 v[176:191], v[104:107], a[60:63], v[176:191]
    ds_read_b64_tr_b16 v[72:73], v10 offset:0
    ds_read_b64_tr_b16 v[74:75], v10 offset:2048
    s_add_u32 m0, s12, 99328
    s_nop 0
    global_load_lds_dwordx4 v4, s[10:11]
    s_waitcnt lgkmcnt(14)
    v_mfma_f32_32x32x16_bf16 v[192:207], v[108:111], a[60:63], v[192:207]
    ds_read_b64_tr_b16 v[76:77], v7 offset:8192
    ds_read_b64_tr_b16 v[78:79], v7 offset:10240
    s_add_u32 m0, s12, 100352
    s_nop 0
    global_load_lds_dwordx4 v5, s[10:11]
    s_waitcnt lgkmcnt(14)
    v_mfma_f32_32x32x16_bf16 v[208:223], v[112:115], a[60:63], v[208:223]
    ds_read_b64_tr_b16 v[80:81], v8 offset:8192
    ds_read_b64_tr_b16 v[82:83], v8 offset:10240
    s_add_u32 m0, s12, 101376
    s_nop 0
    global_load_lds_dwordx4 v6, s[10:11]
    s_add_u32 s30, s30, 1
    s_cmp_eq_u32 s30, s31
    s_cselect_b32 s34, s33, s27
    s_cselect_b32 s35, -1, 0
    s_cselect_b32 s30, 0, s30
    s_add_u32 s10, s10, s34
    s_addc_u32 s11, s11, s35
    s_waitcnt lgkmcnt(14)
    v_mfma_f32_32x32x16_bf16 v[224:239], v[116:119], a[60:63], v[224:239]
    ds_read_b64_tr_b16 v[84:85], v9 offset:8192
    ds_read_b64_tr_b16 v[86:87], v9 offset:10240
    s_waitcnt lgkmcnt(14)
    v_mfma_f32_32x32x16_bf16 v[240:255], v[120:123], a[60:63], v[240:255]
    ds_read_b64_tr_b16 v[88:89], v10 offset:8192
    ds_read_b64_tr_b16 v[90:91], v10 offset:10240
    s_sub_u32 s13, s13, 1
    s_cmp_lg_u32 s13, 0
    s_cbranch_scc1 gl_166
    s_waitcnt lgkmcnt(14)
    v_mfma_f32_32x32x16_bf16 v[128:143], v[60:63], a[0:3], v[128:143]
    ds_read_b64_tr_b16 v[92:93], v7 offset:4096
    ds_read_b64_tr_b16 v[94:95], v7 offset:6144
    s_waitcnt lgkmcnt(14)
    v_mfma_f32_32x32x16_bf16 v[144:159], v[64:67], a[0:3], v[144:159]
    ds_read_b64_tr_b16 v[96:97], v8 offset:4096
    ds_read_b64_tr_b16 v[98:99], v8 offset:6144
    s_waitcnt lgkmcnt(14)
    v_mfma_f32_32x32x16_bf16 v[160:175], v[68:71], a[0:3], v[160:175]
    ds_read_b64_tr_b16 v[100:101], v9 offset:4096
    ds_read_b64_tr_b16 v[102:103], v9 offset:6144
    s_waitcnt lgkmcnt(14)
    v_mfma_f32_32x32x16_bf16 v[176:191], v[72:75], a[0:3], v[176:191]
    ds_read_b64_tr_b16 v[104:105], v10 offset:4096
    ds_read_b64_tr_b16 v[106:107], v10 offset:6144
    s_waitcnt lgkmcnt(14)
    v_mfma_f32_32x32x16_bf16 v[192:207], v[76:79], a[0:3], v[192:207]
    ds_read_b64_tr_b16 v[108:109], v7 offset:12288
    ds_read_b64_tr_b16 v[110:111], v7 offset:14336
    s_waitcnt lgkmcnt(14)
    v_mfma_f32_32x32x16_bf16 v[208:223], v[80:83], a[0:3], v[208:223]
    ds_read_b64_tr_b16 v[112:113], v8 offset:12288
    ds_read_b64_tr_b16 v[114:115], v8 offset:14336
    s_waitcnt lgkmcnt(14)
    v_mfma_f32_32x32x16_bf16 v[224:239], v[84:87], a[0:3], v[224:239]
    ds_read_b64_tr_b16 v[116:117], v9 offset:12288
    ds_read_b64_tr_b16 v[118:119], v9 offset:14336
    s_waitcnt lgkmcnt(14)
    v_mfma_f32_32x32x16_bf16 v[240:255], v[88:91], a[0:3], v[240:255]
    ds_read_b64_tr_b16 v[120:121], v10 offset:12288
    ds_read_b64_tr_b16 v[122:123], v10 offset:14336
    s_waitcnt vmcnt(30)
    s_barrier
    s_waitcnt lgkmcnt(14)
    v_mfma_f32_32x32x16_bf16 v[128:143], v[92:95], a[4:7], v[128:143]
    ds_read_b64_tr_b16 v[60:61], v7 offset:16384
    ds_read_b64_tr_b16 v[62:63], v7 offset:18432
    global_load_dwordx4 a[56:59], v2, s[8:9] offset:0 sc1
    s_waitcnt lgkmcnt(14)
    v_mfma_f32_32x32x16_bf16 v[144:159], v[96:99], a[4:7], v[144:159]
    ds_read_b64_tr_b16 v[64:65], v8 offset:16384
    ds_read_b64_tr_b16 v[66:67], v8 offset:18432
    global_load_dwordx4 a[60:63], v2, s[8:9] offset:1024 sc1
    s_add_u32 s29, s29, 1
    s_cmp_eq_u32 s29, s31
    s_cselect_b32 s34, s32, 2048
    s_cselect_b32 s35, -1, 0
    s_cselect_b32 s29, 0, s29
    s_add_u32 s8, s8, s34
    s_addc_u32 s9, s9, s35
    s_waitcnt lgkmcnt(14)
    v_mfma_f32_32x32x16_bf16 v[160:175], v[100:103], a[4:7], v[160:175]
    ds_read_b64_tr_b16 v[68:69], v9 offset:16384
    ds_read_b64_tr_b16 v[70:71], v9 offset:18432
    s_add_u32 m0, s12, 114688
    s_nop 0
    global_load_lds_dwordx4 v3, s[10:11]
    s_waitcnt lgkmcnt(14)
    v_mfma_f32_32x32x16_bf16 v[176:191], v[104:107], a[4:7], v[176:191]
    ds_read_b64_tr_b16 v[72:73], v10 offset:16384
    ds_read_b64_tr_b16 v[74:75], v10 offset:18432
    s_add_u32 m0, s12, 115712
    s_nop 0
    global_load_lds_dwordx4 v4, s[10:11]
    s_waitcnt lgkmcnt(14)
    v_mfma_f32_32x32x16_bf16 v[192:207], v[108:111], a[4:7], v[192:207]
    ds_read_b64_tr_b16 v[76:77], v7 offset:24576
    ds_read_b64_tr_b16 v[78:79], v7 offset:26624
    s_add_u32 m0, s12, 116736
    s_nop 0
    global_load_lds_dwordx4 v5, s[10:11]
    s_waitcnt lgkmcnt(14)
    v_mfma_f32_32x32x16_bf16 v[208:223], v[112:115], a[4:7], v[208:223]
    ds_read_b64_tr_b16 v[80:81], v8 offset:24576
    ds_read_b64_tr_b16 v[82:83], v8 offset:26624
    s_add_u32 m0, s12, 117760
    s_nop 0
    global_load_lds_dwordx4 v6, s[10:11]
    s_add_u32 s30, s30, 1
    s_cmp_eq_u32 s30, s31
    s_cselect_b32 s34, s33, s27
    s_cselect_b32 s35, -1, 0
    s_cselect_b32 s30, 0, s30
    s_add_u32 s10, s10, s34
    s_addc_u32 s11, s11, s35
    s_waitcnt lgkmcnt(14)
    v_mfma_f32_32x32x16_bf16 v[224:239], v[116:119], a[4:7], v[224:239]
    ds_read_b64_tr_b16 v[84:85], v9 offset:24576
    ds_read_b64_tr_b16 v[86:87], v9 offset:26624
    s_waitcnt lgkmcnt(14)
    v_mfma_f32_32x32x16_bf16 v[240:255], v[120:123], a[4:7], v[240:255]
    ds_read_b64_tr_b16 v[88:89], v10 offset:24576
    ds_read_b64_tr_b16 v[90:91], v10 offset:26624
    s_waitcnt lgkmcnt(14)
    v_mfma_f32_32x32x16_bf16 v[128:143], v[60:63], a[8:11], v[128:143]
    ds_read_b64_tr_b16 v[92:93], v7 offset:20480
    ds_read_b64_tr_b16 v[94:95], v7 offset:22528
    s_waitcnt lgkmcnt(14)
    v_mfma_f32_32x32x16_bf16 v[144:159], v[64:67], a[8:11], v[144:159]
    ds_read_b64_tr_b16 v[96:97], v8 offset:20480
    ds_read_b64_tr_b16 v[98:99], v8 offset:22528
    s_waitcnt lgkmcnt(14)
    v_mfma_f32_32x32x16_bf16 v[160:175], v[68:71], a[8:11], v[160:175]
    ds_read_b64_tr_b16 v[100:101], v9 offset:20480
    ds_read_b64_tr_b16 v[102:103], v9 offset:22528
    s_waitcnt lgkmcnt(14)
    v_mfma_f32_32x32x16_bf16 v[176:191], v[72:75], a[8:11], v[176:191]
    ds_read_b64_tr_b16 v[104:105], v10 offset:20480
    ds_read_b64_tr_b16 v[106:107], v10 offset:22528
    s_waitcnt lgkmcnt(14)
    v_mfma_f32_32x32x16_bf16 v[192:207], v[76:79], a[8:11], v[192:207]
    ds_read_b64_tr_b16 v[108:109], v7 offset:28672
    ds_read_b64_tr_b16 v[110:111], v7 offset:30720
    s_waitcnt lgkmcnt(14)
    v_mfma_f32_32x32x16_bf16 v[208:223], v[80:83], a[8:11], v[208:223]
    ds_read_b64_tr_b16 v[112:113], v8 offset:28672
    ds_read_b64_tr_b16 v[114:115], v8 offset:30720
    s_waitcnt lgkmcnt(14)
    v_mfma_f32_32x32x16_bf16 v[224:239], v[84:87], a[8:11], v[224:239]
    ds_read_b64_tr_b16 v[116:117], v9 offset:28672
    ds_read_b64_tr_b16 v[118:119], v9 offset:30720
    s_waitcnt lgkmcnt(14)
    v_mfma_f32_32x32x16_bf16 v[240:255], v[88:91], a[8:11], v[240:255]
    ds_read_b64_tr_b16 v[120:121], v10 offset:28672
    ds_read_b64_tr_b16 v[122:123], v10 offset:30720
    s_waitcnt vmcnt(30)
    s_barrier
    s_waitcnt lgkmcnt(14)
    v_mfma_f32_32x32x16_bf16 v[128:143], v[92:95], a[12:15], v[128:143]
    ds_read_b64_tr_b16 v[60:61], v7 offset:32768
    ds_read_b64_tr_b16 v[62:63], v7 offset:34816
    s_waitcnt lgkmcnt(14)
    v_mfma_f32_32x32x16_bf16 v[144:159], v[96:99], a[12:15], v[144:159]
    ds_read_b64_tr_b16 v[64:65], v8 offset:32768
    ds_read_b64_tr_b16 v[66:67], v8 offset:34816
    s_waitcnt lgkmcnt(14)
    v_mfma_f32_32x32x16_bf16 v[160:175], v[100:103], a[12:15], v[160:175]
    ds_read_b64_tr_b16 v[68:69], v9 offset:32768
    ds_read_b64_tr_b16 v[70:71], v9 offset:34816
    s_waitcnt lgkmcnt(14)
    v_mfma_f32_32x32x16_bf16 v[176:191], v[104:107], a[12:15], v[176:191]
    ds_read_b64_tr_b16 v[72:73], v10 offset:32768
    ds_read_b64_tr_b16 v[74:75], v10 offset:34816
    s_waitcnt lgkmcnt(14)
    v_mfma_f32_32x32x16_bf16 v[192:207], v[108:111], a[12:15], v[192:207]
    ds_read_b64_tr_b16 v[76:77], v7 offset:40960
    ds_read_b64_tr_b16 v[78:79], v7 offset:43008
    s_waitcnt lgkmcnt(14)
    v_mfma_f32_32x32x16_bf16 v[208:223], v[112:115], a[12:15], v[208:223]
    ds_read_b64_tr_b16 v[80:81], v8 offset:40960
    ds_read_b64_tr_b16 v[82:83], v8 offset:43008
    s_waitcnt lgkmcnt(14)
    v_mfma_f32_32x32x16_bf16 v[224:239], v[116:119], a[12:15], v[224:239]
    ds_read_b64_tr_b16 v[84:85], v9 offset:40960
    ds_read_b64_tr_b16 v[86:87], v9 offset:43008
    s_waitcnt lgkmcnt(14)
    v_mfma_f32_32x32x16_bf16 v[240:255], v[120:123], a[12:15], v[240:255]
    ds_read_b64_tr_b16 v[88:89], v10 offset:40960
    ds_read_b64_tr_b16 v[90:91], v10 offset:43008
    s_waitcnt lgkmcnt(14)
    v_mfma_f32_32x32x16_bf16 v[128:143], v[60:63], a[16:19], v[128:143]
    ds_read_b64_tr_b16 v[92:93], v7 offset:36864
    ds_read_b64_tr_b16 v[94:95], v7 offset:38912
    s_waitcnt lgkmcnt(14)
    v_mfma_f32_32x32x16_bf16 v[144:159], v[64:67], a[16:19], v[144:159]
    ds_read_b64_tr_b16 v[96:97], v8 offset:36864
    ds_read_b64_tr_b16 v[98:99], v8 offset:38912
    s_waitcnt lgkmcnt(14)
    v_mfma_f32_32x32x16_bf16 v[160:175], v[68:71], a[16:19], v[160:175]
    ds_read_b64_tr_b16 v[100:101], v9 offset:36864
    ds_read_b64_tr_b16 v[102:103], v9 offset:38912
    s_waitcnt lgkmcnt(14)
    v_mfma_f32_32x32x16_bf16 v[176:191], v[72:75], a[16:19], v[176:191]
    ds_read_b64_tr_b16 v[104:105], v10 offset:36864
    ds_read_b64_tr_b16 v[106:107], v10 offset:38912
    s_waitcnt lgkmcnt(14)
    v_mfma_f32_32x32x16_bf16 v[192:207], v[76:79], a[16:19], v[192:207]
    ds_read_b64_tr_b16 v[108:109], v7 offset:45056
    ds_read_b64_tr_b16 v[110:111], v7 offset:47104
    s_waitcnt lgkmcnt(14)
    v_mfma_f32_32x32x16_bf16 v[208:223], v[80:83], a[16:19], v[208:223]
    ds_read_b64_tr_b16 v[112:113], v8 offset:45056
    ds_read_b64_tr_b16 v[114:115], v8 offset:47104
    s_waitcnt lgkmcnt(14)
    v_mfma_f32_32x32x16_bf16 v[224:239], v[84:87], a[16:19], v[224:239]
    ds_read_b64_tr_b16 v[116:117], v9 offset:45056
    ds_read_b64_tr_b16 v[118:119], v9 offset:47104
    s_waitcnt lgkmcnt(14)
    v_mfma_f32_32x32x16_bf16 v[240:255], v[88:91], a[16:19], v[240:255]
    ds_read_b64_tr_b16 v[120:121], v10 offset:45056
    ds_read_b64_tr_b16 v[122:123], v10 offset:47104
    s_waitcnt vmcnt(24)
    s_barrier
    s_waitcnt lgkmcnt(14)
    v_mfma_f32_32x32x16_bf16 v[128:143], v[92:95], a[20:23], v[128:143]
    ds_read_b64_tr_b16 v[60:61], v7 offset:49152
    ds_read_b64_tr_b16 v[62:63], v7 offset:51200
    s_waitcnt lgkmcnt(14)
    v_mfma_f32_32x32x16_bf16 v[144:159], v[96:99], a[20:23], v[144:159]
    ds_read_b64_tr_b16 v[64:65], v8 offset:49152
    ds_read_b64_tr_b16 v[66:67], v8 offset:51200
    s_waitcnt lgkmcnt(14)
    v_mfma_f32_32x32x16_bf16 v[160:175], v[100:103], a[20:23], v[160:175]
    ds_read_b64_tr_b16 v[68:69], v9 offset:49152
    ds_read_b64_tr_b16 v[70:71], v9 offset:51200
    s_waitcnt lgkmcnt(14)
    v_mfma_f32_32x32x16_bf16 v[176:191], v[104:107], a[20:23], v[176:191]
    ds_read_b64_tr_b16 v[72:73], v10 offset:49152
    ds_read_b64_tr_b16 v[74:75], v10 offset:51200
    s_waitcnt lgkmcnt(14)
    v_mfma_f32_32x32x16_bf16 v[192:207], v[108:111], a[20:23], v[192:207]
    ds_read_b64_tr_b16 v[76:77], v7 offset:57344
    ds_read_b64_tr_b16 v[78:79], v7 offset:59392
    s_waitcnt lgkmcnt(14)
    v_mfma_f32_32x32x16_bf16 v[208:223], v[112:115], a[20:23], v[208:223]
    ds_read_b64_tr_b16 v[80:81], v8 offset:57344
    ds_read_b64_tr_b16 v[82:83], v8 offset:59392
    s_waitcnt lgkmcnt(14)
    v_mfma_f32_32x32x16_bf16 v[224:239], v[116:119], a[20:23], v[224:239]
    ds_read_b64_tr_b16 v[84:85], v9 offset:57344
    ds_read_b64_tr_b16 v[86:87], v9 offset:59392
    s_waitcnt lgkmcnt(14)
    v_mfma_f32_32x32x16_bf16 v[240:255], v[120:123], a[20:23], v[240:255]
    ds_read_b64_tr_b16 v[88:89], v10 offset:57344
    ds_read_b64_tr_b16 v[90:91], v10 offset:59392
    s_waitcnt lgkmcnt(14)
    v_mfma_f32_32x32x16_bf16 v[128:143], v[60:63], a[24:27], v[128:143]
    ds_read_b64_tr_b16 v[92:93], v7 offset:53248
    ds_read_b64_tr_b16 v[94:95], v7 offset:55296
    s_waitcnt lgkmcnt(14)
    v_mfma_f32_32x32x16_bf16 v[144:159], v[64:67], a[24:27], v[144:159]
    ds_read_b64_tr_b16 v[96:97], v8 offset:53248
    ds_read_b64_tr_b16 v[98:99], v8 offset:55296
    s_waitcnt lgkmcnt(14)
    v_mfma_f32_32x32x16_bf16 v[160:175], v[68:71], a[24:27], v[160:175]
    ds_read_b64_tr_b16 v[100:101], v9 offset:53248
    ds_read_b64_tr_b16 v[102:103], v9 offset:55296
    s_waitcnt lgkmcnt(14)
    v_mfma_f32_32x32x16_bf16 v[176:191], v[72:75], a[24:27], v[176:191]
    ds_read_b64_tr_b16 v[104:105], v10 offset:53248
    ds_read_b64_tr_b16 v[106:107], v10 offset:55296
    s_waitcnt lgkmcnt(14)
    v_mfma_f32_32x32x16_bf16 v[192:207], v[76:79], a[24:27], v[192:207]
    ds_read_b64_tr_b16 v[108:109], v7 offset:61440
    ds_read_b64_tr_b16 v[110:111], v7 offset:63488
    s_waitcnt lgkmcnt(14)
    v_mfma_f32_32x32x16_bf16 v[208:223], v[80:83], a[24:27], v[208:223]
    ds_read_b64_tr_b16 v[112:113], v8 offset:61440
    ds_read_b64_tr_b16 v[114:115], v8 offset:63488
    s_waitcnt lgkmcnt(14)
    v_mfma_f32_32x32x16_bf16 v[224:239], v[84:87], a[24:27], v[224:239]
    ds_read_b64_tr_b16 v[116:117], v9 offset:61440
    ds_read_b64_tr_b16 v[118:119], v9 offset:63488
    s_waitcnt lgkmcnt(14)
    v_mfma_f32_32x32x16_bf16 v[240:255], v[88:91], a[24:27], v[240:255]
    ds_read_b64_tr_b16 v[120:121], v10 offset:61440
    ds_read_b64_tr_b16 v[122:123], v10 offset:63488
    s_waitcnt vmcnt(18)
    s_barrier
    s_waitcnt lgkmcnt(14)
    v_mfma_f32_32x32x16_bf16 v[128:143], v[92:95], a[28:31], v[128:143]
    ds_read_b64_tr_b16 v[60:61], v21 offset:0
    ds_read_b64_tr_b16 v[62:63], v21 offset:2048
    s_waitcnt lgkmcnt(14)
    v_mfma_f32_32x32x16_bf16 v[144:159], v[96:99], a[28:31], v[144:159]
    ds_read_b64_tr_b16 v[64:65], v22 offset:0
    ds_read_b64_tr_b16 v[66:67], v22 offset:2048
    s_waitcnt lgkmcnt(14)
    v_mfma_f32_32x32x16_bf16 v[160:175], v[100:103], a[28:31], v[160:175]
    ds_read_b64_tr_b16 v[68:69], v23 offset:0
    ds_read_b64_tr_b16 v[70:71], v23 offset:2048
    s_waitcnt lgkmcnt(14)
    v_mfma_f32_32x32x16_bf16 v[176:191], v[104:107], a[28:31], v[176:191]
    ds_read_b64_tr_b16 v[72:73], v24 offset:0
    ds_read_b64_tr_b16 v[74:75], v24 offset:2048
    s_waitcnt lgkmcnt(14)
    v_mfma_f32_32x32x16_bf16 v[192:207], v[108:111], a[28:31], v[192:207]
    ds_read_b64_tr_b16 v[76:77], v21 offset:8192
    ds_read_b64_tr_b16 v[78:79], v21 offset:10240
    s_waitcnt lgkmcnt(14)
    v_mfma_f32_32x32x16_bf16 v[208:223], v[112:115], a[28:31], v[208:223]
    ds_read_b64_tr_b16 v[80:81], v22 offset:8192
    ds_read_b64_tr_b16 v[82:83], v22 offset:10240
    s_waitcnt lgkmcnt(14)
    v_mfma_f32_32x32x16_bf16 v[224:239], v[116:119], a[28:31], v[224:239]
    ds_read_b64_tr_b16 v[84:85], v23 offset:8192
    ds_read_b64_tr_b16 v[86:87], v23 offset:10240
    s_waitcnt lgkmcnt(14)
    v_mfma_f32_32x32x16_bf16 v[240:255], v[120:123], a[28:31], v[240:255]
    ds_read_b64_tr_b16 v[88:89], v24 offset:8192
    ds_read_b64_tr_b16 v[90:91], v24 offset:10240
    s_waitcnt lgkmcnt(14)
    v_mfma_f32_32x32x16_bf16 v[128:143], v[60:63], a[32:35], v[128:143]
    ds_read_b64_tr_b16 v[92:93], v21 offset:4096
    ds_read_b64_tr_b16 v[94:95], v21 offset:6144
    s_waitcnt lgkmcnt(14)
    v_mfma_f32_32x32x16_bf16 v[144:159], v[64:67], a[32:35], v[144:159]
    ds_read_b64_tr_b16 v[96:97], v22 offset:4096
    ds_read_b64_tr_b16 v[98:99], v22 offset:6144
    s_waitcnt lgkmcnt(14)
    v_mfma_f32_32x32x16_bf16 v[160:175], v[68:71], a[32:35], v[160:175]
    ds_read_b64_tr_b16 v[100:101], v23 offset:4096
    ds_read_b64_tr_b16 v[102:103], v23 offset:6144
    s_waitcnt lgkmcnt(14)
    v_mfma_f32_32x32x16_bf16 v[176:191], v[72:75], a[32:35], v[176:191]
    ds_read_b64_tr_b16 v[104:105], v24 offset:4096
    ds_read_b64_tr_b16 v[106:107], v24 offset:6144
    s_waitcnt lgkmcnt(14)
    v_mfma_f32_32x32x16_bf16 v[192:207], v[76:79], a[32:35], v[192:207]
    ds_read_b64_tr_b16 v[108:109], v21 offset:12288
    ds_read_b64_tr_b16 v[110:111], v21 offset:14336
    s_waitcnt lgkmcnt(14)
    v_mfma_f32_32x32x16_bf16 v[208:223], v[80:83], a[32:35], v[208:223]
    ds_read_b64_tr_b16 v[112:113], v22 offset:12288
    ds_read_b64_tr_b16 v[114:115], v22 offset:14336
    s_waitcnt lgkmcnt(14)
    v_mfma_f32_32x32x16_bf16 v[224:239], v[84:87], a[32:35], v[224:239]
    ds_read_b64_tr_b16 v[116:117], v23 offset:12288
    ds_read_b64_tr_b16 v[118:119], v23 offset:14336
    s_waitcnt lgkmcnt(14)
    v_mfma_f32_32x32x16_bf16 v[240:255], v[88:91], a[32:35], v[240:255]
    ds_read_b64_tr_b16 v[120:121], v24 offset:12288
    ds_read_b64_tr_b16 v[122:123], v24 offset:14336
    s_waitcnt vmcnt(12)
    s_barrier
    s_waitcnt lgkmcnt(14)
    v_mfma_f32_32x32x16_bf16 v[128:143], v[92:95], a[36:39], v[128:143]
    ds_read_b64_tr_b16 v[60:61], v21 offset:16384
    ds_read_b64_tr_b16 v[62:63], v21 offset:18432
    s_waitcnt lgkmcnt(14)
    v_mfma_f32_32x32x16_bf16 v[144:159], v[96:99], a[36:39], v[144:159]
    ds_read_b64_tr_b16 v[64:65], v22 offset:16384
    ds_read_b64_tr_b16 v[66:67], v22 offset:18432
    s_waitcnt lgkmcnt(14)
    v_mfma_f32_32x32x16_bf16 v[160:175], v[100:103], a[36:39], v[160:175]
    ds_read_b64_tr_b16 v[68:69], v23 offset:16384
    ds_read_b64_tr_b16 v[70:71], v23 offset:18432
    s_waitcnt lgkmcnt(14)
    v_mfma_f32_32x32x16_bf16 v[176:191], v[104:107], a[36:39], v[176:191]
    ds_read_b64_tr_b16 v[72:73], v24 offset:16384
    ds_read_b64_tr_b16 v[74:75], v24 offset:18432
    s_waitcnt lgkmcnt(14)
    v_mfma_f32_32x32x16_bf16 v[192:207], v[108:111], a[36:39], v[192:207]
    ds_read_b64_tr_b16 v[76:77], v21 offset:24576
    ds_read_b64_tr_b16 v[78:79], v21 offset:26624
    s_waitcnt lgkmcnt(14)
    v_mfma_f32_32x32x16_bf16 v[208:223], v[112:115], a[36:39], v[208:223]
    ds_read_b64_tr_b16 v[80:81], v22 offset:24576
    ds_read_b64_tr_b16 v[82:83], v22 offset:26624
    s_waitcnt lgkmcnt(14)
    v_mfma_f32_32x32x16_bf16 v[224:239], v[116:119], a[36:39], v[224:239]
    ds_read_b64_tr_b16 v[84:85], v23 offset:24576
    ds_read_b64_tr_b16 v[86:87], v23 offset:26624
    s_waitcnt lgkmcnt(14)
    v_mfma_f32_32x32x16_bf16 v[240:255], v[120:123], a[36:39], v[240:255]
    ds_read_b64_tr_b16 v[88:89], v24 offset:24576
    ds_read_b64_tr_b16 v[90:91], v24 offset:26624
    s_waitcnt lgkmcnt(14)
    v_mfma_f32_32x32x16_bf16 v[128:143], v[60:63], a[40:43], v[128:143]
    ds_read_b64_tr_b16 v[92:93], v21 offset:20480
    ds_read_b64_tr_b16 v[94:95], v21 offset:22528
    s_waitcnt lgkmcnt(14)
    v_mfma_f32_32x32x16_bf16 v[144:159], v[64:67], a[40:43], v[144:159]
    ds_read_b64_tr_b16 v[96:97], v22 offset:20480
    ds_read_b64_tr_b16 v[98:99], v22 offset:22528
    s_waitcnt lgkmcnt(14)
    v_mfma_f32_32x32x16_bf16 v[160:175], v[68:71], a[40:43], v[160:175]
    ds_read_b64_tr_b16 v[100:101], v23 offset:20480
    ds_read_b64_tr_b16 v[102:103], v23 offset:22528
    s_waitcnt lgkmcnt(14)
    v_mfma_f32_32x32x16_bf16 v[176:191], v[72:75], a[40:43], v[176:191]
    ds_read_b64_tr_b16 v[104:105], v24 offset:20480
    ds_read_b64_tr_b16 v[106:107], v24 offset:22528
    s_waitcnt lgkmcnt(14)
    v_mfma_f32_32x32x16_bf16 v[192:207], v[76:79], a[40:43], v[192:207]
    ds_read_b64_tr_b16 v[108:109], v21 offset:28672
    ds_read_b64_tr_b16 v[110:111], v21 offset:30720
    s_waitcnt lgkmcnt(14)
    v_mfma_f32_32x32x16_bf16 v[208:223], v[80:83], a[40:43], v[208:223]
    ds_read_b64_tr_b16 v[112:113], v22 offset:28672
    ds_read_b64_tr_b16 v[114:115], v22 offset:30720
    s_waitcnt lgkmcnt(14)
    v_mfma_f32_32x32x16_bf16 v[224:239], v[84:87], a[40:43], v[224:239]
    ds_read_b64_tr_b16 v[116:117], v23 offset:28672
    ds_read_b64_tr_b16 v[118:119], v23 offset:30720
    s_waitcnt lgkmcnt(14)
    v_mfma_f32_32x32x16_bf16 v[240:255], v[88:91], a[40:43], v[240:255]
    ds_read_b64_tr_b16 v[120:121], v24 offset:28672
    ds_read_b64_tr_b16 v[122:123], v24 offset:30720
    s_waitcnt vmcnt(6)
    s_barrier
    s_waitcnt lgkmcnt(14)
    v_mfma_f32_32x32x16_bf16 v[128:143], v[92:95], a[44:47], v[128:143]
    ds_read_b64_tr_b16 v[60:61], v21 offset:32768
    ds_read_b64_tr_b16 v[62:63], v21 offset:34816
    s_waitcnt lgkmcnt(14)
    v_mfma_f32_32x32x16_bf16 v[144:159], v[96:99], a[44:47], v[144:159]
    ds_read_b64_tr_b16 v[64:65], v22 offset:32768
    ds_read_b64_tr_b16 v[66:67], v22 offset:34816
    s_waitcnt lgkmcnt(14)
    v_mfma_f32_32x32x16_bf16 v[160:175], v[100:103], a[44:47], v[160:175]
    ds_read_b64_tr_b16 v[68:69], v23 offset:32768
    ds_read_b64_tr_b16 v[70:71], v23 offset:34816
    s_waitcnt lgkmcnt(14)
    v_mfma_f32_32x32x16_bf16 v[176:191], v[104:107], a[44:47], v[176:191]
    ds_read_b64_tr_b16 v[72:73], v24 offset:32768
    ds_read_b64_tr_b16 v[74:75], v24 offset:34816
    s_waitcnt lgkmcnt(14)
    v_mfma_f32_32x32x16_bf16 v[192:207], v[108:111], a[44:47], v[192:207]
    ds_read_b64_tr_b16 v[76:77], v21 offset:40960
    ds_read_b64_tr_b16 v[78:79], v21 offset:43008
    s_waitcnt lgkmcnt(14)
    v_mfma_f32_32x32x16_bf16 v[208:223], v[112:115], a[44:47], v[208:223]
    ds_read_b64_tr_b16 v[80:81], v22 offset:40960
    ds_read_b64_tr_b16 v[82:83], v22 offset:43008
    s_waitcnt lgkmcnt(14)
    v_mfma_f32_32x32x16_bf16 v[224:239], v[116:119], a[44:47], v[224:239]
    ds_read_b64_tr_b16 v[84:85], v23 offset:40960
    ds_read_b64_tr_b16 v[86:87], v23 offset:43008
    s_waitcnt lgkmcnt(14)
    v_mfma_f32_32x32x16_bf16 v[240:255], v[120:123], a[44:47], v[240:255]
    ds_read_b64_tr_b16 v[88:89], v24 offset:40960
    ds_read_b64_tr_b16 v[90:91], v24 offset:43008
    s_waitcnt lgkmcnt(14)
    v_mfma_f32_32x32x16_bf16 v[128:143], v[60:63], a[48:51], v[128:143]
    ds_read_b64_tr_b16 v[92:93], v21 offset:36864
    ds_read_b64_tr_b16 v[94:95], v21 offset:38912
    s_waitcnt lgkmcnt(14)
    v_mfma_f32_32x32x16_bf16 v[144:159], v[64:67], a[48:51], v[144:159]
    ds_read_b64_tr_b16 v[96:97], v22 offset:36864
    ds_read_b64_tr_b16 v[98:99], v22 offset:38912
    s_waitcnt lgkmcnt(14)
    v_mfma_f32_32x32x16_bf16 v[160:175], v[68:71], a[48:51], v[160:175]
    ds_read_b64_tr_b16 v[100:101], v23 offset:36864
    ds_read_b64_tr_b16 v[102:103], v23 offset:38912
    s_waitcnt lgkmcnt(14)
    v_mfma_f32_32x32x16_bf16 v[176:191], v[72:75], a[48:51], v[176:191]
    ds_read_b64_tr_b16 v[104:105], v24 offset:36864
    ds_read_b64_tr_b16 v[106:107], v24 offset:38912
    s_waitcnt lgkmcnt(14)
    v_mfma_f32_32x32x16_bf16 v[192:207], v[76:79], a[48:51], v[192:207]
    ds_read_b64_tr_b16 v[108:109], v21 offset:45056
    ds_read_b64_tr_b16 v[110:111], v21 offset:47104
    s_waitcnt lgkmcnt(14)
    v_mfma_f32_32x32x16_bf16 v[208:223], v[80:83], a[48:51], v[208:223]
    ds_read_b64_tr_b16 v[112:113], v22 offset:45056
    ds_read_b64_tr_b16 v[114:115], v22 offset:47104
    s_waitcnt lgkmcnt(14)
    v_mfma_f32_32x32x16_bf16 v[224:239], v[84:87], a[48:51], v[224:239]
    ds_read_b64_tr_b16 v[116:117], v23 offset:45056
    ds_read_b64_tr_b16 v[118:119], v23 offset:47104
    s_waitcnt lgkmcnt(14)
    v_mfma_f32_32x32x16_bf16 v[240:255], v[88:91], a[48:51], v[240:255]
    ds_read_b64_tr_b16 v[120:121], v24 offset:45056
    ds_read_b64_tr_b16 v[122:123], v24 offset:47104
    s_waitcnt vmcnt(0)
    s_barrier
    s_waitcnt lgkmcnt(14)
    v_mfma_f32_32x32x16_bf16 v[128:143], v[92:95], a[52:55], v[128:143]
    ds_read_b64_tr_b16 v[60:61], v21 offset:49152
    ds_read_b64_tr_b16 v[62:63], v21 offset:51200
    s_waitcnt lgkmcnt(14)
    v_mfma_f32_32x32x16_bf16 v[144:159], v[96:99], a[52:55], v[144:159]
    ds_read_b64_tr_b16 v[64:65], v22 offset:49152
    ds_read_b64_tr_b16 v[66:67], v22 offset:51200
    s_waitcnt lgkmcnt(14)
    v_mfma_f32_32x32x16_bf16 v[160:175], v[100:103], a[52:55], v[160:175]
    ds_read_b64_tr_b16 v[68:69], v23 offset:49152
    ds_read_b64_tr_b16 v[70:71], v23 offset:51200
    s_waitcnt lgkmcnt(14)
    v_mfma_f32_32x32x16_bf16 v[176:191], v[104:107], a[52:55], v[176:191]
    ds_read_b64_tr_b16 v[72:73], v24 offset:49152
    ds_read_b64_tr_b16 v[74:75], v24 offset:51200
    s_waitcnt lgkmcnt(14)
    v_mfma_f32_32x32x16_bf16 v[192:207], v[108:111], a[52:55], v[192:207]
    ds_read_b64_tr_b16 v[76:77], v21 offset:57344
    ds_read_b64_tr_b16 v[78:79], v21 offset:59392
    s_waitcnt lgkmcnt(14)
    v_mfma_f32_32x32x16_bf16 v[208:223], v[112:115], a[52:55], v[208:223]
    ds_read_b64_tr_b16 v[80:81], v22 offset:57344
    ds_read_b64_tr_b16 v[82:83], v22 offset:59392
    s_waitcnt lgkmcnt(14)
    v_mfma_f32_32x32x16_bf16 v[224:239], v[116:119], a[52:55], v[224:239]
    ds_read_b64_tr_b16 v[84:85], v23 offset:57344
    ds_read_b64_tr_b16 v[86:87], v23 offset:59392
    s_waitcnt lgkmcnt(14)
    v_mfma_f32_32x32x16_bf16 v[240:255], v[120:123], a[52:55], v[240:255]
    ds_read_b64_tr_b16 v[88:89], v24 offset:57344
    ds_read_b64_tr_b16 v[90:91], v24 offset:59392
    s_waitcnt lgkmcnt(14)
    v_mfma_f32_32x32x16_bf16 v[128:143], v[60:63], a[56:59], v[128:143]
    ds_read_b64_tr_b16 v[92:93], v21 offset:53248
    ds_read_b64_tr_b16 v[94:95], v21 offset:55296
    s_waitcnt lgkmcnt(14)
    v_mfma_f32_32x32x16_bf16 v[144:159], v[64:67], a[56:59], v[144:159]
    ds_read_b64_tr_b16 v[96:97], v22 offset:53248
    ds_read_b64_tr_b16 v[98:99], v22 offset:55296
    s_waitcnt lgkmcnt(14)
    v_mfma_f32_32x32x16_bf16 v[160:175], v[68:71], a[56:59], v[160:175]
    ds_read_b64_tr_b16 v[100:101], v23 offset:53248
    ds_read_b64_tr_b16 v[102:103], v23 offset:55296
    s_waitcnt lgkmcnt(14)
    v_mfma_f32_32x32x16_bf16 v[176:191], v[72:75], a[56:59], v[176:191]
    ds_read_b64_tr_b16 v[104:105], v24 offset:53248
    ds_read_b64_tr_b16 v[106:107], v24 offset:55296
    s_waitcnt lgkmcnt(14)
    v_mfma_f32_32x32x16_bf16 v[192:207], v[76:79], a[56:59], v[192:207]
    ds_read_b64_tr_b16 v[108:109], v21 offset:61440
    ds_read_b64_tr_b16 v[110:111], v21 offset:63488
    s_waitcnt lgkmcnt(14)
    v_mfma_f32_32x32x16_bf16 v[208:223], v[80:83], a[56:59], v[208:223]
    ds_read_b64_tr_b16 v[112:113], v22 offset:61440
    ds_read_b64_tr_b16 v[114:115], v22 offset:63488
    s_waitcnt lgkmcnt(14)
    v_mfma_f32_32x32x16_bf16 v[224:239], v[84:87], a[56:59], v[224:239]
    ds_read_b64_tr_b16 v[116:117], v23 offset:61440
    ds_read_b64_tr_b16 v[118:119], v23 offset:63488
    s_waitcnt lgkmcnt(14)
    v_mfma_f32_32x32x16_bf16 v[240:255], v[88:91], a[56:59], v[240:255]
    ds_read_b64_tr_b16 v[120:121], v24 offset:61440
    ds_read_b64_tr_b16 v[122:123], v24 offset:63488
    s_waitcnt lgkmcnt(14)
    v_mfma_f32_32x32x16_bf16 v[128:143], v[92:95], a[60:63], v[128:143]
    s_waitcnt lgkmcnt(12)
    v_mfma_f32_32x32x16_bf16 v[144:159], v[96:99], a[60:63], v[144:159]
    s_waitcnt lgkmcnt(10)
    v_mfma_f32_32x32x16_bf16 v[160:175], v[100:103], a[60:63], v[160:175]
    s_waitcnt lgkmcnt(8)
    v_mfma_f32_32x32x16_bf16 v[176:191], v[104:107], a[60:63], v[176:191]
    s_waitcnt lgkmcnt(6)
    v_mfma_f32_32x32x16_bf16 v[192:207], v[108:111], a[60:63], v[192:207]
    s_waitcnt lgkmcnt(4)
    v_mfma_f32_32x32x16_bf16 v[208:223], v[112:115], a[60:63], v[208:223]
    s_waitcnt lgkmcnt(2)
    v_mfma_f32_32x32x16_bf16 v[224:239], v[116:119], a[60:63], v[224:239]
    s_waitcnt lgkmcnt(0)
    v_mfma_f32_32x32x16_bf16 v[240:255], v[120:123], a[60:63], v[240:255]
    s_nop 11
    v_cvt_pk_bf16_f32 v60, v128, v129
    v_lshlrev_b32 v128, 16, v60
    v_and_b32 v129, 0xffff0000, v60
    v_cvt_pk_bf16_f32 v61, v130, v131
    v_lshlrev_b32 v130, 16, v61
    v_and_b32 v131, 0xffff0000, v61
    v_cvt_pk_bf16_f32 v62, v132, v133
    v_lshlrev_b32 v132, 16, v62
    v_and_b32 v133, 0xffff0000, v62
    v_cvt_pk_bf16_f32 v63, v134, v135
    v_lshlrev_b32 v134, 16, v63
    v_and_b32 v135, 0xffff0000, v63
    v_cvt_pk_bf16_f32 v64, v136, v137
    v_lshlrev_b32 v136, 16, v64
    v_and_b32 v137, 0xffff0000, v64
    v_cvt_pk_bf16_f32 v65, v138, v139
    v_lshlrev_b32 v138, 16, v65
    v_and_b32 v139, 0xffff0000, v65
    v_cvt_pk_bf16_f32 v66, v140, v141
    v_lshlrev_b32 v140, 16, v66
    v_and_b32 v141, 0xffff0000, v66
    v_cvt_pk_bf16_f32 v67, v142, v143
    v_lshlrev_b32 v142, 16, v67
    v_and_b32 v143, 0xffff0000, v67
    v_mul_f32 v68, 0xbfb8aa3b, v128
    v_mul_f32 v69, 0xbfb8aa3b, v129
    v_mul_f32 v70, 0xbfb8aa3b, v130
    v_mul_f32 v71, 0xbfb8aa3b, v131
    v_mul_f32 v72, 0xbfb8aa3b, v132
    v_mul_f32 v73, 0xbfb8aa3b, v133
    v_mul_f32 v74, 0xbfb8aa3b, v134
    v_mul_f32 v75, 0xbfb8aa3b, v135
    v_mul_f32 v76, 0xbfb8aa3b, v136
    v_mul_f32 v77, 0xbfb8aa3b, v137
    v_mul_f32 v78, 0xbfb8aa3b, v138
    v_mul_f32 v79, 0xbfb8aa3b, v139
    v_mul_f32 v80, 0xbfb8aa3b, v140
    v_mul_f32 v81, 0xbfb8aa3b, v141
    v_mul_f32 v82, 0xbfb8aa3b, v142
    v_mul_f32 v83, 0xbfb8aa3b, v143
    v_exp_f32 v68, v68
    v_exp_f32 v69, v69
    v_exp_f32 v70, v70
    v_exp_f32 v71, v71
    v_exp_f32 v72, v72
    v_exp_f32 v73, v73
    v_exp_f32 v74, v74
    v_exp_f32 v75, v75
    v_exp_f32 v76, v76
    v_exp_f32 v77, v77
    v_exp_f32 v78, v78
    v_exp_f32 v79, v79
    v_exp_f32 v80, v80
    v_exp_f32 v81, v81
    v_exp_f32 v82, v82
    v_exp_f32 v83, v83
    v_add_f32 v68, 1.0, v68
    v_add_f32 v69, 1.0, v69
    v_add_f32 v70, 1.0, v70
    v_add_f32 v71, 1.0, v71
    v_add_f32 v72, 1.0, v72
    v_add_f32 v73, 1.0, v73
    v_add_f32 v74, 1.0, v74
    v_add_f32 v75, 1.0, v75
    v_add_f32 v76, 1.0, v76
    v_add_f32 v77, 1.0, v77
    v_add_f32 v78, 1.0, v78
    v_add_f32 v79, 1.0, v79
    v_add_f32 v80, 1.0, v80
    v_add_f32 v81, 1.0, v81
    v_add_f32 v82, 1.0, v82
    v_add_f32 v83, 1.0, v83
    v_rcp_f32 v68, v68
    v_rcp_f32 v69, v69
    v_rcp_f32 v70, v70
    v_rcp_f32 v71, v71
    v_rcp_f32 v72, v72
    v_rcp_f32 v73, v73
    v_rcp_f32 v74, v74
    v_rcp_f32 v75, v75
    v_rcp_f32 v76, v76
    v_rcp_f32 v77, v77
    v_rcp_f32 v78, v78
    v_rcp_f32 v79, v79
    v_rcp_f32 v80, v80
    v_rcp_f32 v81, v81
    v_rcp_f32 v82, v82
    v_rcp_f32 v83, v83
    v_mul_f32 v128, v128, v68
    v_mul_f32 v129, v129, v69
    v_mul_f32 v130, v130, v70
    v_mul_f32 v131, v131, v71
    v_mul_f32 v132, v132, v72
    v_mul_f32 v133, v133, v73
    v_mul_f32 v134, v134, v74
    v_mul_f32 v135, v135, v75
    v_mul_f32 v136, v136, v76
    v_mul_f32 v137, v137, v77
    v_mul_f32 v138, v138, v78
    v_mul_f32 v139, v139, v79
    v_mul_f32 v140, v140, v80
    v_mul_f32 v141, v141, v81
    v_mul_f32 v142, v142, v82
    v_mul_f32 v143, v143, v83
    v_cvt_pk_bf16_f32 v92, v128, v129
    v_cvt_pk_bf16_f32 v93, v130, v131
    v_cvt_pk_bf16_f32 v94, v132, v133
    v_cvt_pk_bf16_f32 v95, v134, v135
    v_cvt_pk_bf16_f32 v96, v136, v137
    v_cvt_pk_bf16_f32 v97, v138, v139
    v_cvt_pk_bf16_f32 v98, v140, v141
    v_cvt_pk_bf16_f32 v99, v142, v143
    global_store_dwordx4 v2, v[92:95], s[18:19] offset:-4096 sc1
    global_store_dwordx4 v2, v[96:99], s[18:19] offset:-3072 sc1
    v_cvt_pk_bf16_f32 v60, v144, v145
    v_lshlrev_b32 v144, 16, v60
    v_and_b32 v145, 0xffff0000, v60
    v_cvt_pk_bf16_f32 v61, v146, v147
    v_lshlrev_b32 v146, 16, v61
    v_and_b32 v147, 0xffff0000, v61
    v_cvt_pk_bf16_f32 v62, v148, v149
    v_lshlrev_b32 v148, 16, v62
    v_and_b32 v149, 0xffff0000, v62
    v_cvt_pk_bf16_f32 v63, v150, v151
    v_lshlrev_b32 v150, 16, v63
    v_and_b32 v151, 0xffff0000, v63
    v_cvt_pk_bf16_f32 v64, v152, v153
    v_lshlrev_b32 v152, 16, v64
    v_and_b32 v153, 0xffff0000, v64
    v_cvt_pk_bf16_f32 v65, v154, v155
    v_lshlrev_b32 v154, 16, v65
    v_and_b32 v155, 0xffff0000, v65
    v_cvt_pk_bf16_f32 v66, v156, v157
    v_lshlrev_b32 v156, 16, v66
    v_and_b32 v157, 0xffff0000, v66
    v_cvt_pk_bf16_f32 v67, v158, v159
    v_lshlrev_b32 v158, 16, v67
    v_and_b32 v159, 0xffff0000, v67
    v_mul_f32 v68, 0xbfb8aa3b, v144
    v_mul_f32 v69, 0xbfb8aa3b, v145
    v_mul_f32 v70, 0xbfb8aa3b, v146
    v_mul_f32 v71, 0xbfb8aa3b, v147
    v_mul_f32 v72, 0xbfb8aa3b, v148
    v_mul_f32 v73, 0xbfb8aa3b, v149
    v_mul_f32 v74, 0xbfb8aa3b, v150
    v_mul_f32 v75, 0xbfb8aa3b, v151
    v_mul_f32 v76, 0xbfb8aa3b, v152
    v_mul_f32 v77, 0xbfb8aa3b, v153
    v_mul_f32 v78, 0xbfb8aa3b, v154
    v_mul_f32 v79, 0xbfb8aa3b, v155
    v_mul_f32 v80, 0xbfb8aa3b, v156
    v_mul_f32 v81, 0xbfb8aa3b, v157
    v_mul_f32 v82, 0xbfb8aa3b, v158
    v_mul_f32 v83, 0xbfb8aa3b, v159
    v_exp_f32 v68, v68
    v_exp_f32 v69, v69
    v_exp_f32 v70, v70
    v_exp_f32 v71, v71
    v_exp_f32 v72, v72
    v_exp_f32 v73, v73
    v_exp_f32 v74, v74
    v_exp_f32 v75, v75
    v_exp_f32 v76, v76
    v_exp_f32 v77, v77
    v_exp_f32 v78, v78
    v_exp_f32 v79, v79
    v_exp_f32 v80, v80
    v_exp_f32 v81, v81
    v_exp_f32 v82, v82
    v_exp_f32 v83, v83
    v_add_f32 v68, 1.0, v68
    v_add_f32 v69, 1.0, v69
    v_add_f32 v70, 1.0, v70
    v_add_f32 v71, 1.0, v71
    v_add_f32 v72, 1.0, v72
    v_add_f32 v73, 1.0, v73
    v_add_f32 v74, 1.0, v74
    v_add_f32 v75, 1.0, v75
    v_add_f32 v76, 1.0, v76
    v_add_f32 v77, 1.0, v77
    v_add_f32 v78, 1.0, v78
    v_add_f32 v79, 1.0, v79
    v_add_f32 v80, 1.0, v80
    v_add_f32 v81, 1.0, v81
    v_add_f32 v82, 1.0, v82
    v_add_f32 v83, 1.0, v83
    v_rcp_f32 v68, v68
    v_rcp_f32 v69, v69
    v_rcp_f32 v70, v70
    v_rcp_f32 v71, v71
    v_rcp_f32 v72, v72
    v_rcp_f32 v73, v73
    v_rcp_f32 v74, v74
    v_rcp_f32 v75, v75
    v_rcp_f32 v76, v76
    v_rcp_f32 v77, v77
    v_rcp_f32 v78, v78
    v_rcp_f32 v79, v79
    v_rcp_f32 v80, v80
    v_rcp_f32 v81, v81
    v_rcp_f32 v82, v82
    v_rcp_f32 v83, v83
    v_mul_f32 v144, v144, v68
    v_mul_f32 v145, v145, v69
    v_mul_f32 v146, v146, v70
    v_mul_f32 v147, v147, v71
    v_mul_f32 v148, v148, v72
    v_mul_f32 v149, v149, v73
    v_mul_f32 v150, v150, v74
    v_mul_f32 v151, v151, v75
    v_mul_f32 v152, v152, v76
    v_mul_f32 v153, v153, v77
    v_mul_f32 v154, v154, v78
    v_mul_f32 v155, v155, v79
    v_mul_f32 v156, v156, v80
    v_mul_f32 v157, v157, v81
    v_mul_f32 v158, v158, v82
    v_mul_f32 v159, v159, v83
    v_cvt_pk_bf16_f32 v100, v144, v145
    v_cvt_pk_bf16_f32 v101, v146, v147
    v_cvt_pk_bf16_f32 v102, v148, v149
    v_cvt_pk_bf16_f32 v103, v150, v151
    v_cvt_pk_bf16_f32 v104, v152, v153
    v_cvt_pk_bf16_f32 v105, v154, v155
    v_cvt_pk_bf16_f32 v106, v156, v157
    v_cvt_pk_bf16_f32 v107, v158, v159
    global_store_dwordx4 v2, v[100:103], s[18:19] offset:-2048 sc1
    global_store_dwordx4 v2, v[104:107], s[18:19] offset:-1024 sc1
    v_cvt_pk_bf16_f32 v60, v160, v161
    v_lshlrev_b32 v160, 16, v60
    v_and_b32 v161, 0xffff0000, v60
    v_cvt_pk_bf16_f32 v61, v162, v163
    v_lshlrev_b32 v162, 16, v61
    v_and_b32 v163, 0xffff0000, v61
    v_cvt_pk_bf16_f32 v62, v164, v165
    v_lshlrev_b32 v164, 16, v62
    v_and_b32 v165, 0xffff0000, v62
    v_cvt_pk_bf16_f32 v63, v166, v167
    v_lshlrev_b32 v166, 16, v63
    v_and_b32 v167, 0xffff0000, v63
    v_cvt_pk_bf16_f32 v64, v168, v169
    v_lshlrev_b32 v168, 16, v64
    v_and_b32 v169, 0xffff0000, v64
    v_cvt_pk_bf16_f32 v65, v170, v171
    v_lshlrev_b32 v170, 16, v65
    v_and_b32 v171, 0xffff0000, v65
    v_cvt_pk_bf16_f32 v66, v172, v173
    v_lshlrev_b32 v172, 16, v66
    v_and_b32 v173, 0xffff0000, v66
    v_cvt_pk_bf16_f32 v67, v174, v175
    v_lshlrev_b32 v174, 16, v67
    v_and_b32 v175, 0xffff0000, v67
    v_mul_f32 v68, 0xbfb8aa3b, v160
    v_mul_f32 v69, 0xbfb8aa3b, v161
    v_mul_f32 v70, 0xbfb8aa3b, v162
    v_mul_f32 v71, 0xbfb8aa3b, v163
    v_mul_f32 v72, 0xbfb8aa3b, v164
    v_mul_f32 v73, 0xbfb8aa3b, v165
    v_mul_f32 v74, 0xbfb8aa3b, v166
    v_mul_f32 v75, 0xbfb8aa3b, v167
    v_mul_f32 v76, 0xbfb8aa3b, v168
    v_mul_f32 v77, 0xbfb8aa3b, v169
    v_mul_f32 v78, 0xbfb8aa3b, v170
    v_mul_f32 v79, 0xbfb8aa3b, v171
    v_mul_f32 v80, 0xbfb8aa3b, v172
    v_mul_f32 v81, 0xbfb8aa3b, v173
    v_mul_f32 v82, 0xbfb8aa3b, v174
    v_mul_f32 v83, 0xbfb8aa3b, v175
    v_exp_f32 v68, v68
    v_exp_f32 v69, v69
    v_exp_f32 v70, v70
    v_exp_f32 v71, v71
    v_exp_f32 v72, v72
    v_exp_f32 v73, v73
    v_exp_f32 v74, v74
    v_exp_f32 v75, v75
    v_exp_f32 v76, v76
    v_exp_f32 v77, v77
    v_exp_f32 v78, v78
    v_exp_f32 v79, v79
    v_exp_f32 v80, v80
    v_exp_f32 v81, v81
    v_exp_f32 v82, v82
    v_exp_f32 v83, v83
    v_add_f32 v68, 1.0, v68
    v_add_f32 v69, 1.0, v69
    v_add_f32 v70, 1.0, v70
    v_add_f32 v71, 1.0, v71
    v_add_f32 v72, 1.0, v72
    v_add_f32 v73, 1.0, v73
    v_add_f32 v74, 1.0, v74
    v_add_f32 v75, 1.0, v75
    v_add_f32 v76, 1.0, v76
    v_add_f32 v77, 1.0, v77
    v_add_f32 v78, 1.0, v78
    v_add_f32 v79, 1.0, v79
    v_add_f32 v80, 1.0, v80
    v_add_f32 v81, 1.0, v81
    v_add_f32 v82, 1.0, v82
    v_add_f32 v83, 1.0, v83
    v_rcp_f32 v68, v68
    v_rcp_f32 v69, v69
    v_rcp_f32 v70, v70
    v_rcp_f32 v71, v71
    v_rcp_f32 v72, v72
    v_rcp_f32 v73, v73
    v_rcp_f32 v74, v74
    v_rcp_f32 v75, v75
    v_rcp_f32 v76, v76
    v_rcp_f32 v77, v77
    v_rcp_f32 v78, v78
    v_rcp_f32 v79, v79
    v_rcp_f32 v80, v80
    v_rcp_f32 v81, v81
    v_rcp_f32 v82, v82
    v_rcp_f32 v83, v83
    v_mul_f32 v160, v160, v68
    v_mul_f32 v161, v161, v69
    v_mul_f32 v162, v162, v70
    v_mul_f32 v163, v163, v71
    v_mul_f32 v164, v164, v72
    v_mul_f32 v165, v165, v73
    v_mul_f32 v166, v166, v74
    v_mul_f32 v167, v167, v75
    v_mul_f32 v168, v168, v76
    v_mul_f32 v169, v169, v77
    v_mul_f32 v170, v170, v78
    v_mul_f32 v171, v171, v79
    v_mul_f32 v172, v172, v80
    v_mul_f32 v173, v173, v81
    v_mul_f32 v174, v174, v82
    v_mul_f32 v175, v175, v83
    v_cvt_pk_bf16_f32 v92, v160, v161
    v_cvt_pk_bf16_f32 v93, v162, v163
    v_cvt_pk_bf16_f32 v94, v164, v165
    v_cvt_pk_bf16_f32 v95, v166, v167
    v_cvt_pk_bf16_f32 v96, v168, v169
    v_cvt_pk_bf16_f32 v97, v170, v171
    v_cvt_pk_bf16_f32 v98, v172, v173
    v_cvt_pk_bf16_f32 v99, v174, v175
    global_store_dwordx4 v2, v[92:95], s[18:19] offset:0 sc1
    global_store_dwordx4 v2, v[96:99], s[18:19] offset:1024 sc1
    v_cvt_pk_bf16_f32 v60, v176, v177
    v_lshlrev_b32 v176, 16, v60
    v_and_b32 v177, 0xffff0000, v60
    v_cvt_pk_bf16_f32 v61, v178, v179
    v_lshlrev_b32 v178, 16, v61
    v_and_b32 v179, 0xffff0000, v61
    v_cvt_pk_bf16_f32 v62, v180, v181
    v_lshlrev_b32 v180, 16, v62
    v_and_b32 v181, 0xffff0000, v62
    v_cvt_pk_bf16_f32 v63, v182, v183
    v_lshlrev_b32 v182, 16, v63
    v_and_b32 v183, 0xffff0000, v63
    v_cvt_pk_bf16_f32 v64, v184, v185
    v_lshlrev_b32 v184, 16, v64
    v_and_b32 v185, 0xffff0000, v64
    v_cvt_pk_bf16_f32 v65, v186, v187
    v_lshlrev_b32 v186, 16, v65
    v_and_b32 v187, 0xffff0000, v65
    v_cvt_pk_bf16_f32 v66, v188, v189
    v_lshlrev_b32 v188, 16, v66
    v_and_b32 v189, 0xffff0000, v66
    v_cvt_pk_bf16_f32 v67, v190, v191
    v_lshlrev_b32 v190, 16, v67
    v_and_b32 v191, 0xffff0000, v67
    v_mul_f32 v68, 0xbfb8aa3b, v176
    v_mul_f32 v69, 0xbfb8aa3b, v177
    v_mul_f32 v70, 0xbfb8aa3b, v178
    v_mul_f32 v71, 0xbfb8aa3b, v179
    v_mul_f32 v72, 0xbfb8aa3b, v180
    v_mul_f32 v73, 0xbfb8aa3b, v181
    v_mul_f32 v74, 0xbfb8aa3b, v182
    v_mul_f32 v75, 0xbfb8aa3b, v183
    v_mul_f32 v76, 0xbfb8aa3b, v184
    v_mul_f32 v77, 0xbfb8aa3b, v185
    v_mul_f32 v78, 0xbfb8aa3b, v186
    v_mul_f32 v79, 0xbfb8aa3b, v187
    v_mul_f32 v80, 0xbfb8aa3b, v188
    v_mul_f32 v81, 0xbfb8aa3b, v189
    v_mul_f32 v82, 0xbfb8aa3b, v190
    v_mul_f32 v83, 0xbfb8aa3b, v191
    v_exp_f32 v68, v68
    v_exp_f32 v69, v69
    v_exp_f32 v70, v70
    v_exp_f32 v71, v71
    v_exp_f32 v72, v72
    v_exp_f32 v73, v73
    v_exp_f32 v74, v74
    v_exp_f32 v75, v75
    v_exp_f32 v76, v76
    v_exp_f32 v77, v77
    v_exp_f32 v78, v78
    v_exp_f32 v79, v79
    v_exp_f32 v80, v80
    v_exp_f32 v81, v81
    v_exp_f32 v82, v82
    v_exp_f32 v83, v83
    v_add_f32 v68, 1.0, v68
    v_add_f32 v69, 1.0, v69
    v_add_f32 v70, 1.0, v70
    v_add_f32 v71, 1.0, v71
    v_add_f32 v72, 1.0, v72
    v_add_f32 v73, 1.0, v73
    v_add_f32 v74, 1.0, v74
    v_add_f32 v75, 1.0, v75
    v_add_f32 v76, 1.0, v76
    v_add_f32 v77, 1.0, v77
    v_add_f32 v78, 1.0, v78
    v_add_f32 v79, 1.0, v79
    v_add_f32 v80, 1.0, v80
    v_add_f32 v81, 1.0, v81
    v_add_f32 v82, 1.0, v82
    v_add_f32 v83, 1.0, v83
    v_rcp_f32 v68, v68
    v_rcp_f32 v69, v69
    v_rcp_f32 v70, v70
    v_rcp_f32 v71, v71
    v_rcp_f32 v72, v72
    v_rcp_f32 v73, v73
    v_rcp_f32 v74, v74
    v_rcp_f32 v75, v75
    v_rcp_f32 v76, v76
    v_rcp_f32 v77, v77
    v_rcp_f32 v78, v78
    v_rcp_f32 v79, v79
    v_rcp_f32 v80, v80
    v_rcp_f32 v81, v81
    v_rcp_f32 v82, v82
    v_rcp_f32 v83, v83
    v_mul_f32 v176, v176, v68
    v_mul_f32 v177, v177, v69
    v_mul_f32 v178, v178, v70
    v_mul_f32 v179, v179, v71
    v_mul_f32 v180, v180, v72
    v_mul_f32 v181, v181, v73
    v_mul_f32 v182, v182, v74
    v_mul_f32 v183, v183, v75
    v_mul_f32 v184, v184, v76
    v_mul_f32 v185, v185, v77
    v_mul_f32 v186, v186, v78
    v_mul_f32 v187, v187, v79
    v_mul_f32 v188, v188, v80
    v_mul_f32 v189, v189, v81
    v_mul_f32 v190, v190, v82
    v_mul_f32 v191, v191, v83
    v_cvt_pk_bf16_f32 v100, v176, v177
    v_cvt_pk_bf16_f32 v101, v178, v179
    v_cvt_pk_bf16_f32 v102, v180, v181
    v_cvt_pk_bf16_f32 v103, v182, v183
    v_cvt_pk_bf16_f32 v104, v184, v185
    v_cvt_pk_bf16_f32 v105, v186, v187
    v_cvt_pk_bf16_f32 v106, v188, v189
    v_cvt_pk_bf16_f32 v107, v190, v191
    global_store_dwordx4 v2, v[100:103], s[18:19] offset:2048 sc1
    global_store_dwordx4 v2, v[104:107], s[18:19] offset:3072 sc1
    v_cvt_pk_bf16_f32 v60, v192, v193
    v_lshlrev_b32 v192, 16, v60
    v_and_b32 v193, 0xffff0000, v60
    v_cvt_pk_bf16_f32 v61, v194, v195
    v_lshlrev_b32 v194, 16, v61
    v_and_b32 v195, 0xffff0000, v61
    v_cvt_pk_bf16_f32 v62, v196, v197
    v_lshlrev_b32 v196, 16, v62
    v_and_b32 v197, 0xffff0000, v62
    v_cvt_pk_bf16_f32 v63, v198, v199
    v_lshlrev_b32 v198, 16, v63
    v_and_b32 v199, 0xffff0000, v63
    v_cvt_pk_bf16_f32 v64, v200, v201
    v_lshlrev_b32 v200, 16, v64
    v_and_b32 v201, 0xffff0000, v64
    v_cvt_pk_bf16_f32 v65, v202, v203
    v_lshlrev_b32 v202, 16, v65
    v_and_b32 v203, 0xffff0000, v65
    v_cvt_pk_bf16_f32 v66, v204, v205
    v_lshlrev_b32 v204, 16, v66
    v_and_b32 v205, 0xffff0000, v66
    v_cvt_pk_bf16_f32 v67, v206, v207
    v_lshlrev_b32 v206, 16, v67
    v_and_b32 v207, 0xffff0000, v67
    v_mul_f32 v68, 0xbfb8aa3b, v192
    v_mul_f32 v69, 0xbfb8aa3b, v193
    v_mul_f32 v70, 0xbfb8aa3b, v194
    v_mul_f32 v71, 0xbfb8aa3b, v195
    v_mul_f32 v72, 0xbfb8aa3b, v196
    v_mul_f32 v73, 0xbfb8aa3b, v197
    v_mul_f32 v74, 0xbfb8aa3b, v198
    v_mul_f32 v75, 0xbfb8aa3b, v199
    v_mul_f32 v76, 0xbfb8aa3b, v200
    v_mul_f32 v77, 0xbfb8aa3b, v201
    v_mul_f32 v78, 0xbfb8aa3b, v202
    v_mul_f32 v79, 0xbfb8aa3b, v203
    v_mul_f32 v80, 0xbfb8aa3b, v204
    v_mul_f32 v81, 0xbfb8aa3b, v205
    v_mul_f32 v82, 0xbfb8aa3b, v206
    v_mul_f32 v83, 0xbfb8aa3b, v207
    v_exp_f32 v68, v68
    v_exp_f32 v69, v69
    v_exp_f32 v70, v70
    v_exp_f32 v71, v71
    v_exp_f32 v72, v72
    v_exp_f32 v73, v73
    v_exp_f32 v74, v74
    v_exp_f32 v75, v75
    v_exp_f32 v76, v76
    v_exp_f32 v77, v77
    v_exp_f32 v78, v78
    v_exp_f32 v79, v79
    v_exp_f32 v80, v80
    v_exp_f32 v81, v81
    v_exp_f32 v82, v82
    v_exp_f32 v83, v83
    v_add_f32 v68, 1.0, v68
    v_add_f32 v69, 1.0, v69
    v_add_f32 v70, 1.0, v70
    v_add_f32 v71, 1.0, v71
    v_add_f32 v72, 1.0, v72
    v_add_f32 v73, 1.0, v73
    v_add_f32 v74, 1.0, v74
    v_add_f32 v75, 1.0, v75
    v_add_f32 v76, 1.0, v76
    v_add_f32 v77, 1.0, v77
    v_add_f32 v78, 1.0, v78
    v_add_f32 v79, 1.0, v79
    v_add_f32 v80, 1.0, v80
    v_add_f32 v81, 1.0, v81
    v_add_f32 v82, 1.0, v82
    v_add_f32 v83, 1.0, v83
    v_rcp_f32 v68, v68
    v_rcp_f32 v69, v69
    v_rcp_f32 v70, v70
    v_rcp_f32 v71, v71
    v_rcp_f32 v72, v72
    v_rcp_f32 v73, v73
    v_rcp_f32 v74, v74
    v_rcp_f32 v75, v75
    v_rcp_f32 v76, v76
    v_rcp_f32 v77, v77
    v_rcp_f32 v78, v78
    v_rcp_f32 v79, v79
    v_rcp_f32 v80, v80
    v_rcp_f32 v81, v81
    v_rcp_f32 v82, v82
    v_rcp_f32 v83, v83
    v_mul_f32 v192, v192, v68
    v_mul_f32 v193, v193, v69
    v_mul_f32 v194, v194, v70
    v_mul_f32 v195, v195, v71
    v_mul_f32 v196, v196, v72
    v_mul_f32 v197, v197, v73
    v_mul_f32 v198, v198, v74
    v_mul_f32 v199, v199, v75
    v_mul_f32 v200, v200, v76
    v_mul_f32 v201, v201, v77
    v_mul_f32 v202, v202, v78
    v_mul_f32 v203, v203, v79
    v_mul_f32 v204, v204, v80
    v_mul_f32 v205, v205, v81
    v_mul_f32 v206, v206, v82
    v_mul_f32 v207, v207, v83
    v_cvt_pk_bf16_f32 v92, v192, v193
    v_cvt_pk_bf16_f32 v93, v194, v195
    v_cvt_pk_bf16_f32 v94, v196, v197
    v_cvt_pk_bf16_f32 v95, v198, v199
    v_cvt_pk_bf16_f32 v96, v200, v201
    v_cvt_pk_bf16_f32 v97, v202, v203
    v_cvt_pk_bf16_f32 v98, v204, v205
    v_cvt_pk_bf16_f32 v99, v206, v207
    global_store_dwordx4 v2, v[92:95], s[20:21] offset:-4096 sc1
    global_store_dwordx4 v2, v[96:99], s[20:21] offset:-3072 sc1
    v_cvt_pk_bf16_f32 v60, v208, v209
    v_lshlrev_b32 v208, 16, v60
    v_and_b32 v209, 0xffff0000, v60
    v_cvt_pk_bf16_f32 v61, v210, v211
    v_lshlrev_b32 v210, 16, v61
    v_and_b32 v211, 0xffff0000, v61
    v_cvt_pk_bf16_f32 v62, v212, v213
    v_lshlrev_b32 v212, 16, v62
    v_and_b32 v213, 0xffff0000, v62
    v_cvt_pk_bf16_f32 v63, v214, v215
    v_lshlrev_b32 v214, 16, v63
    v_and_b32 v215, 0xffff0000, v63
    v_cvt_pk_bf16_f32 v64, v216, v217
    v_lshlrev_b32 v216, 16, v64
    v_and_b32 v217, 0xffff0000, v64
    v_cvt_pk_bf16_f32 v65, v218, v219
    v_lshlrev_b32 v218, 16, v65
    v_and_b32 v219, 0xffff0000, v65
    v_cvt_pk_bf16_f32 v66, v220, v221
    v_lshlrev_b32 v220, 16, v66
    v_and_b32 v221, 0xffff0000, v66
    v_cvt_pk_bf16_f32 v67, v222, v223
    v_lshlrev_b32 v222, 16, v67
    v_and_b32 v223, 0xffff0000, v67
    v_mul_f32 v68, 0xbfb8aa3b, v208
    v_mul_f32 v69, 0xbfb8aa3b, v209
    v_mul_f32 v70, 0xbfb8aa3b, v210
    v_mul_f32 v71, 0xbfb8aa3b, v211
    v_mul_f32 v72, 0xbfb8aa3b, v212
    v_mul_f32 v73, 0xbfb8aa3b, v213
    v_mul_f32 v74, 0xbfb8aa3b, v214
    v_mul_f32 v75, 0xbfb8aa3b, v215
    v_mul_f32 v76, 0xbfb8aa3b, v216
    v_mul_f32 v77, 0xbfb8aa3b, v217
    v_mul_f32 v78, 0xbfb8aa3b, v218
    v_mul_f32 v79, 0xbfb8aa3b, v219
    v_mul_f32 v80, 0xbfb8aa3b, v220
    v_mul_f32 v81, 0xbfb8aa3b, v221
    v_mul_f32 v82, 0xbfb8aa3b, v222
    v_mul_f32 v83, 0xbfb8aa3b, v223
    v_exp_f32 v68, v68
    v_exp_f32 v69, v69
    v_exp_f32 v70, v70
    v_exp_f32 v71, v71
    v_exp_f32 v72, v72
    v_exp_f32 v73, v73
    v_exp_f32 v74, v74
    v_exp_f32 v75, v75
    v_exp_f32 v76, v76
    v_exp_f32 v77, v77
    v_exp_f32 v78, v78
    v_exp_f32 v79, v79
    v_exp_f32 v80, v80
    v_exp_f32 v81, v81
    v_exp_f32 v82, v82
    v_exp_f32 v83, v83
    v_add_f32 v68, 1.0, v68
    v_add_f32 v69, 1.0, v69
    v_add_f32 v70, 1.0, v70
    v_add_f32 v71, 1.0, v71
    v_add_f32 v72, 1.0, v72
    v_add_f32 v73, 1.0, v73
    v_add_f32 v74, 1.0, v74
    v_add_f32 v75, 1.0, v75
    v_add_f32 v76, 1.0, v76
    v_add_f32 v77, 1.0, v77
    v_add_f32 v78, 1.0, v78
    v_add_f32 v79, 1.0, v79
    v_add_f32 v80, 1.0, v80
    v_add_f32 v81, 1.0, v81
    v_add_f32 v82, 1.0, v82
    v_add_f32 v83, 1.0, v83
    v_rcp_f32 v68, v68
    v_rcp_f32 v69, v69
    v_rcp_f32 v70, v70
    v_rcp_f32 v71, v71
    v_rcp_f32 v72, v72
    v_rcp_f32 v73, v73
    v_rcp_f32 v74, v74
    v_rcp_f32 v75, v75
    v_rcp_f32 v76, v76
    v_rcp_f32 v77, v77
    v_rcp_f32 v78, v78
    v_rcp_f32 v79, v79
    v_rcp_f32 v80, v80
    v_rcp_f32 v81, v81
    v_rcp_f32 v82, v82
    v_rcp_f32 v83, v83
    v_mul_f32 v208, v208, v68
    v_mul_f32 v209, v209, v69
    v_mul_f32 v210, v210, v70
    v_mul_f32 v211, v211, v71
    v_mul_f32 v212, v212, v72
    v_mul_f32 v213, v213, v73
    v_mul_f32 v214, v214, v74
    v_mul_f32 v215, v215, v75
    v_mul_f32 v216, v216, v76
    v_mul_f32 v217, v217, v77
    v_mul_f32 v218, v218, v78
    v_mul_f32 v219, v219, v79
    v_mul_f32 v220, v220, v80
    v_mul_f32 v221, v221, v81
    v_mul_f32 v222, v222, v82
    v_mul_f32 v223, v223, v83
    v_cvt_pk_bf16_f32 v100, v208, v209
    v_cvt_pk_bf16_f32 v101, v210, v211
    v_cvt_pk_bf16_f32 v102, v212, v213
    v_cvt_pk_bf16_f32 v103, v214, v215
    v_cvt_pk_bf16_f32 v104, v216, v217
    v_cvt_pk_bf16_f32 v105, v218, v219
    v_cvt_pk_bf16_f32 v106, v220, v221
    v_cvt_pk_bf16_f32 v107, v222, v223
    global_store_dwordx4 v2, v[100:103], s[20:21] offset:-2048 sc1
    global_store_dwordx4 v2, v[104:107], s[20:21] offset:-1024 sc1
    v_cvt_pk_bf16_f32 v60, v224, v225
    v_lshlrev_b32 v224, 16, v60
    v_and_b32 v225, 0xffff0000, v60
    v_cvt_pk_bf16_f32 v61, v226, v227
    v_lshlrev_b32 v226, 16, v61
    v_and_b32 v227, 0xffff0000, v61
    v_cvt_pk_bf16_f32 v62, v228, v229
    v_lshlrev_b32 v228, 16, v62
    v_and_b32 v229, 0xffff0000, v62
    v_cvt_pk_bf16_f32 v63, v230, v231
    v_lshlrev_b32 v230, 16, v63
    v_and_b32 v231, 0xffff0000, v63
    v_cvt_pk_bf16_f32 v64, v232, v233
    v_lshlrev_b32 v232, 16, v64
    v_and_b32 v233, 0xffff0000, v64
    v_cvt_pk_bf16_f32 v65, v234, v235
    v_lshlrev_b32 v234, 16, v65
    v_and_b32 v235, 0xffff0000, v65
    v_cvt_pk_bf16_f32 v66, v236, v237
    v_lshlrev_b32 v236, 16, v66
    v_and_b32 v237, 0xffff0000, v66
    v_cvt_pk_bf16_f32 v67, v238, v239
    v_lshlrev_b32 v238, 16, v67
    v_and_b32 v239, 0xffff0000, v67
    v_mul_f32 v68, 0xbfb8aa3b, v224
    v_mul_f32 v69, 0xbfb8aa3b, v225
    v_mul_f32 v70, 0xbfb8aa3b, v226
    v_mul_f32 v71, 0xbfb8aa3b, v227
    v_mul_f32 v72, 0xbfb8aa3b, v228
    v_mul_f32 v73, 0xbfb8aa3b, v229
    v_mul_f32 v74, 0xbfb8aa3b, v230
    v_mul_f32 v75, 0xbfb8aa3b, v231
    v_mul_f32 v76, 0xbfb8aa3b, v232
    v_mul_f32 v77, 0xbfb8aa3b, v233
    v_mul_f32 v78, 0xbfb8aa3b, v234
    v_mul_f32 v79, 0xbfb8aa3b, v235
    v_mul_f32 v80, 0xbfb8aa3b, v236
    v_mul_f32 v81, 0xbfb8aa3b, v237
    v_mul_f32 v82, 0xbfb8aa3b, v238
    v_mul_f32 v83, 0xbfb8aa3b, v239
    v_exp_f32 v68, v68
    v_exp_f32 v69, v69
    v_exp_f32 v70, v70
    v_exp_f32 v71, v71
    v_exp_f32 v72, v72
    v_exp_f32 v73, v73
    v_exp_f32 v74, v74
    v_exp_f32 v75, v75
    v_exp_f32 v76, v76
    v_exp_f32 v77, v77
    v_exp_f32 v78, v78
    v_exp_f32 v79, v79
    v_exp_f32 v80, v80
    v_exp_f32 v81, v81
    v_exp_f32 v82, v82
    v_exp_f32 v83, v83
    v_add_f32 v68, 1.0, v68
    v_add_f32 v69, 1.0, v69
    v_add_f32 v70, 1.0, v70
    v_add_f32 v71, 1.0, v71
    v_add_f32 v72, 1.0, v72
    v_add_f32 v73, 1.0, v73
    v_add_f32 v74, 1.0, v74
    v_add_f32 v75, 1.0, v75
    v_add_f32 v76, 1.0, v76
    v_add_f32 v77, 1.0, v77
    v_add_f32 v78, 1.0, v78
    v_add_f32 v79, 1.0, v79
    v_add_f32 v80, 1.0, v80
    v_add_f32 v81, 1.0, v81
    v_add_f32 v82, 1.0, v82
    v_add_f32 v83, 1.0, v83
    v_rcp_f32 v68, v68
    v_rcp_f32 v69, v69
    v_rcp_f32 v70, v70
    v_rcp_f32 v71, v71
    v_rcp_f32 v72, v72
    v_rcp_f32 v73, v73
    v_rcp_f32 v74, v74
    v_rcp_f32 v75, v75
    v_rcp_f32 v76, v76
    v_rcp_f32 v77, v77
    v_rcp_f32 v78, v78
    v_rcp_f32 v79, v79
    v_rcp_f32 v80, v80
    v_rcp_f32 v81, v81
    v_rcp_f32 v82, v82
    v_rcp_f32 v83, v83
    v_mul_f32 v224, v224, v68
    v_mul_f32 v225, v225, v69
    v_mul_f32 v226, v226, v70
    v_mul_f32 v227, v227, v71
    v_mul_f32 v228, v228, v72
    v_mul_f32 v229, v229, v73
    v_mul_f32 v230, v230, v74
    v_mul_f32 v231, v231, v75
    v_mul_f32 v232, v232, v76
    v_mul_f32 v233, v233, v77
    v_mul_f32 v234, v234, v78
    v_mul_f32 v235, v235, v79
    v_mul_f32 v236, v236, v80
    v_mul_f32 v237, v237, v81
    v_mul_f32 v238, v238, v82
    v_mul_f32 v239, v239, v83
    v_cvt_pk_bf16_f32 v92, v224, v225
    v_cvt_pk_bf16_f32 v93, v226, v227
    v_cvt_pk_bf16_f32 v94, v228, v229
    v_cvt_pk_bf16_f32 v95, v230, v231
    v_cvt_pk_bf16_f32 v96, v232, v233
    v_cvt_pk_bf16_f32 v97, v234, v235
    v_cvt_pk_bf16_f32 v98, v236, v237
    v_cvt_pk_bf16_f32 v99, v238, v239
    global_store_dwordx4 v2, v[92:95], s[20:21] offset:0 sc1
    global_store_dwordx4 v2, v[96:99], s[20:21] offset:1024 sc1
    v_cvt_pk_bf16_f32 v60, v240, v241
    v_lshlrev_b32 v240, 16, v60
    v_and_b32 v241, 0xffff0000, v60
    v_cvt_pk_bf16_f32 v61, v242, v243
    v_lshlrev_b32 v242, 16, v61
    v_and_b32 v243, 0xffff0000, v61
    v_cvt_pk_bf16_f32 v62, v244, v245
    v_lshlrev_b32 v244, 16, v62
    v_and_b32 v245, 0xffff0000, v62
    v_cvt_pk_bf16_f32 v63, v246, v247
    v_lshlrev_b32 v246, 16, v63
    v_and_b32 v247, 0xffff0000, v63
    v_cvt_pk_bf16_f32 v64, v248, v249
    v_lshlrev_b32 v248, 16, v64
    v_and_b32 v249, 0xffff0000, v64
    v_cvt_pk_bf16_f32 v65, v250, v251
    v_lshlrev_b32 v250, 16, v65
    v_and_b32 v251, 0xffff0000, v65
    v_cvt_pk_bf16_f32 v66, v252, v253
    v_lshlrev_b32 v252, 16, v66
    v_and_b32 v253, 0xffff0000, v66
    v_cvt_pk_bf16_f32 v67, v254, v255
    v_lshlrev_b32 v254, 16, v67
    v_and_b32 v255, 0xffff0000, v67
    v_mul_f32 v68, 0xbfb8aa3b, v240
    v_mul_f32 v69, 0xbfb8aa3b, v241
    v_mul_f32 v70, 0xbfb8aa3b, v242
    v_mul_f32 v71, 0xbfb8aa3b, v243
    v_mul_f32 v72, 0xbfb8aa3b, v244
    v_mul_f32 v73, 0xbfb8aa3b, v245
    v_mul_f32 v74, 0xbfb8aa3b, v246
    v_mul_f32 v75, 0xbfb8aa3b, v247
    v_mul_f32 v76, 0xbfb8aa3b, v248
    v_mul_f32 v77, 0xbfb8aa3b, v249
    v_mul_f32 v78, 0xbfb8aa3b, v250
    v_mul_f32 v79, 0xbfb8aa3b, v251
    v_mul_f32 v80, 0xbfb8aa3b, v252
    v_mul_f32 v81, 0xbfb8aa3b, v253
    v_mul_f32 v82, 0xbfb8aa3b, v254
    v_mul_f32 v83, 0xbfb8aa3b, v255
    v_exp_f32 v68, v68
    v_exp_f32 v69, v69
    v_exp_f32 v70, v70
    v_exp_f32 v71, v71
    v_exp_f32 v72, v72
    v_exp_f32 v73, v73
    v_exp_f32 v74, v74
    v_exp_f32 v75, v75
    v_exp_f32 v76, v76
    v_exp_f32 v77, v77
    v_exp_f32 v78, v78
    v_exp_f32 v79, v79
    v_exp_f32 v80, v80
    v_exp_f32 v81, v81
    v_exp_f32 v82, v82
    v_exp_f32 v83, v83
    v_add_f32 v68, 1.0, v68
    v_add_f32 v69, 1.0, v69
    v_add_f32 v70, 1.0, v70
    v_add_f32 v71, 1.0, v71
    v_add_f32 v72, 1.0, v72
    v_add_f32 v73, 1.0, v73
    v_add_f32 v74, 1.0, v74
    v_add_f32 v75, 1.0, v75
    v_add_f32 v76, 1.0, v76
    v_add_f32 v77, 1.0, v77
    v_add_f32 v78, 1.0, v78
    v_add_f32 v79, 1.0, v79
    v_add_f32 v80, 1.0, v80
    v_add_f32 v81, 1.0, v81
    v_add_f32 v82, 1.0, v82
    v_add_f32 v83, 1.0, v83
    v_rcp_f32 v68, v68
    v_rcp_f32 v69, v69
    v_rcp_f32 v70, v70
    v_rcp_f32 v71, v71
    v_rcp_f32 v72, v72
    v_rcp_f32 v73, v73
    v_rcp_f32 v74, v74
    v_rcp_f32 v75, v75
    v_rcp_f32 v76, v76
    v_rcp_f32 v77, v77
    v_rcp_f32 v78, v78
    v_rcp_f32 v79, v79
    v_rcp_f32 v80, v80
    v_rcp_f32 v81, v81
    v_rcp_f32 v82, v82
    v_rcp_f32 v83, v83
    v_mul_f32 v240, v240, v68
    v_mul_f32 v241, v241, v69
    v_mul_f32 v242, v242, v70
    v_mul_f32 v243, v243, v71
    v_mul_f32 v244, v244, v72
    v_mul_f32 v245, v245, v73
    v_mul_f32 v246, v246, v74
    v_mul_f32 v247, v247, v75
    v_mul_f32 v248, v248, v76
    v_mul_f32 v249, v249, v77
    v_mul_f32 v250, v250, v78
    v_mul_f32 v251, v251, v79
    v_mul_f32 v252, v252, v80
    v_mul_f32 v253, v253, v81
    v_mul_f32 v254, v254, v82
    v_mul_f32 v255, v255, v83
    v_cvt_pk_bf16_f32 v100, v240, v241
    v_cvt_pk_bf16_f32 v101, v242, v243
    v_cvt_pk_bf16_f32 v102, v244, v245
    v_cvt_pk_bf16_f32 v103, v246, v247
    v_cvt_pk_bf16_f32 v104, v248, v249
    v_cvt_pk_bf16_f32 v105, v250, v251
    v_cvt_pk_bf16_f32 v106, v252, v253
    v_cvt_pk_bf16_f32 v107, v254, v255
    global_store_dwordx4 v2, v[100:103], s[20:21] offset:2048 sc1
    global_store_dwordx4 v2, v[104:107], s[20:21] offset:3072 sc1
    s_lshl_b32 s88, s52, 7
    s_add_u32 s88, s88, 8192
    s_waitcnt vmcnt(0)
    s_barrier
    s_cmp_lg_u32 s4, 0
    s_cbranch_scc1 pub_167
    v_mov_b32 v13, s88
    v_mov_b32 v14, 1
    s_mov_b64 exec, 1
    global_atomic_add v13, v14, s[82:83] sc1
    v_mov_b32 v13, 15488
    global_atomic_add v13, v14, s[82:83] sc1
    s_mov_b64 exec, -1
pub_167:
next_135:
    s_add_u32 s85, s85, 1
    s_cmp_lt_u32 s85, 5
    s_cbranch_scc1 round_133
tail_134:
    s_waitcnt vmcnt(0) lgkmcnt(0)
    s_barrier
    s_lshr_b32 s90, s84, 5
    s_bfe_u32 s91, s84, 0x30002
    s_and_b32 s92, s84, 3
    v_lshrrev_b32 v20, 4, v1
    v_and_b32 v21, 15, v1
    v_lshlrev_b32 v22, 2, v20
    v_xor_b32 v21, v21, v22
    v_lshlrev_b32 v21, 4, v21
    v_lshl_add_u32 v232, v20, 10, v21
    s_lshl_b32 s87, s91, 19
    s_lshl_b32 s88, s4, 17
    s_add_u32 s87, s87, s88
    s_lshl_b32 s88, s92, 8
    s_add_u32 s87, s87, s88
    s_add_u32 s94, s68, s87
    s_addc_u32 s95, s69, 0
    s_lshl_b32 s88, s4, 15
    s_add_u32 m0, s88, 0
    s_nop 0
    global_load_lds_dwordx4 v232, s[94:95]
    s_add_u32 s94, s94, 4096
    s_addc_u32 s95, s95, 0
    s_add_u32 m0, s88, 1024
    s_nop 0
    global_load_lds_dwordx4 v232, s[94:95]
    s_add_u32 s94, s94, 4096
    s_addc_u32 s95, s95, 0
    s_add_u32 m0, s88, 2048
    s_nop 0
    global_load_lds_dwordx4 v232, s[94:95]
    s_add_u32 s94, s94, 4096
    s_addc_u32 s95, s95, 0
    s_add_u32 m0, s88, 3072
    s_nop 0
    global_load_lds_dwordx4 v232, s[94:95]
    s_add_u32 s94, s94, 4096
    s_addc_u32 s95, s95, 0
    s_add_u32 m0, s88, 4096
    s_nop 0
    global_load_lds_dwordx4 v232, s[94:95]
    s_add_u32 s94, s94, 4096
    s_addc_u32 s95, s95, 0
    s_add_u32 m0, s88, 5120
    s_nop 0
    global_load_lds_dwordx4 v232, s[94:95]
    s_add_u32 s94, s94, 4096
    s_addc_u32 s95, s95, 0
    s_add_u32 m0, s88, 6144
    s_nop 0
    global_load_lds_dwordx4 v232, s[94:95]
    s_add_u32 s94, s94, 4096
    s_addc_u32 s95, s95, 0
    s_add_u32 m0, s88, 7168
    s_nop 0
    global_load_lds_dwordx4 v232, s[94:95]
    s_add_u32 s94, s94, 4096
    s_addc_u32 s95, s95, 0
    s_add_u32 m0, s88, 8192
    s_nop 0
    global_load_lds_dwordx4 v232, s[94:95]
    s_add_u32 s94, s94, 4096
    s_addc_u32 s95, s95, 0
    s_add_u32 m0, s88, 9216
    s_nop 0
    global_load_lds_dwordx4 v232, s[94:95]
    s_add_u32 s94, s94, 4096
    s_addc_u32 s95, s95, 0
    s_add_u32 m0, s88, 10240
    s_nop 0
    global_load_lds_dwordx4 v232, s[94:95]
    s_add_u32 s94, s94, 4096
    s_addc_u32 s95, s95, 0
    s_add_u32 m0, s88, 11264
    s_nop 0
    global_load_lds_dwordx4 v232, s[94:95]
    s_add_u32 s94, s94, 4096
    s_addc_u32 s95, s95, 0
    s_add_u32 m0, s88, 12288
    s_nop 0
    global_load_lds_dwordx4 v232, s[94:95]
    s_add_u32 s94, s94, 4096
    s_addc_u32 s95, s95, 0
    s_add_u32 m0, s88, 13312
    s_nop 0
    global_load_lds_dwordx4 v232, s[94:95]
    s_add_u32 s94, s94, 4096
    s_addc_u32 s95, s95, 0
    s_add_u32 m0, s88, 14336
    s_nop 0
    global_load_lds_dwordx4 v232, s[94:95]
    s_add_u32 s94, s94, 4096
    s_addc_u32 s95, s95, 0
    s_add_u32 m0, s88, 15360
    s_nop 0
    global_load_lds_dwordx4 v232, s[94:95]
    s_add_u32 s94, s94, 4096
    s_addc_u32 s95, s95, 0
    s_add_u32 m0, s88, 16384
    s_nop 0
    global_load_lds_dwordx4 v232, s[94:95]
    s_add_u32 s94, s94, 4096
    s_addc_u32 s95, s95, 0
    s_add_u32 m0, s88, 17408
    s_nop 0
    global_load_lds_dwordx4 v232, s[94:95]
    s_add_u32 s94, s94, 4096
    s_addc_u32 s95, s95, 0
    s_add_u32 m0, s88, 18432
    s_nop 0
    global_load_lds_dwordx4 v232, s[94:95]
    s_add_u32 s94, s94, 4096
    s_addc_u32 s95, s95, 0
    s_add_u32 m0, s88, 19456
    s_nop 0
    global_load_lds_dwordx4 v232, s[94:95]
    s_add_u32 s94, s94, 4096
    s_addc_u32 s95, s95, 0
    s_add_u32 m0, s88, 20480
    s_nop 0
    global_load_lds_dwordx4 v232, s[94:95]
    s_add_u32 s94, s94, 4096
    s_addc_u32 s95, s95, 0
    s_add_u32 m0, s88, 21504
    s_nop 0
    global_load_lds_dwordx4 v232, s[94:95]
    s_add_u32 s94, s94, 4096
    s_addc_u32 s95, s95, 0
    s_add_u32 m0, s88, 22528
    s_nop 0
    global_load_lds_dwordx4 v232, s[94:95]
    s_add_u32 s94, s94, 4096
    s_addc_u32 s95, s95, 0
    s_add_u32 m0, s88, 23552
    s_nop 0
    global_load_lds_dwordx4 v232, s[94:95]
    s_add_u32 s94, s94, 4096
    s_addc_u32 s95, s95, 0
    s_add_u32 m0, s88, 24576
    s_nop 0
    global_load_lds_dwordx4 v232, s[94:95]
    s_add_u32 s94, s94, 4096
    s_addc_u32 s95, s95, 0
    s_add_u32 m0, s88, 25600
    s_nop 0
    global_load_lds_dwordx4 v232, s[94:95]
    s_add_u32 s94, s94, 4096
    s_addc_u32 s95, s95, 0
    s_add_u32 m0, s88, 26624
    s_nop 0
    global_load_lds_dwordx4 v232, s[94:95]
    s_add_u32 s94, s94, 4096
    s_addc_u32 s95, s95, 0
    s_add_u32 m0, s88, 27648
    s_nop 0
    global_load_lds_dwordx4 v232, s[94:95]
    s_add_u32 s94, s94, 4096
    s_addc_u32 s95, s95, 0
    s_add_u32 m0, s88, 28672
    s_nop 0
    global_load_lds_dwordx4 v232, s[94:95]
    s_add_u32 s94, s94, 4096
    s_addc_u32 s95, s95, 0
    s_add_u32 m0, s88, 29696
    s_nop 0
    global_load_lds_dwordx4 v232, s[94:95]
    s_add_u32 s94, s94, 4096
    s_addc_u32 s95, s95, 0
    s_add_u32 m0, s88, 30720
    s_nop 0
    global_load_lds_dwordx4 v232, s[94:95]
    s_add_u32 s94, s94, 4096
    s_addc_u32 s95, s95, 0
    s_add_u32 m0, s88, 31744
    s_nop 0
    global_load_lds_dwordx4 v232, s[94:95]
    s_add_u32 s94, s94, 4096
    s_addc_u32 s95, s95, 0
    s_lshl_b32 s89, s4, 13
    s_add_u32 s89, s89, 131072
    v_lshlrev_b32 v2, 4, v1
    v_lshlrev_b32 v3, 3, v1
    v_and_b32 v20, 15, v1
    v_lshrrev_b32 v21, 4, v1
    v_bfe_u32 v22, v20, 2, 2
    v_xor_b32 v22, v22, v21
    v_lshlrev_b32 v22, 3, v22
    v_lshl_add_u32 v22, v20, 5, v22
    v_add_u32 v4, s89, v22
    v_bfe_u32 v22, v1, 2, 2
    v_lshrrev_b32 v23, 1, v21
    v_lshl_add_u32 v22, v23, 4, v22
    v_and_b32 v23, 1, v21
    v_lshl_add_u32 v22, v23, 2, v22
    v_and_b32 v24, 3, v1
    v_xor_b32 v24, v24, v23
    v_lshlrev_b32 v24, 3, v24
    v_lshl_add_u32 v22, v22, 5, v24
    v_add_u32 v5, s89, v22
    v_xor_b32 v6, 16, v5
    v_lshrrev_b32 v22, 3, v20
    v_lshlrev_b32 v22, 4, v22
    v_and_b32 v23, 7, v20
    v_add_u32 v22, v22, v23
    v_lshrrev_b32 v23, 1, v21
    v_lshlrev_b32 v23, 4, v23
    v_and_b32 v24, 1, v21
    v_lshl_add_u32 v23, v24, 2, v23
    v_sub_u32 v9, v22, v23
    v_add_u32 v10, 8, v9
    v_lshl_add_u32 v25, v24, 5, v22
    v_lshlrev_b32 v25, 4, v25
    v_lshrrev_b32 v23, 1, v21
    v_lshl_add_u32 v7, v23, 10, v25
    v_add_u32 v8, 128, v7
    v_mov_b32 v15, 0
    v_mov_b32 v16, 0
    s_mov_b32 s26, 0x3fb8aa3b
    s_mov_b32 s27, 0x3db504f3
    v_add_u32 v7, s89, v7
    v_add_u32 v8, s89, v8
    v_lshrrev_b32 v20, 4, v1
    v_bfe_u32 v21, v1, 2, 2
    v_and_b32 v22, 3, v1
    v_lshrrev_b32 v23, 1, v20
    v_lshl_add_u32 v23, v23, 2, v21
    v_xor_b32 v24, s4, v21
    v_lshlrev_b32 v24, 2, v24
    v_and_b32 v25, 1, v20
    v_lshl_add_u32 v24, v25, 1, v24
    v_lshrrev_b32 v25, 1, v22
    v_add_u32 v24, v24, v25
    v_and_b32 v25, 1, v22
    v_lshlrev_b32 v25, 3, v25
    v_lshl_add_u32 v25, v24, 4, v25
    v_lshl_add_u32 v233, v23, 8, v25
    v_add_u32 v234, 0x10000, v233
    v_add_u32 v235, 131072, v2
    v_and_b32 v20, 31, v1
    v_lshlrev_b32 v20, 10, v20
    v_lshrrev_b32 v21, 5, v1
    v_lshl_add_u32 v236, v21, 3, v20
    s_lshl_b32 s9, s91, 2
    s_add_u32 s9, s9, s4
    s_lshr_b32 s87, s84, 5
    s_lshl_b32 s87, s87, 2
    s_add_u32 s87, s87, s92
    s_lshl_b32 s87, s87, 18
    s_add_u32 s48, s87, 76546048
    s_lshl_b32 s87, s4, 9
    v_add_u32 v237, s87, v3
    v_mov_b32 v20, -1
    v_mov_b32 v21, -1
    s_lshl_b32 s87, s91, 11
    s_add_u32 s87, s87, s48
    s_add_u32 s94, s80, s87
    s_addc_u32 s95, s81, 0
    global_store_dwordx2 v237, v[20:21], s[94:95] sc1
    s_add_u32 s94, s94, 16384
    s_addc_u32 s95, s95, 0
    global_store_dwordx2 v237, v[20:21], s[94:95] sc1
    s_add_u32 s94, s94, 16384
    s_addc_u32 s95, s95, 0
    global_store_dwordx2 v237, v[20:21], s[94:95] sc1
    s_add_u32 s94, s94, 16384
    s_addc_u32 s95, s95, 0
    global_store_dwordx2 v237, v[20:21], s[94:95] sc1
    s_add_u32 s94, s94, 16384
    s_addc_u32 s95, s95, 0
    global_store_dwordx2 v237, v[20:21], s[94:95] sc1
    s_add_u32 s94, s94, 16384
    s_addc_u32 s95, s95, 0
    global_store_dwordx2 v237, v[20:21], s[94:95] sc1
    s_add_u32 s94, s94, 16384
    s_addc_u32 s95, s95, 0
    global_store_dwordx2 v237, v[20:21], s[94:95] sc1
    s_add_u32 s94, s94, 16384
    s_addc_u32 s95, s95, 0
    global_store_dwordx2 v237, v[20:21], s[94:95] sc1
    s_add_u32 s94, s94, 16384
    s_addc_u32 s95, s95, 0
    global_store_dwordx2 v237, v[20:21], s[94:95] sc1
    s_add_u32 s94, s94, 16384
    s_addc_u32 s95, s95, 0
    global_store_dwordx2 v237, v[20:21], s[94:95] sc1
    s_add_u32 s94, s94, 16384
    s_addc_u32 s95, s95, 0
    global_store_dwordx2 v237, v[20:21], s[94:95] sc1
    s_add_u32 s94, s94, 16384
    s_addc_u32 s95, s95, 0
    global_store_dwordx2 v237, v[20:21], s[94:95] sc1
    s_add_u32 s94, s94, 16384
    s_addc_u32 s95, s95, 0
    global_store_dwordx2 v237, v[20:21], s[94:95] sc1
    s_add_u32 s94, s94, 16384
    s_addc_u32 s95, s95, 0
    global_store_dwordx2 v237, v[20:21], s[94:95] sc1
    s_add_u32 s94, s94, 16384
    s_addc_u32 s95, s95, 0
    global_store_dwordx2 v237, v[20:21], s[94:95] sc1
    s_add_u32 s94, s94, 16384
    s_addc_u32 s95, s95, 0
    global_store_dwordx2 v237, v[20:21], s[94:95] sc1
    s_add_u32 s94, s94, 16384
    s_addc_u32 s95, s95, 0
    s_waitcnt vmcnt(0)
    s_barrier
    s_mov_b32 s58, 0
    s_mov_b32 s50, 0
    s_mov_b32 s59, 0
    s_lshr_b32 s87, s84, 5
    s_lshl_b32 s87, s87, 2
    s_add_u32 s87, s87, s92
    s_lshl_b32 s87, s87, 3
    s_add_u32 s51, s87, 15616
    s_cmp_lg_u32 s4, 0
    s_cbranch_scc1 grp_168
    s_getreg_b32 s87, hwreg(HW_REG_XCC_ID, 0, 3)
    s_lshl_b32 s87, s87, 3
    s_lshl_b64 s[94:95], 1, s87
    v_mov_b32 v20, s51
    v_mov_b32 v22, s94
    v_mov_b32 v23, s95
    s_mov_b64 exec, 1
    global_atomic_add_x2 v20, v[22:23], s[82:83] sc1
    s_mov_b64 exec, -1
grp_168:
gw_170:
    v_mov_b32 v20, s51
    global_load_dwordx2 v[22:23], v20, s[82:83] sc1
    s_waitcnt vmcnt(0)
    v_readfirstlane_b32 s94, v22
    v_readfirstlane_b32 s95, v23
    s_and_b32 s87, s94, 0x0f0f0f0f
    s_and_b32 s88, s95, 0x0f0f0f0f
    s_add_u32 s87, s87, s88
    s_mul_i32 s87, s87, 0x01010101
    s_lshr_b32 s87, s87, 24
    s_cmp_ge_u32 s87, 8
    s_cbranch_scc1 gk_169
    s_sub_u32 s86, s86, 1
    s_cbranch_scc1 gk_169
    s_sleep 32
    s_branch gw_170
gk_169:
    s_getreg_b32 s87, hwreg(HW_REG_XCC_ID, 0, 3)
    s_lshl_b32 s87, s87, 3
    s_lshr_b64 s[94:95], s[94:95], s87
    s_and_b32 s87, s94, 0xff
    s_cmp_eq_u32 s87, 8
    s_cselect_b32 s59, 1, 2
tl_171:
    s_cmp_ge_u32 s90, 64
    s_cbranch_scc1 tdone_172
    s_mov_b32 s8, s90
    s_cmp_lg_u32 s58, 0
    s_cbranch_scc1 skf_173
    s_lshr_b32 s88, s90, 2
    s_lshl_b32 s88, s88, 7
    s_add_u32 s89, s88, 2048
    v_mov_b32 v20, s89
wf_174:
    global_load_dword v21, v20, s[82:83] sc1
    s_waitcnt vmcnt(0)
    v_readfirstlane_b32 s87, v21
    s_cmp_ge_u32 s87, 32
    s_cbranch_scc1 wfd_175
    s_sub_u32 s86, s86, 1
    s_cbranch_scc1 wfd_175_x
    s_sleep 8
    s_branch wf_174
wfd_175_x:
    s_mov_b32 s86, 0
wfd_175:
    s_lshr_b32 s88, s90, 2
    s_lshl_b32 s88, s88, 7
    s_add_u32 s89, s88, 4096
    v_mov_b32 v20, s89
wf_176:
    global_load_dword v21, v20, s[82:83] sc1
    s_waitcnt vmcnt(0)
    v_readfirstlane_b32 s87, v21
    s_cmp_ge_u32 s87, 16
    s_cbranch_scc1 wfd_177
    s_sub_u32 s86, s86, 1
    s_cbranch_scc1 wfd_177_x
    s_sleep 8
    s_branch wf_176
wfd_177_x:
    s_mov_b32 s86, 0
wfd_177:
    v_mov_b32 v20, 15488
    global_load_dword v21, v20, s[82:83] sc1
    s_waitcnt vmcnt(0)
    v_readfirstlane_b32 s87, v21
    s_cmp_ge_u32 s87, 800
    s_cselect_b32 s58, 1, 0
skf_173:
    s_lshl_b32 s22, s8, 5
    s_add_u32 s22, s22, s9
    s_lshl_b32 s23, s22, 13
    s_add_u32 s24, s23, 4096
    s_add_u32 s12, s80, s24
    s_addc_u32 s13, s81, 0
    s_add_u32 s24, s23, 16781312
    s_add_u32 s14, s80, s24
    s_addc_u32 s15, s81, 0
    s_add_u32 s24, s23, 33558528
    s_add_u32 s10, s80, s24
    s_addc_u32 s11, s81, 0
    s_lshl_b32 s23, s22, 12
    s_add_u32 s24, s23, 50462720
    s_add_u32 s16, s80, s24
    s_addc_u32 s17, s81, 0
    global_load_dwordx4 v[32:35], v2, s[10:11] offset:-4096 sc1
    global_load_dwordx4 v[36:39], v2, s[10:11] offset:-3072 sc1
    global_load_dwordx4 v[40:43], v2, s[10:11] offset:-2048 sc1
    global_load_dwordx4 v[44:47], v2, s[10:11] offset:-1024 sc1
    global_load_dwordx4 v[48:51], v2, s[10:11] offset:0 sc1
    global_load_dwordx4 v[52:55], v2, s[10:11] offset:1024 sc1
    global_load_dwordx4 v[56:59], v2, s[10:11] offset:2048 sc1
    global_load_dwordx4 v[60:63], v2, s[10:11] offset:3072 sc1
    global_load_dwordx4 v[64:67], v2, s[12:13] offset:-4096 sc1
    global_load_dwordx4 v[68:71], v2, s[12:13] offset:-3072 sc1
    global_load_dwordx4 v[72:75], v2, s[12:13] offset:-2048 sc1
    global_load_dwordx4 v[76:79], v2, s[12:13] offset:-1024 sc1
    global_load_dwordx4 v[80:83], v2, s[12:13] offset:0 sc1
    global_load_dwordx4 v[84:87], v2, s[12:13] offset:1024 sc1
    global_load_dwordx4 v[88:91], v2, s[12:13] offset:2048 sc1
    global_load_dwordx4 v[92:95], v2, s[12:13] offset:3072 sc1
    global_load_dwordx4 v[96:99], v2, s[14:15] offset:-4096 sc1
    global_load_dwordx4 v[100:103], v2, s[14:15] offset:-3072 sc1
    global_load_dwordx4 v[104:107], v2, s[14:15] offset:-2048 sc1
    global_load_dwordx4 v[108:111], v2, s[14:15] offset:-1024 sc1
    global_load_dwordx4 v[112:115], v2, s[14:15] offset:0 sc1
    global_load_dwordx4 v[116:119], v2, s[14:15] offset:1024 sc1
    global_load_dwordx4 v[120:123], v2, s[14:15] offset:2048 sc1
    global_load_dwordx4 v[124:127], v2, s[14:15] offset:3072 sc1
    s_waitcnt vmcnt(8)
    v_mfma_f32_16x16x32_bf16 v[156:159], v[64:67], v[32:35], 0
    v_mfma_f32_16x16x32_bf16 v[160:163], v[80:83], v[32:35], 0
    v_mfma_f32_16x16x32_bf16 v[156:159], v[68:71], v[36:39], v[156:159]
    v_mfma_f32_16x16x32_bf16 v[160:163], v[84:87], v[36:39], v[160:163]
    v_mfma_f32_16x16x32_bf16 v[156:159], v[72:75], v[40:43], v[156:159]
    v_mfma_f32_16x16x32_bf16 v[160:163], v[88:91], v[40:43], v[160:163]
    v_mfma_f32_16x16x32_bf16 v[156:159], v[76:79], v[44:47], v[156:159]
    v_mfma_f32_16x16x32_bf16 v[160:163], v[92:95], v[44:47], v[160:163]
    v_mfma_f32_16x16x32_bf16 v[168:171], v[64:67], v[48:51], 0
    v_mfma_f32_16x16x32_bf16 v[172:175], v[80:83], v[48:51], 0
    v_mfma_f32_16x16x32_bf16 v[168:171], v[68:71], v[52:55], v[168:171]
    v_mfma_f32_16x16x32_bf16 v[172:175], v[84:87], v[52:55], v[172:175]
    v_mfma_f32_16x16x32_bf16 v[168:171], v[72:75], v[56:59], v[168:171]
    v_mfma_f32_16x16x32_bf16 v[172:175], v[88:91], v[56:59], v[172:175]
    v_mfma_f32_16x16x32_bf16 v[168:171], v[76:79], v[60:63], v[168:171]
    v_mfma_f32_16x16x32_bf16 v[172:175], v[92:95], v[60:63], v[172:175]
    v_cvt_pk_bf16_f32 v20, v156, v157
    v_lshlrev_b32 v156, 16, v20
    v_and_b32 v157, 0xffff0000, v20
    v_cvt_pk_bf16_f32 v21, v158, v159
    v_lshlrev_b32 v158, 16, v21
    v_and_b32 v159, 0xffff0000, v21
    v_cvt_pk_bf16_f32 v22, v160, v161
    v_lshlrev_b32 v160, 16, v22
    v_and_b32 v161, 0xffff0000, v22
    v_cvt_pk_bf16_f32 v23, v162, v163
    v_lshlrev_b32 v162, 16, v23
    v_and_b32 v163, 0xffff0000, v23
    v_mul_f32 v156, s27, v156
    v_mul_f32 v157, s27, v157
    v_mul_f32 v158, s27, v158
    v_mul_f32 v159, s27, v159
    v_mul_f32 v160, s27, v160
    v_mul_f32 v161, s27, v161
    v_mul_f32 v162, s27, v162
    v_mul_f32 v163, s27, v163
    v_cvt_pk_bf16_f32 v20, v156, v157
    v_lshlrev_b32 v156, 16, v20
    v_and_b32 v157, 0xffff0000, v20
    v_cvt_pk_bf16_f32 v21, v158, v159
    v_lshlrev_b32 v158, 16, v21
    v_and_b32 v159, 0xffff0000, v21
    v_cvt_pk_bf16_f32 v22, v160, v161
    v_lshlrev_b32 v160, 16, v22
    v_and_b32 v161, 0xffff0000, v22
    v_cvt_pk_bf16_f32 v23, v162, v163
    v_lshlrev_b32 v162, 16, v23
    v_and_b32 v163, 0xffff0000, v23
    v_mov_b32 v26, 0xf149f2ca
    v_cmp_le_i32 vcc, 0, v9
    s_nop 1
    v_cndmask_b32 v156, v26, v156, vcc
    v_cmp_le_i32 vcc, 1, v9
    s_nop 1
    v_cndmask_b32 v157, v26, v157, vcc
    v_cmp_le_i32 vcc, 2, v9
    s_nop 1
    v_cndmask_b32 v158, v26, v158, vcc
    v_cmp_le_i32 vcc, 3, v9
    s_nop 1
    v_cndmask_b32 v159, v26, v159, vcc
    v_cmp_le_i32 vcc, 8, v9
    s_nop 1
    v_cndmask_b32 v160, v26, v160, vcc
    v_cmp_le_i32 vcc, 9, v9
    s_nop 1
    v_cndmask_b32 v161, v26, v161, vcc
    v_cmp_le_i32 vcc, 10, v9
    s_nop 1
    v_cndmask_b32 v162, v26, v162, vcc
    v_cmp_le_i32 vcc, 11, v9
    s_nop 1
    v_cndmask_b32 v163, v26, v163, vcc
    v_max3_f32 v20, v156, v157, v158
    v_max3_f32 v21, v159, v160, v161
    v_max3_f32 v20, v162, v163, v20
    v_max_f32 v18, v20, v21
    v_cvt_pk_bf16_f32 v20, v168, v169
    v_lshlrev_b32 v168, 16, v20
    v_and_b32 v169, 0xffff0000, v20
    v_cvt_pk_bf16_f32 v21, v170, v171
    v_lshlrev_b32 v170, 16, v21
    v_and_b32 v171, 0xffff0000, v21
    v_cvt_pk_bf16_f32 v22, v172, v173
    v_lshlrev_b32 v172, 16, v22
    v_and_b32 v173, 0xffff0000, v22
    v_cvt_pk_bf16_f32 v23, v174, v175
    v_lshlrev_b32 v174, 16, v23
    v_and_b32 v175, 0xffff0000, v23
    v_mul_f32 v168, s27, v168
    v_mul_f32 v169, s27, v169
    v_mul_f32 v170, s27, v170
    v_mul_f32 v171, s27, v171
    v_mul_f32 v172, s27, v172
    v_mul_f32 v173, s27, v173
    v_mul_f32 v174, s27, v174
    v_mul_f32 v175, s27, v175
    v_cvt_pk_bf16_f32 v20, v168, v169
    v_lshlrev_b32 v168, 16, v20
    v_and_b32 v169, 0xffff0000, v20
    v_cvt_pk_bf16_f32 v21, v170, v171
    v_lshlrev_b32 v170, 16, v21
    v_and_b32 v171, 0xffff0000, v21
    v_cvt_pk_bf16_f32 v22, v172, v173
    v_lshlrev_b32 v172, 16, v22
    v_and_b32 v173, 0xffff0000, v22
    v_cvt_pk_bf16_f32 v23, v174, v175
    v_lshlrev_b32 v174, 16, v23
    v_and_b32 v175, 0xffff0000, v23
    v_mov_b32 v26, 0xf149f2ca
    v_cmp_le_i32 vcc, 0, v10
    s_nop 1
    v_cndmask_b32 v168, v26, v168, vcc
    v_cmp_le_i32 vcc, 1, v10
    s_nop 1
    v_cndmask_b32 v169, v26, v169, vcc
    v_cmp_le_i32 vcc, 2, v10
    s_nop 1
    v_cndmask_b32 v170, v26, v170, vcc
    v_cmp_le_i32 vcc, 3, v10
    s_nop 1
    v_cndmask_b32 v171, v26, v171, vcc
    v_cmp_le_i32 vcc, 8, v10
    s_nop 1
    v_cndmask_b32 v172, v26, v172, vcc
    v_cmp_le_i32 vcc, 9, v10
    s_nop 1
    v_cndmask_b32 v173, v26, v173, vcc
    v_cmp_le_i32 vcc, 10, v10
    s_nop 1
    v_cndmask_b32 v174, v26, v174, vcc
    v_cmp_le_i32 vcc, 11, v10
    s_nop 1
    v_cndmask_b32 v175, v26, v175, vcc
    v_max3_f32 v20, v168, v169, v170
    v_max3_f32 v21, v171, v172, v173
    v_max3_f32 v20, v174, v175, v20
    v_max_f32 v19, v20, v21
    s_cmp_ge_u32 s90, 62
    s_cbranch_scc1 dir_178
    s_lshl_b32 s89, s9, 7
    s_add_u32 s89, s89, 10240
    s_add_u32 s88, s90, 2
    s_cmp_ge_u32 s90, 56
    s_cbranch_scc1 lz_180
    v_mov_b32 v20, s89
wf_182:
    global_load_dword v21, v20, s[82:83] sc1
    s_waitcnt vmcnt(0)
    v_readfirstlane_b32 s87, v21
    s_cmp_ge_u32 s87, s88
    s_cbranch_scc1 wfd_183
    s_sub_u32 s86, s86, 1
    s_cbranch_scc1 wfd_183_x
    s_sleep 64
    s_branch wf_182
wfd_183_x:
    s_mov_b32 s86, 0
wfd_183:
    s_branch lq_181
lz_180:
    v_mov_b32 v20, s89
wf_184:
    global_load_dword v21, v20, s[82:83] sc1
    s_waitcnt vmcnt(0)
    v_readfirstlane_b32 s87, v21
    s_cmp_ge_u32 s87, s88
    s_cbranch_scc1 wfd_185
    s_sub_u32 s86, s86, 1
    s_cbranch_scc1 wfd_185_x
    s_sleep 2
    s_branch wf_184
wfd_185_x:
    s_mov_b32 s86, 0
wfd_185:
lq_181:
    global_load_dwordx4 v[200:203], v2, s[16:17] offset:0 sc1
    global_load_dwordx4 v[204:207], v2, s[16:17] offset:1024 sc1
    global_load_dwordx4 v[208:211], v2, s[16:17] offset:2048 sc1
    global_load_dwordx4 v[212:215], v2, s[16:17] offset:3072 sc1
    s_waitcnt vmcnt(0)
    s_branch kvj_179
dir_178:
    s_mov_b32 s89, 15488
    v_mov_b32 v20, s89
wf_186:
    global_load_dword v21, v20, s[82:83] sc1
    s_waitcnt vmcnt(0)
    v_readfirstlane_b32 s87, v21
    s_cmp_ge_u32 s87, 800
    s_cbranch_scc1 wfd_187
    s_sub_u32 s86, s86, 1
    s_cbranch_scc1 wfd_187_x
    s_sleep 8
    s_branch wf_186
wfd_187_x:
    s_mov_b32 s86, 0
wfd_187:
dl_188:
    global_load_dwordx4 v[200:203], v2, s[16:17] offset:0 sc1
    global_load_dwordx4 v[204:207], v2, s[16:17] offset:1024 sc1
    global_load_dwordx4 v[208:211], v2, s[16:17] offset:2048 sc1
    global_load_dwordx4 v[212:215], v2, s[16:17] offset:3072 sc1
    s_waitcnt vmcnt(0)
    v_max3_u32 v20, v200, v201, v202
    v_max3_u32 v20, v203, v204, v20
    v_max3_u32 v20, v205, v206, v20
    v_max3_u32 v20, v207, v208, v20
    v_max3_u32 v20, v209, v210, v20
    v_max3_u32 v20, v211, v212, v20
    v_max3_u32 v20, v213, v214, v20
    v_max_u32 v20, v20, v215
    v_cmp_eq_u32 vcc, -1, v20
    s_cbranch_vccz do_189
    s_sub_u32 s86, s86, 1
    s_cbranch_scc1 do_189_x
    s_sleep 2
    s_branch dl_188
do_189_x:
    s_mov_b32 s86, 0
do_189:
kvj_179:
    ds_write2_b32 v4, v200, v201 offset0:0 offset1:128
    v_add_u32 v28, 1024, v4
    ds_write2_b32 v28, v204, v205 offset0:0 offset1:128
    v_add_u32 v28, 2048, v4
    ds_write2_b32 v28, v208, v209 offset0:0 offset1:128
    v_add_u32 v28, 3072, v4
    ds_write2_b32 v28, v212, v213 offset0:0 offset1:128
    s_waitcnt lgkmcnt(0)
    ds_read_b64_tr_b16 v[128:129], v5 offset:0
    ds_read_b64_tr_b16 v[130:131], v6 offset:256
    ds_read_b64_tr_b16 v[132:133], v5 offset:1024
    ds_read_b64_tr_b16 v[134:135], v6 offset:1280
    ds_read_b64_tr_b16 v[136:137], v5 offset:2048
    ds_read_b64_tr_b16 v[138:139], v6 offset:2304
    ds_read_b64_tr_b16 v[140:141], v5 offset:3072
    ds_read_b64_tr_b16 v[142:143], v6 offset:3328
    s_waitcnt lgkmcnt(0)
    v_mfma_f32_16x16x32_bf16 v[152:155], v[128:131], v[32:35], 0
    v_mfma_f32_16x16x32_bf16 v[164:167], v[128:131], v[48:51], 0
    v_mfma_f32_16x16x32_bf16 v[152:155], v[132:135], v[36:39], v[152:155]
    v_mfma_f32_16x16x32_bf16 v[164:167], v[132:135], v[52:55], v[164:167]
    v_mfma_f32_16x16x32_bf16 v[152:155], v[136:139], v[40:43], v[152:155]
    v_mfma_f32_16x16x32_bf16 v[164:167], v[136:139], v[56:59], v[164:167]
    v_mfma_f32_16x16x32_bf16 v[152:155], v[140:143], v[44:47], v[152:155]
    v_mfma_f32_16x16x32_bf16 v[164:167], v[140:143], v[60:63], v[164:167]
    s_nop 6
    v_cvt_pk_bf16_f32 v20, v152, v153
    v_lshlrev_b32 v152, 16, v20
    v_and_b32 v153, 0xffff0000, v20
    v_cvt_pk_bf16_f32 v21, v164, v165
    v_lshlrev_b32 v164, 16, v21
    v_and_b32 v165, 0xffff0000, v21
    v_mul_f32 v152, s27, v152
    v_mul_f32 v153, s27, v153
    v_mul_f32 v164, s27, v164
    v_mul_f32 v165, s27, v165
    v_cvt_pk_bf16_f32 v20, v152, v153
    v_lshlrev_b32 v152, 16, v20
    v_and_b32 v153, 0xffff0000, v20
    v_cvt_pk_bf16_f32 v21, v164, v165
    v_lshlrev_b32 v164, 16, v21
    v_and_b32 v165, 0xffff0000, v21
    v_max3_f32 v20, v152, v153, v18
    v_max3_f32 v22, v164, v165, v19
    v_mov_b32 v21, v20
    v_mov_b32 v23, v22
    s_nop 0
    v_permlane32_swap_b32 v20, v21
    v_permlane32_swap_b32 v22, v23
    v_max_f32 v20, v20, v21
    v_max_f32 v22, v22, v23
    v_mov_b32 v21, v20
    v_mov_b32 v23, v22
    s_nop 0
    v_permlane16_swap_b32 v20, v21
    v_permlane16_swap_b32 v22, v23
    v_max_f32 v20, v20, v21
    v_max_f32 v22, v22, v23
    v_sub_f32 v152, v152, v20
    v_sub_f32 v153, v153, v20
    v_sub_f32 v156, v156, v20
    v_sub_f32 v157, v157, v20
    v_sub_f32 v158, v158, v20
    v_sub_f32 v159, v159, v20
    v_sub_f32 v160, v160, v20
    v_sub_f32 v161, v161, v20
    v_sub_f32 v162, v162, v20
    v_sub_f32 v163, v163, v20
    v_sub_f32 v164, v164, v22
    v_sub_f32 v165, v165, v22
    v_sub_f32 v168, v168, v22
    v_sub_f32 v169, v169, v22
    v_sub_f32 v170, v170, v22
    v_sub_f32 v171, v171, v22
    v_sub_f32 v172, v172, v22
    v_sub_f32 v173, v173, v22
    v_sub_f32 v174, v174, v22
    v_sub_f32 v175, v175, v22
    v_mul_f32 v152, s26, v152
    v_mul_f32 v153, s26, v153
    v_mul_f32 v156, s26, v156
    v_mul_f32 v157, s26, v157
    v_mul_f32 v158, s26, v158
    v_mul_f32 v159, s26, v159
    v_mul_f32 v160, s26, v160
    v_mul_f32 v161, s26, v161
    v_mul_f32 v162, s26, v162
    v_mul_f32 v163, s26, v163
    v_mul_f32 v164, s26, v164
    v_mul_f32 v165, s26, v165
    v_mul_f32 v168, s26, v168
    v_mul_f32 v169, s26, v169
    v_mul_f32 v170, s26, v170
    v_mul_f32 v171, s26, v171
    v_mul_f32 v172, s26, v172
    v_mul_f32 v173, s26, v173
    v_mul_f32 v174, s26, v174
    v_mul_f32 v175, s26, v175
    v_exp_f32 v152, v152
    v_exp_f32 v153, v153
    v_exp_f32 v156, v156
    v_exp_f32 v157, v157
    v_exp_f32 v158, v158
    v_exp_f32 v159, v159
    v_exp_f32 v160, v160
    v_exp_f32 v161, v161
    v_exp_f32 v162, v162
    v_exp_f32 v163, v163
    v_exp_f32 v164, v164
    v_exp_f32 v165, v165
    v_exp_f32 v168, v168
    v_exp_f32 v169, v169
    v_exp_f32 v170, v170
    v_exp_f32 v171, v171
    v_exp_f32 v172, v172
    v_exp_f32 v173, v173
    v_exp_f32 v174, v174
    v_exp_f32 v175, v175
    v_add_f32 v24, v152, v153
    v_add_f32 v26, v164, v165
    v_add_f32 v24, v24, v156
    v_add_f32 v26, v26, v168
    v_add_f32 v24, v24, v157
    v_add_f32 v26, v26, v169
    v_add_f32 v24, v24, v158
    v_add_f32 v26, v26, v170
    v_add_f32 v24, v24, v159
    v_add_f32 v26, v26, v171
    v_add_f32 v24, v24, v160
    v_add_f32 v26, v26, v172
    v_add_f32 v24, v24, v161
    v_add_f32 v26, v26, v173
    v_add_f32 v24, v24, v162
    v_add_f32 v26, v26, v174
    v_add_f32 v24, v24, v163
    v_add_f32 v26, v26, v175
    v_mov_b32 v25, v24
    v_mov_b32 v27, v26
    s_nop 0
    v_permlane32_swap_b32 v24, v25
    v_permlane32_swap_b32 v26, v27
    v_add_f32 v24, v24, v25
    v_add_f32 v26, v26, v27
    v_mov_b32 v25, v24
    v_mov_b32 v27, v26
    s_nop 0
    v_permlane16_swap_b32 v24, v25
    v_permlane16_swap_b32 v26, v27
    v_add_f32 v24, v24, v25
    v_add_f32 v26, v26, v27
    v_rcp_f32 v24, v24
    v_rcp_f32 v26, v26
    v_mul_f32 v152, v24, v152
    v_mul_f32 v153, v24, v153
    v_mul_f32 v156, v24, v156
    v_mul_f32 v157, v24, v157
    v_mul_f32 v158, v24, v158
    v_mul_f32 v159, v24, v159
    v_mul_f32 v160, v24, v160
    v_mul_f32 v161, v24, v161
    v_mul_f32 v162, v24, v162
    v_mul_f32 v163, v24, v163
    v_mul_f32 v164, v26, v164
    v_mul_f32 v165, v26, v165
    v_mul_f32 v168, v26, v168
    v_mul_f32 v169, v26, v169
    v_mul_f32 v170, v26, v170
    v_mul_f32 v171, v26, v171
    v_mul_f32 v172, v26, v172
    v_mul_f32 v173, v26, v173
    v_mul_f32 v174, v26, v174
    v_mul_f32 v175, v26, v175
    v_cvt_pk_bf16_f32 v176, v156, v157
    v_cvt_pk_bf16_f32 v177, v158, v159
    v_cvt_pk_bf16_f32 v178, v160, v161
    v_cvt_pk_bf16_f32 v179, v162, v163
    v_cvt_pk_bf16_f32 v14, v152, v153
    v_mov_b32 v17, v14
    s_nop 0
    v_mfma_f32_16x16x16_bf16 v[184:187], v[202:203], v[14:15], 0
    v_mfma_f32_16x16x16_bf16 v[188:191], v[202:203], v[16:17], 0
    s_nop 4
    v_mfma_f32_16x16x32_bf16 v[184:187], v[96:99], v[176:179], v[184:187]
    v_mfma_f32_16x16x32_bf16 v[188:191], v[100:103], v[176:179], v[188:191]
    s_nop 6
    v_cvt_pk_bf16_f32 v24, v184, v185
    v_cvt_pk_bf16_f32 v25, v186, v187
    v_cvt_pk_bf16_f32 v26, v188, v189
    v_cvt_pk_bf16_f32 v27, v190, v191
    ds_write_b128 v7, v[24:27] offset:0
    v_mfma_f32_16x16x16_bf16 v[192:195], v[206:207], v[14:15], 0
    v_mfma_f32_16x16x16_bf16 v[196:199], v[206:207], v[16:17], 0
    s_nop 4
    v_mfma_f32_16x16x32_bf16 v[192:195], v[104:107], v[176:179], v[192:195]
    v_mfma_f32_16x16x32_bf16 v[196:199], v[108:111], v[176:179], v[196:199]
    s_nop 6
    v_cvt_pk_bf16_f32 v28, v192, v193
    v_cvt_pk_bf16_f32 v29, v194, v195
    v_cvt_pk_bf16_f32 v30, v196, v197
    v_cvt_pk_bf16_f32 v31, v198, v199
    ds_write_b128 v7, v[28:31] offset:2048
    v_mfma_f32_16x16x16_bf16 v[184:187], v[210:211], v[14:15], 0
    v_mfma_f32_16x16x16_bf16 v[188:191], v[210:211], v[16:17], 0
    s_nop 4
    v_mfma_f32_16x16x32_bf16 v[184:187], v[112:115], v[176:179], v[184:187]
    v_mfma_f32_16x16x32_bf16 v[188:191], v[116:119], v[176:179], v[188:191]
    s_nop 6
    v_cvt_pk_bf16_f32 v24, v184, v185
    v_cvt_pk_bf16_f32 v25, v186, v187
    v_cvt_pk_bf16_f32 v26, v188, v189
    v_cvt_pk_bf16_f32 v27, v190, v191
    ds_write_b128 v7, v[24:27] offset:4096
    v_mfma_f32_16x16x16_bf16 v[192:195], v[214:215], v[14:15], 0
    v_mfma_f32_16x16x16_bf16 v[196:199], v[214:215], v[16:17], 0
    s_nop 4
    v_mfma_f32_16x16x32_bf16 v[192:195], v[120:123], v[176:179], v[192:195]
    v_mfma_f32_16x16x32_bf16 v[196:199], v[124:127], v[176:179], v[196:199]
    s_nop 6
    v_cvt_pk_bf16_f32 v28, v192, v193
    v_cvt_pk_bf16_f32 v29, v194, v195
    v_cvt_pk_bf16_f32 v30, v196, v197
    v_cvt_pk_bf16_f32 v31, v198, v199
    ds_write_b128 v7, v[28:31] offset:6144
    v_cvt_pk_bf16_f32 v180, v168, v169
    v_cvt_pk_bf16_f32 v181, v170, v171
    v_cvt_pk_bf16_f32 v182, v172, v173
    v_cvt_pk_bf16_f32 v183, v174, v175
    v_cvt_pk_bf16_f32 v14, v164, v165
    v_mov_b32 v17, v14
    s_nop 0
    v_mfma_f32_16x16x16_bf16 v[184:187], v[202:203], v[14:15], 0
    v_mfma_f32_16x16x16_bf16 v[188:191], v[202:203], v[16:17], 0
    s_nop 4
    v_mfma_f32_16x16x32_bf16 v[184:187], v[96:99], v[180:183], v[184:187]
    v_mfma_f32_16x16x32_bf16 v[188:191], v[100:103], v[180:183], v[188:191]
    s_nop 6
    v_cvt_pk_bf16_f32 v24, v184, v185
    v_cvt_pk_bf16_f32 v25, v186, v187
    v_cvt_pk_bf16_f32 v26, v188, v189
    v_cvt_pk_bf16_f32 v27, v190, v191
    ds_write_b128 v8, v[24:27] offset:0
    v_mfma_f32_16x16x16_bf16 v[192:195], v[206:207], v[14:15], 0
    v_mfma_f32_16x16x16_bf16 v[196:199], v[206:207], v[16:17], 0
    s_nop 4
    v_mfma_f32_16x16x32_bf16 v[192:195], v[104:107], v[180:183], v[192:195]
    v_mfma_f32_16x16x32_bf16 v[196:199], v[108:111], v[180:183], v[196:199]
    s_nop 6
    v_cvt_pk_bf16_f32 v28, v192, v193
    v_cvt_pk_bf16_f32 v29, v194, v195
    v_cvt_pk_bf16_f32 v30, v196, v197
    v_cvt_pk_bf16_f32 v31, v198, v199
    ds_write_b128 v8, v[28:31] offset:2048
    v_mfma_f32_16x16x16_bf16 v[184:187], v[210:211], v[14:15], 0
    v_mfma_f32_16x16x16_bf16 v[188:191], v[210:211], v[16:17], 0
    s_nop 4
    v_mfma_f32_16x16x32_bf16 v[184:187], v[112:115], v[180:183], v[184:187]
    v_mfma_f32_16x16x32_bf16 v[188:191], v[116:119], v[180:183], v[188:191]
    s_nop 6
    v_cvt_pk_bf16_f32 v24, v184, v185
    v_cvt_pk_bf16_f32 v25, v186, v187
    v_cvt_pk_bf16_f32 v26, v188, v189
    v_cvt_pk_bf16_f32 v27, v190, v191
    ds_write_b128 v8, v[24:27] offset:4096
    v_mfma_f32_16x16x16_bf16 v[192:195], v[214:215], v[14:15], 0
    v_mfma_f32_16x16x16_bf16 v[196:199], v[214:215], v[16:17], 0
    s_nop 4
    v_mfma_f32_16x16x32_bf16 v[192:195], v[120:123], v[180:183], v[192:195]
    v_mfma_f32_16x16x32_bf16 v[196:199], v[124:127], v[180:183], v[196:199]
    s_nop 6
    v_cvt_pk_bf16_f32 v28, v192, v193
    v_cvt_pk_bf16_f32 v29, v194, v195
    v_cvt_pk_bf16_f32 v30, v196, v197
    v_cvt_pk_bf16_f32 v31, v198, v199
    ds_write_b128 v8, v[28:31] offset:6144
    s_waitcnt lgkmcnt(0)
    s_barrier
    s_cmp_lg_u32 s58, 0
    s_cbranch_scc1 skg_190
    s_lshr_b32 s88, s90, 2
    s_lshl_b32 s88, s88, 7
    s_add_u32 s89, s88, 8192
    v_mov_b32 v20, s89
wf_191:
    global_load_dword v21, v20, s[82:83] sc1
    s_waitcnt vmcnt(0)
    v_readfirstlane_b32 s87, v21
    s_cmp_ge_u32 s87, 2
    s_cbranch_scc1 wfd_192
    s_sub_u32 s86, s86, 1
    s_cbranch_scc1 wfd_192_x
    s_sleep 8
    s_branch wf_191
wfd_192_x:
    s_mov_b32 s86, 0
wfd_192:
skg_190:
    s_lshl_b32 s87, s90, 15
    s_lshl_b32 s88, s92, 2
    s_add_u32 s88, s88, s4
    s_lshl_b32 s89, s88, 11
    s_add_u32 s89, s89, s87
    s_add_u32 s89, s89, 72351744
    s_lshr_b32 s98, s91, 2
    s_lshl_b32 s98, s98, 10
    s_add_u32 s89, s89, s98
    s_and_b32 s98, s91, 3
    s_lshl_b32 s98, s98, 2
    s_add_u32 s89, s89, s98
    s_add_u32 s94, s80, s89
    s_addc_u32 s95, s81, 0
    global_load_dword v176, v2, s[94:95] sc1
    s_lshl_b32 s88, s88, 6
    s_add_u32 s88, s88, s87
    s_lshr_b32 s98, s91, 1
    s_lshl_b32 s98, s98, 4
    s_add_u32 s88, s88, s98
    s_and_b32 s98, s91, 1
    s_lshl_b32 s98, s98, 2
    s_add_u32 s88, s88, s98
    s_add_u32 s94, s60, s88
    s_addc_u32 s95, s61, 0
    s_add_u32 s56, s76, s88
    s_addc_u32 s57, s77, 0
    global_load_dword v177, v236, s[94:95]
    v_mov_b64 v[240:241], 0
    v_mov_b64 v[242:243], 0
    v_mov_b64 v[244:245], 0
    v_mov_b64 v[246:247], 0
    v_mov_b64 v[248:249], 0
    v_mov_b64 v[250:251], 0
    v_mov_b64 v[252:253], 0
    v_mov_b64 v[254:255], 0
    ds_read_b64_tr_b16 v[32:33], v233 offset:0
    ds_read_b64_tr_b16 v[34:35], v233 offset:4096
    ds_read_b128 v[64:67], v235 offset:0
    ds_read_b64_tr_b16 v[36:37], v233 offset:2048
    ds_read_b64_tr_b16 v[38:39], v233 offset:6144
    ds_read_b128 v[68:71], v235 offset:1024
    ds_read_b64_tr_b16 v[40:41], v233 offset:8192
    ds_read_b64_tr_b16 v[42:43], v233 offset:12288
    ds_read_b128 v[72:75], v235 offset:2048
    ds_read_b64_tr_b16 v[44:45], v233 offset:10240
    ds_read_b64_tr_b16 v[46:47], v233 offset:14336
    ds_read_b128 v[76:79], v235 offset:3072
    s_waitcnt lgkmcnt(9)
    v_mfma_f32_32x32x16_bf16 v[240:255], v[32:35], v[64:67], v[240:255]
    ds_read_b64_tr_b16 v[32:33], v233 offset:16384
    ds_read_b64_tr_b16 v[34:35], v233 offset:20480
    ds_read_b128 v[64:67], v235 offset:4096
    s_waitcnt lgkmcnt(9)
    v_mfma_f32_32x32x16_bf16 v[240:255], v[36:39], v[68:71], v[240:255]
    ds_read_b64_tr_b16 v[36:37], v233 offset:18432
    ds_read_b64_tr_b16 v[38:39], v233 offset:22528
    ds_read_b128 v[68:71], v235 offset:5120
    s_waitcnt lgkmcnt(9)
    v_mfma_f32_32x32x16_bf16 v[240:255], v[40:43], v[72:75], v[240:255]
    ds_read_b64_tr_b16 v[40:41], v233 offset:24576
    ds_read_b64_tr_b16 v[42:43], v233 offset:28672
    ds_read_b128 v[72:75], v235 offset:6144
    s_waitcnt lgkmcnt(9)
    v_mfma_f32_32x32x16_bf16 v[240:255], v[44:47], v[76:79], v[240:255]
    ds_read_b64_tr_b16 v[44:45], v233 offset:26624
    ds_read_b64_tr_b16 v[46:47], v233 offset:30720
    ds_read_b128 v[76:79], v235 offset:7168
    s_waitcnt lgkmcnt(9)
    v_mfma_f32_32x32x16_bf16 v[240:255], v[32:35], v[64:67], v[240:255]
    ds_read_b64_tr_b16 v[32:33], v233 offset:32768
    ds_read_b64_tr_b16 v[34:35], v233 offset:36864
    ds_read_b128 v[64:67], v235 offset:8192
    s_waitcnt lgkmcnt(9)
    v_mfma_f32_32x32x16_bf16 v[240:255], v[36:39], v[68:71], v[240:255]
    ds_read_b64_tr_b16 v[36:37], v233 offset:34816
    ds_read_b64_tr_b16 v[38:39], v233 offset:38912
    ds_read_b128 v[68:71], v235 offset:9216
    s_waitcnt lgkmcnt(9)
    v_mfma_f32_32x32x16_bf16 v[240:255], v[40:43], v[72:75], v[240:255]
    ds_read_b64_tr_b16 v[40:41], v233 offset:40960
    ds_read_b64_tr_b16 v[42:43], v233 offset:45056
    ds_read_b128 v[72:75], v235 offset:10240
    s_waitcnt lgkmcnt(9)
    v_mfma_f32_32x32x16_bf16 v[240:255], v[44:47], v[76:79], v[240:255]
    ds_read_b64_tr_b16 v[44:45], v233 offset:43008
    ds_read_b64_tr_b16 v[46:47], v233 offset:47104
    ds_read_b128 v[76:79], v235 offset:11264
    s_waitcnt lgkmcnt(9)
    v_mfma_f32_32x32x16_bf16 v[240:255], v[32:35], v[64:67], v[240:255]
    ds_read_b64_tr_b16 v[32:33], v233 offset:49152
    ds_read_b64_tr_b16 v[34:35], v233 offset:53248
    ds_read_b128 v[64:67], v235 offset:12288
    s_waitcnt lgkmcnt(9)
    v_mfma_f32_32x32x16_bf16 v[240:255], v[36:39], v[68:71], v[240:255]
    ds_read_b64_tr_b16 v[36:37], v233 offset:51200
    ds_read_b64_tr_b16 v[38:39], v233 offset:55296
    ds_read_b128 v[68:71], v235 offset:13312
    s_waitcnt lgkmcnt(9)
    v_mfma_f32_32x32x16_bf16 v[240:255], v[40:43], v[72:75], v[240:255]
    ds_read_b64_tr_b16 v[40:41], v233 offset:57344
    ds_read_b64_tr_b16 v[42:43], v233 offset:61440
    ds_read_b128 v[72:75], v235 offset:14336
    s_waitcnt lgkmcnt(9)
    v_mfma_f32_32x32x16_bf16 v[240:255], v[44:47], v[76:79], v[240:255]
    ds_read_b64_tr_b16 v[44:45], v233 offset:59392
    ds_read_b64_tr_b16 v[46:47], v233 offset:63488
    ds_read_b128 v[76:79], v235 offset:15360
    s_waitcnt lgkmcnt(9)
    v_mfma_f32_32x32x16_bf16 v[240:255], v[32:35], v[64:67], v[240:255]
    ds_read_b64_tr_b16 v[32:33], v234 offset:0
    ds_read_b64_tr_b16 v[34:35], v234 offset:4096
    ds_read_b128 v[64:67], v235 offset:16384
    s_waitcnt lgkmcnt(9)
    v_mfma_f32_32x32x16_bf16 v[240:255], v[36:39], v[68:71], v[240:255]
    ds_read_b64_tr_b16 v[36:37], v234 offset:2048
    ds_read_b64_tr_b16 v[38:39], v234 offset:6144
    ds_read_b128 v[68:71], v235 offset:17408
    s_waitcnt lgkmcnt(9)
    v_mfma_f32_32x32x16_bf16 v[240:255], v[40:43], v[72:75], v[240:255]
    ds_read_b64_tr_b16 v[40:41], v234 offset:8192
    ds_read_b64_tr_b16 v[42:43], v234 offset:12288
    ds_read_b128 v[72:75], v235 offset:18432
    s_waitcnt lgkmcnt(9)
    v_mfma_f32_32x32x16_bf16 v[240:255], v[44:47], v[76:79], v[240:255]
    ds_read_b64_tr_b16 v[44:45], v234 offset:10240
    ds_read_b64_tr_b16 v[46:47], v234 offset:14336
    ds_read_b128 v[76:79], v235 offset:19456
    s_waitcnt lgkmcnt(9)
    v_mfma_f32_32x32x16_bf16 v[240:255], v[32:35], v[64:67], v[240:255]
    ds_read_b64_tr_b16 v[32:33], v234 offset:16384
    ds_read_b64_tr_b16 v[34:35], v234 offset:20480
    ds_read_b128 v[64:67], v235 offset:20480
    s_waitcnt lgkmcnt(9)
    v_mfma_f32_32x32x16_bf16 v[240:255], v[36:39], v[68:71], v[240:255]
    ds_read_b64_tr_b16 v[36:37], v234 offset:18432
    ds_read_b64_tr_b16 v[38:39], v234 offset:22528
    ds_read_b128 v[68:71], v235 offset:21504
    s_waitcnt lgkmcnt(9)
    v_mfma_f32_32x32x16_bf16 v[240:255], v[40:43], v[72:75], v[240:255]
    ds_read_b64_tr_b16 v[40:41], v234 offset:24576
    ds_read_b64_tr_b16 v[42:43], v234 offset:28672
    ds_read_b128 v[72:75], v235 offset:22528
    s_waitcnt lgkmcnt(9)
    v_mfma_f32_32x32x16_bf16 v[240:255], v[44:47], v[76:79], v[240:255]
    ds_read_b64_tr_b16 v[44:45], v234 offset:26624
    ds_read_b64_tr_b16 v[46:47], v234 offset:30720
    ds_read_b128 v[76:79], v235 offset:23552
    s_waitcnt lgkmcnt(9)
    v_mfma_f32_32x32x16_bf16 v[240:255], v[32:35], v[64:67], v[240:255]
    ds_read_b64_tr_b16 v[32:33], v234 offset:32768
    ds_read_b64_tr_b16 v[34:35], v234 offset:36864
    ds_read_b128 v[64:67], v235 offset:24576
    s_waitcnt lgkmcnt(9)
    v_mfma_f32_32x32x16_bf16 v[240:255], v[36:39], v[68:71], v[240:255]
    ds_read_b64_tr_b16 v[36:37], v234 offset:34816
    ds_read_b64_tr_b16 v[38:39], v234 offset:38912
    ds_read_b128 v[68:71], v235 offset:25600
    s_waitcnt lgkmcnt(9)
    v_mfma_f32_32x32x16_bf16 v[240:255], v[40:43], v[72:75], v[240:255]
    ds_read_b64_tr_b16 v[40:41], v234 offset:40960
    ds_read_b64_tr_b16 v[42:43], v234 offset:45056
    ds_read_b128 v[72:75], v235 offset:26624
    s_waitcnt lgkmcnt(9)
    v_mfma_f32_32x32x16_bf16 v[240:255], v[44:47], v[76:79], v[240:255]
    ds_read_b64_tr_b16 v[44:45], v234 offset:43008
    ds_read_b64_tr_b16 v[46:47], v234 offset:47104
    ds_read_b128 v[76:79], v235 offset:27648
    s_waitcnt lgkmcnt(9)
    v_mfma_f32_32x32x16_bf16 v[240:255], v[32:35], v[64:67], v[240:255]
    ds_read_b64_tr_b16 v[32:33], v234 offset:49152
    ds_read_b64_tr_b16 v[34:35], v234 offset:53248
    ds_read_b128 v[64:67], v235 offset:28672
    s_waitcnt lgkmcnt(9)
    v_mfma_f32_32x32x16_bf16 v[240:255], v[36:39], v[68:71], v[240:255]
    ds_read_b64_tr_b16 v[36:37], v234 offset:51200
    ds_read_b64_tr_b16 v[38:39], v234 offset:55296
    ds_read_b128 v[68:71], v235 offset:29696
    s_waitcnt lgkmcnt(9)
    v_mfma_f32_32x32x16_bf16 v[240:255], v[40:43], v[72:75], v[240:255]
    ds_read_b64_tr_b16 v[40:41], v234 offset:57344
    ds_read_b64_tr_b16 v[42:43], v234 offset:61440
    ds_read_b128 v[72:75], v235 offset:30720
    s_waitcnt lgkmcnt(9)
    v_mfma_f32_32x32x16_bf16 v[240:255], v[44:47], v[76:79], v[240:255]
    ds_read_b64_tr_b16 v[44:45], v234 offset:59392
    ds_read_b64_tr_b16 v[46:47], v234 offset:63488
    ds_read_b128 v[76:79], v235 offset:31744
    s_waitcnt lgkmcnt(9)
    v_mfma_f32_32x32x16_bf16 v[240:255], v[32:35], v[64:67], v[240:255]
    s_waitcnt lgkmcnt(6)
    v_mfma_f32_32x32x16_bf16 v[240:255], v[36:39], v[68:71], v[240:255]
    s_waitcnt lgkmcnt(3)
    v_mfma_f32_32x32x16_bf16 v[240:255], v[40:43], v[72:75], v[240:255]
    s_waitcnt lgkmcnt(0)
    v_mfma_f32_32x32x16_bf16 v[240:255], v[44:47], v[76:79], v[240:255]
    s_nop 11
    s_and_b32 s87, s50, 1
    s_lshl_b32 s87, s87, 17
    s_add_u32 s87, s87, s48
    s_bfe_u32 s49, s50, 0x10001
    v_and_b32 v240, -2, v240
    v_or_b32 v240, s49, v240
    v_and_b32 v242, -2, v242
    v_or_b32 v242, s49, v242
    v_and_b32 v244, -2, v244
    v_or_b32 v244, s49, v244
    v_and_b32 v246, -2, v246
    v_or_b32 v246, s49, v246
    v_and_b32 v248, -2, v248
    v_or_b32 v248, s49, v248
    v_and_b32 v250, -2, v250
    v_or_b32 v250, s49, v250
    v_and_b32 v252, -2, v252
    v_or_b32 v252, s49, v252
    v_and_b32 v254, -2, v254
    v_or_b32 v254, s49, v254
    s_lshl_b32 s88, s91, 11
    s_add_u32 s88, s88, s87
    s_add_u32 s94, s80, s88
    s_addc_u32 s95, s81, 0
    s_cmp_eq_u32 s59, 1
    s_cbranch_scc1 pf_193
    s_mov_b64 s[96:97], s[94:95]
    global_store_dwordx2 v237, v[240:241], s[96:97] sc1
    s_add_u32 s96, s96, 16384
    s_addc_u32 s97, s97, 0
    global_store_dwordx2 v237, v[242:243], s[96:97] sc1
    s_add_u32 s96, s96, 16384
    s_addc_u32 s97, s97, 0
    global_store_dwordx2 v237, v[244:245], s[96:97] sc1
    s_add_u32 s96, s96, 16384
    s_addc_u32 s97, s97, 0
    global_store_dwordx2 v237, v[246:247], s[96:97] sc1
    s_add_u32 s96, s96, 16384
    s_addc_u32 s97, s97, 0
    global_store_dwordx2 v237, v[248:249], s[96:97] sc1
    s_add_u32 s96, s96, 16384
    s_addc_u32 s97, s97, 0
    global_store_dwordx2 v237, v[250:251], s[96:97] sc1
    s_add_u32 s96, s96, 16384
    s_addc_u32 s97, s97, 0
    global_store_dwordx2 v237, v[252:253], s[96:97] sc1
    s_add_u32 s96, s96, 16384
    s_addc_u32 s97, s97, 0
    global_store_dwordx2 v237, v[254:255], s[96:97] sc1
    s_branch pj_194
pf_193:
    s_mov_b64 s[96:97], s[94:95]
    global_store_dwordx2 v237, v[240:241], s[96:97]
    s_add_u32 s96, s96, 16384
    s_addc_u32 s97, s97, 0
    global_store_dwordx2 v237, v[242:243], s[96:97]
    s_add_u32 s96, s96, 16384
    s_addc_u32 s97, s97, 0
    global_store_dwordx2 v237, v[244:245], s[96:97]
    s_add_u32 s96, s96, 16384
    s_addc_u32 s97, s97, 0
    global_store_dwordx2 v237, v[246:247], s[96:97]
    s_add_u32 s96, s96, 16384
    s_addc_u32 s97, s97, 0
    global_store_dwordx2 v237, v[248:249], s[96:97]
    s_add_u32 s96, s96, 16384
    s_addc_u32 s97, s97, 0
    global_store_dwordx2 v237, v[250:251], s[96:97]
    s_add_u32 s96, s96, 16384
    s_addc_u32 s97, s97, 0
    global_store_dwordx2 v237, v[252:253], s[96:97]
    s_add_u32 s96, s96, 16384
    s_addc_u32 s97, s97, 0
    global_store_dwordx2 v237, v[254:255], s[96:97]
pj_194:
    s_lshl_b32 s88, s91, 14
    s_add_u32 s88, s88, s87
    s_add_u32 s96, s80, s88
    s_addc_u32 s97, s81, 0
    s_add_u32 s94, s96, 8192
    s_addc_u32 s95, s97, 0
pl_195:
    global_load_dwordx2 v[32:33], v237, s[96:97] offset:0 sc1
    global_load_dwordx2 v[34:35], v237, s[96:97] offset:2048 sc1
    v_add_u32 v26, 4096, v237
    global_load_dwordx2 v[36:37], v26, s[96:97] sc1
    v_add_u32 v26, 6144, v237
    global_load_dwordx2 v[38:39], v26, s[96:97] sc1
    global_load_dwordx2 v[40:41], v237, s[94:95] offset:0 sc1
    global_load_dwordx2 v[42:43], v237, s[94:95] offset:2048 sc1
    v_add_u32 v26, 4096, v237
    global_load_dwordx2 v[44:45], v26, s[94:95] sc1
    v_add_u32 v26, 6144, v237
    global_load_dwordx2 v[46:47], v26, s[94:95] sc1
    s_waitcnt vmcnt(0)
    v_xor_b32 v20, v32, v34
    v_xor_b32 v21, v32, v36
    v_or_b32 v20, v20, v21
    v_xor_b32 v21, v32, v38
    v_or_b32 v20, v20, v21
    v_xor_b32 v21, v32, v40
    v_or_b32 v20, v20, v21
    v_xor_b32 v21, v32, v42
    v_or_b32 v20, v20, v21
    v_xor_b32 v21, v32, v44
    v_or_b32 v20, v20, v21
    v_xor_b32 v21, v32, v46
    v_or_b32 v20, v20, v21
    v_xor_b32 v21, s49, v32
    v_or_b32 v20, v20, v21
    v_and_b32 v20, 1, v20
    v_cmp_ne_u32 vcc, 0, v20
    s_cbranch_vccz po_196
    s_sub_u32 s86, s86, 1
    s_cbranch_scc1 po_196_x
    s_sleep 1
    s_branch pl_195
po_196_x:
    s_mov_b32 s86, 0
po_196:
    v_add_f32 v32, v32, v34
    v_add_f32 v33, v33, v35
    v_add_f32 v32, v32, v36
    v_add_f32 v33, v33, v37
    v_add_f32 v32, v32, v38
    v_add_f32 v33, v33, v39
    v_add_f32 v32, v32, v40
    v_add_f32 v33, v33, v41
    v_add_f32 v32, v32, v42
    v_add_f32 v33, v33, v43
    v_add_f32 v32, v32, v44
    v_add_f32 v33, v33, v45
    v_add_f32 v32, v32, v46
    v_add_f32 v33, v33, v47
    v_cvt_pk_bf16_f32 v192, v32, v33
    v_lshlrev_b32 v32, 16, v192
    v_and_b32 v33, 0xffff0000, v192
    v_lshlrev_b32 v192, 16, v176
    v_and_b32 v193, 0xffff0000, v176
    v_mul_f32 v32, v32, v192
    v_mul_f32 v33, v33, v193
    v_cvt_pk_bf16_f32 v194, v32, v33
    v_lshlrev_b32 v32, 16, v194
    v_and_b32 v33, 0xffff0000, v194
    v_lshlrev_b32 v192, 16, v177
    v_and_b32 v193, 0xffff0000, v177
    v_add_f32 v32, v32, v192
    v_add_f32 v33, v33, v193
    v_cvt_pk_bf16_f32 v192, v32, v33
    global_store_dword v236, v192, s[56:57] nt
    s_barrier
    s_add_u32 s50, s50, 1
    s_add_u32 s90, s90, 7
    s_branch tl_171
tdone_172:
mega_done:
    s_endpgm

.section .rodata,"a"
.p2align 6
.amdhsa_kernel recurrent_scan__memory_aug_recurrent_mem_tr__swiglu_ffn__prompt_kernel
  .amdhsa_next_free_vgpr 512
  .amdhsa_next_free_sgpr 102
  .amdhsa_accum_offset 256
  .amdhsa_group_segment_fixed_size 0
  .amdhsa_kernarg_size 112
  .amdhsa_user_sgpr_count 2
  .amdhsa_user_sgpr_kernarg_segment_ptr 1
  .amdhsa_system_sgpr_workgroup_id_x 1
.end_amdhsa_kernel
```
